```python
import torch

def _softmax(x, axis=-1):
    return torch.softmax(x, dim=axis)

def _gelu(x):
    return torch.nn.functional.gelu(x, approximate='tanh')

def _silu(x):
    return torch.nn.functional.silu(x)

def _sigmoid(x):
    return torch.sigmoid(x)

def _layernorm(x, axis=-1, eps=1e-05):
    m = x.mean(dim=axis, keepdim=True)
    v = x.var(dim=axis, keepdim=True, unbiased=False)
    return (x - m) / torch.sqrt(v + eps)

def _scatter_add(tgt, idx, src, axis=0):
    return tgt.clone().index_add_(axis, idx, src)

def _segment_sum(src, seg, n):
    out = torch.zeros((n,) + src.shape[1:], dtype=src.dtype)
    return out.index_add_(0, seg, src)

def _pad(x, pw):
    flat = tuple((v for pair in reversed(pw) for v in pair))
    return torch.nn.functional.pad(x, flat)
kernel_name = 'concat_heads__memory_aug_recurrent_mem_tr__sliding_local_dilated__prompt'

def setup_inputs():

    _w = lambda a: (lambda t: t.to(torch.bfloat16) if t.is_floating_point() else t)(torch.as_tensor(a))

    def _A_setup():
        B, S, Dm = (1, 2048, 640)
        H, Dh = (32, 192)
        M, seg = (8, 32)
        seg = min(seg, S)
        S = S // seg * seg
        return {'x': _w((lambda *s: torch.randn(*s, dtype=torch.bfloat16) * 0.05)(B, S, Dm)), 'mem0': _w((lambda *s: torch.randn(*s, dtype=torch.bfloat16) * 1.6)(B, M, Dm)), 'Wq': _w((lambda *s: torch.randn(*s, dtype=torch.bfloat16) * 0.8)(Dm, H, Dh) * Dm ** (-0.5)), 'Wk': _w((lambda *s: torch.randn(*s, dtype=torch.bfloat16) * 0.8)(Dm, H, Dh) * Dm ** (-0.5)), 'Wv': _w((lambda *s: torch.randn(*s, dtype=torch.bfloat16) * 1.6)(Dm, H, Dh) * Dm ** (-0.5)), 'Wo': _w((lambda *s: torch.randn(*s, dtype=torch.bfloat16) * 1.6)(H, Dh, Dm) * (H * Dh) ** (-0.5)), 'seg_len': seg}
    _A_in = _A_setup()

    def _B_setup():
        B, S, D = (1, 2048, 640)
        return {'x': _w((lambda *s: torch.randn(*s, dtype=torch.bfloat16) * 0.2)(B, S, D)), 'wqkv': _w((lambda *s: torch.randn(*s, dtype=torch.bfloat16) * 0.2)(D, 3 * D)), 'wo': _w((lambda *s: torch.randn(*s, dtype=torch.bfloat16) * 0.05)(D, D))}
    _B_in = _B_setup()
    return {'A_x': _A_in['x'], 'A_mem0': _A_in['mem0'], 'A_Wq': _A_in['Wq'], 'A_Wk': _A_in['Wk'], 'A_Wv': _A_in['Wv'], 'A_Wo': _A_in['Wo'], 'A_seg_len': _A_in['seg_len'], 'B_x': _B_in['x'], 'B_wqkv': _B_in['wqkv'], 'B_wo': _B_in['wo']}

def reference(A_x, A_mem0, A_Wq, A_Wk, A_Wv, A_Wo, A_seg_len, B_x, B_wqkv, B_wo):

    def _A_ref(x, mem0, Wq, Wk, Wv, Wo, seg_len):
        B, S, Dm = x.shape
        H, Dh = (Wq.shape[1], Wq.shape[2])
        M = mem0.shape[1]
        scale = Dh ** (-0.5)
        n_seg = S // seg_len
        L = M + seg_len
        idx = torch.arange(L)
        mask = (idx[:, None] < M) | (idx[:, None] >= idx[None, :])
        mem = mem0
        outs = []
        for s in range(n_seg):
            xs = x[:, s * seg_len:(s + 1) * seg_len, :].clone()
            h = torch.concatenate([mem, xs], axis=1)
            q = torch.einsum('btd,dhe->bhte', h, Wq)
            k = torch.einsum('btd,dhe->bhte', h, Wk)
            v = torch.einsum('btd,dhe->bhte', h, Wv)
            scores = torch.einsum('bhqe,bhke->bhqk', q, k) * scale
            scores = torch.where(mask[None, None], scores, -1000000000.0)
            p = _softmax(scores, axis=-1)
            o = torch.einsum('bhqk,bhke->bhqe', p, v)
            o = torch.einsum('bhte,hed->btd', o, Wo)
            mem = o[:, :M, :].clone()
            outs.append(o[:, M:, :])
        return torch.concatenate(outs, axis=1)

    def _B_ref(x, wqkv, wo):
        B, S, D = x.shape
        H = 32
        Dh = D // H
        W, dil = (8, 2)
        qkv = (lambda x, *d: x.permute(*d))((x @ wqkv).reshape(B, S, 3, H, Dh), 2, 0, 3, 1, 4)
        q, k, v = (qkv[0], qkv[1], qkv[2])
        scale = Dh ** (-0.5)
        pos = torch.arange(S)
        off = torch.arange(W) * dil
        idx = pos[:, None] - off[None, :]
        mask = idx >= 0
        idx_c = torch.where(mask, idx, 0).reshape(-1)
        kg = k[:, :, idx_c, :].reshape(B, H, S, W, Dh)
        vg = v[:, :, idx_c, :].reshape(B, H, S, W, Dh)
        logits = torch.einsum('bhsd,bhswd->bhsw', q, kg) * scale
        logits = torch.where(mask[None, None, :, :], logits, -1000000000.0)
        attn = _softmax(logits, axis=-1)
        o = torch.einsum('bhsw,bhswd->bhsd', attn, vg)
        return (lambda x, *d: x.permute(*d))(o, 0, 2, 1, 3).reshape(B, S, D) @ wo
    a = _A_ref(A_x, A_mem0, A_Wq, A_Wk, A_Wv, A_Wo, A_seg_len)
    b = _B_ref(B_x, B_wqkv, B_wo)
    return torch.concatenate([a, b], axis=-1)
```

```asm
; @launch grid=(256,1,1) block=(256,1,1) lds=163840
.amdgcn_target "amdgcn-amd-amdhsa--gfx950"
.text
.globl concat_heads__memory_aug_recurrent_mem_tr__sliding_local_dilated__prompt_kernel
.p2align 8
.type concat_heads__memory_aug_recurrent_mem_tr__sliding_local_dilated__prompt_kernel,@function
concat_heads__memory_aug_recurrent_mem_tr__sliding_local_dilated__prompt_kernel:
    s_cmp_ge_u32 s2, 256
    s_cbranch_scc1 L_exit
    s_load_dword s20, s[0:1], 0
    s_load_dwordx2 s[4:5], s[0:1], 96
    s_load_dwordx2 s[8:9], s[0:1], 88
    s_mov_b32 s6, 268435456
    s_mov_b32 s7, 0x20000
    v_lshrrev_b32 v1, 6, v0
    v_and_b32 v0, 63, v0
    v_readfirstlane_b32 s13, v1
    s_getpc_b64 s[18:19]
L_pc:
    s_bfe_u32 s17, s2, 0x50003
    s_lshl_b32 s17, s17, 2
    s_add_u32 s17, s17, s13
    s_mul_i32 s17, s17, 640
    v_lshl_add_u32 v6, v0, 4, s17
    v_min_u32 v6, L_last-L_pc-16, v6
    v_mov_b32 v7, s19
    v_add_co_u32 v6, vcc, s18, v6
    s_nop 1
    v_addc_co_u32 v7, vcc, 0, v7, vcc
    s_mov_b64 exec, -1
    global_load_dwordx4 a[252:255], v[6:7], off
    s_mov_b64 exec, -1
    s_getreg_b32 s16, hwreg(HW_REG_XCC_ID)
    s_and_b32 s16, s16, 15
    s_mov_b32 s12, 300000
    s_mov_b32 s11, 0
    s_getreg_b32 s17, hwreg(HW_REG_HW_ID)
    s_bfe_u32 s18, s17, 0x2000d
    s_bfe_u32 s17, s17, 0x40008
    s_mov_b32 s15, 0
    s_lshl_b32 s10, s16, 5
    s_cmp_ge_u32 s16, 8
    s_waitcnt lgkmcnt(0)
    s_cbranch_scc1 L_over
    s_cmp_ge_u32 s17, 8
    s_cbranch_scc1 L_cu8
    s_sub_u32 s17, s17, 1
    s_and_b32 s17, s17, 7
    s_lshl_b32 s17, s17, 2
    s_add_u32 s17, s17, s18
L_slot:
    s_add_u32 s10, s10, s17
    s_or_b32 s84, s15, s13
    s_cbranch_scc1 Lan_1
    s_lshl_b32 s84, 1, s10
    s_and_b32 s85, s10, 0xe0
    v_mov_b32 v2, s84
    v_mov_b32 v3, 0x100
    v_mov_b32 v4, s85
    s_mov_b64 exec, 1
    global_atomic_add_x2 v4, v[2:3], s[8:9]
    s_mov_b64 exec, -1
Lan_1:
L_dispatch:
    s_mul_i32 s14, s15, 8388608
    s_add_u32 s14, s14, 117440512
    s_sub_u32 s17, 0, s4
    s_and_b32 s17, s17, 0x1fffff
    s_add_u32 s14, s14, s17
    s_and_b32 s17, s10, 31
    s_cmp_ge_u32 s10, 128
    s_cbranch_scc1 L_side
    s_cmp_lt_u32 s17, 24
    s_cbranch_scc1 Lc_start
    s_branch L4_start
L_side:
    s_cmp_lt_u32 s17, 18
    s_cbranch_scc1 L1_start
    s_cmp_lt_u32 s17, 28
    s_cbranch_scc1 L5_start
    s_branch Lb_start
L_cu8:
    s_lshl_b32 s19, 0x11111111, s18
    v_mov_b32 v1, s10
    v_mov_b32 v5, 163836
    s_cmp_eq_u32 s13, 0
    s_cbranch_scc0 L_c8b
    s_mov_b32 s20, 40
L_c8a:
    s_sleep 24
    global_load_dword v2, v1, s[8:9] sc1
    s_waitcnt vmcnt(0)
    v_readfirstlane_b32 s21, v2
    s_nop 0
    s_andn2_b32 s21, s19, s21
    s_bcnt1_i32_b32 s22, s21
    s_cmp_eq_u32 s22, 1
    s_cbranch_scc1 L_c8w
    s_sub_u32 s20, s20, 1
    s_cbranch_scc0 L_c8a
    s_mov_b32 s21, 1
L_c8w:
    s_ff1_i32_b32 s21, s21
    v_mov_b32 v2, s21
    ds_write_b32 v5, v2
    s_waitcnt lgkmcnt(0)
L_c8b:
    s_barrier
    ds_read_b32 v2, v5
    s_waitcnt lgkmcnt(0)
    v_readfirstlane_b32 s17, v2
    s_barrier
    s_branch L_slot
L_over:
    s_cmp_eq_u32 s13, 0
    s_cbranch_scc0 L_generic
    v_mov_b32 v2, 12
    v_mov_b32 v3, 1
    s_mov_b64 exec, 1
    global_atomic_add v2, v3, s[8:9]
    s_mov_b64 exec, -1
    s_branch L_generic
L_again:
    s_cmp_eq_u32 s84, 32
    s_cbranch_scc0 L_generic
    s_waitcnt vmcnt(0) lgkmcnt(0)
    v_mov_b32 v1, 12
    global_load_dword v2, v1, s[8:9] sc1
    s_waitcnt vmcnt(0)
    v_cmp_eq_u32 vcc, 0, v2
    s_cbranch_vccz L_generic
    s_barrier
    s_and_b32 s10, s10, 0xe0
    v_mov_b32 v5, 163836
    s_cmp_eq_u32 s13, 0
    s_cbranch_scc0 L_t1
    s_add_u32 s17, s10, 8
    v_mov_b32 v1, s17
    v_mov_b32 v2, 1
    s_mov_b64 exec, 1
    global_atomic_add v3, v1, v2, s[8:9] sc0
    s_waitcnt vmcnt(0)
    ds_write_b32 v5, v3
    s_waitcnt lgkmcnt(0)
    s_mov_b64 exec, -1
L_t1:
    s_barrier
    ds_read_b32 v3, v5
    s_waitcnt lgkmcnt(0)
    v_readfirstlane_b32 s17, v3
    s_barrier
    s_and_b32 s17, s17, 31
    s_add_u32 s10, s10, s17
    s_mov_b32 s15, 2
    s_branch L_lane
L_generic:
    s_waitcnt vmcnt(0) lgkmcnt(0)
    s_barrier
    s_mov_b32 s11, 1
    s_mov_b32 s15, 1
    s_mov_b32 s10, s2
L_lane:
    v_mbcnt_lo_u32_b32 v0, -1, 0
    v_mbcnt_hi_u32_b32 v0, -1, v0
    s_branch L_dispatch
L_abort:
    v_mov_b32 v0, 16
    v_mov_b32 v1, 1
    s_mov_b64 exec, 1
    global_atomic_add v0, v1, s[8:9]
    s_mov_b64 exec, -1
    v_mov_b32 v1, s10
    global_store_dword v0, v1, s[8:9] offset:4
L_exit:
    s_endpgm
Lc_start:
    v_mov_b32 v40, v0
    s_lshr_b32 s38, s10, 5
    s_and_b32 s39, s10, 31
    s_mul_i32 s41, s38, 24
    s_add_u32 s47, s41, s39
    s_lshr_b32 s45, s13, 1
    s_and_b32 s46, s13, 1
    s_load_dwordx2 s[16:17], s[0:1], 16
    s_mov_b32 s18, 7864320
    s_mov_b32 s19, 0x20000
    s_load_dwordx2 s[20:21], s[0:1], 24
    s_mov_b32 s22, 7864320
    s_mov_b32 s23, 0x20000
    s_load_dwordx2 s[24:25], s[0:1], 32
    s_mov_b32 s26, 7864320
    s_mov_b32 s27, 0x20000
    s_load_dwordx2 s[28:29], s[0:1], 40
    s_mov_b32 s30, 7864320
    s_mov_b32 s31, 0x20000
    v_lshrrev_b32 v30, 3, v40
    v_and_b32 v31, 7, v40
    v_xor_b32 v31, v31, v30
    v_mul_u32_u24 v32, 12288, v30
    v_lshl_add_u32 v50, v31, 4, v32
    v_lshrrev_b32 v30, 2, v40
    v_and_b32 v31, 3, v40
    v_mul_u32_u24 v32, 1280, v30
    v_lshl_add_u32 v51, v31, 4, v32
    s_mul_i32 s41, s45, 320
    s_lshl_b32 s42, s46, 5
    s_add_u32 s41, s41, s42
    s_mul_i32 s41, s41, 12288
    s_lshl_b32 s43, s47, 7
    s_add_u32 s48, s41, s43
    s_cmp_ge_u32 s39, 20
    s_cselect_b32 s43, 20, 0
    s_sub_u32 s43, s39, s43
    s_lshl_b32 s54, s43, 2
    s_add_u32 s54, s54, s13
    s_mul_i32 s41, s38, 1966080
    s_lshl_b32 s43, s43, 6
    s_add_u32 s49, s41, s43
    s_mul_i32 s41, s39, 21846
    s_lshr_b32 s41, s41, 16
    s_mul_i32 s41, s41, 0
    s_add_u32 s41, s41, s13
    s_add_u32 s43, s41, 0
    s_cmp_ge_u32 s43, 24
    s_cselect_b32 s44, 24, 0
    s_sub_u32 s43, s43, s44
    s_lshl_b32 s94, s43, 10
    s_add_u32 s43, s41, 4
    s_cmp_ge_u32 s43, 24
    s_cselect_b32 s44, 24, 0
    s_sub_u32 s43, s43, s44
    s_lshl_b32 s95, s43, 10
    s_add_u32 s43, s41, 8
    s_cmp_ge_u32 s43, 24
    s_cselect_b32 s44, 24, 0
    s_sub_u32 s43, s43, s44
    s_lshl_b32 s96, s43, 10
    s_add_u32 s43, s41, 12
    s_cmp_ge_u32 s43, 24
    s_cselect_b32 s44, 24, 0
    s_sub_u32 s43, s43, s44
    s_lshl_b32 s97, s43, 10
    s_add_u32 s43, s41, 16
    s_cmp_ge_u32 s43, 24
    s_cselect_b32 s44, 24, 0
    s_sub_u32 s43, s43, s44
    s_lshl_b32 s98, s43, 10
    s_add_u32 s43, s41, 20
    s_cmp_ge_u32 s43, 24
    s_cselect_b32 s44, 24, 0
    s_sub_u32 s43, s43, s44
    s_lshl_b32 s99, s43, 10
    s_mul_i32 s41, s45, 73728
    s_lshl_b32 s42, s46, 12
    s_add_u32 s50, s41, s42
    v_and_b32 v30, 15, v40
    v_bfe_u32 v31, v40, 4, 1
    v_bfe_u32 v32, v40, 5, 1
    v_bfe_u32 v33, v40, 3, 1
    v_and_b32 v34, 7, v40
    v_lshrrev_b32 v35, 4, v40
    s_waitcnt lgkmcnt(0)
    s_add_u32 m0, s50, 0
    s_add_u32 s41, s48, 0
    buffer_load_dwordx4 v50, s[16:19], s41 offen  lds
    s_add_u32 m0, s50, 1024
    s_add_u32 s41, s48, 98304
    buffer_load_dwordx4 v50, s[16:19], s41 offen  lds
    s_add_u32 m0, s50, 2048
    s_add_u32 s41, s48, 196608
    buffer_load_dwordx4 v50, s[16:19], s41 offen  lds
    s_add_u32 m0, s50, 3072
    s_add_u32 s41, s48, 294912
    buffer_load_dwordx4 v50, s[16:19], s41 offen  lds
    s_add_u32 m0, s50, 8192
    s_add_u32 s41, s48, 0
    buffer_load_dwordx4 v50, s[20:23], s41 offen  lds
    s_add_u32 m0, s50, 9216
    s_add_u32 s41, s48, 98304
    buffer_load_dwordx4 v50, s[20:23], s41 offen  lds
    s_add_u32 m0, s50, 10240
    s_add_u32 s41, s48, 196608
    buffer_load_dwordx4 v50, s[20:23], s41 offen  lds
    s_add_u32 m0, s50, 11264
    s_add_u32 s41, s48, 294912
    buffer_load_dwordx4 v50, s[20:23], s41 offen  lds
    s_add_u32 m0, s50, 16384
    s_add_u32 s41, s48, 0
    buffer_load_dwordx4 v50, s[24:27], s41 offen  lds
    s_add_u32 m0, s50, 17408
    s_add_u32 s41, s48, 98304
    buffer_load_dwordx4 v50, s[24:27], s41 offen  lds
    s_add_u32 m0, s50, 18432
    s_add_u32 s41, s48, 196608
    buffer_load_dwordx4 v50, s[24:27], s41 offen  lds
    s_add_u32 m0, s50, 19456
    s_add_u32 s41, s48, 294912
    buffer_load_dwordx4 v50, s[24:27], s41 offen  lds
    s_add_u32 m0, s50, 24576
    s_add_u32 s41, s48, 786432
    buffer_load_dwordx4 v50, s[16:19], s41 offen  lds
    s_add_u32 m0, s50, 25600
    s_add_u32 s41, s48, 884736
    buffer_load_dwordx4 v50, s[16:19], s41 offen  lds
    s_add_u32 m0, s50, 26624
    s_add_u32 s41, s48, 983040
    buffer_load_dwordx4 v50, s[16:19], s41 offen  lds
    s_add_u32 m0, s50, 27648
    s_add_u32 s41, s48, 1081344
    buffer_load_dwordx4 v50, s[16:19], s41 offen  lds
    s_add_u32 m0, s50, 32768
    s_add_u32 s41, s48, 786432
    buffer_load_dwordx4 v50, s[20:23], s41 offen  lds
    s_add_u32 m0, s50, 33792
    s_add_u32 s41, s48, 884736
    buffer_load_dwordx4 v50, s[20:23], s41 offen  lds
    s_add_u32 m0, s50, 34816
    s_add_u32 s41, s48, 983040
    buffer_load_dwordx4 v50, s[20:23], s41 offen  lds
    s_add_u32 m0, s50, 35840
    s_add_u32 s41, s48, 1081344
    buffer_load_dwordx4 v50, s[20:23], s41 offen  lds
    s_add_u32 m0, s50, 40960
    s_add_u32 s41, s48, 786432
    buffer_load_dwordx4 v50, s[24:27], s41 offen  lds
    s_add_u32 m0, s50, 41984
    s_add_u32 s41, s48, 884736
    buffer_load_dwordx4 v50, s[24:27], s41 offen  lds
    s_add_u32 m0, s50, 43008
    s_add_u32 s41, s48, 983040
    buffer_load_dwordx4 v50, s[24:27], s41 offen  lds
    s_add_u32 m0, s50, 44032
    s_add_u32 s41, s48, 1081344
    buffer_load_dwordx4 v50, s[24:27], s41 offen  lds
    s_add_u32 m0, s50, 49152
    s_add_u32 s41, s48, 1572864
    buffer_load_dwordx4 v50, s[16:19], s41 offen  lds
    s_add_u32 m0, s50, 50176
    s_add_u32 s41, s48, 1671168
    buffer_load_dwordx4 v50, s[16:19], s41 offen  lds
    s_add_u32 m0, s50, 51200
    s_add_u32 s41, s48, 1769472
    buffer_load_dwordx4 v50, s[16:19], s41 offen  lds
    s_add_u32 m0, s50, 52224
    s_add_u32 s41, s48, 1867776
    buffer_load_dwordx4 v50, s[16:19], s41 offen  lds
    s_add_u32 m0, s50, 57344
    s_add_u32 s41, s48, 1572864
    buffer_load_dwordx4 v50, s[20:23], s41 offen  lds
    s_add_u32 m0, s50, 58368
    s_add_u32 s41, s48, 1671168
    buffer_load_dwordx4 v50, s[20:23], s41 offen  lds
    s_add_u32 m0, s50, 59392
    s_add_u32 s41, s48, 1769472
    buffer_load_dwordx4 v50, s[20:23], s41 offen  lds
    s_add_u32 m0, s50, 60416
    s_add_u32 s41, s48, 1867776
    buffer_load_dwordx4 v50, s[20:23], s41 offen  lds
    v_bfe_u32 v37, v40, 2, 1
    v_and_b32 v38, 3, v40
    s_mul_i32 s41, s45, 73728
    v_lshl_add_u32 v44, v31, 2, v37
    v_add_u32 v44, 0, v44
    v_lshrrev_b32 v45, 1, v38
    s_lshl_b32 s42, s46, 2
    s_add_u32 s42, s42, 0
    v_add_u32 v45, s42, v45
    v_xor_b32 v45, v45, v44
    v_lshl_add_u32 v44, v32, 4, v44
    v_lshl_add_u32 v44, v33, 3, v44
    v_lshl_add_u32 v44, v44, 7, s41
    v_lshl_add_u32 v44, v45, 4, v44
    v_and_b32 v45, 1, v38
    v_lshl_add_u32 v52, v45, 3, v44
    v_lshl_add_u32 v44, v31, 2, v37
    v_add_u32 v44, 0, v44
    v_lshrrev_b32 v45, 1, v38
    s_lshl_b32 s42, s46, 2
    s_add_u32 s42, s42, 2
    v_add_u32 v45, s42, v45
    v_xor_b32 v45, v45, v44
    v_lshl_add_u32 v44, v32, 4, v44
    v_lshl_add_u32 v44, v33, 3, v44
    v_lshl_add_u32 v44, v44, 7, s41
    v_lshl_add_u32 v44, v45, 4, v44
    v_and_b32 v45, 1, v38
    v_lshl_add_u32 v53, v45, 3, v44
    v_lshl_add_u32 v44, v31, 2, v37
    v_add_u32 v44, 2, v44
    v_lshrrev_b32 v45, 1, v38
    s_lshl_b32 s42, s46, 2
    s_add_u32 s42, s42, 0
    v_add_u32 v45, s42, v45
    v_xor_b32 v45, v45, v44
    v_lshl_add_u32 v44, v32, 4, v44
    v_lshl_add_u32 v44, v33, 3, v44
    v_lshl_add_u32 v44, v44, 7, s41
    v_lshl_add_u32 v44, v45, 4, v44
    v_and_b32 v45, 1, v38
    v_lshl_add_u32 v54, v45, 3, v44
    v_lshl_add_u32 v44, v31, 2, v37
    v_add_u32 v44, 2, v44
    v_lshrrev_b32 v45, 1, v38
    s_lshl_b32 s42, s46, 2
    s_add_u32 s42, s42, 2
    v_add_u32 v45, s42, v45
    v_xor_b32 v45, v45, v44
    v_lshl_add_u32 v44, v32, 4, v44
    v_lshl_add_u32 v44, v33, 3, v44
    v_lshl_add_u32 v44, v44, 7, s41
    v_lshl_add_u32 v44, v45, 4, v44
    v_and_b32 v45, 1, v38
    v_lshl_add_u32 v55, v45, 3, v44
    v_lshl_add_u32 v44, v33, 5, v37
    v_lshl_add_u32 v44, v31, 4, v44
    v_lshl_add_u32 v44, v32, 2, v44
    v_lshl_add_u32 v44, v44, 6, s50
    v_lshl_add_u32 v56, v38, 3, v44
    v_add_u32 v57, 57344, v52
    v_add_u32 v58, 57344, v53
    v_add_u32 v59, 57344, v54
    v_add_u32 v60, 57344, v55
    v_add_u32 v61, 57344, v56
    v_lshlrev_b32 v0, 4, v40
    v_lshlrev_b32 v1, 2, v40
    v_mul_u32_u24 v36, 0xAAAA, v33
    v_add_u32 v2, 0x4444, v36
    s_mul_i32 s41, s45, 1152
    s_lshl_b32 s42, s46, 8
    s_add_u32 s41, s41, s42
    v_mul_u32_u24 v36, 2304, v32
    v_mul_u32_u24 v37, 576, v31
    v_add3_u32 v36, v36, v37, s41
    v_lshl_add_u32 v3, v30, 3, v36
    v_mul_u32_u24 v36, 576, v38
    v_lshrrev_b32 v37, 2, v40
    v_lshl_add_u32 v4, v37, 3, v36
    s_lshl_b32 s41, s46, 10
    s_lshl_b32 s42, s45, 9
    s_add_u32 s41, s41, s42
    s_add_u32 s41, s41, 4608
    v_lshl_add_u32 v36, v31, 8, s41
    v_lshl_add_u32 v36, v30, 4, v36
    v_lshl_add_u32 v5, v32, 3, v36
    v_lshl_add_u32 v6, v33, 30, v0
    s_mul_i32 s41, s13, 1152
    s_add_u32 s41, s41, 24576
    v_lshl_add_u32 v36, v32, 9, s41
    v_lshl_add_u32 v36, v30, 4, v36
    v_lshl_add_u32 v11, v31, 3, v36
    s_lshl_b32 s41, s13, 7
    s_add_u32 s41, s41, 24576
    v_mul_u32_u24 v36, 1152, v35
    v_lshl_add_u32 v36, v34, 4, v36
    v_add_u32 v26, s41, v36
    s_mov_b32 s36, 0x00ff00ff
    s_mov_b32 s37, 0x00ff00ff
    s_lshl_b32 s41, s38, 7
    v_lshlrev_b32 v36, 4, v34
    v_lshl_add_u32 v36, v31, 3, v36
    v_lshl_add_u32 v37, v32, 1, v33
    v_mul_u32_u24 v37, 81920, v37
    v_add3_u32 v7, v37, v36, s41
    v_or_b32 v37, v32, v33
    v_lshl_add_u32 v9, v37, 30, v36
    v_lshlrev_b32 v36, 7, v35
    v_lshl_add_u32 v36, v34, 4, v36
    v_cmp_eq_u32 vcc, s38, v35
    s_nop 1
    v_cndmask_b32 v37, 0, 1, vcc
    v_or_b32 v37, v37, v33
    v_lshl_add_u32 v8, v37, 30, v36
    v_xor_b32 v37, s46, v33
    v_lshl_add_u32 v27, v37, 30, v0
    v_and_b32 v36, 1, v40
    v_lshlrev_b32 v36, 4, v36
    v_mov_b32 v37, 0x3f80
    v_lshlrev_b32 v37, v36, v37
    v_lshrrev_b32 v36, 1, v34
    v_cmp_eq_u32 vcc, 0, v36
    s_nop 1
    v_cndmask_b32 v12, 0, v37, vcc
    v_cmp_eq_u32 vcc, 1, v36
    s_nop 1
    v_cndmask_b32 v13, 0, v37, vcc
    v_cmp_eq_u32 vcc, 2, v36
    s_nop 1
    v_cndmask_b32 v14, 0, v37, vcc
    v_cmp_eq_u32 vcc, 3, v36
    s_nop 1
    v_cndmask_b32 v15, 0, v37, vcc
    v_mov_b32 v36, 0x3f803f80
    v_mov_b32 v37, 0x3f003f00
    v_accvgpr_write_b32 a240, v36
    v_accvgpr_write_b32 a241, v36
    v_accvgpr_write_b32 a242, v36
    v_accvgpr_write_b32 a243, v36
    v_accvgpr_write_b32 a244, v37
    v_accvgpr_write_b32 a245, v37
    s_mov_b32 s53, 0x7f817f81
    v_mov_b32 v16, s53
    v_mov_b32 v17, s53
    v_mov_b32 v18, s53
    v_mov_b32 v19, s53
    s_mov_b32 s34, 0x3dd53b95
    s_mov_b32 s35, 0x3dd53b95
    s_mul_i32 s41, s38, 655360
    s_add_u32 s41, s41, s14
    s_add_u32 s41, s41, 2097152
    s_mul_i32 s42, s38, 98304
    s_sub_u32 s52, s41, s42
    s_lshl_b32 s42, s39, 10
    s_add_u32 s55, s41, s42
    s_mov_b32 s56, s41
    s_lshr_b32 s41, s54, 4
    s_lshl_b32 s41, s41, 14
    s_and_b32 s42, s54, 15
    s_lshl_b32 s42, s42, 9
    s_add_u32 s41, s41, s42
    s_add_u32 s57, s41, s14
    s_lshl_b32 s41, s38, 16
    s_add_u32 s41, s41, s14
    s_add_u32 s41, s41, 5242880
    s_mul_i32 s42, s45, 5120
    s_add_u32 s58, s41, s42
    s_lshl_b32 s42, s54, 7
    s_add_u32 s59, s41, s42
    s_cmp_ge_u32 s39, 20
    s_cselect_b32 s41, 1073741824, 0
    v_bfe_u32 v36, v40, 3, 2
    v_lshlrev_b32 v36, 9, v36
    v_lshl_add_u32 v36, v34, 4, v36
    s_lshl_b32 s42, s13, 1
    v_add_u32 v37, s42, v32
    v_mul_u32_u24 v37, 81920, v37
    s_lshl_b32 s42, s38, 7
    v_add3_u32 v36, v36, v37, s42
    v_subrev_u32 v39, 163840, v36
    v_lshl_add_u32 v37, v32, 30, v0
    s_cmp_eq_u32 s13, 2
    s_cselect_b64 vcc, -1, 0
    v_cndmask_b32 v36, v36, v37, vcc
    v_or_b32 v136, s41, v36
    v_or_b32 v7, s41, v7
    v_or_b32 v9, s41, v9
    s_add_u32 s44, s52, 524288
    s_lshl_b32 s41, s47, 12
    s_add_u32 s60, s41, s44
    s_mul_i32 s41, s47, 21846
    s_lshr_b32 s41, s41, 16
    s_lshl_b32 s42, s41, 7
    s_add_u32 s42, s42, s14
    s_add_u32 s66, s42, 5586944
    s_mul_i32 s41, s41, 3
    s_sub_u32 s42, s47, s41
    s_mul_i32 s43, s46, 3
    s_add_u32 s43, s43, s42
    s_lshl_b32 s43, s43, 7
    s_sub_u32 s74, s66, s14
    s_sub_u32 s74, s74, 5586944
    s_lshl_b32 s74, s74, 4
    s_add_u32 s74, s74, s43
    s_add_u32 s74, s74, s14
    s_add_u32 s74, s74, 5505408
    s_cmp_eq_u32 s42, 0
    s_cselect_b32 s43, 1, 0
    s_add_u32 s43, s43, s41
    s_lshl_b32 s43, s43, 12
    s_add_u32 s61, s43, s44
    s_cmp_eq_u32 s42, 2
    s_cselect_b32 s43, 1, 2
    s_add_u32 s43, s43, s41
    s_lshl_b32 s43, s43, 12
    s_add_u32 s62, s43, s44
    s_mul_i32 s41, s47, 815104
    s_mul_i32 s42, s46, 270336
    s_add_u32 s41, s41, s42
    s_add_u32 s63, s41, 270336
    s_lshl_b32 s41, s47, 12
    s_lshl_b32 s42, s13, 10
    s_add_u32 s41, s41, s42
    s_add_u32 s41, s41, s52
    s_add_u32 s64, s41, 131072
    s_lshl_b32 s41, s46, 12
    s_add_u32 s65, s41, 8192
    s_mov_b32 s77, 0
    s_lshl_b32 s41, s38, 11
    s_add_u32 s41, s41, s14
    s_add_u32 s73, s41, 5595136
    s_and_b32 s41, s39, 0
    s_lshl_b32 s41, s41, 5
    s_lshr_b32 s42, s39, 0
    s_add_u32 s41, s41, s42
    s_lshl_b32 s41, s41, 2
    s_cmp_eq_u32 s13, 3
    s_cselect_b32 s41, s41, 0
    s_add_u32 s73, s73, s41
    v_lshrrev_b32 v36, 6, v40
    v_and_b32 v37, 63, v40
    v_min_u32 v37, 23, v37
    v_lshl_add_u32 v36, v36, 5, v37
    v_lshlrev_b32 v137, 2, v36
    v_mov_b32 v138, 0
    v_mov_b32 v140, 0
    v_mov_b32 v142, 0
    v_max_u32 v36, 1, v35
    v_xor_b32 v36, s38, v36
    v_lshlrev_b32 v139, 9, v36
    s_lshl_b32 s41, s38, 9
    v_mov_b32 v141, s41
    s_mov_b32 s80, 0
    s_mov_b32 s81, 0
    s_mov_b32 s82, 0
    s_mov_b32 s83, 0
    s_waitcnt vmcnt(28) lgkmcnt(0)
    s_barrier
    s_add_u32 m0, s50, 65536
    s_add_u32 s41, s48, 1572864
    buffer_load_dwordx4 v50, s[24:27], s41 offen  lds
    s_add_u32 m0, s50, 66560
    s_add_u32 s41, s48, 1671168
    buffer_load_dwordx4 v50, s[24:27], s41 offen  lds
    s_add_u32 m0, s50, 67584
    s_add_u32 s41, s48, 1769472
    buffer_load_dwordx4 v50, s[24:27], s41 offen  lds
    s_add_u32 m0, s50, 68608
    s_add_u32 s41, s48, 1867776
    buffer_load_dwordx4 v50, s[24:27], s41 offen  lds
    ds_read_b64_tr_b16 a[0:1], v52 offset:0
    ds_read_b64_tr_b16 a[2:3], v54 offset:0
    ds_read_b64_tr_b16 a[4:5], v52 offset:4096
    ds_read_b64_tr_b16 a[6:7], v54 offset:4096
    ds_read_b64_tr_b16 a[40:41], v53 offset:0
    ds_read_b64_tr_b16 a[42:43], v55 offset:0
    ds_read_b64_tr_b16 a[44:45], v53 offset:4096
    ds_read_b64_tr_b16 a[46:47], v55 offset:4096
    s_waitcnt vmcnt(28) lgkmcnt(0)
    s_barrier
    s_add_u32 m0, s50, 0
    s_add_u32 s41, s48, 2359296
    buffer_load_dwordx4 v50, s[16:19], s41 offen  lds
    s_add_u32 m0, s50, 1024
    s_add_u32 s41, s48, 2457600
    buffer_load_dwordx4 v50, s[16:19], s41 offen  lds
    s_add_u32 m0, s50, 2048
    s_add_u32 s41, s48, 2555904
    buffer_load_dwordx4 v50, s[16:19], s41 offen  lds
    s_add_u32 m0, s50, 3072
    s_add_u32 s41, s48, 2654208
    buffer_load_dwordx4 v50, s[16:19], s41 offen  lds
    ds_read_b64_tr_b16 a[80:81], v52 offset:8192
    ds_read_b64_tr_b16 a[82:83], v54 offset:8192
    ds_read_b64_tr_b16 a[84:85], v52 offset:12288
    ds_read_b64_tr_b16 a[86:87], v54 offset:12288
    ds_read_b64_tr_b16 a[120:121], v53 offset:8192
    ds_read_b64_tr_b16 a[122:123], v55 offset:8192
    ds_read_b64_tr_b16 a[124:125], v53 offset:12288
    ds_read_b64_tr_b16 a[126:127], v55 offset:12288
    s_waitcnt vmcnt(28) lgkmcnt(0)
    s_barrier
    s_add_u32 m0, s50, 8192
    s_add_u32 s41, s48, 2359296
    buffer_load_dwordx4 v50, s[20:23], s41 offen  lds
    s_add_u32 m0, s50, 9216
    s_add_u32 s41, s48, 2457600
    buffer_load_dwordx4 v50, s[20:23], s41 offen  lds
    s_add_u32 m0, s50, 10240
    s_add_u32 s41, s48, 2555904
    buffer_load_dwordx4 v50, s[20:23], s41 offen  lds
    s_add_u32 m0, s50, 11264
    s_add_u32 s41, s48, 2654208
    buffer_load_dwordx4 v50, s[20:23], s41 offen  lds
    ds_read_b64_tr_b16 a[160:161], v52 offset:16384
    ds_read_b64_tr_b16 a[162:163], v54 offset:16384
    ds_read_b64_tr_b16 a[164:165], v52 offset:20480
    ds_read_b64_tr_b16 a[166:167], v54 offset:20480
    ds_read_b64_tr_b16 a[200:201], v53 offset:16384
    ds_read_b64_tr_b16 a[202:203], v55 offset:16384
    ds_read_b64_tr_b16 a[204:205], v53 offset:20480
    ds_read_b64_tr_b16 a[206:207], v55 offset:20480
    s_waitcnt vmcnt(28) lgkmcnt(0)
    s_barrier
    s_add_u32 m0, s50, 16384
    s_add_u32 s41, s48, 2359296
    buffer_load_dwordx4 v50, s[24:27], s41 offen  lds
    s_add_u32 m0, s50, 17408
    s_add_u32 s41, s48, 2457600
    buffer_load_dwordx4 v50, s[24:27], s41 offen  lds
    s_add_u32 m0, s50, 18432
    s_add_u32 s41, s48, 2555904
    buffer_load_dwordx4 v50, s[24:27], s41 offen  lds
    s_add_u32 m0, s50, 19456
    s_add_u32 s41, s48, 2654208
    buffer_load_dwordx4 v50, s[24:27], s41 offen  lds
    ds_read_b64_tr_b16 a[8:9], v52 offset:24576
    ds_read_b64_tr_b16 a[10:11], v54 offset:24576
    ds_read_b64_tr_b16 a[12:13], v52 offset:28672
    ds_read_b64_tr_b16 a[14:15], v54 offset:28672
    ds_read_b64_tr_b16 a[48:49], v53 offset:24576
    ds_read_b64_tr_b16 a[50:51], v55 offset:24576
    ds_read_b64_tr_b16 a[52:53], v53 offset:28672
    ds_read_b64_tr_b16 a[54:55], v55 offset:28672
    s_waitcnt vmcnt(28) lgkmcnt(0)
    s_barrier
    s_add_u32 m0, s50, 24576
    s_add_u32 s41, s48, 3145728
    buffer_load_dwordx4 v50, s[16:19], s41 offen  lds
    s_add_u32 m0, s50, 25600
    s_add_u32 s41, s48, 3244032
    buffer_load_dwordx4 v50, s[16:19], s41 offen  lds
    s_add_u32 m0, s50, 26624
    s_add_u32 s41, s48, 3342336
    buffer_load_dwordx4 v50, s[16:19], s41 offen  lds
    s_add_u32 m0, s50, 27648
    s_add_u32 s41, s48, 3440640
    buffer_load_dwordx4 v50, s[16:19], s41 offen  lds
    ds_read_b64_tr_b16 a[88:89], v52 offset:32768
    ds_read_b64_tr_b16 a[90:91], v54 offset:32768
    ds_read_b64_tr_b16 a[92:93], v52 offset:36864
    ds_read_b64_tr_b16 a[94:95], v54 offset:36864
    ds_read_b64_tr_b16 a[128:129], v53 offset:32768
    ds_read_b64_tr_b16 a[130:131], v55 offset:32768
    ds_read_b64_tr_b16 a[132:133], v53 offset:36864
    ds_read_b64_tr_b16 a[134:135], v55 offset:36864
    s_waitcnt vmcnt(28) lgkmcnt(0)
    s_barrier
    s_add_u32 m0, s50, 32768
    s_add_u32 s41, s48, 3145728
    buffer_load_dwordx4 v50, s[20:23], s41 offen  lds
    s_add_u32 m0, s50, 33792
    s_add_u32 s41, s48, 3244032
    buffer_load_dwordx4 v50, s[20:23], s41 offen  lds
    s_add_u32 m0, s50, 34816
    s_add_u32 s41, s48, 3342336
    buffer_load_dwordx4 v50, s[20:23], s41 offen  lds
    s_add_u32 m0, s50, 35840
    s_add_u32 s41, s48, 3440640
    buffer_load_dwordx4 v50, s[20:23], s41 offen  lds
    ds_read_b64_tr_b16 a[168:169], v52 offset:40960
    ds_read_b64_tr_b16 a[170:171], v54 offset:40960
    ds_read_b64_tr_b16 a[172:173], v52 offset:45056
    ds_read_b64_tr_b16 a[174:175], v54 offset:45056
    ds_read_b64_tr_b16 a[208:209], v53 offset:40960
    ds_read_b64_tr_b16 a[210:211], v55 offset:40960
    ds_read_b64_tr_b16 a[212:213], v53 offset:45056
    ds_read_b64_tr_b16 a[214:215], v55 offset:45056
    s_waitcnt vmcnt(28) lgkmcnt(0)
    s_barrier
    s_add_u32 m0, s50, 40960
    s_add_u32 s41, s48, 3145728
    buffer_load_dwordx4 v50, s[24:27], s41 offen  lds
    s_add_u32 m0, s50, 41984
    s_add_u32 s41, s48, 3244032
    buffer_load_dwordx4 v50, s[24:27], s41 offen  lds
    s_add_u32 m0, s50, 43008
    s_add_u32 s41, s48, 3342336
    buffer_load_dwordx4 v50, s[24:27], s41 offen  lds
    s_add_u32 m0, s50, 44032
    s_add_u32 s41, s48, 3440640
    buffer_load_dwordx4 v50, s[24:27], s41 offen  lds
    ds_read_b64_tr_b16 a[16:17], v52 offset:49152
    ds_read_b64_tr_b16 a[18:19], v54 offset:49152
    ds_read_b64_tr_b16 a[20:21], v52 offset:53248
    ds_read_b64_tr_b16 a[22:23], v54 offset:53248
    ds_read_b64_tr_b16 a[56:57], v53 offset:49152
    ds_read_b64_tr_b16 a[58:59], v55 offset:49152
    ds_read_b64_tr_b16 a[60:61], v53 offset:53248
    ds_read_b64_tr_b16 a[62:63], v55 offset:53248
    s_waitcnt vmcnt(28) lgkmcnt(0)
    s_barrier
    s_add_u32 m0, s50, 49152
    s_mul_i32 s41, s94, 80
    s_add_u32 s41, s41, s49
    buffer_load_dwordx4 v51, s[28:31], s41 offen  lds
    s_add_u32 m0, s50, 50176
    s_mul_i32 s41, s94, 80
    s_add_u32 s41, s41, s49
    s_add_u32 s41, s41, 20480
    buffer_load_dwordx4 v51, s[28:31], s41 offen  lds
    s_add_u32 m0, s50, 51200
    s_mul_i32 s41, s94, 80
    s_add_u32 s41, s41, s49
    s_add_u32 s41, s41, 40960
    buffer_load_dwordx4 v51, s[28:31], s41 offen  lds
    s_add_u32 m0, s50, 52224
    s_mul_i32 s41, s94, 80
    s_add_u32 s41, s41, s49
    s_add_u32 s41, s41, 61440
    buffer_load_dwordx4 v51, s[28:31], s41 offen  lds
    ds_read_b64_tr_b16 a[96:97], v57 offset:0
    ds_read_b64_tr_b16 a[98:99], v59 offset:0
    ds_read_b64_tr_b16 a[100:101], v57 offset:4096
    ds_read_b64_tr_b16 a[102:103], v59 offset:4096
    ds_read_b64_tr_b16 a[136:137], v58 offset:0
    ds_read_b64_tr_b16 a[138:139], v60 offset:0
    ds_read_b64_tr_b16 a[140:141], v58 offset:4096
    ds_read_b64_tr_b16 a[142:143], v60 offset:4096
    s_waitcnt vmcnt(28) lgkmcnt(0)
    s_barrier
    s_add_u32 m0, s50, 57344
    s_mul_i32 s41, s95, 80
    s_add_u32 s41, s41, s49
    buffer_load_dwordx4 v51, s[28:31], s41 offen  lds
    s_add_u32 m0, s50, 58368
    s_mul_i32 s41, s95, 80
    s_add_u32 s41, s41, s49
    s_add_u32 s41, s41, 20480
    buffer_load_dwordx4 v51, s[28:31], s41 offen  lds
    s_add_u32 m0, s50, 59392
    s_mul_i32 s41, s95, 80
    s_add_u32 s41, s41, s49
    s_add_u32 s41, s41, 40960
    buffer_load_dwordx4 v51, s[28:31], s41 offen  lds
    s_add_u32 m0, s50, 60416
    s_mul_i32 s41, s95, 80
    s_add_u32 s41, s41, s49
    s_add_u32 s41, s41, 61440
    buffer_load_dwordx4 v51, s[28:31], s41 offen  lds
    s_getpc_b64 s[84:85]
Lc_pc:
    s_lshl_b32 s41, s39, 2
    s_add_u32 s41, s41, s13
    s_lshl_b32 s41, s41, 10
    v_add_u32 v46, s41, v0
    v_min_u32 v46, L4_end-Lc_pc, v46
    v_mov_b32 v47, s85
    v_add_co_u32 v46, vcc, s84, v46
    s_nop 1
    v_addc_co_u32 v47, vcc, 0, v47, vcc
    global_load_dwordx4 v[64:67], v[46:47], off
    s_cmp_eq_u32 s13, 1
    s_cbranch_scc0 Lc_nref
    s_and_b32 s41, s39, 3
    s_lshl_b32 s41, s41, 13
    s_add_u32 s41, s41, Lc00_loop-Lc_pc
    v_lshl_add_u32 v46, v40, 7, s41
    v_min_u32 v46, L4_end-Lc_pc, v46
    v_mov_b32 v139, s85
    v_add_co_u32 v138, vcc, s84, v46
    s_nop 1
    v_addc_co_u32 v139, vcc, 0, v139, vcc
Lc_nref:
    ds_read_b64_tr_b16 a[176:177], v57 offset:8192
    ds_read_b64_tr_b16 a[178:179], v59 offset:8192
    ds_read_b64_tr_b16 a[180:181], v57 offset:12288
    ds_read_b64_tr_b16 a[182:183], v59 offset:12288
    ds_read_b64_tr_b16 a[216:217], v58 offset:8192
    ds_read_b64_tr_b16 a[218:219], v60 offset:8192
    ds_read_b64_tr_b16 a[220:221], v58 offset:12288
    ds_read_b64_tr_b16 a[222:223], v60 offset:12288
    s_waitcnt vmcnt(28) lgkmcnt(0)
    s_barrier
    s_add_u32 m0, s50, 65536
    s_mul_i32 s41, s96, 80
    s_add_u32 s41, s41, s49
    buffer_load_dwordx4 v51, s[28:31], s41 offen  lds
    s_add_u32 m0, s50, 66560
    s_mul_i32 s41, s96, 80
    s_add_u32 s41, s41, s49
    s_add_u32 s41, s41, 20480
    buffer_load_dwordx4 v51, s[28:31], s41 offen  lds
    s_add_u32 m0, s50, 67584
    s_mul_i32 s41, s96, 80
    s_add_u32 s41, s41, s49
    s_add_u32 s41, s41, 40960
    buffer_load_dwordx4 v51, s[28:31], s41 offen  lds
    s_add_u32 m0, s50, 68608
    s_mul_i32 s41, s96, 80
    s_add_u32 s41, s41, s49
    s_add_u32 s41, s41, 61440
    buffer_load_dwordx4 v51, s[28:31], s41 offen  lds
    ds_read_b64_tr_b16 a[24:25], v52 offset:0
    ds_read_b64_tr_b16 a[26:27], v54 offset:0
    ds_read_b64_tr_b16 a[28:29], v52 offset:4096
    ds_read_b64_tr_b16 a[30:31], v54 offset:4096
    ds_read_b64_tr_b16 a[64:65], v53 offset:0
    ds_read_b64_tr_b16 a[66:67], v55 offset:0
    ds_read_b64_tr_b16 a[68:69], v53 offset:4096
    ds_read_b64_tr_b16 a[70:71], v55 offset:4096
    s_waitcnt vmcnt(28) lgkmcnt(0)
    s_barrier
    s_add_u32 m0, s50, 0
    s_mul_i32 s41, s97, 80
    s_add_u32 s41, s41, s49
    buffer_load_dwordx4 v51, s[28:31], s41 offen  lds
    s_add_u32 m0, s50, 1024
    s_mul_i32 s41, s97, 80
    s_add_u32 s41, s41, s49
    s_add_u32 s41, s41, 20480
    buffer_load_dwordx4 v51, s[28:31], s41 offen  lds
    s_add_u32 m0, s50, 2048
    s_mul_i32 s41, s97, 80
    s_add_u32 s41, s41, s49
    s_add_u32 s41, s41, 40960
    buffer_load_dwordx4 v51, s[28:31], s41 offen  lds
    s_add_u32 m0, s50, 3072
    s_mul_i32 s41, s97, 80
    s_add_u32 s41, s41, s49
    s_add_u32 s41, s41, 61440
    buffer_load_dwordx4 v51, s[28:31], s41 offen  lds
    ds_read_b64_tr_b16 a[104:105], v52 offset:8192
    ds_read_b64_tr_b16 a[106:107], v54 offset:8192
    ds_read_b64_tr_b16 a[108:109], v52 offset:12288
    ds_read_b64_tr_b16 a[110:111], v54 offset:12288
    ds_read_b64_tr_b16 a[144:145], v53 offset:8192
    ds_read_b64_tr_b16 a[146:147], v55 offset:8192
    ds_read_b64_tr_b16 a[148:149], v53 offset:12288
    ds_read_b64_tr_b16 a[150:151], v55 offset:12288
    s_waitcnt vmcnt(28) lgkmcnt(0)
    s_barrier
    s_add_u32 m0, s50, 8192
    s_mul_i32 s41, s98, 80
    s_add_u32 s41, s41, s49
    buffer_load_dwordx4 v51, s[28:31], s41 offen  lds
    s_add_u32 m0, s50, 9216
    s_mul_i32 s41, s98, 80
    s_add_u32 s41, s41, s49
    s_add_u32 s41, s41, 20480
    buffer_load_dwordx4 v51, s[28:31], s41 offen  lds
    s_add_u32 m0, s50, 10240
    s_mul_i32 s41, s98, 80
    s_add_u32 s41, s41, s49
    s_add_u32 s41, s41, 40960
    buffer_load_dwordx4 v51, s[28:31], s41 offen  lds
    s_add_u32 m0, s50, 11264
    s_mul_i32 s41, s98, 80
    s_add_u32 s41, s41, s49
    s_add_u32 s41, s41, 61440
    buffer_load_dwordx4 v51, s[28:31], s41 offen  lds
    ds_read_b64_tr_b16 a[184:185], v52 offset:16384
    ds_read_b64_tr_b16 a[186:187], v54 offset:16384
    ds_read_b64_tr_b16 a[188:189], v52 offset:20480
    ds_read_b64_tr_b16 a[190:191], v54 offset:20480
    ds_read_b64_tr_b16 a[224:225], v53 offset:16384
    ds_read_b64_tr_b16 a[226:227], v55 offset:16384
    ds_read_b64_tr_b16 a[228:229], v53 offset:20480
    ds_read_b64_tr_b16 a[230:231], v55 offset:20480
    s_waitcnt vmcnt(28) lgkmcnt(0)
    s_barrier
    v_lshlrev_b32 v44, 2, v40
    global_load_dword v45, v44, s[8:9] sc1
    s_add_u32 m0, s50, 16384
    s_mul_i32 s41, s99, 80
    s_add_u32 s41, s41, s49
    buffer_load_dwordx4 v51, s[28:31], s41 offen  lds
    s_add_u32 m0, s50, 17408
    s_mul_i32 s41, s99, 80
    s_add_u32 s41, s41, s49
    s_add_u32 s41, s41, 20480
    buffer_load_dwordx4 v51, s[28:31], s41 offen  lds
    s_add_u32 m0, s50, 18432
    s_mul_i32 s41, s99, 80
    s_add_u32 s41, s41, s49
    s_add_u32 s41, s41, 40960
    buffer_load_dwordx4 v51, s[28:31], s41 offen  lds
    s_add_u32 m0, s50, 19456
    s_mul_i32 s41, s99, 80
    s_add_u32 s41, s41, s49
    s_add_u32 s41, s41, 61440
    buffer_load_dwordx4 v51, s[28:31], s41 offen  lds
    ds_read_b64_tr_b16 a[32:33], v52 offset:24576
    ds_read_b64_tr_b16 a[34:35], v54 offset:24576
    ds_read_b64_tr_b16 a[36:37], v52 offset:28672
    ds_read_b64_tr_b16 a[38:39], v54 offset:28672
    ds_read_b64_tr_b16 a[72:73], v53 offset:24576
    ds_read_b64_tr_b16 a[74:75], v55 offset:24576
    ds_read_b64_tr_b16 a[76:77], v53 offset:28672
    ds_read_b64_tr_b16 a[78:79], v55 offset:28672
    s_waitcnt vmcnt(28) lgkmcnt(0)
    s_barrier
    ds_read_b64_tr_b16 a[112:113], v52 offset:32768
    ds_read_b64_tr_b16 a[114:115], v54 offset:32768
    ds_read_b64_tr_b16 a[116:117], v52 offset:36864
    ds_read_b64_tr_b16 a[118:119], v54 offset:36864
    ds_read_b64_tr_b16 a[152:153], v53 offset:32768
    ds_read_b64_tr_b16 a[154:155], v55 offset:32768
    ds_read_b64_tr_b16 a[156:157], v53 offset:36864
    ds_read_b64_tr_b16 a[158:159], v55 offset:36864
    s_waitcnt vmcnt(24) lgkmcnt(0)
    s_barrier
    ds_read_b64_tr_b16 a[192:193], v52 offset:40960
    ds_read_b64_tr_b16 a[194:195], v54 offset:40960
    ds_read_b64_tr_b16 a[196:197], v52 offset:45056
    ds_read_b64_tr_b16 a[198:199], v54 offset:45056
    ds_read_b64_tr_b16 a[232:233], v53 offset:40960
    ds_read_b64_tr_b16 a[234:235], v55 offset:40960
    ds_read_b64_tr_b16 a[236:237], v53 offset:45056
    ds_read_b64_tr_b16 a[238:239], v55 offset:45056
    s_waitcnt vmcnt(20) lgkmcnt(0)
    s_barrier
    ds_read_b64_tr_b16 v[168:169], v56 offset:49152
    ds_read_b64_tr_b16 v[170:171], v56 offset:49280
    ds_read_b64_tr_b16 v[172:173], v56 offset:49664
    ds_read_b64_tr_b16 v[174:175], v56 offset:49792
    ds_read_b64_tr_b16 v[176:177], v56 offset:49184
    ds_read_b64_tr_b16 v[178:179], v56 offset:49312
    ds_read_b64_tr_b16 v[180:181], v56 offset:49696
    ds_read_b64_tr_b16 v[182:183], v56 offset:49824
    s_waitcnt vmcnt(16) lgkmcnt(0)
    s_barrier
    ds_read_b64_tr_b16 v[184:185], v61 offset:0
    ds_read_b64_tr_b16 v[186:187], v61 offset:128
    ds_read_b64_tr_b16 v[188:189], v61 offset:512
    ds_read_b64_tr_b16 v[190:191], v61 offset:640
    ds_read_b64_tr_b16 v[192:193], v61 offset:32
    ds_read_b64_tr_b16 v[194:195], v61 offset:160
    ds_read_b64_tr_b16 v[196:197], v61 offset:544
    ds_read_b64_tr_b16 v[198:199], v61 offset:672
    s_waitcnt vmcnt(12) lgkmcnt(0)
    s_barrier
    ds_read_b64_tr_b16 v[200:201], v61 offset:8192
    ds_read_b64_tr_b16 v[202:203], v61 offset:8320
    ds_read_b64_tr_b16 v[204:205], v61 offset:8704
    ds_read_b64_tr_b16 v[206:207], v61 offset:8832
    ds_read_b64_tr_b16 v[208:209], v61 offset:8224
    ds_read_b64_tr_b16 v[210:211], v61 offset:8352
    ds_read_b64_tr_b16 v[212:213], v61 offset:8736
    ds_read_b64_tr_b16 v[214:215], v61 offset:8864
    s_waitcnt vmcnt(8) lgkmcnt(0)
    s_barrier
    ds_read_b64_tr_b16 v[216:217], v56 offset:0
    ds_read_b64_tr_b16 v[218:219], v56 offset:128
    ds_read_b64_tr_b16 v[220:221], v56 offset:512
    ds_read_b64_tr_b16 v[222:223], v56 offset:640
    ds_read_b64_tr_b16 v[224:225], v56 offset:32
    ds_read_b64_tr_b16 v[226:227], v56 offset:160
    ds_read_b64_tr_b16 v[228:229], v56 offset:544
    ds_read_b64_tr_b16 v[230:231], v56 offset:672
    s_waitcnt vmcnt(4) lgkmcnt(0)
    s_barrier
    ds_read_b64_tr_b16 v[232:233], v56 offset:8192
    ds_read_b64_tr_b16 v[234:235], v56 offset:8320
    ds_read_b64_tr_b16 v[236:237], v56 offset:8704
    ds_read_b64_tr_b16 v[238:239], v56 offset:8832
    ds_read_b64_tr_b16 v[240:241], v56 offset:8224
    ds_read_b64_tr_b16 v[242:243], v56 offset:8352
    ds_read_b64_tr_b16 v[244:245], v56 offset:8736
    ds_read_b64_tr_b16 v[246:247], v56 offset:8864
    s_waitcnt vmcnt(0) lgkmcnt(0)
    s_barrier
    ds_read_b64_tr_b16 v[248:249], v56 offset:16384
    ds_read_b64_tr_b16 v[250:251], v56 offset:16512
    ds_read_b64_tr_b16 v[252:253], v56 offset:16896
    ds_read_b64_tr_b16 v[254:255], v56 offset:17024
    ds_read_b64_tr_b16 a[248:249], v56 offset:16416
    ds_read_b64_tr_b16 a[250:251], v56 offset:16544
    ds_read_b64_tr_b16 a[252:253], v56 offset:16928
    ds_read_b64_tr_b16 a[254:255], v56 offset:17056
    s_waitcnt lgkmcnt(0)
    s_branch Lc_cm_e
Lc_cm:
    global_load_dword v45, v44, s[8:9] sc1
    s_sub_u32 s12, s12, 1
    s_cbranch_scc1 L_abort
Lc_cm_e:
    s_add_u32 s85, s15, 11
    s_cmp_lg_u32 s15, 0
    s_waitcnt vmcnt(0)
    s_cbranch_scc1 Lc_cm_m
    v_cmp_eq_u32 vcc, -1, v45
    s_nop 0
    s_and_b32 s86, vcc_lo, vcc_hi
    v_cmp_eq_u32 vcc, 0x2000, v45
    s_nop 0
    s_and_b32 s87, vcc_lo, vcc_hi
    s_lshr_b32 s87, s87, 1
    s_and_b32 s86, s86, s87
    s_and_b32 s86, s86, 0x01010101
    s_cmp_eq_u32 s86, 0x01010101
    s_cbranch_scc1 Lc_cm_m
    v_readlane_b32 s86, v45, 3
    s_mov_b32 s84, 0
    v_readlane_b32 s87, v45, 1
    s_nop 0
    s_lshr_b32 s87, s87, 8
    s_add_u32 s86, s86, s87
    s_max_u32 s84, s84, s87
    v_readlane_b32 s87, v45, 9
    s_nop 0
    s_lshr_b32 s87, s87, 8
    s_add_u32 s86, s86, s87
    s_max_u32 s84, s84, s87
    v_readlane_b32 s87, v45, 17
    s_nop 0
    s_lshr_b32 s87, s87, 8
    s_add_u32 s86, s86, s87
    s_max_u32 s84, s84, s87
    v_readlane_b32 s87, v45, 25
    s_nop 0
    s_lshr_b32 s87, s87, 8
    s_add_u32 s86, s86, s87
    s_max_u32 s84, s84, s87
    v_readlane_b32 s87, v45, 33
    s_nop 0
    s_lshr_b32 s87, s87, 8
    s_add_u32 s86, s86, s87
    s_max_u32 s84, s84, s87
    v_readlane_b32 s87, v45, 41
    s_nop 0
    s_lshr_b32 s87, s87, 8
    s_add_u32 s86, s86, s87
    s_max_u32 s84, s84, s87
    v_readlane_b32 s87, v45, 49
    s_nop 0
    s_lshr_b32 s87, s87, 8
    s_add_u32 s86, s86, s87
    s_max_u32 s84, s84, s87
    v_readlane_b32 s87, v45, 57
    s_nop 0
    s_lshr_b32 s87, s87, 8
    s_add_u32 s86, s86, s87
    s_max_u32 s84, s84, s87
    s_cmp_eq_u32 s86, 256
    s_cbranch_scc1 L_again
Lc_cm_z:
    s_sleep 4
    s_branch Lc_cm
Lc_cm_m:
    v_readlane_b32 s84, v45, s85
    s_nop 0
    s_and_b32 s86, s84, 0xffff
    s_cmp_eq_u32 s86, 32
    s_cbranch_scc0 Lc_cm_z
    s_cmp_gt_u32 s84, 12582944
    s_cselect_b32 s41, 8192, 0
    s_add_u32 s57, s57, s41
    s_add_u32 s41, s41, s14
    s_add_u32 s78, s41, 1982464
    s_barrier
    s_lshl_b32 s41, s13, 15
    s_add_u32 s41, s41, s55
    buffer_load_dwordx4 v[64:67], v0, s[4:7], s41 offen sc1
    s_lshl_b32 s41, s13, 10
    s_add_u32 s41, s41, s60
    buffer_load_dwordx4 v[64:67], v0, s[4:7], s41 offen sc1
    s_add_u32 s41, s59, 0
    buffer_load_dword v64, off, s[4:7], s41 sc1
    s_add_u32 s41, s59, 16384
    buffer_load_dword v64, off, s[4:7], s41 sc1
    s_add_u32 s41, s59, 32768
    buffer_load_dword v64, off, s[4:7], s41 sc1
    s_add_u32 s41, s59, 49152
    buffer_load_dword v64, off, s[4:7], s41 sc1
    s_mov_b32 s40, 0
    s_cmp_eq_u32 s45, 1
    s_cbranch_scc1 Lc_f1
Lc_f0:
    buffer_load_dword v143, off, s[4:7], s74 sc1
    s_sub_u32 s12, s12, 1
    s_cbranch_scc1 L_abort
    s_waitcnt vmcnt(0)
    v_cmp_eq_u32 vcc, 0, v143
    s_cbranch_vccnz Lc_f0
    s_and_b32 s42, s40, 1
    s_lshl_b32 s42, s42, 13
    s_add_u32 m0, s42, s65
    s_lshl_b32 s41, s40, 12
    s_add_u32 s41, s41, s63
    buffer_load_dwordx4 v0, s[4:7], s41 offen offset:0 sc1 lds
    buffer_load_dwordx4 v0, s[4:7], s41 offen offset:1024 sc1 lds
    buffer_load_dwordx4 v0, s[4:7], s41 offen offset:2048 sc1 lds
    buffer_load_dwordx4 v0, s[4:7], s41 offen offset:3072 sc1 lds
Lc_f1:
    s_mov_b32 s67, s58
    s_add_u32 s68, s67, 4096
    s_mov_b32 s71, 1073741824
    s_mov_b32 s72, 1073741824
    s_waitcnt vmcnt(0)
    v_mov_b64 v[48:49], 0
    v_mov_b64 v[50:51], 0
    v_mov_b64 v[52:53], 0
    v_mov_b64 v[54:55], 0
    v_mov_b64 v[56:57], 0
    v_mov_b64 v[58:59], 0
    v_mov_b64 v[60:61], 0
    v_mov_b64 v[62:63], 0
    v_mov_b64 v[64:65], 0
    v_mov_b64 v[66:67], 0
    v_mov_b64 v[68:69], 0
    v_mov_b64 v[70:71], 0
    s_barrier
    s_lshl_b32 s41, s11, 2
    s_add_u32 s41, s41, s13
    s_cmp_eq_u32 s41, 0
    s_cbranch_scc1 Lc00_loop
    s_lshl_b32 s41, s11, 2
    s_add_u32 s41, s41, s13
    s_cmp_eq_u32 s41, 1
    s_cbranch_scc1 Lc01_loop
    s_lshl_b32 s41, s11, 2
    s_add_u32 s41, s41, s13
    s_cmp_eq_u32 s41, 2
    s_cbranch_scc1 Lc02_loop
    s_lshl_b32 s41, s11, 2
    s_add_u32 s41, s41, s13
    s_cmp_eq_u32 s41, 3
    s_cbranch_scc1 Lc03_loop
    s_lshl_b32 s41, s11, 2
    s_add_u32 s41, s41, s13
    s_cmp_eq_u32 s41, 4
    s_cbranch_scc1 Lc10_loop
    s_lshl_b32 s41, s11, 2
    s_add_u32 s41, s41, s13
    s_cmp_eq_u32 s41, 5
    s_cbranch_scc1 Lc11_loop
    s_lshl_b32 s41, s11, 2
    s_add_u32 s41, s41, s13
    s_cmp_eq_u32 s41, 6
    s_cbranch_scc1 Lc12_loop
    s_branch Lc13_loop
    .p2align 6
Lc00_loop:
    s_barrier
    s_and_b32 s41, s40, 1
    s_lshl_b32 s69, s41, 11
    s_lshl_b32 s41, s41, 13
    s_add_u32 s41, s41, 8192
    v_add_u32_e64 v10, s41, v0
    ds_read_b128 v[72:75], v10 offset:0
    s_nop 13
    buffer_load_dwordx4 v[28:31], v0, s[4:7], s67 offen offset:0 sc1
    ds_read_b128 v[80:83], v10 offset:2048
    s_add_u32 s49, s69, s60
    s_and_b32 s41, s40, 3
    s_nop 0
    s_nop 3
    buffer_load_dwordx4 v[32:35], v0, s[4:7], s67 offen offset:1024 sc1
    s_mul_i32 s70, s41, 327680
    s_add_u32 s70, s70, s57
    s_mul_i32 s71, s41, 98304
    s_nop 0
    s_nop 3
    buffer_load_dwordx4 v[36:39], v0, s[4:7], s67 offen offset:2048 sc1
    s_add_u32 s71, s71, s64
    s_lshl_b32 s75, s41, 15
    s_bfe_u32 s50, s40, 0x10002
    s_nop 4
    buffer_load_dwordx4 v[40:43], v0, s[4:7], s67 offen offset:3072 sc1
    s_nop 7
    buffer_load_dwordx4 v[44:47], v0, s[4:7], s68 offen offset:0 sc1
    s_waitcnt vmcnt(4)
    v_cmp_u_f32 vcc, v28, v30
    s_cbranch_vccnz Lc0s_Df0
Lc00_Dk0:
    v_smfmac_f32_16x16x64_bf16 v[48:51], v[28:31], a[0:7], v2
    s_waitcnt vmcnt(3)
    v_cmp_u_f32_e64 vcc, v32, v34
    v_smfmac_f32_16x16x64_bf16 v[52:55], v[28:31], a[80:87], v2
    v_smfmac_f32_16x16x64_bf16 v[56:59], v[28:31], a[40:47], v2
    v_smfmac_f32_16x16x64_bf16 v[60:63], v[28:31], a[120:127], v2
    s_cbranch_vccnz Lc0s_Df1
Lc00_Dk1:
    v_smfmac_f32_16x16x64_bf16 v[48:51], v[32:35], a[8:15], v2
    s_waitcnt vmcnt(2)
    v_cmp_u_f32_e64 vcc, v36, v38
    v_smfmac_f32_16x16x64_bf16 v[52:55], v[32:35], a[88:95], v2
    v_smfmac_f32_16x16x64_bf16 v[56:59], v[32:35], a[48:55], v2
    v_smfmac_f32_16x16x64_bf16 v[60:63], v[32:35], a[128:135], v2
    s_cbranch_vccnz Lc0s_Df2
Lc00_Dk2:
    v_smfmac_f32_16x16x64_bf16 v[48:51], v[36:39], a[16:23], v2
    s_waitcnt vmcnt(1)
    v_cmp_u_f32_e64 vcc, v40, v42
    v_smfmac_f32_16x16x64_bf16 v[52:55], v[36:39], a[96:103], v2
    v_smfmac_f32_16x16x64_bf16 v[56:59], v[36:39], a[56:63], v2
    v_smfmac_f32_16x16x64_bf16 v[60:63], v[36:39], a[136:143], v2
    s_cbranch_vccnz Lc0s_Df3
Lc00_Dk3:
    v_smfmac_f32_16x16x64_bf16 v[48:51], v[40:43], a[24:31], v2
    s_waitcnt vmcnt(0)
    v_cmp_u_f32_e64 vcc, v44, v46
    v_smfmac_f32_16x16x64_bf16 v[52:55], v[40:43], a[104:111], v2
    v_smfmac_f32_16x16x64_bf16 v[56:59], v[40:43], a[64:71], v2
    v_smfmac_f32_16x16x64_bf16 v[60:63], v[40:43], a[144:151], v2
    s_cbranch_vccnz Lc0s_Df4
Lc00_Dk4:
    v_smfmac_f32_16x16x64_bf16 v[48:51], v[44:47], a[32:39], v2
    v_smfmac_f32_16x16x64_bf16 v[52:55], v[44:47], a[112:119], v2
    v_smfmac_f32_16x16x64_bf16 v[56:59], v[44:47], a[72:79], v2
    v_smfmac_f32_16x16x64_bf16 v[60:63], v[44:47], a[152:159], v2
Lc00_Ddone:
    v_permlane32_swap_b32 v48, v52
    v_permlane32_swap_b32 v49, v53
    v_permlane32_swap_b32 v50, v54
    v_permlane32_swap_b32_e64 v51, v55
    v_pk_add_f32 v[48:49], v[48:49], v[52:53]
    v_pk_add_f32 v[50:51], v[50:51], v[54:55]
    v_cvt_pk_bf16_f32 v48, v48, v49
    v_cvt_pk_bf16_f32 v49, v50, v51
    ds_write_b64 v3, v[48:49] offset:0
    v_permlane32_swap_b32 v56, v60
    v_permlane32_swap_b32 v57, v61
    v_permlane32_swap_b32 v58, v62
    v_permlane32_swap_b32 v59, v63
    v_pk_add_f32 v[56:57], v[56:57], v[60:61]
    v_pk_add_f32 v[58:59], v[58:59], v[62:63]
    v_cvt_pk_bf16_f32 v56, v56, v57
    v_cvt_pk_bf16_f32 v57, v58, v59
    ds_write_b64 v3, v[56:57] offset:128
    v_smfmac_f32_16x16x64_bf16 v[64:67], v[28:31], a[160:167], v2
    v_smfmac_f32_16x16x64_bf16 v[68:71], v[28:31], a[200:207], v2
Lc00_Dback:
    buffer_load_dword v143, off, s[4:7], s66 sc1
    v_smfmac_f32_16x16x64_bf16 v[64:67], v[32:35], a[168:175], v2
    s_waitcnt lgkmcnt(0)
    s_barrier
    v_smfmac_f32_16x16x64_bf16 v[68:71], v[32:35], a[208:215], v2
    ds_read_b64_tr_b16 v[48:49], v4 offset:0
    ds_read_b64_tr_b16 v[50:51], v4 offset:128
    ds_read_b64_tr_b16 v[56:57], v4 offset:256
    ds_read_b64_tr_b16 v[58:59], v4 offset:384
    s_waitcnt lgkmcnt(2)
    v_mfma_f32_16x16x32_bf16 v[104:107], v[72:75], v[48:51], 0
    s_waitcnt lgkmcnt(0)
    v_mfma_f32_16x16x32_bf16 v[104:107], v[80:83], v[56:59], v[104:107]
    v_smfmac_f32_16x16x64_bf16 v[64:67], v[36:39], a[176:183], v2
    s_nop 0
    s_nop 2
    v_add_f32_dpp v20, v104, v104 row_ror:8 row_mask:0xf bank_mask:0x3
    v_add_f32_dpp v21, v105, v105 row_ror:8 row_mask:0xf bank_mask:0x3
    v_add_f32_dpp v22, v106, v106 row_ror:8 row_mask:0xf bank_mask:0x3
    v_add_f32_dpp v23, v107, v107 row_ror:8 row_mask:0xf bank_mask:0x3
    buffer_store_dwordx4 v[20:23], v27, s[4:7], s49 offen
    ds_read_b64_tr_b16 v[160:161], v4 offset:2304
    ds_read_b64_tr_b16 v[162:163], v4 offset:2432
    v_smfmac_f32_16x16x64_bf16 v[68:71], v[36:39], a[216:223], v2
    v_smfmac_f32_16x16x64_bf16 v[64:67], v[40:43], a[184:191], v2
    v_smfmac_f32_16x16x64_bf16 v[68:71], v[40:43], a[224:231], v2
    v_smfmac_f32_16x16x64_bf16 v[64:67], v[44:47], a[192:199], v2
    v_smfmac_f32_16x16x64_bf16 v[68:71], v[44:47], a[232:239], v2
    s_nop 7
    v_permlane32_swap_b32 v64, v68
    v_permlane32_swap_b32 v65, v69
    v_permlane32_swap_b32 v66, v70
    v_permlane32_swap_b32_e64 v67, v71
    v_pk_add_f32 v[64:65], v[64:65], v[68:69]
    v_pk_add_f32 v[66:67], v[66:67], v[70:71]
    v_cvt_pk_bf16_f32 v64, v64, v65
    v_cvt_pk_bf16_f32 v65, v66, v67
    ds_write_b64 v5, v[64:65]
    s_cmp_eq_u32 s40, 63
    s_waitcnt lgkmcnt(0)
    s_barrier
    s_cbranch_scc1 Lc00_fin
    v_mov_b64 v[64:65], 0
    v_mov_b64 v[66:67], 0
    v_mov_b64 v[68:69], 0
    v_mov_b64 v[70:71], 0
    s_add_u32 s41, s40, 1
    s_and_b32 s41, s41, 3
    s_lshl_b32 s41, s41, 14
    s_add_u32 s67, s41, s58
    s_add_u32 s68, s67, 4096
    s_add_u32 s76, s41, s59
    s_add_u32 s41, s75, s56
    v_add_u32_e64 v10, s41, v0
    v_and_or_b32 v160, v160, -2, s50
    s_cmp_ge_u32 s40, 61
    s_cbranch_scc1 Lc00_pe
Lc00_pe_c:
    s_and_b32 s41, s40, 3
    s_xor_b32 s41, s41, 2
    s_mul_i32 s72, s41, 327680
    s_add_u32 s72, s72, s57
    s_sub_u32 s72, s72, 0
    s_add_u32 s48, s40, 1
    s_and_b32 s42, s48, 1
    s_lshl_b32 s42, s42, 13
    s_add_u32 m0, s42, s65
    s_lshl_b32 s74, s48, 12
    s_add_u32 s74, s74, s63
    s_add_u32 s51, s40, 2
    s_waitcnt vmcnt(1)
    v_cmp_gt_u32 vcc, s51, v143
    s_cbranch_vccnz Lc00_F_s
Lc00_F_c:
    s_nop 15
    s_nop 15
    s_nop 15
    s_nop 15
    s_nop 5
    v_mov_b32 v20, s48
Lc00_al:
    s_cmp_eq_u32 s39, 20
    buffer_load_dword v138, v137, s[4:7], s73 offen sc1
    v_cmp_gt_u32 vcc, s48, v138
    s_nop 3
    s_cbranch_vccz Lc00_al_ok
    buffer_load_dword v138, v137, s[4:7], s73 offen sc1
    v_cmp_gt_u32 vcc, s48, v138
    s_nop 3
    s_cbranch_vccz Lc00_al_ok
    buffer_load_dword v138, v137, s[4:7], s73 offen sc1
    v_cmp_gt_u32 vcc, s48, v138
    s_nop 3
    s_cbranch_vccz Lc00_al_ok
    buffer_load_dword v138, v137, s[4:7], s73 offen sc1
    v_cmp_gt_u32 vcc, s48, v138
    s_nop 3
    s_cbranch_vccz Lc00_al_ok
    s_waitcnt vmcnt(16)
    s_sub_u32 s12, s12, 1
    s_cbranch_scc1 L_abort
    s_branch Lc00_al
    s_nop 0
    s_nop 0
    s_nop 0
    s_nop 0
    s_nop 0
Lc00_al_ok:
    s_cbranch_scc0 Lc00_al_n
    buffer_store_dword v20, v141, s[4:7], s78 offen sc1
Lc00_al_n:
    s_nop 5
    s_cmp_ge_u32 s39, 20
    s_barrier
    s_cbranch_scc1 Lc00_sh
    s_nop 10
    buffer_load_dwordx4 v[80:83], v10, s[4:7], s94 offen sc1
    s_nop 5
    buffer_load_dwordx4 v[84:87], v10, s[4:7], s95 offen sc1
    s_nop 5
    buffer_load_dwordx4 v[88:91], v10, s[4:7], s96 offen sc1
    s_nop 5
    buffer_load_dwordx4 v[92:95], v10, s[4:7], s97 offen sc1
    s_nop 5
    buffer_load_dwordx4 v[96:99], v10, s[4:7], s98 offen sc1
    s_nop 0
    s_nop 4
    buffer_load_dwordx4 v[100:103], v10, s[4:7], s99 offen sc1
    s_waitcnt vmcnt(4)
    v_cmp_u_f32 vcc, v80, v84
    s_cbranch_vccnz Lc00_Gf0
Lc00_Gk0:
    v_smfmac_f32_16x16x64_bf16 v[64:67], v[80:83], v[168:175], v2
    s_waitcnt vmcnt(2)
    v_cmp_u_f32 vcc, v88, v92
    v_smfmac_f32_16x16x64_bf16 v[68:71], v[80:83], v[176:183], v2
    v_smfmac_f32_16x16x64_bf16 v[64:67], v[84:87], v[184:191], v2
    v_smfmac_f32_16x16x64_bf16 v[68:71], v[84:87], v[192:199], v2
    s_cbranch_vccnz Lc00_Gf1
Lc00_Gk1:
    buffer_load_dword v140, v139, s[4:7], s78 offen sc1
    v_smfmac_f32_16x16x64_bf16 v[64:67], v[88:91], v[200:207], v2
    s_waitcnt vmcnt(2)
    v_cmp_u_f32 vcc, v96, v96
    v_smfmac_f32_16x16x64_bf16 v[68:71], v[88:91], v[208:215], v2
    v_smfmac_f32_16x16x64_bf16 v[64:67], v[92:95], v[216:223], v2
    v_smfmac_f32_16x16x64_bf16 v[68:71], v[92:95], v[224:231], v2
    s_cbranch_vccnz Lc00_Gf2
Lc00_Gk2:
    buffer_load_dword v140, v139, s[4:7], s78 offen sc1
    s_waitcnt vmcnt(2)
    v_cmp_u_f32 vcc, v100, v100
    v_smfmac_f32_16x16x64_bf16 v[64:67], v[96:99], v[232:239], v2
    v_smfmac_f32_16x16x64_bf16 v[68:71], v[96:99], v[240:247], v2
    s_cbranch_vccnz Lc00_Gf3
Lc00_Gk3:
    buffer_load_dword v140, v139, s[4:7], s78 offen sc1
    v_smfmac_f32_16x16x64_bf16 v[64:67], v[100:103], v[248:255], v2
    v_smfmac_f32_16x16x64_bf16 v[68:71], v[100:103], a[248:255], v2
Lc00_Gdone:
    buffer_load_dword v140, v139, s[4:7], s78 offen sc1
    buffer_load_dwordx4 v0, s[4:7], s74 offen offset:0 sc1 lds
    buffer_load_dwordx4 v0, s[4:7], s74 offen offset:1024 sc1 lds
    s_nop 0
    v_cvt_pk_bf16_f32 v64, v64, v65
    v_cvt_pk_bf16_f32 v65, v66, v67
    ds_write_b64 v11, v[64:65] offset:0
    s_nop 0
    v_cvt_pk_bf16_f32 v68, v68, v69
    v_cvt_pk_bf16_f32 v69, v70, v71
    ds_write_b64 v11, v[68:69] offset:256
    buffer_load_dwordx4 v0, s[4:7], s74 offen offset:2048 sc1 lds
    buffer_load_dwordx4 v0, s[4:7], s74 offen offset:3072 sc1 lds
    v_cmp_gt_u32 vcc, s48, v140
    s_cbranch_vccnz Lc00_xs
Lc00_xc:
    s_waitcnt lgkmcnt(0)
    s_barrier
    ds_read_b128 v[80:83], v26 offset:0
    ds_read_b128 v[84:87], v26 offset:512
    buffer_store_dwordx4 v[160:163], v0, s[4:7], s71 offen
    s_nop 0
    s_waitcnt lgkmcnt(1)
    v_mfma_f32_16x16x32_bf16 v[116:119], v[80:83], v[12:15], 0
    s_waitcnt lgkmcnt(0)
    v_mfma_f32_16x16x32_bf16 v[116:119], v[84:87], v[12:15], v[116:119]
    s_nop 7
    v_cvt_pk_bf16_f32 v164, v116, v117
    v_cvt_pk_bf16_f32 v165, v118, v119
    buffer_store_dwordx2 v[164:165], v7, s[4:7], s70 offen sc1
    s_nop 15
    s_nop 15
    s_nop 1
    v_mov_b64 v[48:49], 0
    v_mov_b64 v[50:51], 0
    v_mov_b64 v[52:53], 0
    v_mov_b64 v[54:55], 0
    v_mov_b64 v[56:57], 0
    v_mov_b64 v[58:59], 0
    v_mov_b64 v[60:61], 0
    v_mov_b64 v[62:63], 0
    v_mov_b64 v[64:65], 0
    v_mov_b64 v[66:67], 0
    v_mov_b64 v[68:69], 0
    v_mov_b64 v[70:71], 0
    s_nop 15
    s_nop 15
    s_nop 0
    s_nop 2
    s_add_u32 s41, s70, 0
    buffer_load_dwordx4 v[28:31], v8, s[4:7], s41 offen sc1
    s_nop 15
    s_nop 9
    s_add_u32 s41, s70, 81920
    buffer_load_dwordx4 v[32:35], v8, s[4:7], s41 offen sc1
    buffer_store_dwordx4 v[16:19], v136, s[4:7], s72 offen sc1
    s_waitcnt vmcnt(2)
    v_mfma_f32_16x16x32_bf16 v[104:107], v[12:15], v[28:31], v[116:119]
    v_cmp_u_f32 vcc, v28, v30
    s_nop 4
    s_cbranch_vccnz Lc00_C_t
Lc00_C_c:
    s_nop 0
    v_cvt_pk_bf16_f32 v164, v104, v105
    v_cvt_pk_bf16_f32 v165, v106, v107
    buffer_store_dwordx2 v[164:165], v9, s[4:7], s76 offen
    s_waitcnt vmcnt(3)
Lc00_join:
    s_add_u32 s40, s40, 1
    s_branch Lc00_loop
Lc00_fin:
    s_waitcnt lgkmcnt(0)
    v_and_or_b32 v160, v160, -2, s50
    buffer_store_dwordx4 v[160:163], v0, s[4:7], s71 offen
    s_endpgm
Lc0s_Df0:
Lc0s_DfF01234:
    buffer_load_dwordx4 v[28:31], v0, s[4:7], s67 offen offset:0 sc1
    s_waitcnt vmcnt(4)
    v_cmp_u_f32 vcc, v32, v34
    s_cbranch_vccnz Lc0s_DfF12340
Lc0s_DfK12340:
    v_smfmac_f32_16x16x64_bf16 v[48:51], v[32:35], a[8:15], v2
    s_waitcnt vmcnt(3)
    v_cmp_u_f32 vcc, v36, v38
    v_smfmac_f32_16x16x64_bf16 v[52:55], v[32:35], a[88:95], v2
    v_smfmac_f32_16x16x64_bf16 v[56:59], v[32:35], a[48:55], v2
    v_smfmac_f32_16x16x64_bf16 v[60:63], v[32:35], a[128:135], v2
    s_cbranch_vccnz Lc0s_DfF2340
Lc0s_DfK2340:
    v_smfmac_f32_16x16x64_bf16 v[48:51], v[36:39], a[16:23], v2
    s_waitcnt vmcnt(2)
    v_cmp_u_f32 vcc, v40, v42
    v_smfmac_f32_16x16x64_bf16 v[52:55], v[36:39], a[96:103], v2
    v_smfmac_f32_16x16x64_bf16 v[56:59], v[36:39], a[56:63], v2
    v_smfmac_f32_16x16x64_bf16 v[60:63], v[36:39], a[136:143], v2
    s_cbranch_vccnz Lc0s_DfF340
Lc0s_DfK340:
    v_smfmac_f32_16x16x64_bf16 v[48:51], v[40:43], a[24:31], v2
    s_waitcnt vmcnt(1)
    v_cmp_u_f32_e64 vcc, v44, v46
    v_smfmac_f32_16x16x64_bf16 v[52:55], v[40:43], a[104:111], v2
    v_smfmac_f32_16x16x64_bf16 v[56:59], v[40:43], a[64:71], v2
    v_smfmac_f32_16x16x64_bf16 v[60:63], v[40:43], a[144:151], v2
    s_cbranch_vccnz Lc0s_DfF40
Lc0s_DfK40:
    v_smfmac_f32_16x16x64_bf16 v[48:51], v[44:47], a[32:39], v2
    s_waitcnt vmcnt(0)
    v_cmp_u_f32_e64 vcc, v28, v30
    v_smfmac_f32_16x16x64_bf16 v[52:55], v[44:47], a[112:119], v2
    v_smfmac_f32_16x16x64_bf16 v[56:59], v[44:47], a[72:79], v2
    v_smfmac_f32_16x16x64_bf16 v[60:63], v[44:47], a[152:159], v2
    s_cbranch_vccnz Lc0s_DfF0
Lc0s_DfK0:
    v_smfmac_f32_16x16x64_bf16 v[48:51], v[28:31], a[0:7], v2
    v_smfmac_f32_16x16x64_bf16 v[52:55], v[28:31], a[80:87], v2
    v_smfmac_f32_16x16x64_bf16 v[56:59], v[28:31], a[40:47], v2
    v_smfmac_f32_16x16x64_bf16 v[60:63], v[28:31], a[120:127], v2
    s_branch Lc0s_Dftail
    s_nop 0
    s_nop 0
    s_nop 0
    s_nop 0
Lc0s_Df1:
Lc0s_DfF1234:
    buffer_load_dwordx4 v[32:35], v0, s[4:7], s67 offen offset:1024 sc1
    s_waitcnt vmcnt(3)
    v_cmp_u_f32 vcc, v36, v38
    s_cbranch_vccnz Lc0s_DfF2341
Lc0s_DfK2341:
    v_smfmac_f32_16x16x64_bf16 v[48:51], v[36:39], a[16:23], v2
    s_waitcnt vmcnt(2)
    v_cmp_u_f32 vcc, v40, v42
    v_smfmac_f32_16x16x64_bf16 v[52:55], v[36:39], a[96:103], v2
    v_smfmac_f32_16x16x64_bf16 v[56:59], v[36:39], a[56:63], v2
    v_smfmac_f32_16x16x64_bf16 v[60:63], v[36:39], a[136:143], v2
    s_cbranch_vccnz Lc0s_DfF341
Lc0s_DfK341:
    v_smfmac_f32_16x16x64_bf16 v[48:51], v[40:43], a[24:31], v2
    s_waitcnt vmcnt(1)
    v_cmp_u_f32 vcc, v44, v46
    v_smfmac_f32_16x16x64_bf16 v[52:55], v[40:43], a[104:111], v2
    v_smfmac_f32_16x16x64_bf16 v[56:59], v[40:43], a[64:71], v2
    v_smfmac_f32_16x16x64_bf16 v[60:63], v[40:43], a[144:151], v2
    s_cbranch_vccnz Lc0s_DfF41
Lc0s_DfK41:
    v_smfmac_f32_16x16x64_bf16 v[48:51], v[44:47], a[32:39], v2
    s_waitcnt vmcnt(0)
    v_cmp_u_f32_e64 vcc, v32, v34
    v_smfmac_f32_16x16x64_bf16 v[52:55], v[44:47], a[112:119], v2
    v_smfmac_f32_16x16x64_bf16 v[56:59], v[44:47], a[72:79], v2
    v_smfmac_f32_16x16x64_bf16 v[60:63], v[44:47], a[152:159], v2
    s_cbranch_vccnz Lc0s_DfF1
Lc0s_DfK1:
    v_smfmac_f32_16x16x64_bf16 v[48:51], v[32:35], a[8:15], v2
    v_smfmac_f32_16x16x64_bf16 v[52:55], v[32:35], a[88:95], v2
    v_smfmac_f32_16x16x64_bf16 v[56:59], v[32:35], a[48:55], v2
    v_smfmac_f32_16x16x64_bf16 v[60:63], v[32:35], a[128:135], v2
    s_branch Lc0s_Dftail
Lc0s_Df2:
Lc0s_DfF234:
    buffer_load_dwordx4 v[36:39], v0, s[4:7], s67 offen offset:2048 sc1
    s_waitcnt vmcnt(2)
    v_cmp_u_f32 vcc, v40, v42
    s_cbranch_vccnz Lc0s_DfF342
Lc0s_DfK342:
    v_smfmac_f32_16x16x64_bf16 v[48:51], v[40:43], a[24:31], v2
    s_waitcnt vmcnt(1)
    v_cmp_u_f32 vcc, v44, v46
    v_smfmac_f32_16x16x64_bf16 v[52:55], v[40:43], a[104:111], v2
    v_smfmac_f32_16x16x64_bf16 v[56:59], v[40:43], a[64:71], v2
    v_smfmac_f32_16x16x64_bf16 v[60:63], v[40:43], a[144:151], v2
    s_cbranch_vccnz Lc0s_DfF42
Lc0s_DfK42:
    v_smfmac_f32_16x16x64_bf16 v[48:51], v[44:47], a[32:39], v2
    s_waitcnt vmcnt(0)
    v_cmp_u_f32 vcc, v36, v38
    v_smfmac_f32_16x16x64_bf16 v[52:55], v[44:47], a[112:119], v2
    v_smfmac_f32_16x16x64_bf16 v[56:59], v[44:47], a[72:79], v2
    v_smfmac_f32_16x16x64_bf16 v[60:63], v[44:47], a[152:159], v2
    s_cbranch_vccnz Lc0s_DfF2
Lc0s_DfK2:
    v_smfmac_f32_16x16x64_bf16 v[48:51], v[36:39], a[16:23], v2
    v_smfmac_f32_16x16x64_bf16 v[52:55], v[36:39], a[96:103], v2
    v_smfmac_f32_16x16x64_bf16 v[56:59], v[36:39], a[56:63], v2
    v_smfmac_f32_16x16x64_bf16 v[60:63], v[36:39], a[136:143], v2
    s_branch Lc0s_Dftail
    s_nop 0
    s_nop 0
    s_nop 0
    s_nop 0
Lc0s_Df3:
Lc0s_DfF34:
    buffer_load_dwordx4 v[40:43], v0, s[4:7], s67 offen offset:3072 sc1
    s_waitcnt vmcnt(1)
    v_cmp_u_f32 vcc, v44, v46
    s_cbranch_vccnz Lc0s_DfF43
Lc0s_DfK43:
    v_smfmac_f32_16x16x64_bf16 v[48:51], v[44:47], a[32:39], v2
    s_waitcnt vmcnt(0)
    v_cmp_u_f32 vcc, v40, v42
    v_smfmac_f32_16x16x64_bf16 v[52:55], v[44:47], a[112:119], v2
    v_smfmac_f32_16x16x64_bf16 v[56:59], v[44:47], a[72:79], v2
    v_smfmac_f32_16x16x64_bf16 v[60:63], v[44:47], a[152:159], v2
    s_cbranch_vccnz Lc0s_DfF3
Lc0s_DfK3:
    v_smfmac_f32_16x16x64_bf16 v[48:51], v[40:43], a[24:31], v2
    v_smfmac_f32_16x16x64_bf16 v[52:55], v[40:43], a[104:111], v2
    v_smfmac_f32_16x16x64_bf16 v[56:59], v[40:43], a[64:71], v2
    v_smfmac_f32_16x16x64_bf16 v[60:63], v[40:43], a[144:151], v2
    s_branch Lc0s_Dftail
    s_nop 0
    s_nop 0
    s_nop 0
    s_nop 0
    s_nop 0
    s_nop 0
    s_nop 0
Lc0s_Df4:
Lc0s_DfF4:
    buffer_load_dwordx4 v[44:47], v0, s[4:7], s68 offen offset:0 sc1
    s_mov_b32 s77, 16
    s_sub_u32 s12, s12, 1
    s_cbranch_scc1 L_abort
    s_and_b32 s52, s12, 15
    s_cbranch_scc0 Lc0s_DfX
    s_waitcnt vmcnt(0)
    v_cmp_u_f32 vcc, v44, v46
    s_cbranch_vccnz Lc0s_DfF4
Lc0s_DfK4:
    v_smfmac_f32_16x16x64_bf16 v[48:51], v[44:47], a[32:39], v2
    v_smfmac_f32_16x16x64_bf16 v[52:55], v[44:47], a[112:119], v2
    v_smfmac_f32_16x16x64_bf16 v[56:59], v[44:47], a[72:79], v2
    v_smfmac_f32_16x16x64_bf16 v[60:63], v[44:47], a[152:159], v2
    s_branch Lc0s_Dftail
    s_nop 0
    s_nop 0
    s_nop 0
    s_nop 0
    s_nop 0
Lc0s_DfF12340:
    buffer_load_dwordx4 v[32:35], v0, s[4:7], s67 offen offset:1024 sc1
    s_waitcnt vmcnt(4)
    v_cmp_u_f32 vcc, v36, v38
    s_cbranch_vccnz Lc0s_DfF23401
Lc0s_DfK23401:
    v_smfmac_f32_16x16x64_bf16 v[48:51], v[36:39], a[16:23], v2
    s_waitcnt vmcnt(3)
    v_cmp_u_f32 vcc, v40, v42
    v_smfmac_f32_16x16x64_bf16 v[52:55], v[36:39], a[96:103], v2
    v_smfmac_f32_16x16x64_bf16 v[56:59], v[36:39], a[56:63], v2
    v_smfmac_f32_16x16x64_bf16 v[60:63], v[36:39], a[136:143], v2
    s_cbranch_vccnz Lc0s_DfF3401
Lc0s_DfK3401:
    v_smfmac_f32_16x16x64_bf16 v[48:51], v[40:43], a[24:31], v2
    s_waitcnt vmcnt(2)
    v_cmp_u_f32 vcc, v44, v46
    v_smfmac_f32_16x16x64_bf16 v[52:55], v[40:43], a[104:111], v2
    v_smfmac_f32_16x16x64_bf16 v[56:59], v[40:43], a[64:71], v2
    v_smfmac_f32_16x16x64_bf16 v[60:63], v[40:43], a[144:151], v2
    s_cbranch_vccnz Lc0s_DfF401
Lc0s_DfK401:
    v_smfmac_f32_16x16x64_bf16 v[48:51], v[44:47], a[32:39], v2
    s_waitcnt vmcnt(1)
    v_cmp_u_f32_e64 vcc, v28, v30
    v_smfmac_f32_16x16x64_bf16 v[52:55], v[44:47], a[112:119], v2
    v_smfmac_f32_16x16x64_bf16 v[56:59], v[44:47], a[72:79], v2
    v_smfmac_f32_16x16x64_bf16 v[60:63], v[44:47], a[152:159], v2
    s_cbranch_vccnz Lc0s_DfF01
Lc0s_DfK01:
    v_smfmac_f32_16x16x64_bf16 v[48:51], v[28:31], a[0:7], v2
    s_waitcnt vmcnt(0)
    v_cmp_u_f32_e64 vcc, v32, v34
    v_smfmac_f32_16x16x64_bf16 v[52:55], v[28:31], a[80:87], v2
    v_smfmac_f32_16x16x64_bf16 v[56:59], v[28:31], a[40:47], v2
    v_smfmac_f32_16x16x64_bf16 v[60:63], v[28:31], a[120:127], v2
    s_cbranch_vccz Lc0s_DfK1
Lc0s_DfF1:
    buffer_load_dwordx4 v[32:35], v0, s[4:7], s67 offen offset:1024 sc1
    s_mov_b32 s77, 2
    s_sub_u32 s12, s12, 1
    s_cbranch_scc1 L_abort
    s_and_b32 s52, s12, 15
    s_cbranch_scc0 Lc0s_DfX
    s_waitcnt vmcnt(0)
    v_cmp_u_f32 vcc, v32, v34
    s_cbranch_vccnz Lc0s_DfF1
    s_branch Lc0s_DfK1
    s_nop 0
    s_nop 0
Lc0s_DfF2340:
    buffer_load_dwordx4 v[36:39], v0, s[4:7], s67 offen offset:2048 sc1
    s_waitcnt vmcnt(3)
    v_cmp_u_f32 vcc, v40, v42
    s_cbranch_vccnz Lc0s_DfF3402
Lc0s_DfK3402:
    v_smfmac_f32_16x16x64_bf16 v[48:51], v[40:43], a[24:31], v2
    s_waitcnt vmcnt(2)
    v_cmp_u_f32 vcc, v44, v46
    v_smfmac_f32_16x16x64_bf16 v[52:55], v[40:43], a[104:111], v2
    v_smfmac_f32_16x16x64_bf16 v[56:59], v[40:43], a[64:71], v2
    v_smfmac_f32_16x16x64_bf16 v[60:63], v[40:43], a[144:151], v2
    s_cbranch_vccnz Lc0s_DfF402
Lc0s_DfK402:
    v_smfmac_f32_16x16x64_bf16 v[48:51], v[44:47], a[32:39], v2
    s_waitcnt vmcnt(1)
    v_cmp_u_f32 vcc, v28, v30
    v_smfmac_f32_16x16x64_bf16 v[52:55], v[44:47], a[112:119], v2
    v_smfmac_f32_16x16x64_bf16 v[56:59], v[44:47], a[72:79], v2
    v_smfmac_f32_16x16x64_bf16 v[60:63], v[44:47], a[152:159], v2
    s_cbranch_vccnz Lc0s_DfF02
Lc0s_DfK02:
    v_smfmac_f32_16x16x64_bf16 v[48:51], v[28:31], a[0:7], v2
    s_waitcnt vmcnt(0)
    v_cmp_u_f32_e64 vcc, v36, v38
    v_smfmac_f32_16x16x64_bf16 v[52:55], v[28:31], a[80:87], v2
    v_smfmac_f32_16x16x64_bf16 v[56:59], v[28:31], a[40:47], v2
    v_smfmac_f32_16x16x64_bf16 v[60:63], v[28:31], a[120:127], v2
    s_cbranch_vccz Lc0s_DfK2
Lc0s_DfF2:
    buffer_load_dwordx4 v[36:39], v0, s[4:7], s67 offen offset:2048 sc1
    s_mov_b32 s77, 4
    s_sub_u32 s12, s12, 1
    s_cbranch_scc1 L_abort
    s_and_b32 s52, s12, 15
    s_cbranch_scc0 Lc0s_DfX
    s_waitcnt vmcnt(0)
    v_cmp_u_f32 vcc, v36, v38
    s_cbranch_vccnz Lc0s_DfF2
    s_branch Lc0s_DfK2
Lc0s_DfF340:
    buffer_load_dwordx4 v[40:43], v0, s[4:7], s67 offen offset:3072 sc1
    s_waitcnt vmcnt(2)
    v_cmp_u_f32_e64 vcc, v44, v46
    s_cbranch_vccnz Lc0s_DfF403
Lc0s_DfK403:
    v_smfmac_f32_16x16x64_bf16 v[48:51], v[44:47], a[32:39], v2
    s_waitcnt vmcnt(1)
    v_cmp_u_f32 vcc, v28, v30
    v_smfmac_f32_16x16x64_bf16 v[52:55], v[44:47], a[112:119], v2
    v_smfmac_f32_16x16x64_bf16 v[56:59], v[44:47], a[72:79], v2
    v_smfmac_f32_16x16x64_bf16 v[60:63], v[44:47], a[152:159], v2
    s_cbranch_vccnz Lc0s_DfF03
Lc0s_DfK03:
    v_smfmac_f32_16x16x64_bf16 v[48:51], v[28:31], a[0:7], v2
    s_waitcnt vmcnt(0)
    v_cmp_u_f32_e64 vcc, v40, v42
    v_smfmac_f32_16x16x64_bf16 v[52:55], v[28:31], a[80:87], v2
    v_smfmac_f32_16x16x64_bf16 v[56:59], v[28:31], a[40:47], v2
    v_smfmac_f32_16x16x64_bf16 v[60:63], v[28:31], a[120:127], v2
    s_cbranch_vccz Lc0s_DfK3
Lc0s_DfF3:
    buffer_load_dwordx4 v[40:43], v0, s[4:7], s67 offen offset:3072 sc1
    s_mov_b32 s77, 8
    s_sub_u32 s12, s12, 1
    s_cbranch_scc1 L_abort
    s_and_b32 s52, s12, 15
    s_cbranch_scc0 Lc0s_DfX
    s_waitcnt vmcnt(0)
    v_cmp_u_f32 vcc, v40, v42
    s_cbranch_vccnz Lc0s_DfF3
    s_branch Lc0s_DfK3
Lc0s_DfF40:
    buffer_load_dwordx4 v[44:47], v0, s[4:7], s68 offen offset:0 sc1
    s_mov_b32 s77, 17
    s_sub_u32 s12, s12, 1
    s_cbranch_scc1 L_abort
    s_and_b32 s52, s12, 15
    s_cbranch_scc0 Lc0s_DfX
    s_waitcnt vmcnt(1)
    v_cmp_u_f32 vcc, v28, v30
    s_cbranch_vccnz Lc0s_DfF04
Lc0s_DfK04:
    v_smfmac_f32_16x16x64_bf16 v[48:51], v[28:31], a[0:7], v2
    s_waitcnt vmcnt(0)
    v_cmp_u_f32 vcc, v44, v46
    v_smfmac_f32_16x16x64_bf16 v[52:55], v[28:31], a[80:87], v2
    v_smfmac_f32_16x16x64_bf16 v[56:59], v[28:31], a[40:47], v2
    v_smfmac_f32_16x16x64_bf16 v[60:63], v[28:31], a[120:127], v2
    s_cbranch_vccnz Lc0s_DfF4
    s_branch Lc0s_DfK4
Lc0s_DfF0:
    buffer_load_dwordx4 v[28:31], v0, s[4:7], s67 offen offset:0 sc1
    s_mov_b32 s77, 1
    s_sub_u32 s12, s12, 1
    s_cbranch_scc1 L_abort
    s_and_b32 s52, s12, 15
    s_cbranch_scc0 Lc0s_DfX
    s_waitcnt vmcnt(0)
    v_cmp_u_f32 vcc, v28, v30
    s_cbranch_vccnz Lc0s_DfF0
    s_branch Lc0s_DfK0
    s_nop 0
    s_nop 0
    s_nop 0
    s_nop 0
    s_nop 0
Lc0s_DfF2341:
    buffer_load_dwordx4 v[36:39], v0, s[4:7], s67 offen offset:2048 sc1
    s_waitcnt vmcnt(3)
    v_cmp_u_f32 vcc, v40, v42
    s_cbranch_vccnz Lc0s_DfF3412
Lc0s_DfK3412:
    v_smfmac_f32_16x16x64_bf16 v[48:51], v[40:43], a[24:31], v2
    s_waitcnt vmcnt(2)
    v_cmp_u_f32 vcc, v44, v46
    v_smfmac_f32_16x16x64_bf16 v[52:55], v[40:43], a[104:111], v2
    v_smfmac_f32_16x16x64_bf16 v[56:59], v[40:43], a[64:71], v2
    v_smfmac_f32_16x16x64_bf16 v[60:63], v[40:43], a[144:151], v2
    s_cbranch_vccnz Lc0s_DfF412
Lc0s_DfK412:
    v_smfmac_f32_16x16x64_bf16 v[48:51], v[44:47], a[32:39], v2
    s_waitcnt vmcnt(1)
    v_cmp_u_f32 vcc, v32, v34
    v_smfmac_f32_16x16x64_bf16 v[52:55], v[44:47], a[112:119], v2
    v_smfmac_f32_16x16x64_bf16 v[56:59], v[44:47], a[72:79], v2
    v_smfmac_f32_16x16x64_bf16 v[60:63], v[44:47], a[152:159], v2
    s_cbranch_vccnz Lc0s_DfF12
Lc0s_DfK12:
    v_smfmac_f32_16x16x64_bf16 v[48:51], v[32:35], a[8:15], v2
    s_waitcnt vmcnt(0)
    v_cmp_u_f32_e64 vcc, v36, v38
    v_smfmac_f32_16x16x64_bf16 v[52:55], v[32:35], a[88:95], v2
    v_smfmac_f32_16x16x64_bf16 v[56:59], v[32:35], a[48:55], v2
    v_smfmac_f32_16x16x64_bf16 v[60:63], v[32:35], a[128:135], v2
    s_cbranch_vccnz Lc0s_DfF2
    s_branch Lc0s_DfK2
Lc0s_DfF341:
    buffer_load_dwordx4 v[40:43], v0, s[4:7], s67 offen offset:3072 sc1
    s_waitcnt vmcnt(2)
    v_cmp_u_f32 vcc, v44, v46
    s_cbranch_vccnz Lc0s_DfF413
Lc0s_DfK413:
    v_smfmac_f32_16x16x64_bf16 v[48:51], v[44:47], a[32:39], v2
    s_waitcnt vmcnt(1)
    v_cmp_u_f32 vcc, v32, v34
    v_smfmac_f32_16x16x64_bf16 v[52:55], v[44:47], a[112:119], v2
    v_smfmac_f32_16x16x64_bf16 v[56:59], v[44:47], a[72:79], v2
    v_smfmac_f32_16x16x64_bf16 v[60:63], v[44:47], a[152:159], v2
    s_cbranch_vccnz Lc0s_DfF13
Lc0s_DfK13:
    v_smfmac_f32_16x16x64_bf16 v[48:51], v[32:35], a[8:15], v2
    s_waitcnt vmcnt(0)
    v_cmp_u_f32 vcc, v40, v42
    v_smfmac_f32_16x16x64_bf16 v[52:55], v[32:35], a[88:95], v2
    v_smfmac_f32_16x16x64_bf16 v[56:59], v[32:35], a[48:55], v2
    v_smfmac_f32_16x16x64_bf16 v[60:63], v[32:35], a[128:135], v2
    s_cbranch_vccnz Lc0s_DfF3
    s_branch Lc0s_DfK3
    s_nop 0
    s_nop 0
    s_nop 0
    s_nop 0
Lc0s_DfF41:
    buffer_load_dwordx4 v[44:47], v0, s[4:7], s68 offen offset:0 sc1
    s_mov_b32 s77, 18
    s_sub_u32 s12, s12, 1
    s_cbranch_scc1 L_abort
    s_and_b32 s52, s12, 15
    s_cbranch_scc0 Lc0s_DfX
    s_waitcnt vmcnt(1)
    v_cmp_u_f32 vcc, v32, v34
    s_cbranch_vccnz Lc0s_DfF14
Lc0s_DfK14:
    v_smfmac_f32_16x16x64_bf16 v[48:51], v[32:35], a[8:15], v2
    s_waitcnt vmcnt(0)
    v_cmp_u_f32 vcc, v44, v46
    v_smfmac_f32_16x16x64_bf16 v[52:55], v[32:35], a[88:95], v2
    v_smfmac_f32_16x16x64_bf16 v[56:59], v[32:35], a[48:55], v2
    v_smfmac_f32_16x16x64_bf16 v[60:63], v[32:35], a[128:135], v2
    s_cbranch_vccnz Lc0s_DfF4
    s_branch Lc0s_DfK4
    s_nop 0
    s_nop 0
Lc0s_DfF342:
    buffer_load_dwordx4 v[40:43], v0, s[4:7], s67 offen offset:3072 sc1
    s_waitcnt vmcnt(2)
    v_cmp_u_f32 vcc, v44, v46
    s_cbranch_vccnz Lc0s_DfF423
Lc0s_DfK423:
    v_smfmac_f32_16x16x64_bf16 v[48:51], v[44:47], a[32:39], v2
    s_waitcnt vmcnt(1)
    v_cmp_u_f32 vcc, v36, v38
    v_smfmac_f32_16x16x64_bf16 v[52:55], v[44:47], a[112:119], v2
    v_smfmac_f32_16x16x64_bf16 v[56:59], v[44:47], a[72:79], v2
    v_smfmac_f32_16x16x64_bf16 v[60:63], v[44:47], a[152:159], v2
    s_cbranch_vccnz Lc0s_DfF23
Lc0s_DfK23:
    v_smfmac_f32_16x16x64_bf16 v[48:51], v[36:39], a[16:23], v2
    s_waitcnt vmcnt(0)
    v_cmp_u_f32 vcc, v40, v42
    v_smfmac_f32_16x16x64_bf16 v[52:55], v[36:39], a[96:103], v2
    v_smfmac_f32_16x16x64_bf16 v[56:59], v[36:39], a[56:63], v2
    v_smfmac_f32_16x16x64_bf16 v[60:63], v[36:39], a[136:143], v2
    s_cbranch_vccnz Lc0s_DfF3
    s_branch Lc0s_DfK3
    s_nop 0
    s_nop 0
    s_nop 0
    s_nop 0
Lc0s_DfF42:
    buffer_load_dwordx4 v[44:47], v0, s[4:7], s68 offen offset:0 sc1
    s_mov_b32 s77, 20
    s_sub_u32 s12, s12, 1
    s_cbranch_scc1 L_abort
    s_and_b32 s52, s12, 15
    s_cbranch_scc0 Lc0s_DfX
    s_waitcnt vmcnt(1)
    v_cmp_u_f32 vcc, v36, v38
    s_cbranch_vccnz Lc0s_DfF24
Lc0s_DfK24:
    v_smfmac_f32_16x16x64_bf16 v[48:51], v[36:39], a[16:23], v2
    s_waitcnt vmcnt(0)
    v_cmp_u_f32 vcc, v44, v46
    v_smfmac_f32_16x16x64_bf16 v[52:55], v[36:39], a[96:103], v2
    v_smfmac_f32_16x16x64_bf16 v[56:59], v[36:39], a[56:63], v2
    v_smfmac_f32_16x16x64_bf16 v[60:63], v[36:39], a[136:143], v2
    s_cbranch_vccnz Lc0s_DfF4
    s_branch Lc0s_DfK4
    s_nop 0
    s_nop 0
Lc0s_DfF43:
    buffer_load_dwordx4 v[44:47], v0, s[4:7], s68 offen offset:0 sc1
    s_mov_b32 s77, 24
    s_sub_u32 s12, s12, 1
    s_cbranch_scc1 L_abort
    s_and_b32 s52, s12, 15
    s_cbranch_scc0 Lc0s_DfX
    s_waitcnt vmcnt(1)
    v_cmp_u_f32 vcc, v40, v42
    s_cbranch_vccnz Lc0s_DfF34
Lc0s_DfK34:
    v_smfmac_f32_16x16x64_bf16 v[48:51], v[40:43], a[24:31], v2
    s_waitcnt vmcnt(0)
    v_cmp_u_f32 vcc, v44, v46
    v_smfmac_f32_16x16x64_bf16 v[52:55], v[40:43], a[104:111], v2
    v_smfmac_f32_16x16x64_bf16 v[56:59], v[40:43], a[64:71], v2
    v_smfmac_f32_16x16x64_bf16 v[60:63], v[40:43], a[144:151], v2
    s_cbranch_vccnz Lc0s_DfF4
    s_branch Lc0s_DfK4
    s_nop 0
    s_nop 0
Lc0s_DfF23401:
    buffer_load_dwordx4 v[36:39], v0, s[4:7], s67 offen offset:2048 sc1
    s_waitcnt vmcnt(4)
    v_cmp_u_f32 vcc, v40, v42
    s_cbranch_vccnz Lc0s_DfF34012
Lc0s_DfK34012:
    v_smfmac_f32_16x16x64_bf16 v[48:51], v[40:43], a[24:31], v2
    s_waitcnt vmcnt(3)
    v_cmp_u_f32 vcc, v44, v46
    v_smfmac_f32_16x16x64_bf16 v[52:55], v[40:43], a[104:111], v2
    v_smfmac_f32_16x16x64_bf16 v[56:59], v[40:43], a[64:71], v2
    v_smfmac_f32_16x16x64_bf16 v[60:63], v[40:43], a[144:151], v2
    s_cbranch_vccnz Lc0s_DfF4012
Lc0s_DfK4012:
    v_smfmac_f32_16x16x64_bf16 v[48:51], v[44:47], a[32:39], v2
    s_waitcnt vmcnt(2)
    v_cmp_u_f32 vcc, v28, v30
    v_smfmac_f32_16x16x64_bf16 v[52:55], v[44:47], a[112:119], v2
    v_smfmac_f32_16x16x64_bf16 v[56:59], v[44:47], a[72:79], v2
    v_smfmac_f32_16x16x64_bf16 v[60:63], v[44:47], a[152:159], v2
    s_cbranch_vccnz Lc0s_DfF012
Lc0s_DfK012:
    v_smfmac_f32_16x16x64_bf16 v[48:51], v[28:31], a[0:7], v2
    s_waitcnt vmcnt(1)
    v_cmp_u_f32_e64 vcc, v32, v34
    v_smfmac_f32_16x16x64_bf16 v[52:55], v[28:31], a[80:87], v2
    v_smfmac_f32_16x16x64_bf16 v[56:59], v[28:31], a[40:47], v2
    v_smfmac_f32_16x16x64_bf16 v[60:63], v[28:31], a[120:127], v2
    s_cbranch_vccz Lc0s_DfK12
Lc0s_DfF12:
    buffer_load_dwordx4 v[32:35], v0, s[4:7], s67 offen offset:1024 sc1
    s_waitcnt vmcnt(1)
    v_cmp_u_f32 vcc, v36, v38
    s_cbranch_vccnz Lc0s_DfF21
Lc0s_DfK21:
    v_smfmac_f32_16x16x64_bf16 v[48:51], v[36:39], a[16:23], v2
    s_waitcnt vmcnt(0)
    v_cmp_u_f32 vcc, v32, v34
    v_smfmac_f32_16x16x64_bf16 v[52:55], v[36:39], a[96:103], v2
    v_smfmac_f32_16x16x64_bf16 v[56:59], v[36:39], a[56:63], v2
    v_smfmac_f32_16x16x64_bf16 v[60:63], v[36:39], a[136:143], v2
    s_cbranch_vccnz Lc0s_DfF1
    s_branch Lc0s_DfK1
Lc0s_DfF3401:
    buffer_load_dwordx4 v[40:43], v0, s[4:7], s67 offen offset:3072 sc1
    s_waitcnt vmcnt(3)
    v_cmp_u_f32 vcc, v44, v46
    s_cbranch_vccnz Lc0s_DfF4013
Lc0s_DfK4013:
    v_smfmac_f32_16x16x64_bf16 v[48:51], v[44:47], a[32:39], v2
    s_waitcnt vmcnt(2)
    v_cmp_u_f32 vcc, v28, v30
    v_smfmac_f32_16x16x64_bf16 v[52:55], v[44:47], a[112:119], v2
    v_smfmac_f32_16x16x64_bf16 v[56:59], v[44:47], a[72:79], v2
    v_smfmac_f32_16x16x64_bf16 v[60:63], v[44:47], a[152:159], v2
    s_cbranch_vccnz Lc0s_DfF013
Lc0s_DfK013:
    v_smfmac_f32_16x16x64_bf16 v[48:51], v[28:31], a[0:7], v2
    s_waitcnt vmcnt(1)
    v_cmp_u_f32 vcc, v32, v34
    v_smfmac_f32_16x16x64_bf16 v[52:55], v[28:31], a[80:87], v2
    v_smfmac_f32_16x16x64_bf16 v[56:59], v[28:31], a[40:47], v2
    v_smfmac_f32_16x16x64_bf16 v[60:63], v[28:31], a[120:127], v2
    s_cbranch_vccz Lc0s_DfK13
Lc0s_DfF13:
    buffer_load_dwordx4 v[32:35], v0, s[4:7], s67 offen offset:1024 sc1
    s_waitcnt vmcnt(1)
    v_cmp_u_f32 vcc, v40, v42
    s_cbranch_vccnz Lc0s_DfF31
Lc0s_DfK31:
    v_smfmac_f32_16x16x64_bf16 v[48:51], v[40:43], a[24:31], v2
    s_waitcnt vmcnt(0)
    v_cmp_u_f32 vcc, v32, v34
    v_smfmac_f32_16x16x64_bf16 v[52:55], v[40:43], a[104:111], v2
    v_smfmac_f32_16x16x64_bf16 v[56:59], v[40:43], a[64:71], v2
    v_smfmac_f32_16x16x64_bf16 v[60:63], v[40:43], a[144:151], v2
    s_cbranch_vccnz Lc0s_DfF1
    s_branch Lc0s_DfK1
    s_nop 0
    s_nop 0
    s_nop 0
    s_nop 0
Lc0s_DfF401:
    buffer_load_dwordx4 v[44:47], v0, s[4:7], s68 offen offset:0 sc1
    s_mov_b32 s77, 19
    s_sub_u32 s12, s12, 1
    s_cbranch_scc1 L_abort
    s_and_b32 s52, s12, 15
    s_cbranch_scc0 Lc0s_DfX
    s_waitcnt vmcnt(2)
    v_cmp_u_f32 vcc, v28, v30
    s_cbranch_vccnz Lc0s_DfF014
Lc0s_DfK014:
    v_smfmac_f32_16x16x64_bf16 v[48:51], v[28:31], a[0:7], v2
    s_waitcnt vmcnt(1)
    v_cmp_u_f32 vcc, v32, v34
    v_smfmac_f32_16x16x64_bf16 v[52:55], v[28:31], a[80:87], v2
    v_smfmac_f32_16x16x64_bf16 v[56:59], v[28:31], a[40:47], v2
    v_smfmac_f32_16x16x64_bf16 v[60:63], v[28:31], a[120:127], v2
    s_cbranch_vccz Lc0s_DfK14
Lc0s_DfF14:
    buffer_load_dwordx4 v[32:35], v0, s[4:7], s67 offen offset:1024 sc1
    s_waitcnt vmcnt(1)
    v_cmp_u_f32 vcc, v44, v46
    s_cbranch_vccnz Lc0s_DfF41
    s_branch Lc0s_DfK41
    s_nop 0
    s_nop 0
    s_nop 0
    s_nop 0
    s_nop 0
Lc0s_DfF01:
    buffer_load_dwordx4 v[28:31], v0, s[4:7], s67 offen offset:0 sc1
    s_waitcnt vmcnt(1)
    v_cmp_u_f32 vcc, v32, v34
    s_cbranch_vccnz Lc0s_DfF10
Lc0s_DfK10:
    v_smfmac_f32_16x16x64_bf16 v[48:51], v[32:35], a[8:15], v2
    s_waitcnt vmcnt(0)
    v_cmp_u_f32 vcc, v28, v30
    v_smfmac_f32_16x16x64_bf16 v[52:55], v[32:35], a[88:95], v2
    v_smfmac_f32_16x16x64_bf16 v[56:59], v[32:35], a[48:55], v2
    v_smfmac_f32_16x16x64_bf16 v[60:63], v[32:35], a[128:135], v2
    s_cbranch_vccnz Lc0s_DfF0
    s_branch Lc0s_DfK0
    s_nop 0
    s_nop 0
    s_nop 0
    s_nop 0
    s_nop 0
    s_nop 0
    s_nop 0
Lc0s_DfF3402:
    buffer_load_dwordx4 v[40:43], v0, s[4:7], s67 offen offset:3072 sc1
    s_waitcnt vmcnt(3)
    v_cmp_u_f32 vcc, v44, v46
    s_cbranch_vccnz Lc0s_DfF4023
Lc0s_DfK4023:
    v_smfmac_f32_16x16x64_bf16 v[48:51], v[44:47], a[32:39], v2
    s_waitcnt vmcnt(2)
    v_cmp_u_f32 vcc, v28, v30
    v_smfmac_f32_16x16x64_bf16 v[52:55], v[44:47], a[112:119], v2
    v_smfmac_f32_16x16x64_bf16 v[56:59], v[44:47], a[72:79], v2
    v_smfmac_f32_16x16x64_bf16 v[60:63], v[44:47], a[152:159], v2
    s_cbranch_vccnz Lc0s_DfF023
Lc0s_DfK023:
    v_smfmac_f32_16x16x64_bf16 v[48:51], v[28:31], a[0:7], v2
    s_waitcnt vmcnt(1)
    v_cmp_u_f32 vcc, v36, v38
    v_smfmac_f32_16x16x64_bf16 v[52:55], v[28:31], a[80:87], v2
    v_smfmac_f32_16x16x64_bf16 v[56:59], v[28:31], a[40:47], v2
    v_smfmac_f32_16x16x64_bf16 v[60:63], v[28:31], a[120:127], v2
    s_cbranch_vccz Lc0s_DfK23
Lc0s_DfF23:
    buffer_load_dwordx4 v[36:39], v0, s[4:7], s67 offen offset:2048 sc1
    s_waitcnt vmcnt(1)
    v_cmp_u_f32 vcc, v40, v42
    s_cbranch_vccnz Lc0s_DfF32
Lc0s_DfK32:
    v_smfmac_f32_16x16x64_bf16 v[48:51], v[40:43], a[24:31], v2
    s_waitcnt vmcnt(0)
    v_cmp_u_f32 vcc, v36, v38
    v_smfmac_f32_16x16x64_bf16 v[52:55], v[40:43], a[104:111], v2
    v_smfmac_f32_16x16x64_bf16 v[56:59], v[40:43], a[64:71], v2
    v_smfmac_f32_16x16x64_bf16 v[60:63], v[40:43], a[144:151], v2
    s_cbranch_vccnz Lc0s_DfF2
    s_branch Lc0s_DfK2
    s_nop 0
    s_nop 0
    s_nop 0
    s_nop 0
Lc0s_DfF402:
    buffer_load_dwordx4 v[44:47], v0, s[4:7], s68 offen offset:0 sc1
    s_mov_b32 s77, 21
    s_sub_u32 s12, s12, 1
    s_cbranch_scc1 L_abort
    s_and_b32 s52, s12, 15
    s_cbranch_scc0 Lc0s_DfX
    s_waitcnt vmcnt(2)
    v_cmp_u_f32 vcc, v28, v30
    s_cbranch_vccnz Lc0s_DfF024
Lc0s_DfK024:
    v_smfmac_f32_16x16x64_bf16 v[48:51], v[28:31], a[0:7], v2
    s_waitcnt vmcnt(1)
    v_cmp_u_f32 vcc, v36, v38
    v_smfmac_f32_16x16x64_bf16 v[52:55], v[28:31], a[80:87], v2
    v_smfmac_f32_16x16x64_bf16 v[56:59], v[28:31], a[40:47], v2
    v_smfmac_f32_16x16x64_bf16 v[60:63], v[28:31], a[120:127], v2
    s_cbranch_vccz Lc0s_DfK24
Lc0s_DfF24:
    buffer_load_dwordx4 v[36:39], v0, s[4:7], s67 offen offset:2048 sc1
    s_waitcnt vmcnt(1)
    v_cmp_u_f32 vcc, v44, v46
    s_cbranch_vccnz Lc0s_DfF42
    s_branch Lc0s_DfK42
    s_nop 0
    s_nop 0
    s_nop 0
    s_nop 0
    s_nop 0
Lc0s_DfF02:
    buffer_load_dwordx4 v[28:31], v0, s[4:7], s67 offen offset:0 sc1
    s_waitcnt vmcnt(1)
    v_cmp_u_f32 vcc, v36, v38
    s_cbranch_vccnz Lc0s_DfF20
Lc0s_DfK20:
    v_smfmac_f32_16x16x64_bf16 v[48:51], v[36:39], a[16:23], v2
    s_waitcnt vmcnt(0)
    v_cmp_u_f32 vcc, v28, v30
    v_smfmac_f32_16x16x64_bf16 v[52:55], v[36:39], a[96:103], v2
    v_smfmac_f32_16x16x64_bf16 v[56:59], v[36:39], a[56:63], v2
    v_smfmac_f32_16x16x64_bf16 v[60:63], v[36:39], a[136:143], v2
    s_cbranch_vccnz Lc0s_DfF0
    s_branch Lc0s_DfK0
    s_nop 0
    s_nop 0
    s_nop 0
    s_nop 0
    s_nop 0
    s_nop 0
    s_nop 0
Lc0s_DfF403:
    buffer_load_dwordx4 v[44:47], v0, s[4:7], s68 offen offset:0 sc1
    s_mov_b32 s77, 25
    s_sub_u32 s12, s12, 1
    s_cbranch_scc1 L_abort
    s_and_b32 s52, s12, 15
    s_cbranch_scc0 Lc0s_DfX
    s_waitcnt vmcnt(2)
    v_cmp_u_f32 vcc, v28, v30
    s_cbranch_vccnz Lc0s_DfF034
Lc0s_DfK034:
    v_smfmac_f32_16x16x64_bf16 v[48:51], v[28:31], a[0:7], v2
    s_waitcnt vmcnt(1)
    v_cmp_u_f32 vcc, v40, v42
    v_smfmac_f32_16x16x64_bf16 v[52:55], v[28:31], a[80:87], v2
    v_smfmac_f32_16x16x64_bf16 v[56:59], v[28:31], a[40:47], v2
    v_smfmac_f32_16x16x64_bf16 v[60:63], v[28:31], a[120:127], v2
    s_cbranch_vccnz Lc0s_DfF34
    s_branch Lc0s_DfK34
    s_nop 0
    s_nop 0
Lc0s_DfF03:
    buffer_load_dwordx4 v[28:31], v0, s[4:7], s67 offen offset:0 sc1
    s_waitcnt vmcnt(1)
    v_cmp_u_f32 vcc, v40, v42
    s_cbranch_vccnz Lc0s_DfF30
Lc0s_DfK30:
    v_smfmac_f32_16x16x64_bf16 v[48:51], v[40:43], a[24:31], v2
    s_waitcnt vmcnt(0)
    v_cmp_u_f32 vcc, v28, v30
    v_smfmac_f32_16x16x64_bf16 v[52:55], v[40:43], a[104:111], v2
    v_smfmac_f32_16x16x64_bf16 v[56:59], v[40:43], a[64:71], v2
    v_smfmac_f32_16x16x64_bf16 v[60:63], v[40:43], a[144:151], v2
    s_cbranch_vccnz Lc0s_DfF0
    s_branch Lc0s_DfK0
    s_nop 0
    s_nop 0
    s_nop 0
    s_nop 0
    s_nop 0
    s_nop 0
    s_nop 0
Lc0s_DfF04:
    buffer_load_dwordx4 v[28:31], v0, s[4:7], s67 offen offset:0 sc1
    s_waitcnt vmcnt(1)
    v_cmp_u_f32 vcc, v44, v46
    s_cbranch_vccnz Lc0s_DfF40
    s_branch Lc0s_DfK40
    s_nop 0
    s_nop 0
Lc0s_DfF3412:
    buffer_load_dwordx4 v[40:43], v0, s[4:7], s67 offen offset:3072 sc1
    s_waitcnt vmcnt(3)
    v_cmp_u_f32 vcc, v44, v46
    s_cbranch_vccnz Lc0s_DfF4123
Lc0s_DfK4123:
    v_smfmac_f32_16x16x64_bf16 v[48:51], v[44:47], a[32:39], v2
    s_waitcnt vmcnt(2)
    v_cmp_u_f32 vcc, v32, v34
    v_smfmac_f32_16x16x64_bf16 v[52:55], v[44:47], a[112:119], v2
    v_smfmac_f32_16x16x64_bf16 v[56:59], v[44:47], a[72:79], v2
    v_smfmac_f32_16x16x64_bf16 v[60:63], v[44:47], a[152:159], v2
    s_cbranch_vccnz Lc0s_DfF123
Lc0s_DfK123:
    v_smfmac_f32_16x16x64_bf16 v[48:51], v[32:35], a[8:15], v2
    s_waitcnt vmcnt(1)
    v_cmp_u_f32 vcc, v36, v38
    v_smfmac_f32_16x16x64_bf16 v[52:55], v[32:35], a[88:95], v2
    v_smfmac_f32_16x16x64_bf16 v[56:59], v[32:35], a[48:55], v2
    v_smfmac_f32_16x16x64_bf16 v[60:63], v[32:35], a[128:135], v2
    s_cbranch_vccnz Lc0s_DfF23
    s_branch Lc0s_DfK23
    s_nop 0
    s_nop 0
    s_nop 0
    s_nop 0
Lc0s_DfF412:
    buffer_load_dwordx4 v[44:47], v0, s[4:7], s68 offen offset:0 sc1
    s_mov_b32 s77, 22
    s_sub_u32 s12, s12, 1
    s_cbranch_scc1 L_abort
    s_and_b32 s52, s12, 15
    s_cbranch_scc0 Lc0s_DfX
    s_waitcnt vmcnt(2)
    v_cmp_u_f32 vcc, v32, v34
    s_cbranch_vccnz Lc0s_DfF124
Lc0s_DfK124:
    v_smfmac_f32_16x16x64_bf16 v[48:51], v[32:35], a[8:15], v2
    s_waitcnt vmcnt(1)
    v_cmp_u_f32 vcc, v36, v38
    v_smfmac_f32_16x16x64_bf16 v[52:55], v[32:35], a[88:95], v2
    v_smfmac_f32_16x16x64_bf16 v[56:59], v[32:35], a[48:55], v2
    v_smfmac_f32_16x16x64_bf16 v[60:63], v[32:35], a[128:135], v2
    s_cbranch_vccnz Lc0s_DfF24
    s_branch Lc0s_DfK24
    s_nop 0
    s_nop 0
Lc0s_DfF413:
    buffer_load_dwordx4 v[44:47], v0, s[4:7], s68 offen offset:0 sc1
    s_mov_b32 s77, 26
    s_sub_u32 s12, s12, 1
    s_cbranch_scc1 L_abort
    s_and_b32 s52, s12, 15
    s_cbranch_scc0 Lc0s_DfX
    s_waitcnt vmcnt(2)
    v_cmp_u_f32 vcc, v32, v34
    s_cbranch_vccnz Lc0s_DfF134
Lc0s_DfK134:
    v_smfmac_f32_16x16x64_bf16 v[48:51], v[32:35], a[8:15], v2
    s_waitcnt vmcnt(1)
    v_cmp_u_f32 vcc, v40, v42
    v_smfmac_f32_16x16x64_bf16 v[52:55], v[32:35], a[88:95], v2
    v_smfmac_f32_16x16x64_bf16 v[56:59], v[32:35], a[48:55], v2
    v_smfmac_f32_16x16x64_bf16 v[60:63], v[32:35], a[128:135], v2
    s_cbranch_vccnz Lc0s_DfF34
    s_branch Lc0s_DfK34
    s_nop 0
    s_nop 0
Lc0s_DfF423:
    buffer_load_dwordx4 v[44:47], v0, s[4:7], s68 offen offset:0 sc1
    s_mov_b32 s77, 28
    s_sub_u32 s12, s12, 1
    s_cbranch_scc1 L_abort
    s_and_b32 s52, s12, 15
    s_cbranch_scc0 Lc0s_DfX
    s_waitcnt vmcnt(2)
    v_cmp_u_f32 vcc, v36, v38
    s_cbranch_vccnz Lc0s_DfF234
Lc0s_DfK234:
    v_smfmac_f32_16x16x64_bf16 v[48:51], v[36:39], a[16:23], v2
    s_waitcnt vmcnt(1)
    v_cmp_u_f32 vcc, v40, v42
    v_smfmac_f32_16x16x64_bf16 v[52:55], v[36:39], a[96:103], v2
    v_smfmac_f32_16x16x64_bf16 v[56:59], v[36:39], a[56:63], v2
    v_smfmac_f32_16x16x64_bf16 v[60:63], v[36:39], a[136:143], v2
    s_cbranch_vccnz Lc0s_DfF34
    s_branch Lc0s_DfK34
    s_nop 0
    s_nop 0
Lc0s_DfF34012:
    buffer_load_dwordx4 v[40:43], v0, s[4:7], s67 offen offset:3072 sc1
    s_waitcnt vmcnt(4)
    v_cmp_u_f32 vcc, v44, v46
    s_cbranch_vccnz Lc0s_DfF40123
Lc0s_DfK40123:
    v_smfmac_f32_16x16x64_bf16 v[48:51], v[44:47], a[32:39], v2
    s_waitcnt vmcnt(3)
    v_cmp_u_f32 vcc, v28, v30
    v_smfmac_f32_16x16x64_bf16 v[52:55], v[44:47], a[112:119], v2
    v_smfmac_f32_16x16x64_bf16 v[56:59], v[44:47], a[72:79], v2
    v_smfmac_f32_16x16x64_bf16 v[60:63], v[44:47], a[152:159], v2
    s_cbranch_vccnz Lc0s_DfF0123
Lc0s_DfK0123:
    v_smfmac_f32_16x16x64_bf16 v[48:51], v[28:31], a[0:7], v2
    s_waitcnt vmcnt(2)
    v_cmp_u_f32 vcc, v32, v34
    v_smfmac_f32_16x16x64_bf16 v[52:55], v[28:31], a[80:87], v2
    v_smfmac_f32_16x16x64_bf16 v[56:59], v[28:31], a[40:47], v2
    v_smfmac_f32_16x16x64_bf16 v[60:63], v[28:31], a[120:127], v2
    s_cbranch_vccz Lc0s_DfK123
Lc0s_DfF123:
    buffer_load_dwordx4 v[32:35], v0, s[4:7], s67 offen offset:1024 sc1
    s_waitcnt vmcnt(2)
    v_cmp_u_f32 vcc, v36, v38
    s_cbranch_vccnz Lc0s_DfF231
Lc0s_DfK231:
    v_smfmac_f32_16x16x64_bf16 v[48:51], v[36:39], a[16:23], v2
    s_waitcnt vmcnt(1)
    v_cmp_u_f32 vcc, v40, v42
    v_smfmac_f32_16x16x64_bf16 v[52:55], v[36:39], a[96:103], v2
    v_smfmac_f32_16x16x64_bf16 v[56:59], v[36:39], a[56:63], v2
    v_smfmac_f32_16x16x64_bf16 v[60:63], v[36:39], a[136:143], v2
    s_cbranch_vccz Lc0s_DfK31
Lc0s_DfF31:
    buffer_load_dwordx4 v[40:43], v0, s[4:7], s67 offen offset:3072 sc1
    s_mov_b32 s77, 10
    s_sub_u32 s12, s12, 1
    s_cbranch_scc1 L_abort
    s_and_b32 s52, s12, 15
    s_cbranch_scc0 Lc0s_DfX
    s_waitcnt vmcnt(1)
    v_cmp_u_f32 vcc, v32, v34
    s_cbranch_vccnz Lc0s_DfF13
    s_branch Lc0s_DfK13
    s_nop 0
    s_nop 0
Lc0s_DfF4012:
    buffer_load_dwordx4 v[44:47], v0, s[4:7], s68 offen offset:0 sc1
    s_mov_b32 s77, 23
    s_sub_u32 s12, s12, 1
    s_cbranch_scc1 L_abort
    s_and_b32 s52, s12, 15
    s_cbranch_scc0 Lc0s_DfX
    s_waitcnt vmcnt(3)
    v_cmp_u_f32 vcc, v28, v30
    s_cbranch_vccnz Lc0s_DfF0124
Lc0s_DfK0124:
    v_smfmac_f32_16x16x64_bf16 v[48:51], v[28:31], a[0:7], v2
    s_waitcnt vmcnt(2)
    v_cmp_u_f32 vcc, v32, v34
    v_smfmac_f32_16x16x64_bf16 v[52:55], v[28:31], a[80:87], v2
    v_smfmac_f32_16x16x64_bf16 v[56:59], v[28:31], a[40:47], v2
    v_smfmac_f32_16x16x64_bf16 v[60:63], v[28:31], a[120:127], v2
    s_cbranch_vccz Lc0s_DfK124
Lc0s_DfF124:
    buffer_load_dwordx4 v[32:35], v0, s[4:7], s67 offen offset:1024 sc1
    s_waitcnt vmcnt(2)
    v_cmp_u_f32 vcc, v36, v38
    s_cbranch_vccnz Lc0s_DfF241
Lc0s_DfK241:
    v_smfmac_f32_16x16x64_bf16 v[48:51], v[36:39], a[16:23], v2
    s_waitcnt vmcnt(1)
    v_cmp_u_f32 vcc, v44, v46
    v_smfmac_f32_16x16x64_bf16 v[52:55], v[36:39], a[96:103], v2
    v_smfmac_f32_16x16x64_bf16 v[56:59], v[36:39], a[56:63], v2
    v_smfmac_f32_16x16x64_bf16 v[60:63], v[36:39], a[136:143], v2
    s_cbranch_vccnz Lc0s_DfF41
    s_branch Lc0s_DfK41
    s_nop 0
    s_nop 0
Lc0s_DfF012:
    buffer_load_dwordx4 v[28:31], v0, s[4:7], s67 offen offset:0 sc1
    s_waitcnt vmcnt(2)
    v_cmp_u_f32 vcc, v32, v34
    s_cbranch_vccnz Lc0s_DfF120
Lc0s_DfK120:
    v_smfmac_f32_16x16x64_bf16 v[48:51], v[32:35], a[8:15], v2
    s_waitcnt vmcnt(1)
    v_cmp_u_f32 vcc, v36, v38
    v_smfmac_f32_16x16x64_bf16 v[52:55], v[32:35], a[88:95], v2
    v_smfmac_f32_16x16x64_bf16 v[56:59], v[32:35], a[48:55], v2
    v_smfmac_f32_16x16x64_bf16 v[60:63], v[32:35], a[128:135], v2
    s_cbranch_vccz Lc0s_DfK20
Lc0s_DfF20:
    buffer_load_dwordx4 v[36:39], v0, s[4:7], s67 offen offset:2048 sc1
    s_mov_b32 s77, 5
    s_sub_u32 s12, s12, 1
    s_cbranch_scc1 L_abort
    s_and_b32 s52, s12, 15
    s_cbranch_scc0 Lc0s_DfX
    s_waitcnt vmcnt(1)
    v_cmp_u_f32 vcc, v28, v30
    s_cbranch_vccnz Lc0s_DfF02
    s_branch Lc0s_DfK02
    s_nop 0
    s_nop 0
    s_nop 0
    s_nop 0
    s_nop 0
Lc0s_DfF21:
    buffer_load_dwordx4 v[36:39], v0, s[4:7], s67 offen offset:2048 sc1
    s_mov_b32 s77, 6
    s_sub_u32 s12, s12, 1
    s_cbranch_scc1 L_abort
    s_and_b32 s52, s12, 15
    s_cbranch_scc0 Lc0s_DfX
    s_waitcnt vmcnt(1)
    v_cmp_u_f32 vcc, v32, v34
    s_cbranch_vccnz Lc0s_DfF12
    s_branch Lc0s_DfK12
    s_nop 0
    s_nop 0
    s_nop 0
    s_nop 0
    s_nop 0
Lc0s_DfF4013:
    buffer_load_dwordx4 v[44:47], v0, s[4:7], s68 offen offset:0 sc1
    s_mov_b32 s77, 27
    s_sub_u32 s12, s12, 1
    s_cbranch_scc1 L_abort
    s_and_b32 s52, s12, 15
    s_cbranch_scc0 Lc0s_DfX
    s_waitcnt vmcnt(3)
    v_cmp_u_f32 vcc, v28, v30
    s_cbranch_vccnz Lc0s_DfF0134
Lc0s_DfK0134:
    v_smfmac_f32_16x16x64_bf16 v[48:51], v[28:31], a[0:7], v2
    s_waitcnt vmcnt(2)
    v_cmp_u_f32 vcc, v32, v34
    v_smfmac_f32_16x16x64_bf16 v[52:55], v[28:31], a[80:87], v2
    v_smfmac_f32_16x16x64_bf16 v[56:59], v[28:31], a[40:47], v2
    v_smfmac_f32_16x16x64_bf16 v[60:63], v[28:31], a[120:127], v2
    s_cbranch_vccz Lc0s_DfK134
Lc0s_DfF134:
    buffer_load_dwordx4 v[32:35], v0, s[4:7], s67 offen offset:1024 sc1
    s_waitcnt vmcnt(2)
    v_cmp_u_f32 vcc, v40, v42
    s_cbranch_vccnz Lc0s_DfF341
    s_branch Lc0s_DfK341
    s_nop 0
    s_nop 0
    s_nop 0
    s_nop 0
    s_nop 0
Lc0s_DfF013:
    buffer_load_dwordx4 v[28:31], v0, s[4:7], s67 offen offset:0 sc1
    s_waitcnt vmcnt(2)
    v_cmp_u_f32 vcc, v32, v34
    s_cbranch_vccnz Lc0s_DfF130
Lc0s_DfK130:
    v_smfmac_f32_16x16x64_bf16 v[48:51], v[32:35], a[8:15], v2
    s_waitcnt vmcnt(1)
    v_cmp_u_f32 vcc, v40, v42
    v_smfmac_f32_16x16x64_bf16 v[52:55], v[32:35], a[88:95], v2
    v_smfmac_f32_16x16x64_bf16 v[56:59], v[32:35], a[48:55], v2
    v_smfmac_f32_16x16x64_bf16 v[60:63], v[32:35], a[128:135], v2
    s_cbranch_vccz Lc0s_DfK30
Lc0s_DfF30:
    buffer_load_dwordx4 v[40:43], v0, s[4:7], s67 offen offset:3072 sc1
    s_mov_b32 s77, 9
    s_sub_u32 s12, s12, 1
    s_cbranch_scc1 L_abort
    s_and_b32 s52, s12, 15
    s_cbranch_scc0 Lc0s_DfX
    s_waitcnt vmcnt(1)
    v_cmp_u_f32 vcc, v28, v30
    s_cbranch_vccnz Lc0s_DfF03
    s_branch Lc0s_DfK03
    s_nop 0
    s_nop 0
    s_nop 0
    s_nop 0
    s_nop 0
Lc0s_DfF014:
    buffer_load_dwordx4 v[28:31], v0, s[4:7], s67 offen offset:0 sc1
    s_waitcnt vmcnt(2)
    v_cmp_u_f32 vcc, v32, v34
    s_cbranch_vccnz Lc0s_DfF140
Lc0s_DfK140:
    v_smfmac_f32_16x16x64_bf16 v[48:51], v[32:35], a[8:15], v2
    s_waitcnt vmcnt(1)
    v_cmp_u_f32 vcc, v44, v46
    v_smfmac_f32_16x16x64_bf16 v[52:55], v[32:35], a[88:95], v2
    v_smfmac_f32_16x16x64_bf16 v[56:59], v[32:35], a[48:55], v2
    v_smfmac_f32_16x16x64_bf16 v[60:63], v[32:35], a[128:135], v2
    s_cbranch_vccnz Lc0s_DfF40
    s_branch Lc0s_DfK40
    s_nop 0
    s_nop 0
    s_nop 0
    s_nop 0
    s_nop 0
    s_nop 0
    s_nop 0
Lc0s_DfF10:
    buffer_load_dwordx4 v[32:35], v0, s[4:7], s67 offen offset:1024 sc1
    s_mov_b32 s77, 3
    s_sub_u32 s12, s12, 1
    s_cbranch_scc1 L_abort
    s_and_b32 s52, s12, 15
    s_cbranch_scc0 Lc0s_DfX
    s_waitcnt vmcnt(1)
    v_cmp_u_f32 vcc, v28, v30
    s_cbranch_vccnz Lc0s_DfF01
    s_branch Lc0s_DfK01
    s_nop 0
    s_nop 0
    s_nop 0
    s_nop 0
    s_nop 0
Lc0s_DfF4023:
    buffer_load_dwordx4 v[44:47], v0, s[4:7], s68 offen offset:0 sc1
    s_mov_b32 s77, 29
    s_sub_u32 s12, s12, 1
    s_cbranch_scc1 L_abort
    s_and_b32 s52, s12, 15
    s_cbranch_scc0 Lc0s_DfX
    s_waitcnt vmcnt(3)
    v_cmp_u_f32 vcc, v28, v30
    s_cbranch_vccnz Lc0s_DfF0234
Lc0s_DfK0234:
    v_smfmac_f32_16x16x64_bf16 v[48:51], v[28:31], a[0:7], v2
    s_waitcnt vmcnt(2)
    v_cmp_u_f32 vcc, v36, v38
    v_smfmac_f32_16x16x64_bf16 v[52:55], v[28:31], a[80:87], v2
    v_smfmac_f32_16x16x64_bf16 v[56:59], v[28:31], a[40:47], v2
    v_smfmac_f32_16x16x64_bf16 v[60:63], v[28:31], a[120:127], v2
    s_cbranch_vccnz Lc0s_DfF234
    s_branch Lc0s_DfK234
    s_nop 0
    s_nop 0
Lc0s_DfF023:
    buffer_load_dwordx4 v[28:31], v0, s[4:7], s67 offen offset:0 sc1
    s_waitcnt vmcnt(2)
    v_cmp_u_f32 vcc, v36, v38
    s_cbranch_vccnz Lc0s_DfF230
Lc0s_DfK230:
    v_smfmac_f32_16x16x64_bf16 v[48:51], v[36:39], a[16:23], v2
    s_waitcnt vmcnt(1)
    v_cmp_u_f32 vcc, v40, v42
    v_smfmac_f32_16x16x64_bf16 v[52:55], v[36:39], a[96:103], v2
    v_smfmac_f32_16x16x64_bf16 v[56:59], v[36:39], a[56:63], v2
    v_smfmac_f32_16x16x64_bf16 v[60:63], v[36:39], a[136:143], v2
    s_cbranch_vccnz Lc0s_DfF30
    s_branch Lc0s_DfK30
    s_nop 0
    s_nop 0
    s_nop 0
    s_nop 0
    s_nop 0
    s_nop 0
    s_nop 0
Lc0s_DfF32:
    buffer_load_dwordx4 v[40:43], v0, s[4:7], s67 offen offset:3072 sc1
    s_mov_b32 s77, 12
    s_sub_u32 s12, s12, 1
    s_cbranch_scc1 L_abort
    s_and_b32 s52, s12, 15
    s_cbranch_scc0 Lc0s_DfX
    s_waitcnt vmcnt(1)
    v_cmp_u_f32 vcc, v36, v38
    s_cbranch_vccnz Lc0s_DfF23
    s_branch Lc0s_DfK23
    s_nop 0
    s_nop 0
    s_nop 0
    s_nop 0
    s_nop 0
Lc0s_DfF024:
    buffer_load_dwordx4 v[28:31], v0, s[4:7], s67 offen offset:0 sc1
    s_waitcnt vmcnt(2)
    v_cmp_u_f32 vcc, v36, v38
    s_cbranch_vccnz Lc0s_DfF240
Lc0s_DfK240:
    v_smfmac_f32_16x16x64_bf16 v[48:51], v[36:39], a[16:23], v2
    s_waitcnt vmcnt(1)
    v_cmp_u_f32 vcc, v44, v46
    v_smfmac_f32_16x16x64_bf16 v[52:55], v[36:39], a[96:103], v2
    v_smfmac_f32_16x16x64_bf16 v[56:59], v[36:39], a[56:63], v2
    v_smfmac_f32_16x16x64_bf16 v[60:63], v[36:39], a[136:143], v2
    s_cbranch_vccnz Lc0s_DfF40
    s_branch Lc0s_DfK40
    s_nop 0
    s_nop 0
    s_nop 0
    s_nop 0
    s_nop 0
    s_nop 0
    s_nop 0
Lc0s_DfF034:
    buffer_load_dwordx4 v[28:31], v0, s[4:7], s67 offen offset:0 sc1
    s_waitcnt vmcnt(2)
    v_cmp_u_f32 vcc, v40, v42
    s_cbranch_vccnz Lc0s_DfF340
    s_branch Lc0s_DfK340
    s_nop 0
    s_nop 0
Lc0s_DfF4123:
    buffer_load_dwordx4 v[44:47], v0, s[4:7], s68 offen offset:0 sc1
    s_mov_b32 s77, 30
    s_sub_u32 s12, s12, 1
    s_cbranch_scc1 L_abort
    s_and_b32 s52, s12, 15
    s_cbranch_scc0 Lc0s_DfX
    s_waitcnt vmcnt(3)
    v_cmp_u_f32 vcc, v32, v34
    s_cbranch_vccnz Lc0s_DfF1234
Lc0s_DfK1234:
    v_smfmac_f32_16x16x64_bf16 v[48:51], v[32:35], a[8:15], v2
    s_waitcnt vmcnt(2)
    v_cmp_u_f32 vcc, v36, v38
    v_smfmac_f32_16x16x64_bf16 v[52:55], v[32:35], a[88:95], v2
    v_smfmac_f32_16x16x64_bf16 v[56:59], v[32:35], a[48:55], v2
    v_smfmac_f32_16x16x64_bf16 v[60:63], v[32:35], a[128:135], v2
    s_cbranch_vccnz Lc0s_DfF234
    s_branch Lc0s_DfK234
    s_nop 0
    s_nop 0
Lc0s_DfF40123:
    buffer_load_dwordx4 v[44:47], v0, s[4:7], s68 offen offset:0 sc1
    s_mov_b32 s77, 31
    s_sub_u32 s12, s12, 1
    s_cbranch_scc1 L_abort
    s_and_b32 s52, s12, 15
    s_cbranch_scc0 Lc0s_DfX
    s_waitcnt vmcnt(4)
    v_cmp_u_f32 vcc, v28, v30
    s_cbranch_vccnz Lc0s_DfF01234
Lc0s_DfK01234:
    v_smfmac_f32_16x16x64_bf16 v[48:51], v[28:31], a[0:7], v2
    s_waitcnt vmcnt(3)
    v_cmp_u_f32 vcc, v32, v34
    v_smfmac_f32_16x16x64_bf16 v[52:55], v[28:31], a[80:87], v2
    v_smfmac_f32_16x16x64_bf16 v[56:59], v[28:31], a[40:47], v2
    v_smfmac_f32_16x16x64_bf16 v[60:63], v[28:31], a[120:127], v2
    s_cbranch_vccnz Lc0s_DfF1234
    s_branch Lc0s_DfK1234
    s_nop 0
    s_nop 0
Lc0s_DfF0123:
    buffer_load_dwordx4 v[28:31], v0, s[4:7], s67 offen offset:0 sc1
    s_waitcnt vmcnt(3)
    v_cmp_u_f32 vcc, v32, v34
    s_cbranch_vccnz Lc0s_DfF1230
Lc0s_DfK1230:
    v_smfmac_f32_16x16x64_bf16 v[48:51], v[32:35], a[8:15], v2
    s_waitcnt vmcnt(2)
    v_cmp_u_f32 vcc, v36, v38
    v_smfmac_f32_16x16x64_bf16 v[52:55], v[32:35], a[88:95], v2
    v_smfmac_f32_16x16x64_bf16 v[56:59], v[32:35], a[48:55], v2
    v_smfmac_f32_16x16x64_bf16 v[60:63], v[32:35], a[128:135], v2
    s_cbranch_vccz Lc0s_DfK230
Lc0s_DfF230:
    buffer_load_dwordx4 v[36:39], v0, s[4:7], s67 offen offset:2048 sc1
    s_waitcnt vmcnt(2)
    v_cmp_u_f32 vcc, v40, v42
    s_cbranch_vccnz Lc0s_DfF302
Lc0s_DfK302:
    v_smfmac_f32_16x16x64_bf16 v[48:51], v[40:43], a[24:31], v2
    s_waitcnt vmcnt(1)
    v_cmp_u_f32 vcc, v28, v30
    v_smfmac_f32_16x16x64_bf16 v[52:55], v[40:43], a[104:111], v2
    v_smfmac_f32_16x16x64_bf16 v[56:59], v[40:43], a[64:71], v2
    v_smfmac_f32_16x16x64_bf16 v[60:63], v[40:43], a[144:151], v2
    s_cbranch_vccnz Lc0s_DfF02
    s_branch Lc0s_DfK02
    s_nop 0
    s_nop 0
    s_nop 0
    s_nop 0
    s_nop 0
    s_nop 0
    s_nop 0
Lc0s_DfF231:
    buffer_load_dwordx4 v[36:39], v0, s[4:7], s67 offen offset:2048 sc1
    s_waitcnt vmcnt(2)
    v_cmp_u_f32 vcc, v40, v42
    s_cbranch_vccnz Lc0s_DfF312
Lc0s_DfK312:
    v_smfmac_f32_16x16x64_bf16 v[48:51], v[40:43], a[24:31], v2
    s_waitcnt vmcnt(1)
    v_cmp_u_f32 vcc, v32, v34
    v_smfmac_f32_16x16x64_bf16 v[52:55], v[40:43], a[104:111], v2
    v_smfmac_f32_16x16x64_bf16 v[56:59], v[40:43], a[64:71], v2
    v_smfmac_f32_16x16x64_bf16 v[60:63], v[40:43], a[144:151], v2
    s_cbranch_vccnz Lc0s_DfF12
    s_branch Lc0s_DfK12
    s_nop 0
    s_nop 0
    s_nop 0
    s_nop 0
    s_nop 0
    s_nop 0
    s_nop 0
Lc0s_DfF0124:
    buffer_load_dwordx4 v[28:31], v0, s[4:7], s67 offen offset:0 sc1
    s_waitcnt vmcnt(3)
    v_cmp_u_f32 vcc, v32, v34
    s_cbranch_vccnz Lc0s_DfF1240
Lc0s_DfK1240:
    v_smfmac_f32_16x16x64_bf16 v[48:51], v[32:35], a[8:15], v2
    s_waitcnt vmcnt(2)
    v_cmp_u_f32 vcc, v36, v38
    v_smfmac_f32_16x16x64_bf16 v[52:55], v[32:35], a[88:95], v2
    v_smfmac_f32_16x16x64_bf16 v[56:59], v[32:35], a[48:55], v2
    v_smfmac_f32_16x16x64_bf16 v[60:63], v[32:35], a[128:135], v2
    s_cbranch_vccz Lc0s_DfK240
Lc0s_DfF240:
    buffer_load_dwordx4 v[36:39], v0, s[4:7], s67 offen offset:2048 sc1
    s_waitcnt vmcnt(2)
    v_cmp_u_f32 vcc, v44, v46
    s_cbranch_vccnz Lc0s_DfF402
    s_branch Lc0s_DfK402
    s_nop 0
    s_nop 0
Lc0s_DfF241:
    buffer_load_dwordx4 v[36:39], v0, s[4:7], s67 offen offset:2048 sc1
    s_waitcnt vmcnt(2)
    v_cmp_u_f32 vcc, v44, v46
    s_cbranch_vccnz Lc0s_DfF412
    s_branch Lc0s_DfK412
    s_nop 0
    s_nop 0
Lc0s_DfF120:
    buffer_load_dwordx4 v[32:35], v0, s[4:7], s67 offen offset:1024 sc1
    s_waitcnt vmcnt(2)
    v_cmp_u_f32 vcc, v36, v38
    s_cbranch_vccnz Lc0s_DfF201
Lc0s_DfK201:
    v_smfmac_f32_16x16x64_bf16 v[48:51], v[36:39], a[16:23], v2
    s_waitcnt vmcnt(1)
    v_cmp_u_f32 vcc, v28, v30
    v_smfmac_f32_16x16x64_bf16 v[52:55], v[36:39], a[96:103], v2
    v_smfmac_f32_16x16x64_bf16 v[56:59], v[36:39], a[56:63], v2
    v_smfmac_f32_16x16x64_bf16 v[60:63], v[36:39], a[136:143], v2
    s_cbranch_vccnz Lc0s_DfF01
    s_branch Lc0s_DfK01
    s_nop 0
    s_nop 0
    s_nop 0
    s_nop 0
    s_nop 0
    s_nop 0
    s_nop 0
Lc0s_DfF0134:
    buffer_load_dwordx4 v[28:31], v0, s[4:7], s67 offen offset:0 sc1
    s_waitcnt vmcnt(3)
    v_cmp_u_f32 vcc, v32, v34
    s_cbranch_vccnz Lc0s_DfF1340
Lc0s_DfK1340:
    v_smfmac_f32_16x16x64_bf16 v[48:51], v[32:35], a[8:15], v2
    s_waitcnt vmcnt(2)
    v_cmp_u_f32 vcc, v40, v42
    v_smfmac_f32_16x16x64_bf16 v[52:55], v[32:35], a[88:95], v2
    v_smfmac_f32_16x16x64_bf16 v[56:59], v[32:35], a[48:55], v2
    v_smfmac_f32_16x16x64_bf16 v[60:63], v[32:35], a[128:135], v2
    s_cbranch_vccnz Lc0s_DfF340
    s_branch Lc0s_DfK340
    s_nop 0
    s_nop 0
    s_nop 0
    s_nop 0
    s_nop 0
    s_nop 0
    s_nop 0
Lc0s_DfF130:
    buffer_load_dwordx4 v[32:35], v0, s[4:7], s67 offen offset:1024 sc1
    s_waitcnt vmcnt(2)
    v_cmp_u_f32 vcc, v40, v42
    s_cbranch_vccnz Lc0s_DfF301
Lc0s_DfK301:
    v_smfmac_f32_16x16x64_bf16 v[48:51], v[40:43], a[24:31], v2
    s_waitcnt vmcnt(1)
    v_cmp_u_f32 vcc, v28, v30
    v_smfmac_f32_16x16x64_bf16 v[52:55], v[40:43], a[104:111], v2
    v_smfmac_f32_16x16x64_bf16 v[56:59], v[40:43], a[64:71], v2
    v_smfmac_f32_16x16x64_bf16 v[60:63], v[40:43], a[144:151], v2
    s_cbranch_vccnz Lc0s_DfF01
    s_branch Lc0s_DfK01
    s_nop 0
    s_nop 0
    s_nop 0
    s_nop 0
    s_nop 0
    s_nop 0
    s_nop 0
Lc0s_DfF140:
    buffer_load_dwordx4 v[32:35], v0, s[4:7], s67 offen offset:1024 sc1
    s_waitcnt vmcnt(2)
    v_cmp_u_f32 vcc, v44, v46
    s_cbranch_vccnz Lc0s_DfF401
    s_branch Lc0s_DfK401
    s_nop 0
    s_nop 0
Lc0s_DfF0234:
    buffer_load_dwordx4 v[28:31], v0, s[4:7], s67 offen offset:0 sc1
    s_waitcnt vmcnt(3)
    v_cmp_u_f32 vcc, v36, v38
    s_cbranch_vccnz Lc0s_DfF2340
    s_branch Lc0s_DfK2340
    s_nop 0
    s_nop 0
Lc0s_DfF1230:
    buffer_load_dwordx4 v[32:35], v0, s[4:7], s67 offen offset:1024 sc1
    s_waitcnt vmcnt(3)
    v_cmp_u_f32 vcc, v36, v38
    s_cbranch_vccnz Lc0s_DfF2301
Lc0s_DfK2301:
    v_smfmac_f32_16x16x64_bf16 v[48:51], v[36:39], a[16:23], v2
    s_waitcnt vmcnt(2)
    v_cmp_u_f32 vcc, v40, v42
    v_smfmac_f32_16x16x64_bf16 v[52:55], v[36:39], a[96:103], v2
    v_smfmac_f32_16x16x64_bf16 v[56:59], v[36:39], a[56:63], v2
    v_smfmac_f32_16x16x64_bf16 v[60:63], v[36:39], a[136:143], v2
    s_cbranch_vccz Lc0s_DfK301
Lc0s_DfF301:
    buffer_load_dwordx4 v[40:43], v0, s[4:7], s67 offen offset:3072 sc1
    s_mov_b32 s77, 11
    s_sub_u32 s12, s12, 1
    s_cbranch_scc1 L_abort
    s_and_b32 s52, s12, 15
    s_cbranch_scc0 Lc0s_DfX
    s_waitcnt vmcnt(2)
    v_cmp_u_f32 vcc, v28, v30
    s_cbranch_vccnz Lc0s_DfF013
    s_branch Lc0s_DfK013
    s_nop 0
    s_nop 0
    s_nop 0
    s_nop 0
    s_nop 0
Lc0s_DfF302:
    buffer_load_dwordx4 v[40:43], v0, s[4:7], s67 offen offset:3072 sc1
    s_mov_b32 s77, 13
    s_sub_u32 s12, s12, 1
    s_cbranch_scc1 L_abort
    s_and_b32 s52, s12, 15
    s_cbranch_scc0 Lc0s_DfX
    s_waitcnt vmcnt(2)
    v_cmp_u_f32 vcc, v28, v30
    s_cbranch_vccnz Lc0s_DfF023
    s_branch Lc0s_DfK023
    s_nop 0
    s_nop 0
    s_nop 0
    s_nop 0
    s_nop 0
Lc0s_DfF312:
    buffer_load_dwordx4 v[40:43], v0, s[4:7], s67 offen offset:3072 sc1
    s_mov_b32 s77, 14
    s_sub_u32 s12, s12, 1
    s_cbranch_scc1 L_abort
    s_and_b32 s52, s12, 15
    s_cbranch_scc0 Lc0s_DfX
    s_waitcnt vmcnt(2)
    v_cmp_u_f32 vcc, v32, v34
    s_cbranch_vccnz Lc0s_DfF123
    s_branch Lc0s_DfK123
    s_nop 0
    s_nop 0
    s_nop 0
    s_nop 0
    s_nop 0
Lc0s_DfF1240:
    buffer_load_dwordx4 v[32:35], v0, s[4:7], s67 offen offset:1024 sc1
    s_waitcnt vmcnt(3)
    v_cmp_u_f32 vcc, v36, v38
    s_cbranch_vccnz Lc0s_DfF2401
Lc0s_DfK2401:
    v_smfmac_f32_16x16x64_bf16 v[48:51], v[36:39], a[16:23], v2
    s_waitcnt vmcnt(2)
    v_cmp_u_f32 vcc, v44, v46
    v_smfmac_f32_16x16x64_bf16 v[52:55], v[36:39], a[96:103], v2
    v_smfmac_f32_16x16x64_bf16 v[56:59], v[36:39], a[56:63], v2
    v_smfmac_f32_16x16x64_bf16 v[60:63], v[36:39], a[136:143], v2
    s_cbranch_vccnz Lc0s_DfF401
    s_branch Lc0s_DfK401
    s_nop 0
    s_nop 0
    s_nop 0
    s_nop 0
    s_nop 0
    s_nop 0
    s_nop 0
Lc0s_DfF201:
    buffer_load_dwordx4 v[36:39], v0, s[4:7], s67 offen offset:2048 sc1
    s_mov_b32 s77, 7
    s_sub_u32 s12, s12, 1
    s_cbranch_scc1 L_abort
    s_and_b32 s52, s12, 15
    s_cbranch_scc0 Lc0s_DfX
    s_waitcnt vmcnt(2)
    v_cmp_u_f32 vcc, v28, v30
    s_cbranch_vccnz Lc0s_DfF012
    s_branch Lc0s_DfK012
    s_nop 0
    s_nop 0
    s_nop 0
    s_nop 0
    s_nop 0
Lc0s_DfF1340:
    buffer_load_dwordx4 v[32:35], v0, s[4:7], s67 offen offset:1024 sc1
    s_waitcnt vmcnt(3)
    v_cmp_u_f32 vcc, v40, v42
    s_cbranch_vccnz Lc0s_DfF3401
    s_branch Lc0s_DfK3401
    s_nop 0
    s_nop 0
Lc0s_DfF2301:
    buffer_load_dwordx4 v[36:39], v0, s[4:7], s67 offen offset:2048 sc1
    s_waitcnt vmcnt(3)
    v_cmp_u_f32 vcc, v40, v42
    s_cbranch_vccnz Lc0s_DfF3012
Lc0s_DfK3012:
    v_smfmac_f32_16x16x64_bf16 v[48:51], v[40:43], a[24:31], v2
    s_waitcnt vmcnt(2)
    v_cmp_u_f32 vcc, v28, v30
    v_smfmac_f32_16x16x64_bf16 v[52:55], v[40:43], a[104:111], v2
    v_smfmac_f32_16x16x64_bf16 v[56:59], v[40:43], a[64:71], v2
    v_smfmac_f32_16x16x64_bf16 v[60:63], v[40:43], a[144:151], v2
    s_cbranch_vccnz Lc0s_DfF012
    s_branch Lc0s_DfK012
    s_nop 0
    s_nop 0
    s_nop 0
    s_nop 0
    s_nop 0
    s_nop 0
    s_nop 0
Lc0s_DfF2401:
    buffer_load_dwordx4 v[36:39], v0, s[4:7], s67 offen offset:2048 sc1
    s_waitcnt vmcnt(3)
    v_cmp_u_f32 vcc, v44, v46
    s_cbranch_vccnz Lc0s_DfF4012
    s_branch Lc0s_DfK4012
    s_nop 0
    s_nop 0
Lc0s_DfF3012:
    buffer_load_dwordx4 v[40:43], v0, s[4:7], s67 offen offset:3072 sc1
    s_mov_b32 s77, 15
    s_sub_u32 s12, s12, 1
    s_cbranch_scc1 L_abort
    s_and_b32 s52, s12, 15
    s_cbranch_scc0 Lc0s_DfX
    s_waitcnt vmcnt(3)
    v_cmp_u_f32 vcc, v28, v30
    s_cbranch_vccnz Lc0s_DfF0123
    s_branch Lc0s_DfK0123
    s_nop 0
    s_nop 0
    s_nop 0
    s_nop 0
    s_nop 0
Lc0s_DfX:
    s_bitcmp1_b32 s77, 0
    s_cbranch_scc0 Lc0s_DfX0n
Lc0s_DfX0:
    buffer_load_dwordx4 v[28:31], v0, s[4:7], s67 offen offset:0 sc1
    s_sub_u32 s12, s12, 1
    s_cbranch_scc1 L_abort
    s_nop 0
    s_waitcnt vmcnt(0)
    v_cmp_eq_u32 s[32:33], s53, v28
    v_cmp_eq_u32 vcc, s53, v30
    s_nop 0
    s_or_b64 s[32:33], s[32:33], vcc
    s_cbranch_scc1 Lc0s_DfX0
    v_smfmac_f32_16x16x64_bf16 v[48:51], v[28:31], a[0:7], v2
    v_smfmac_f32_16x16x64_bf16 v[52:55], v[28:31], a[80:87], v2
    v_smfmac_f32_16x16x64_bf16 v[56:59], v[28:31], a[40:47], v2
    v_smfmac_f32_16x16x64_bf16 v[60:63], v[28:31], a[120:127], v2
Lc0s_DfX0n:
    s_bitcmp1_b32 s77, 1
    s_cbranch_scc0 Lc0s_DfX1n
Lc0s_DfX1:
    buffer_load_dwordx4 v[32:35], v0, s[4:7], s67 offen offset:1024 sc1
    s_sub_u32 s12, s12, 1
    s_cbranch_scc1 L_abort
    s_waitcnt vmcnt(0)
    v_cmp_eq_u32 s[32:33], s53, v32
    v_cmp_eq_u32 vcc, s53, v34
    s_nop 0
    s_or_b64 s[32:33], s[32:33], vcc
    s_cbranch_scc1 Lc0s_DfX1
    v_smfmac_f32_16x16x64_bf16 v[48:51], v[32:35], a[8:15], v2
    v_smfmac_f32_16x16x64_bf16 v[52:55], v[32:35], a[88:95], v2
    v_smfmac_f32_16x16x64_bf16 v[56:59], v[32:35], a[48:55], v2
    v_smfmac_f32_16x16x64_bf16 v[60:63], v[32:35], a[128:135], v2
Lc0s_DfX1n:
    s_bitcmp1_b32 s77, 2
    s_cbranch_scc0 Lc0s_DfX2n
Lc0s_DfX2:
    buffer_load_dwordx4 v[36:39], v0, s[4:7], s67 offen offset:2048 sc1
    s_sub_u32 s12, s12, 1
    s_cbranch_scc1 L_abort
    s_waitcnt vmcnt(0)
    v_cmp_eq_u32 s[32:33], s53, v36
    v_cmp_eq_u32 vcc, s53, v38
    s_nop 0
    s_or_b64 s[32:33], s[32:33], vcc
    s_cbranch_scc1 Lc0s_DfX2
    v_smfmac_f32_16x16x64_bf16 v[48:51], v[36:39], a[16:23], v2
    v_smfmac_f32_16x16x64_bf16 v[52:55], v[36:39], a[96:103], v2
    v_smfmac_f32_16x16x64_bf16 v[56:59], v[36:39], a[56:63], v2
    v_smfmac_f32_16x16x64_bf16 v[60:63], v[36:39], a[136:143], v2
Lc0s_DfX2n:
    s_bitcmp1_b32 s77, 3
    s_cbranch_scc0 Lc0s_DfX3n
Lc0s_DfX3:
    buffer_load_dwordx4 v[40:43], v0, s[4:7], s67 offen offset:3072 sc1
    s_sub_u32 s12, s12, 1
    s_cbranch_scc1 L_abort
    s_nop 0
    s_waitcnt vmcnt(0)
    v_cmp_eq_u32 s[32:33], s53, v40
    v_cmp_eq_u32 vcc, s53, v42
    s_nop 0
    s_or_b64 s[32:33], s[32:33], vcc
    s_cbranch_scc1 Lc0s_DfX3
    v_smfmac_f32_16x16x64_bf16 v[48:51], v[40:43], a[24:31], v2
    v_smfmac_f32_16x16x64_bf16 v[52:55], v[40:43], a[104:111], v2
    v_smfmac_f32_16x16x64_bf16 v[56:59], v[40:43], a[64:71], v2
    v_smfmac_f32_16x16x64_bf16 v[60:63], v[40:43], a[144:151], v2
Lc0s_DfX3n:
    s_bitcmp1_b32 s77, 4
    s_cbranch_scc0 Lc0s_DfX4n
Lc0s_DfX4:
    buffer_load_dwordx4 v[44:47], v0, s[4:7], s68 offen offset:0 sc1
    s_sub_u32 s12, s12, 1
    s_cbranch_scc1 L_abort
    s_waitcnt vmcnt(0)
    v_cmp_eq_u32 s[32:33], s53, v44
    v_cmp_eq_u32 vcc, s53, v46
    s_nop 0
    s_or_b64 s[32:33], s[32:33], vcc
    s_cbranch_scc1 Lc0s_DfX4
    v_smfmac_f32_16x16x64_bf16 v[48:51], v[44:47], a[32:39], v2
    v_smfmac_f32_16x16x64_bf16 v[52:55], v[44:47], a[112:119], v2
    v_smfmac_f32_16x16x64_bf16 v[56:59], v[44:47], a[72:79], v2
    v_smfmac_f32_16x16x64_bf16 v[60:63], v[44:47], a[152:159], v2
Lc0s_DfX4n:
    s_nop 7
Lc0s_Dftail:
    v_permlane32_swap_b32 v48, v52
    v_permlane32_swap_b32 v49, v53
    v_permlane32_swap_b32 v50, v54
    v_permlane32_swap_b32 v51, v55
    v_pk_add_f32 v[48:49], v[48:49], v[52:53]
    v_pk_add_f32 v[50:51], v[50:51], v[54:55]
    v_cvt_pk_bf16_f32 v48, v48, v49
    v_cvt_pk_bf16_f32 v49, v50, v51
    ds_write_b64 v3, v[48:49] offset:0
    v_permlane32_swap_b32 v56, v60
    v_permlane32_swap_b32 v57, v61
    v_permlane32_swap_b32 v58, v62
    v_permlane32_swap_b32 v59, v63
    v_pk_add_f32 v[56:57], v[56:57], v[60:61]
    v_pk_add_f32 v[58:59], v[58:59], v[62:63]
    v_cvt_pk_bf16_f32 v56, v56, v57
    v_cvt_pk_bf16_f32 v57, v58, v59
    ds_write_b64 v3, v[56:57] offset:128
    s_cmp_eq_u32 s45, 0
    v_smfmac_f32_16x16x64_bf16 v[64:67], v[28:31], a[160:167], v2
    s_cbranch_scc0 Lc0s_Dhi
    s_cmp_eq_u32 s46, 0
    v_smfmac_f32_16x16x64_bf16 v[68:71], v[28:31], a[200:207], v2
    s_cbranch_scc1 Lc00_Dback
    s_branch Lc01_Dback
    s_nop 0
    s_nop 0
    s_nop 0
    s_nop 0
    s_nop 0
    s_nop 0
    s_nop 0
Lc0s_Dhi:
    s_cmp_eq_u32 s46, 0
    v_smfmac_f32_16x16x64_bf16 v[68:71], v[28:31], a[200:207], v2
    s_cbranch_scc1 Lc02_Dback
    s_branch Lc03_Dback
    s_nop 0
    s_nop 0
    s_nop 0
Lc00_pe:
    buffer_store_dwordx4 v[160:163], v0, s[4:7], s71 offen
    s_mov_b32 s71, 1073741824
    s_branch Lc00_pe_c
    s_nop 0
    s_nop 0
    s_nop 0
    s_nop 0
Lc00_F_s:
    buffer_load_dword v143, off, s[4:7], s66 sc1
    s_sub_u32 s12, s12, 1
    s_cbranch_scc1 L_abort
    s_waitcnt vmcnt(0)
    v_cmp_gt_u32 vcc, s51, v143
    s_cbranch_vccnz Lc00_F_s
    s_branch Lc00_F_c
Lc00_sh:
    s_nop 15
    buffer_load_dword v140, v139, s[4:7], s78 offen sc1
    s_nop 15
    buffer_load_dword v140, v139, s[4:7], s78 offen sc1
    s_nop 0
    s_nop 14
    buffer_load_dword v140, v139, s[4:7], s78 offen sc1
    s_nop 15
    buffer_load_dword v140, v139, s[4:7], s78 offen sc1
    s_nop 15
    buffer_load_dword v140, v139, s[4:7], s78 offen sc1
    s_nop 15
    buffer_load_dword v140, v139, s[4:7], s78 offen sc1
    s_nop 15
    buffer_load_dword v140, v139, s[4:7], s78 offen sc1
    s_nop 0
    s_nop 14
    buffer_load_dword v140, v139, s[4:7], s78 offen sc1
    s_nop 15
    buffer_load_dword v140, v139, s[4:7], s78 offen sc1
    s_nop 15
    buffer_load_dword v140, v139, s[4:7], s78 offen sc1
    s_nop 15
    buffer_load_dword v140, v139, s[4:7], s78 offen sc1
    s_nop 15
    buffer_load_dword v140, v139, s[4:7], s78 offen sc1
    s_branch Lc00_Gdone
    s_nop 0
Lc00_Gr0:
    s_waitcnt vmcnt(0)
    v_cmp_u_f32_e64 vcc, v80, v84
    s_cbranch_vccz Lc00_Gk0
Lc00_Gf0:
    buffer_load_dwordx4 v[80:83], v10, s[4:7], s94 offen sc1
    buffer_load_dwordx4 v[84:87], v10, s[4:7], s95 offen sc1
    buffer_load_dwordx4 v[88:91], v10, s[4:7], s96 offen sc1
    buffer_load_dwordx4 v[92:95], v10, s[4:7], s97 offen sc1
    buffer_load_dwordx4 v[96:99], v10, s[4:7], s98 offen sc1
    buffer_load_dwordx4 v[100:103], v10, s[4:7], s99 offen sc1
    s_sub_u32 s12, s12, 1
    s_cbranch_scc1 L_abort
    s_and_b32 s52, s12, 15
    s_cbranch_scc1 Lc00_Gr0
    s_waitcnt vmcnt(0)
    v_cmp_eq_u32 s[32:33], s53, v80
    v_cmp_eq_u32 vcc, s53, v84
    s_nop 0
    s_or_b64 s[32:33], s[32:33], vcc
    s_cbranch_scc1 Lc00_Gf0
    s_branch Lc00_Gk0
    s_nop 0
    s_nop 0
    s_nop 0
    s_nop 0
Lc00_Gr1:
    s_waitcnt vmcnt(0)
    v_cmp_u_f32_e64 vcc, v88, v92
    s_cbranch_vccz Lc00_Gk1
Lc00_Gf1:
    buffer_load_dwordx4 v[88:91], v10, s[4:7], s96 offen sc1
    buffer_load_dwordx4 v[92:95], v10, s[4:7], s97 offen sc1
    buffer_load_dwordx4 v[96:99], v10, s[4:7], s98 offen sc1
    buffer_load_dwordx4 v[100:103], v10, s[4:7], s99 offen sc1
    s_sub_u32 s12, s12, 1
    s_cbranch_scc1 L_abort
    s_and_b32 s52, s12, 15
    s_cbranch_scc1 Lc00_Gr1
    s_waitcnt vmcnt(0)
    v_cmp_eq_u32 s[32:33], s53, v88
    v_cmp_eq_u32 vcc, s53, v92
    s_nop 0
    s_or_b64 s[32:33], s[32:33], vcc
    s_cbranch_scc1 Lc00_Gf1
    s_branch Lc00_Gk1
Lc00_Gr2:
    s_waitcnt vmcnt(0)
    v_cmp_u_f32 vcc, v96, v96
    s_cbranch_vccz Lc00_Gk2
Lc00_Gf2:
    buffer_load_dwordx4 v[96:99], v10, s[4:7], s98 offen sc1
    buffer_load_dwordx4 v[100:103], v10, s[4:7], s99 offen sc1
    s_sub_u32 s12, s12, 1
    s_cbranch_scc1 L_abort
    s_and_b32 s52, s12, 15
    s_cbranch_scc1 Lc00_Gr2
    s_waitcnt vmcnt(0)
    v_cmp_eq_u32 s[32:33], s53, v96
    v_cmp_eq_u32 vcc, s53, v96
    s_nop 0
    s_or_b64 s[32:33], s[32:33], vcc
    s_cbranch_scc1 Lc00_Gf2
    s_branch Lc00_Gk2
    s_nop 0
    s_nop 0
    s_nop 0
    s_nop 0
    s_nop 0
Lc00_Gr3:
    s_waitcnt vmcnt(0)
    v_cmp_u_f32 vcc, v100, v100
    s_cbranch_vccz Lc00_Gk3
Lc00_Gf3:
    buffer_load_dwordx4 v[100:103], v10, s[4:7], s99 offen sc1
    s_sub_u32 s12, s12, 1
    s_cbranch_scc1 L_abort
    s_and_b32 s52, s12, 15
    s_cbranch_scc1 Lc00_Gr3
    s_waitcnt vmcnt(0)
    v_cmp_eq_u32 s[32:33], s53, v100
    v_cmp_eq_u32 vcc, s53, v100
    s_nop 0
    s_or_b64 s[32:33], s[32:33], vcc
    s_cbranch_scc1 Lc00_Gf3
    s_branch Lc00_Gk3
    s_nop 0
    s_nop 0
    s_nop 0
    s_nop 0
    s_nop 0
    s_nop 0
    s_nop 0
Lc00_xs:
    buffer_load_dword v140, v139, s[4:7], s78 offen sc1
    s_nop 3
    v_cmp_gt_u32 vcc, s48, v140
    s_cbranch_vccz Lc00_xo
    buffer_load_dword v140, v139, s[4:7], s78 offen sc1
    s_nop 3
    v_cmp_gt_u32 vcc, s48, v140
    s_cbranch_vccz Lc00_xo
    buffer_load_dword v140, v139, s[4:7], s78 offen sc1
    s_nop 3
    v_cmp_gt_u32_e64 vcc, s48, v140
    s_cbranch_vccz Lc00_xo
    buffer_load_dword v140, v139, s[4:7], s78 offen sc1
    s_nop 3
    v_cmp_gt_u32 vcc, s48, v140
    s_cbranch_vccz Lc00_xo
    s_waitcnt vmcnt(16)
    s_sub_u32 s12, s12, 1
    s_cbranch_scc1 L_abort
    s_branch Lc00_xs
    s_nop 0
    s_nop 0
    s_nop 0
    s_nop 0
    s_nop 0
    s_nop 0
    s_nop 0
Lc00_xo:
    s_branch Lc00_xc
    s_nop 0
    s_nop 0
    s_nop 0
    s_nop 0
    s_nop 0
    s_nop 0
    s_nop 0
Lc00_C_t:
    s_add_u32 s41, s70, 163840
    buffer_load_dwordx4 v[28:31], v8, s[4:7], s41 offen sc1
    s_waitcnt vmcnt(2)
    v_mfma_f32_16x16x32_bf16 v[104:107], v[12:15], v[32:35], v[116:119]
    v_cmp_u_f32 vcc, v32, v34
    s_nop 0
    s_nop 3
    s_cbranch_vccz Lc00_C_c
    s_add_u32 s41, s70, 245760
    buffer_load_dwordx4 v[32:35], v8, s[4:7], s41 offen sc1
    s_waitcnt vmcnt(1)
    v_mfma_f32_16x16x32_bf16 v[104:107], v[12:15], v[28:31], v[116:119]
    v_cmp_u_f32 vcc, v28, v30
    s_nop 4
    s_cbranch_vccz Lc00_C_c
    s_waitcnt vmcnt(0)
    v_mfma_f32_16x16x32_bf16 v[104:107], v[12:15], v[32:35], v[116:119]
    v_cmp_u_f32 vcc, v32, v34
    s_nop 4
    s_cbranch_vccz Lc00_C_c
Lc00_C_x:
    s_add_u32 s41, s70, 0
    buffer_load_dwordx4 v[28:31], v8, s[4:7], s41 offen sc1
    s_sub_u32 s12, s12, 1
    s_cbranch_scc1 L_abort
    s_and_b32 s52, s12, 15
    s_cbranch_scc1 Lc00_C_r
    s_waitcnt vmcnt(0)
    v_cmp_eq_u32 s[32:33], s53, v28
    v_cmp_eq_u32 vcc, s53, v30
    s_nop 0
    s_or_b64 s[32:33], s[32:33], vcc
    s_cbranch_scc1 Lc00_C_x
    v_mfma_f32_16x16x32_bf16 v[104:107], v[12:15], v[28:31], v[116:119]
    s_nop 5
    s_branch Lc00_C_c
    s_nop 0
    s_nop 0
    s_nop 0
Lc00_C_r:
    s_waitcnt vmcnt(0)
    v_mfma_f32_16x16x32_bf16 v[104:107], v[12:15], v[28:31], v[116:119]
    v_cmp_u_f32 vcc, v28, v30
    s_nop 4
    s_cbranch_vccz Lc00_C_c
    s_branch Lc00_C_x
    .p2align 6
Lc01_loop:
    s_barrier
    s_and_b32 s41, s40, 1
    s_lshl_b32 s69, s41, 11
    s_lshl_b32 s41, s41, 13
    s_add_u32 s41, s41, 8192
    v_add_u32_e64 v10, s41, v0
    ds_read_b128 v[76:79], v10 offset:1024
    s_nop 13
    buffer_load_dwordx4 v[28:31], v0, s[4:7], s67 offen offset:0 sc1
    ds_read_b128 v[84:87], v10 offset:3072
    s_add_u32 s49, s69, s60
    s_and_b32 s41, s40, 3
    s_nop 0
    s_nop 3
    buffer_load_dwordx4 v[32:35], v0, s[4:7], s67 offen offset:1024 sc1
    s_mul_i32 s70, s41, 327680
    s_add_u32 s70, s70, s57
    s_mul_i32 s71, s41, 98304
    s_nop 0
    s_nop 3
    buffer_load_dwordx4 v[36:39], v0, s[4:7], s67 offen offset:2048 sc1
    s_add_u32 s71, s71, s64
    s_lshl_b32 s75, s41, 15
    s_bfe_u32 s50, s40, 0x10002
    s_nop 4
    buffer_load_dwordx4 v[40:43], v0, s[4:7], s67 offen offset:3072 sc1
    s_nop 7
    buffer_load_dwordx4 v[44:47], v0, s[4:7], s68 offen offset:0 sc1
    s_waitcnt vmcnt(4)
    v_cmp_u_f32 vcc, v28, v30
    s_cbranch_vccnz Lc0s_Df0
Lc01_Dk0:
    v_smfmac_f32_16x16x64_bf16 v[48:51], v[28:31], a[0:7], v2
    s_waitcnt vmcnt(3)
    v_cmp_u_f32_e64 vcc, v32, v34
    v_smfmac_f32_16x16x64_bf16 v[52:55], v[28:31], a[80:87], v2
    v_smfmac_f32_16x16x64_bf16 v[56:59], v[28:31], a[40:47], v2
    v_smfmac_f32_16x16x64_bf16 v[60:63], v[28:31], a[120:127], v2
    s_cbranch_vccnz Lc0s_Df1
Lc01_Dk1:
    v_smfmac_f32_16x16x64_bf16 v[48:51], v[32:35], a[8:15], v2
    s_waitcnt vmcnt(2)
    v_cmp_u_f32_e64 vcc, v36, v38
    v_smfmac_f32_16x16x64_bf16 v[52:55], v[32:35], a[88:95], v2
    v_smfmac_f32_16x16x64_bf16 v[56:59], v[32:35], a[48:55], v2
    v_smfmac_f32_16x16x64_bf16 v[60:63], v[32:35], a[128:135], v2
    s_cbranch_vccnz Lc0s_Df2
Lc01_Dk2:
    v_smfmac_f32_16x16x64_bf16 v[48:51], v[36:39], a[16:23], v2
    s_waitcnt vmcnt(1)
    v_cmp_u_f32_e64 vcc, v40, v42
    v_smfmac_f32_16x16x64_bf16 v[52:55], v[36:39], a[96:103], v2
    v_smfmac_f32_16x16x64_bf16 v[56:59], v[36:39], a[56:63], v2
    v_smfmac_f32_16x16x64_bf16 v[60:63], v[36:39], a[136:143], v2
    s_cbranch_vccnz Lc0s_Df3
Lc01_Dk3:
    v_smfmac_f32_16x16x64_bf16 v[48:51], v[40:43], a[24:31], v2
    s_waitcnt vmcnt(0)
    v_cmp_u_f32_e64 vcc, v44, v46
    v_smfmac_f32_16x16x64_bf16 v[52:55], v[40:43], a[104:111], v2
    v_smfmac_f32_16x16x64_bf16 v[56:59], v[40:43], a[64:71], v2
    v_smfmac_f32_16x16x64_bf16 v[60:63], v[40:43], a[144:151], v2
    s_cbranch_vccnz Lc0s_Df4
Lc01_Dk4:
    v_smfmac_f32_16x16x64_bf16 v[48:51], v[44:47], a[32:39], v2
    v_smfmac_f32_16x16x64_bf16 v[52:55], v[44:47], a[112:119], v2
    v_smfmac_f32_16x16x64_bf16 v[56:59], v[44:47], a[72:79], v2
    v_smfmac_f32_16x16x64_bf16 v[60:63], v[44:47], a[152:159], v2
Lc01_Ddone:
    v_permlane32_swap_b32 v48, v52
    v_permlane32_swap_b32 v49, v53
    v_permlane32_swap_b32 v50, v54
    v_permlane32_swap_b32_e64 v51, v55
    v_pk_add_f32 v[48:49], v[48:49], v[52:53]
    v_pk_add_f32 v[50:51], v[50:51], v[54:55]
    v_cvt_pk_bf16_f32 v48, v48, v49
    v_cvt_pk_bf16_f32 v49, v50, v51
    ds_write_b64 v3, v[48:49] offset:0
    v_permlane32_swap_b32 v56, v60
    v_permlane32_swap_b32 v57, v61
    v_permlane32_swap_b32 v58, v62
    v_permlane32_swap_b32 v59, v63
    v_pk_add_f32 v[56:57], v[56:57], v[60:61]
    v_pk_add_f32 v[58:59], v[58:59], v[62:63]
    v_cvt_pk_bf16_f32 v56, v56, v57
    v_cvt_pk_bf16_f32 v57, v58, v59
    ds_write_b64 v3, v[56:57] offset:128
    v_smfmac_f32_16x16x64_bf16 v[64:67], v[28:31], a[160:167], v2
    v_smfmac_f32_16x16x64_bf16 v[68:71], v[28:31], a[200:207], v2
Lc01_Dback:
    buffer_load_dword v143, off, s[4:7], s66 sc1
    v_smfmac_f32_16x16x64_bf16 v[64:67], v[32:35], a[168:175], v2
    s_waitcnt lgkmcnt(0)
    s_barrier
    v_smfmac_f32_16x16x64_bf16 v[68:71], v[32:35], a[208:215], v2
    ds_read_b64_tr_b16 v[48:49], v4 offset:0
    ds_read_b64_tr_b16 v[50:51], v4 offset:128
    ds_read_b64_tr_b16 v[56:57], v4 offset:256
    ds_read_b64_tr_b16 v[58:59], v4 offset:384
    s_waitcnt lgkmcnt(2)
    v_mfma_f32_16x16x32_bf16 v[108:111], v[76:79], v[48:51], 0
    s_waitcnt lgkmcnt(0)
    v_mfma_f32_16x16x32_bf16 v[108:111], v[84:87], v[56:59], v[108:111]
    v_smfmac_f32_16x16x64_bf16 v[64:67], v[36:39], a[176:183], v2
    s_nop 0
    s_nop 2
    v_add_f32_dpp v20, v108, v108 row_ror:8 row_mask:0xf bank_mask:0xc
    v_add_f32_dpp v21, v109, v109 row_ror:8 row_mask:0xf bank_mask:0xc
    v_add_f32_dpp v22, v110, v110 row_ror:8 row_mask:0xf bank_mask:0xc
    v_add_f32_dpp v23, v111, v111 row_ror:8 row_mask:0xf bank_mask:0xc
    buffer_store_dwordx4 v[20:23], v27, s[4:7], s49 offen
    ds_read_b64_tr_b16 v[160:161], v4 offset:2560
    ds_read_b64_tr_b16 v[162:163], v4 offset:2688
    v_smfmac_f32_16x16x64_bf16 v[68:71], v[36:39], a[216:223], v2
    v_smfmac_f32_16x16x64_bf16 v[64:67], v[40:43], a[184:191], v2
    v_smfmac_f32_16x16x64_bf16 v[68:71], v[40:43], a[224:231], v2
    v_smfmac_f32_16x16x64_bf16 v[64:67], v[44:47], a[192:199], v2
    v_smfmac_f32_16x16x64_bf16 v[68:71], v[44:47], a[232:239], v2
    s_nop 7
    v_permlane32_swap_b32 v64, v68
    v_permlane32_swap_b32 v65, v69
    v_permlane32_swap_b32 v66, v70
    v_permlane32_swap_b32_e64 v67, v71
    v_pk_add_f32 v[64:65], v[64:65], v[68:69]
    v_pk_add_f32 v[66:67], v[66:67], v[70:71]
    v_cvt_pk_bf16_f32 v64, v64, v65
    v_cvt_pk_bf16_f32 v65, v66, v67
    ds_write_b64 v5, v[64:65]
    s_cmp_eq_u32 s40, 63
    s_waitcnt lgkmcnt(0)
    s_barrier
    s_cbranch_scc1 Lc01_fin
    v_mov_b64 v[64:65], 0
    v_mov_b64 v[66:67], 0
    v_mov_b64 v[68:69], 0
    v_mov_b64 v[70:71], 0
    s_add_u32 s41, s40, 1
    s_and_b32 s41, s41, 3
    s_lshl_b32 s41, s41, 14
    s_add_u32 s67, s41, s58
    s_add_u32 s68, s67, 4096
    s_add_u32 s76, s41, s59
    s_add_u32 s41, s75, s56
    v_add_u32_e64 v10, s41, v0
    v_and_or_b32 v160, v160, -2, s50
    s_cmp_ge_u32 s40, 61
    s_cbranch_scc1 Lc01_pe
Lc01_pe_c:
    s_and_b32 s41, s40, 3
    s_xor_b32 s41, s41, 2
    s_mul_i32 s72, s41, 327680
    s_add_u32 s72, s72, s57
    s_sub_u32 s72, s72, 512
    s_add_u32 s48, s40, 1
    s_and_b32 s42, s48, 1
    s_lshl_b32 s42, s42, 13
    s_add_u32 m0, s42, s65
    s_lshl_b32 s74, s48, 12
    s_add_u32 s74, s74, s63
    s_add_u32 s51, s40, 2
    s_waitcnt vmcnt(1)
    v_cmp_gt_u32 vcc, s51, v143
    s_cbranch_vccnz Lc01_F_s
Lc01_F_c:
    s_cmp_ge_u32 s39, 20
    s_barrier
    s_cbranch_scc1 Lc01_sh
    s_nop 10
    buffer_load_dwordx4 v[80:83], v10, s[4:7], s94 offen sc1
    s_nop 5
    buffer_load_dwordx4 v[84:87], v10, s[4:7], s95 offen sc1
    s_nop 0
    s_nop 4
    buffer_load_dwordx4 v[88:91], v10, s[4:7], s96 offen sc1
    s_nop 5
    buffer_load_dwordx4 v[92:95], v10, s[4:7], s97 offen sc1
    s_nop 5
    buffer_load_dwordx4 v[96:99], v10, s[4:7], s98 offen sc1
    s_nop 5
    buffer_load_dwordx4 v[100:103], v10, s[4:7], s99 offen sc1
    s_waitcnt vmcnt(4)
    v_cmp_u_f32 vcc, v80, v84
    s_cbranch_vccnz Lc01_Gf0
Lc01_Gk0:
    v_smfmac_f32_16x16x64_bf16 v[64:67], v[80:83], v[168:175], v2
    s_waitcnt vmcnt(2)
    v_cmp_u_f32 vcc, v88, v92
    v_smfmac_f32_16x16x64_bf16 v[68:71], v[80:83], v[176:183], v2
    v_smfmac_f32_16x16x64_bf16 v[64:67], v[84:87], v[184:191], v2
    v_smfmac_f32_16x16x64_bf16 v[68:71], v[84:87], v[192:199], v2
    s_cbranch_vccnz Lc01_Gf1
Lc01_Gk1:
    v_smfmac_f32_16x16x64_bf16 v[64:67], v[88:91], v[200:207], v2
    s_waitcnt vmcnt(1)
    v_cmp_u_f32_e64 vcc, v96, v96
    v_smfmac_f32_16x16x64_bf16 v[68:71], v[88:91], v[208:215], v2
    v_smfmac_f32_16x16x64_bf16 v[64:67], v[92:95], v[216:223], v2
    v_smfmac_f32_16x16x64_bf16 v[68:71], v[92:95], v[224:231], v2
    s_cbranch_vccnz Lc01_Gf2
Lc01_Gk2:
    s_waitcnt vmcnt(0)
    v_cmp_u_f32_e64 vcc, v100, v100
    v_smfmac_f32_16x16x64_bf16 v[64:67], v[96:99], v[232:239], v2
    v_smfmac_f32_16x16x64_bf16 v[68:71], v[96:99], v[240:247], v2
    s_cbranch_vccnz Lc01_Gf3
Lc01_Gk3:
    v_smfmac_f32_16x16x64_bf16 v[64:67], v[100:103], v[248:255], v2
    v_smfmac_f32_16x16x64_bf16 v[68:71], v[100:103], a[248:255], v2
Lc01_Gdone:
    buffer_load_dwordx4 v0, s[4:7], s74 offen offset:0 sc1 lds
    buffer_load_dwordx4 v0, s[4:7], s74 offen offset:1024 sc1 lds
    s_nop 1
    v_cvt_pk_bf16_f32 v64, v64, v65
    v_cvt_pk_bf16_f32 v65, v66, v67
    ds_write_b64 v11, v[64:65] offset:0
    s_nop 0
    v_cvt_pk_bf16_f32 v68, v68, v69
    v_cvt_pk_bf16_f32 v69, v70, v71
    ds_write_b64 v11, v[68:69] offset:256
    buffer_load_dwordx4 v0, s[4:7], s74 offen offset:2048 sc1 lds
    buffer_load_dwordx4 v0, s[4:7], s74 offen offset:3072 sc1 lds
    s_waitcnt lgkmcnt(0)
    s_barrier
    ds_read_b128 v[80:83], v26 offset:0
    ds_read_b128 v[84:87], v26 offset:512
    buffer_store_dwordx4 v[160:163], v0, s[4:7], s71 offen
    s_waitcnt lgkmcnt(1)
    v_mfma_f32_16x16x32_bf16 v[116:119], v[80:83], v[12:15], 0
    s_waitcnt lgkmcnt(0)
    v_mfma_f32_16x16x32_bf16 v[116:119], v[84:87], v[12:15], v[116:119]
    s_nop 7
    v_cvt_pk_bf16_f32 v164, v116, v117
    v_cvt_pk_bf16_f32 v165, v118, v119
    buffer_store_dwordx2 v[164:165], v7, s[4:7], s70 offen sc1
    s_nop 15
    s_nop 15
    s_nop 13
    v_mov_b64 v[48:49], 0
    v_mov_b64 v[50:51], 0
    v_mov_b64 v[52:53], 0
    v_mov_b64 v[54:55], 0
    v_mov_b64 v[56:57], 0
    v_mov_b64 v[58:59], 0
    v_mov_b64 v[60:61], 0
    v_mov_b64 v[62:63], 0
    v_mov_b64 v[64:65], 0
    v_mov_b64 v[66:67], 0
    v_mov_b64 v[68:69], 0
    v_mov_b64 v[70:71], 0
    s_nop 15
    s_nop 7
    s_add_u32 s41, s70, 0
    buffer_load_dwordx4 v[28:31], v8, s[4:7], s41 offen sc1
    s_nop 15
    s_nop 9
    s_add_u32 s41, s70, 81920
    buffer_load_dwordx4 v[32:35], v8, s[4:7], s41 offen sc1
    buffer_store_dwordx4 v[16:19], v136, s[4:7], s72 offen sc1
    s_waitcnt vmcnt(2)
    v_mfma_f32_16x16x32_bf16 v[104:107], v[12:15], v[28:31], v[116:119]
    v_cmp_u_f32 vcc, v28, v30
    s_nop 0
    s_nop 3
    s_cbranch_vccnz Lc01_C_t
Lc01_C_c:
    s_nop 0
    v_cvt_pk_bf16_f32 v164, v104, v105
    v_cvt_pk_bf16_f32 v165, v106, v107
    buffer_store_dwordx2 v[164:165], v9, s[4:7], s76 offen
    s_waitcnt vmcnt(3)
Lc01_join:
    s_add_u32 s40, s40, 1
    s_branch Lc01_loop
    s_nop 0
    s_nop 0
    s_nop 0
    s_nop 0
    s_nop 0
    s_nop 0
    s_nop 0
Lc01_fin:
    s_waitcnt lgkmcnt(0)
    v_and_or_b32 v160, v160, -2, s50
    buffer_store_dwordx4 v[160:163], v0, s[4:7], s71 offen
    s_endpgm
    s_nop 0
    s_nop 0
Lc01_pe:
    buffer_store_dwordx4 v[160:163], v0, s[4:7], s71 offen
    s_mov_b32 s71, 1073741824
    s_branch Lc01_pe_c
    s_nop 0
    s_nop 0
    s_nop 0
    s_nop 0
Lc01_F_s:
    buffer_load_dword v143, off, s[4:7], s66 sc1
    s_sub_u32 s12, s12, 1
    s_cbranch_scc1 L_abort
    s_waitcnt vmcnt(0)
    v_cmp_gt_u32 vcc, s51, v143
    s_cbranch_vccnz Lc01_F_s
    s_branch Lc01_F_c
Lc01_sh:
    global_load_dword v140, v[138:139], off sc1
    s_nop 15
    s_nop 15
    s_nop 15
    s_nop 15
    s_nop 15
    s_nop 15
    s_nop 15
    s_nop 15
    s_nop 15
    s_nop 15
    s_nop 15
    s_nop 15
    s_nop 11
    s_branch Lc01_Gdone
Lc01_Gr0:
    s_waitcnt vmcnt(4)
    v_cmp_u_f32_e64 vcc, v80, v84
    s_cbranch_vccz Lc01_Gk0
Lc01_Gf0:
    buffer_load_dwordx4 v[80:83], v10, s[4:7], s94 offen sc1
    buffer_load_dwordx4 v[84:87], v10, s[4:7], s95 offen sc1
    buffer_load_dwordx4 v[88:91], v10, s[4:7], s96 offen sc1
    buffer_load_dwordx4 v[92:95], v10, s[4:7], s97 offen sc1
    buffer_load_dwordx4 v[96:99], v10, s[4:7], s98 offen sc1
    buffer_load_dwordx4 v[100:103], v10, s[4:7], s99 offen sc1
    s_sub_u32 s12, s12, 1
    s_cbranch_scc1 L_abort
    s_and_b32 s52, s12, 15
    s_cbranch_scc1 Lc01_Gr0
    s_waitcnt vmcnt(0)
    v_cmp_eq_u32 s[32:33], s53, v80
    v_cmp_eq_u32 vcc, s53, v84
    s_nop 0
    s_or_b64 s[32:33], s[32:33], vcc
    s_cbranch_scc1 Lc01_Gf0
    s_branch Lc01_Gk0
    s_nop 0
    s_nop 0
    s_nop 0
    s_nop 0
Lc01_Gr1:
    s_waitcnt vmcnt(2)
    v_cmp_u_f32_e64 vcc, v88, v92
    s_cbranch_vccz Lc01_Gk1
Lc01_Gf1:
    buffer_load_dwordx4 v[88:91], v10, s[4:7], s96 offen sc1
    buffer_load_dwordx4 v[92:95], v10, s[4:7], s97 offen sc1
    buffer_load_dwordx4 v[96:99], v10, s[4:7], s98 offen sc1
    buffer_load_dwordx4 v[100:103], v10, s[4:7], s99 offen sc1
    s_sub_u32 s12, s12, 1
    s_cbranch_scc1 L_abort
    s_and_b32 s52, s12, 15
    s_cbranch_scc1 Lc01_Gr1
    s_waitcnt vmcnt(0)
    v_cmp_eq_u32 s[32:33], s53, v88
    v_cmp_eq_u32 vcc, s53, v92
    s_nop 0
    s_or_b64 s[32:33], s[32:33], vcc
    s_cbranch_scc1 Lc01_Gf1
    s_branch Lc01_Gk1
Lc01_Gr2:
    s_waitcnt vmcnt(1)
    v_cmp_u_f32 vcc, v96, v96
    s_cbranch_vccz Lc01_Gk2
Lc01_Gf2:
    buffer_load_dwordx4 v[96:99], v10, s[4:7], s98 offen sc1
    buffer_load_dwordx4 v[100:103], v10, s[4:7], s99 offen sc1
    s_sub_u32 s12, s12, 1
    s_cbranch_scc1 L_abort
    s_and_b32 s52, s12, 15
    s_cbranch_scc1 Lc01_Gr2
    s_waitcnt vmcnt(0)
    v_cmp_eq_u32 s[32:33], s53, v96
    v_cmp_eq_u32 vcc, s53, v96
    s_nop 0
    s_or_b64 s[32:33], s[32:33], vcc
    s_cbranch_scc1 Lc01_Gf2
    s_branch Lc01_Gk2
    s_nop 0
    s_nop 0
    s_nop 0
    s_nop 0
    s_nop 0
Lc01_Gr3:
    s_waitcnt vmcnt(0)
    v_cmp_u_f32 vcc, v100, v100
    s_cbranch_vccz Lc01_Gk3
Lc01_Gf3:
    buffer_load_dwordx4 v[100:103], v10, s[4:7], s99 offen sc1
    s_sub_u32 s12, s12, 1
    s_cbranch_scc1 L_abort
    s_and_b32 s52, s12, 15
    s_cbranch_scc1 Lc01_Gr3
    s_waitcnt vmcnt(0)
    v_cmp_eq_u32 s[32:33], s53, v100
    v_cmp_eq_u32 vcc, s53, v100
    s_nop 0
    s_or_b64 s[32:33], s[32:33], vcc
    s_cbranch_scc1 Lc01_Gf3
    s_branch Lc01_Gk3
    s_nop 0
    s_nop 0
    s_nop 0
    s_nop 0
    s_nop 0
    s_nop 0
    s_nop 0
Lc01_C_t:
    s_add_u32 s41, s70, 163840
    buffer_load_dwordx4 v[28:31], v8, s[4:7], s41 offen sc1
    s_waitcnt vmcnt(2)
    v_mfma_f32_16x16x32_bf16 v[104:107], v[12:15], v[32:35], v[116:119]
    v_cmp_u_f32 vcc, v32, v34
    s_nop 0
    s_nop 3
    s_cbranch_vccz Lc01_C_c
    s_add_u32 s41, s70, 245760
    buffer_load_dwordx4 v[32:35], v8, s[4:7], s41 offen sc1
    s_waitcnt vmcnt(1)
    v_mfma_f32_16x16x32_bf16 v[104:107], v[12:15], v[28:31], v[116:119]
    v_cmp_u_f32 vcc, v28, v30
    s_nop 4
    s_cbranch_vccz Lc01_C_c
    s_waitcnt vmcnt(0)
    v_mfma_f32_16x16x32_bf16 v[104:107], v[12:15], v[32:35], v[116:119]
    v_cmp_u_f32 vcc, v32, v34
    s_nop 4
    s_cbranch_vccz Lc01_C_c
Lc01_C_x:
    s_add_u32 s41, s70, 0
    buffer_load_dwordx4 v[28:31], v8, s[4:7], s41 offen sc1
    s_sub_u32 s12, s12, 1
    s_cbranch_scc1 L_abort
    s_and_b32 s52, s12, 15
    s_cbranch_scc1 Lc01_C_r
    s_waitcnt vmcnt(0)
    v_cmp_eq_u32 s[32:33], s53, v28
    v_cmp_eq_u32 vcc, s53, v30
    s_nop 0
    s_or_b64 s[32:33], s[32:33], vcc
    s_cbranch_scc1 Lc01_C_x
    v_mfma_f32_16x16x32_bf16 v[104:107], v[12:15], v[28:31], v[116:119]
    s_nop 5
    s_branch Lc01_C_c
    s_nop 0
    s_nop 0
    s_nop 0
Lc01_C_r:
    s_waitcnt vmcnt(0)
    v_mfma_f32_16x16x32_bf16 v[104:107], v[12:15], v[28:31], v[116:119]
    v_cmp_u_f32 vcc, v28, v30
    s_nop 4
    s_cbranch_vccz Lc01_C_c
    s_branch Lc01_C_x
    .p2align 6
Lc02_loop:
    s_barrier
    s_and_b32 s41, s40, 1
    s_lshl_b32 s69, s41, 11
    s_lshl_b32 s41, s41, 13
    s_add_u32 s41, s41, 8192
    v_add_u32 v10, s41, v0
    s_add_u32 s49, s69, s60
    s_nop 13
    buffer_load_dwordx4 v[28:31], v0, s[4:7], s67 offen offset:0 sc1
    s_and_b32 s41, s40, 3
    s_mul_i32 s70, s41, 327680
    s_nop 0
    s_nop 4
    buffer_load_dwordx4 v[32:35], v0, s[4:7], s67 offen offset:1024 sc1
    s_add_u32 s70, s70, s57
    s_mul_i32 s71, s41, 98304
    s_nop 5
    buffer_load_dwordx4 v[36:39], v0, s[4:7], s67 offen offset:2048 sc1
    s_add_u32 s71, s71, s64
    s_lshl_b32 s75, s41, 15
    s_nop 5
    buffer_load_dwordx4 v[40:43], v0, s[4:7], s67 offen offset:3072 sc1
    s_bfe_u32 s50, s40, 0x10002
    s_nop 6
    buffer_load_dwordx4 v[44:47], v0, s[4:7], s68 offen offset:0 sc1
    s_waitcnt vmcnt(4)
    v_cmp_u_f32 vcc, v28, v30
    s_cbranch_vccnz Lc0s_Df0
Lc02_Dk0:
    v_smfmac_f32_16x16x64_bf16 v[48:51], v[28:31], a[0:7], v2
    s_waitcnt vmcnt(3)
    v_cmp_u_f32 vcc, v32, v34
    v_smfmac_f32_16x16x64_bf16 v[52:55], v[28:31], a[80:87], v2
    v_smfmac_f32_16x16x64_bf16 v[56:59], v[28:31], a[40:47], v2
    v_smfmac_f32_16x16x64_bf16 v[60:63], v[28:31], a[120:127], v2
    s_cbranch_vccnz Lc0s_Df1
Lc02_Dk1:
    v_smfmac_f32_16x16x64_bf16 v[48:51], v[32:35], a[8:15], v2
    s_waitcnt vmcnt(2)
    v_cmp_u_f32 vcc, v36, v38
    v_smfmac_f32_16x16x64_bf16 v[52:55], v[32:35], a[88:95], v2
    v_smfmac_f32_16x16x64_bf16 v[56:59], v[32:35], a[48:55], v2
    v_smfmac_f32_16x16x64_bf16 v[60:63], v[32:35], a[128:135], v2
    s_cbranch_vccnz Lc0s_Df2
Lc02_Dk2:
    v_smfmac_f32_16x16x64_bf16 v[48:51], v[36:39], a[16:23], v2
    s_waitcnt vmcnt(1)
    v_cmp_u_f32_e64 vcc, v40, v42
    v_smfmac_f32_16x16x64_bf16 v[52:55], v[36:39], a[96:103], v2
    v_smfmac_f32_16x16x64_bf16 v[56:59], v[36:39], a[56:63], v2
    v_smfmac_f32_16x16x64_bf16 v[60:63], v[36:39], a[136:143], v2
    s_cbranch_vccnz Lc0s_Df3
Lc02_Dk3:
    v_smfmac_f32_16x16x64_bf16 v[48:51], v[40:43], a[24:31], v2
    s_waitcnt vmcnt(0)
    v_cmp_u_f32_e64 vcc, v44, v46
    v_smfmac_f32_16x16x64_bf16 v[52:55], v[40:43], a[104:111], v2
    v_smfmac_f32_16x16x64_bf16 v[56:59], v[40:43], a[64:71], v2
    v_smfmac_f32_16x16x64_bf16 v[60:63], v[40:43], a[144:151], v2
    s_cbranch_vccnz Lc0s_Df4
Lc02_Dk4:
    v_smfmac_f32_16x16x64_bf16 v[48:51], v[44:47], a[32:39], v2
    v_smfmac_f32_16x16x64_bf16 v[52:55], v[44:47], a[112:119], v2
    v_smfmac_f32_16x16x64_bf16 v[56:59], v[44:47], a[72:79], v2
    v_smfmac_f32_16x16x64_bf16 v[60:63], v[44:47], a[152:159], v2
Lc02_Ddone:
    v_permlane32_swap_b32 v48, v52
    v_permlane32_swap_b32 v49, v53
    v_permlane32_swap_b32 v50, v54
    v_permlane32_swap_b32_e64 v51, v55
    v_pk_add_f32 v[48:49], v[48:49], v[52:53]
    v_pk_add_f32 v[50:51], v[50:51], v[54:55]
    v_cvt_pk_bf16_f32 v48, v48, v49
    v_cvt_pk_bf16_f32 v49, v50, v51
    ds_write_b64 v3, v[48:49] offset:0
    v_permlane32_swap_b32 v56, v60
    v_permlane32_swap_b32 v57, v61
    v_permlane32_swap_b32 v58, v62
    v_permlane32_swap_b32 v59, v63
    v_pk_add_f32 v[56:57], v[56:57], v[60:61]
    v_pk_add_f32 v[58:59], v[58:59], v[62:63]
    v_cvt_pk_bf16_f32 v56, v56, v57
    v_cvt_pk_bf16_f32 v57, v58, v59
    ds_write_b64 v3, v[56:57] offset:128
    v_smfmac_f32_16x16x64_bf16 v[64:67], v[28:31], a[160:167], v2
    v_smfmac_f32_16x16x64_bf16 v[68:71], v[28:31], a[200:207], v2
Lc02_Dback:
    v_smfmac_f32_16x16x64_bf16 v[64:67], v[32:35], a[168:175], v2
    s_waitcnt lgkmcnt(0)
    s_barrier
    ds_read_b64_tr_b16 v[48:49], v4 offset:0
    ds_read_b64_tr_b16 v[50:51], v4 offset:128
    ds_read_b64_tr_b16 v[52:53], v4 offset:2304
    ds_read_b64_tr_b16 v[54:55], v4 offset:2432
    ds_read_b64_tr_b16 v[56:57], v4 offset:256
    ds_read_b64_tr_b16 v[58:59], v4 offset:384
    ds_read_b64_tr_b16 v[60:61], v4 offset:2560
    ds_read_b64_tr_b16 v[62:63], v4 offset:2688
    s_waitcnt lgkmcnt(4)
    v_mfma_f32_16x16x32_bf16 v[112:115], v[52:55], v[48:51], 0
    s_waitcnt lgkmcnt(0)
    v_mfma_f32_16x16x32_bf16 v[112:115], v[60:63], v[56:59], v[112:115]
    v_smfmac_f32_16x16x64_bf16 v[68:71], v[32:35], a[208:215], v2
    s_nop 3
    v_add_f32_dpp v24, v112, v112 row_ror:8 row_mask:0xf bank_mask:0x3
    v_add_f32_dpp v25, v113, v113 row_ror:8 row_mask:0xf bank_mask:0x3
    s_nop 0
    v_add_f32_dpp v24, v114, v114 row_ror:8 row_mask:0xf bank_mask:0xc
    v_add_f32_dpp v25, v115, v115 row_ror:8 row_mask:0xf bank_mask:0xc
    s_nop 1
    v_permlane32_swap_b32 v24, v25
    v_add_f32_e64 v24, v24, v25
    buffer_store_dword v24, v1, s[4:7], s49 offen offset:1024
    v_smfmac_f32_16x16x64_bf16 v[64:67], v[36:39], a[176:183], v2
    v_smfmac_f32_16x16x64_bf16 v[68:71], v[36:39], a[216:223], v2
    v_smfmac_f32_16x16x64_bf16 v[64:67], v[40:43], a[184:191], v2
    v_smfmac_f32_16x16x64_bf16 v[68:71], v[40:43], a[224:231], v2
    v_smfmac_f32_16x16x64_bf16 v[64:67], v[44:47], a[192:199], v2
    v_smfmac_f32_16x16x64_bf16 v[68:71], v[44:47], a[232:239], v2
    s_nop 7
    v_permlane32_swap_b32 v64, v68
    v_permlane32_swap_b32 v65, v69
    v_permlane32_swap_b32 v66, v70
    v_permlane32_swap_b32_e64 v67, v71
    v_pk_add_f32 v[64:65], v[64:65], v[68:69]
    v_pk_add_f32 v[66:67], v[66:67], v[70:71]
    v_cvt_pk_bf16_f32 v64, v64, v65
    v_cvt_pk_bf16_f32 v65, v66, v67
    ds_write_b64 v5, v[64:65]
    s_cmp_eq_u32 s40, 63
    s_nop 0
    s_waitcnt lgkmcnt(0)
    s_barrier
    ds_read_b128 v[160:163], v0 offset:4608
    s_cbranch_scc1 Lc02_fin
    v_mov_b64 v[64:65], 0
    v_mov_b64 v[66:67], 0
    v_mov_b64 v[68:69], 0
    v_mov_b64 v[70:71], 0
    s_add_u32 s41, s40, 1
    s_and_b32 s41, s41, 3
    s_lshl_b32 s41, s41, 14
    s_add_u32 s67, s41, s58
    s_add_u32 s68, s67, 4096
    s_add_u32 s76, s41, s59
    s_add_u32 s41, s75, s56
    v_add_u32 v10, s41, v0
    s_waitcnt lgkmcnt(0)
    v_and_or_b32 v160, v160, -2, s50
    s_cmp_ge_u32 s40, 61
    s_cbranch_scc1 Lc02_pe
Lc02_pe_c:
    s_and_b32 s41, s40, 3
    s_xor_b32 s41, s41, 2
    s_lshl_b32 s41, s41, 14
    s_add_u32 s72, s41, s59
    s_sub_u32 s72, s72, 256
    s_xor_b32 s51, s75, 65536
    s_add_u32 s51, s51, s55
    s_cmp_ge_u32 s39, 20
    s_barrier
    s_cbranch_scc1 Lc02_sh
    s_nop 10
    buffer_load_dwordx4 v[80:83], v10, s[4:7], s94 offen sc1
    s_nop 5
    buffer_load_dwordx4 v[84:87], v10, s[4:7], s95 offen sc1
    s_nop 5
    buffer_load_dwordx4 v[88:91], v10, s[4:7], s96 offen sc1
    s_nop 5
    buffer_load_dwordx4 v[92:95], v10, s[4:7], s97 offen sc1
    s_nop 5
    buffer_load_dwordx4 v[96:99], v10, s[4:7], s98 offen sc1
    s_nop 5
    buffer_load_dwordx4 v[100:103], v10, s[4:7], s99 offen sc1
    s_waitcnt vmcnt(4)
    v_cmp_u_f32 vcc, v80, v84
    s_cbranch_vccnz Lc02_Gf0
Lc02_Gk0:
    v_smfmac_f32_16x16x64_bf16 v[64:67], v[80:83], v[168:175], v2
    s_waitcnt vmcnt(2)
    v_cmp_u_f32 vcc, v88, v92
    v_smfmac_f32_16x16x64_bf16 v[68:71], v[80:83], v[176:183], v2
    v_smfmac_f32_16x16x64_bf16 v[64:67], v[84:87], v[184:191], v2
    v_smfmac_f32_16x16x64_bf16 v[68:71], v[84:87], v[192:199], v2
    s_cbranch_vccnz Lc02_Gf1
Lc02_Gk1:
    v_smfmac_f32_16x16x64_bf16 v[64:67], v[88:91], v[200:207], v2
    s_waitcnt vmcnt(1)
    v_cmp_u_f32_e64 vcc, v96, v96
    v_smfmac_f32_16x16x64_bf16 v[68:71], v[88:91], v[208:215], v2
    v_smfmac_f32_16x16x64_bf16 v[64:67], v[92:95], v[216:223], v2
    v_smfmac_f32_16x16x64_bf16 v[68:71], v[92:95], v[224:231], v2
    s_cbranch_vccnz Lc02_Gf2
Lc02_Gk2:
    s_waitcnt vmcnt(0)
    v_cmp_u_f32_e64 vcc, v100, v100
    v_smfmac_f32_16x16x64_bf16 v[64:67], v[96:99], v[232:239], v2
    v_smfmac_f32_16x16x64_bf16 v[68:71], v[96:99], v[240:247], v2
    s_cbranch_vccnz Lc02_Gf3
Lc02_Gk3:
    v_smfmac_f32_16x16x64_bf16 v[64:67], v[100:103], v[248:255], v2
    v_smfmac_f32_16x16x64_bf16 v[68:71], v[100:103], a[248:255], v2
Lc02_Gdone:
    buffer_store_dwordx4 v[16:19], v136, s[4:7], s72 offen
    buffer_store_dwordx4 v[16:19], v0, s[4:7], s51 offen
    s_nop 1
    v_cvt_pk_bf16_f32 v64, v64, v65
    v_cvt_pk_bf16_f32 v65, v66, v67
    ds_write_b64 v11, v[64:65] offset:0
    s_nop 0
    v_cvt_pk_bf16_f32 v68, v68, v69
    v_cvt_pk_bf16_f32 v69, v70, v71
    ds_write_b64 v11, v[68:69] offset:256
    buffer_store_dwordx4 v[160:163], v0, s[4:7], s71 offen
    s_nop 0
    s_waitcnt lgkmcnt(0)
    s_barrier
    ds_read_b128 v[80:83], v26 offset:0
    ds_read_b128 v[84:87], v26 offset:512
    s_waitcnt lgkmcnt(1)
    v_mfma_f32_16x16x32_bf16 v[116:119], v[80:83], v[12:15], 0
    s_waitcnt lgkmcnt(0)
    v_mfma_f32_16x16x32_bf16 v[116:119], v[84:87], v[12:15], v[116:119]
    s_nop 0
    s_nop 6
    v_cvt_pk_bf16_f32 v164, v116, v117
    v_cvt_pk_bf16_f32 v165, v118, v119
    buffer_store_dwordx2 v[164:165], v7, s[4:7], s70 offen sc1
    s_nop 15
    s_nop 15
    s_nop 15
    s_nop 9
    v_mov_b64 v[48:49], 0
    v_mov_b64 v[50:51], 0
    v_mov_b64 v[52:53], 0
    v_mov_b64 v[54:55], 0
    v_mov_b64 v[56:57], 0
    v_mov_b64 v[58:59], 0
    v_mov_b64 v[60:61], 0
    v_mov_b64 v[62:63], 0
    v_mov_b64 v[64:65], 0
    v_mov_b64 v[66:67], 0
    v_mov_b64 v[68:69], 0
    v_mov_b64 v[70:71], 0
    s_nop 11
    s_add_u32 s41, s70, 0
    buffer_load_dwordx4 v[28:31], v8, s[4:7], s41 offen sc1
    s_nop 15
    s_nop 9
    s_add_u32 s41, s70, 81920
    buffer_load_dwordx4 v[32:35], v8, s[4:7], s41 offen sc1
    s_waitcnt vmcnt(1)
    v_mfma_f32_16x16x32_bf16 v[104:107], v[12:15], v[28:31], v[116:119]
    v_cmp_u_f32 vcc, v28, v30
    s_nop 0
    s_nop 3
    s_cbranch_vccnz Lc02_C_t
Lc02_C_c:
    s_nop 0
    v_cvt_pk_bf16_f32 v164, v104, v105
    v_cvt_pk_bf16_f32 v165, v106, v107
    buffer_store_dwordx2 v[164:165], v9, s[4:7], s76 offen
    s_waitcnt vmcnt(2)
Lc02_join:
    s_add_u32 s40, s40, 1
    s_branch Lc02_loop
    s_nop 0
    s_nop 0
    s_nop 0
Lc02_fin:
    s_waitcnt lgkmcnt(0)
    v_and_or_b32 v160, v160, -2, s50
    buffer_store_dwordx4 v[160:163], v0, s[4:7], s71 offen
    s_endpgm
    s_nop 0
    s_nop 0
Lc02_pe:
    buffer_store_dwordx4 v[160:163], v0, s[4:7], s71 offen
    ds_read_b128 v[128:131], v0 offset:5632
    s_nop 0
    s_waitcnt lgkmcnt(0)
    v_and_or_b32 v128, v128, -2, s50
    buffer_store_dwordx4 v[128:131], v0, s[4:7], s71 offen offset:1024
    s_mov_b32 s71, 1073741824
    s_branch Lc02_pe_c
    s_nop 0
    s_nop 0
    s_nop 0
    s_nop 0
Lc02_sh:
    s_nop 15
    s_nop 15
    s_nop 15
    s_nop 15
    s_nop 15
    s_nop 15
    s_nop 15
    s_nop 15
    s_nop 15
    s_nop 15
    s_nop 15
    s_nop 15
    s_nop 11
    s_branch Lc02_Gdone
    s_nop 0
    s_nop 0
Lc02_Gr0:
    s_waitcnt vmcnt(4)
    v_cmp_u_f32_e64 vcc, v80, v84
    s_cbranch_vccz Lc02_Gk0
Lc02_Gf0:
    buffer_load_dwordx4 v[80:83], v10, s[4:7], s94 offen sc1
    buffer_load_dwordx4 v[84:87], v10, s[4:7], s95 offen sc1
    buffer_load_dwordx4 v[88:91], v10, s[4:7], s96 offen sc1
    buffer_load_dwordx4 v[92:95], v10, s[4:7], s97 offen sc1
    buffer_load_dwordx4 v[96:99], v10, s[4:7], s98 offen sc1
    buffer_load_dwordx4 v[100:103], v10, s[4:7], s99 offen sc1
    s_sub_u32 s12, s12, 1
    s_cbranch_scc1 L_abort
    s_and_b32 s52, s12, 15
    s_cbranch_scc1 Lc02_Gr0
    s_waitcnt vmcnt(0)
    v_cmp_eq_u32 s[32:33], s53, v80
    v_cmp_eq_u32 vcc, s53, v84
    s_nop 0
    s_or_b64 s[32:33], s[32:33], vcc
    s_cbranch_scc1 Lc02_Gf0
    s_branch Lc02_Gk0
    s_nop 0
    s_nop 0
    s_nop 0
    s_nop 0
Lc02_Gr1:
    s_waitcnt vmcnt(2)
    v_cmp_u_f32_e64 vcc, v88, v92
    s_cbranch_vccz Lc02_Gk1
Lc02_Gf1:
    buffer_load_dwordx4 v[88:91], v10, s[4:7], s96 offen sc1
    buffer_load_dwordx4 v[92:95], v10, s[4:7], s97 offen sc1
    buffer_load_dwordx4 v[96:99], v10, s[4:7], s98 offen sc1
    buffer_load_dwordx4 v[100:103], v10, s[4:7], s99 offen sc1
    s_sub_u32 s12, s12, 1
    s_cbranch_scc1 L_abort
    s_and_b32 s52, s12, 15
    s_cbranch_scc1 Lc02_Gr1
    s_waitcnt vmcnt(0)
    v_cmp_eq_u32 s[32:33], s53, v88
    v_cmp_eq_u32 vcc, s53, v92
    s_nop 0
    s_or_b64 s[32:33], s[32:33], vcc
    s_cbranch_scc1 Lc02_Gf1
    s_branch Lc02_Gk1
Lc02_Gr2:
    s_waitcnt vmcnt(1)
    v_cmp_u_f32 vcc, v96, v96
    s_cbranch_vccz Lc02_Gk2
Lc02_Gf2:
    buffer_load_dwordx4 v[96:99], v10, s[4:7], s98 offen sc1
    buffer_load_dwordx4 v[100:103], v10, s[4:7], s99 offen sc1
    s_sub_u32 s12, s12, 1
    s_cbranch_scc1 L_abort
    s_and_b32 s52, s12, 15
    s_cbranch_scc1 Lc02_Gr2
    s_waitcnt vmcnt(0)
    v_cmp_eq_u32 s[32:33], s53, v96
    v_cmp_eq_u32 vcc, s53, v96
    s_nop 0
    s_or_b64 s[32:33], s[32:33], vcc
    s_cbranch_scc1 Lc02_Gf2
    s_branch Lc02_Gk2
    s_nop 0
    s_nop 0
    s_nop 0
    s_nop 0
    s_nop 0
Lc02_Gr3:
    s_waitcnt vmcnt(0)
    v_cmp_u_f32 vcc, v100, v100
    s_cbranch_vccz Lc02_Gk3
Lc02_Gf3:
    buffer_load_dwordx4 v[100:103], v10, s[4:7], s99 offen sc1
    s_sub_u32 s12, s12, 1
    s_cbranch_scc1 L_abort
    s_and_b32 s52, s12, 15
    s_cbranch_scc1 Lc02_Gr3
    s_waitcnt vmcnt(0)
    v_cmp_eq_u32 s[32:33], s53, v100
    v_cmp_eq_u32 vcc, s53, v100
    s_nop 0
    s_or_b64 s[32:33], s[32:33], vcc
    s_cbranch_scc1 Lc02_Gf3
    s_branch Lc02_Gk3
    s_nop 0
    s_nop 0
    s_nop 0
    s_nop 0
    s_nop 0
    s_nop 0
    s_nop 0
Lc02_C_t:
    s_add_u32 s41, s70, 163840
    buffer_load_dwordx4 v[28:31], v8, s[4:7], s41 offen sc1
    s_waitcnt vmcnt(1)
    v_mfma_f32_16x16x32_bf16 v[104:107], v[12:15], v[32:35], v[116:119]
    v_cmp_u_f32 vcc, v32, v34
    s_nop 0
    s_nop 3
    s_cbranch_vccz Lc02_C_c
    s_add_u32 s41, s70, 245760
    buffer_load_dwordx4 v[32:35], v8, s[4:7], s41 offen sc1
    s_waitcnt vmcnt(1)
    v_mfma_f32_16x16x32_bf16 v[104:107], v[12:15], v[28:31], v[116:119]
    v_cmp_u_f32 vcc, v28, v30
    s_nop 4
    s_cbranch_vccz Lc02_C_c
    s_waitcnt vmcnt(0)
    v_mfma_f32_16x16x32_bf16 v[104:107], v[12:15], v[32:35], v[116:119]
    v_cmp_u_f32 vcc, v32, v34
    s_nop 4
    s_cbranch_vccz Lc02_C_c
Lc02_C_x:
    s_add_u32 s41, s70, 0
    buffer_load_dwordx4 v[28:31], v8, s[4:7], s41 offen sc1
    s_sub_u32 s12, s12, 1
    s_cbranch_scc1 L_abort
    s_and_b32 s52, s12, 15
    s_cbranch_scc1 Lc02_C_r
    s_waitcnt vmcnt(0)
    v_cmp_eq_u32 s[32:33], s53, v28
    v_cmp_eq_u32 vcc, s53, v30
    s_nop 0
    s_or_b64 s[32:33], s[32:33], vcc
    s_cbranch_scc1 Lc02_C_x
    v_mfma_f32_16x16x32_bf16 v[104:107], v[12:15], v[28:31], v[116:119]
    s_nop 5
    s_branch Lc02_C_c
    s_nop 0
    s_nop 0
    s_nop 0
Lc02_C_r:
    s_waitcnt vmcnt(0)
    v_mfma_f32_16x16x32_bf16 v[104:107], v[12:15], v[28:31], v[116:119]
    v_cmp_u_f32 vcc, v28, v30
    s_nop 4
    s_cbranch_vccz Lc02_C_c
    s_branch Lc02_C_x
    .p2align 6
Lc03_loop:
    s_barrier
    s_and_b32 s41, s40, 1
    s_lshl_b32 s69, s41, 11
    s_lshl_b32 s41, s41, 13
    s_add_u32 s41, s41, 8192
    v_add_u32_e64 v10, s41, v0
    ds_read_b128 v[72:75], v10 offset:0
    s_nop 0
    s_nop 12
    buffer_load_dwordx4 v[28:31], v0, s[4:7], s67 offen offset:0 sc1
    ds_read_b128 v[76:79], v10 offset:1024
    ds_read_b128 v[80:83], v10 offset:2048
    ds_read_b128 v[84:87], v10 offset:3072
    ds_read_b128 v[88:91], v10 offset:4096
    s_nop 0
    s_nop 2
    buffer_load_dwordx4 v[32:35], v0, s[4:7], s67 offen offset:1024 sc1
    ds_read_b128 v[92:95], v10 offset:5120
    ds_read_b128 v[96:99], v10 offset:6144
    ds_read_b128 v[100:103], v10 offset:7168
    s_add_u32 s49, s69, s60
    s_nop 3
    buffer_load_dwordx4 v[36:39], v0, s[4:7], s67 offen offset:2048 sc1
    s_and_b32 s41, s40, 3
    s_mul_i32 s70, s41, 327680
    s_add_u32 s70, s70, s57
    s_mul_i32 s71, s41, 98304
    s_nop 0
    s_nop 2
    buffer_load_dwordx4 v[40:43], v0, s[4:7], s67 offen offset:3072 sc1
    s_add_u32 s71, s71, s64
    s_lshl_b32 s75, s41, 15
    s_bfe_u32 s50, s40, 0x10002
    s_nop 4
    buffer_load_dwordx4 v[44:47], v0, s[4:7], s68 offen offset:0 sc1
    s_waitcnt vmcnt(4)
    v_cmp_u_f32 vcc, v28, v30
    s_cbranch_vccnz Lc0s_Df0
Lc03_Dk0:
    v_smfmac_f32_16x16x64_bf16 v[48:51], v[28:31], a[0:7], v2
    s_waitcnt vmcnt(3)
    v_cmp_u_f32 vcc, v32, v34
    v_smfmac_f32_16x16x64_bf16 v[52:55], v[28:31], a[80:87], v2
    v_smfmac_f32_16x16x64_bf16 v[56:59], v[28:31], a[40:47], v2
    v_smfmac_f32_16x16x64_bf16 v[60:63], v[28:31], a[120:127], v2
    s_cbranch_vccnz Lc0s_Df1
Lc03_Dk1:
    v_smfmac_f32_16x16x64_bf16 v[48:51], v[32:35], a[8:15], v2
    s_waitcnt vmcnt(2)
    v_cmp_u_f32_e64 vcc, v36, v38
    v_smfmac_f32_16x16x64_bf16 v[52:55], v[32:35], a[88:95], v2
    v_smfmac_f32_16x16x64_bf16 v[56:59], v[32:35], a[48:55], v2
    v_smfmac_f32_16x16x64_bf16 v[60:63], v[32:35], a[128:135], v2
    s_cbranch_vccnz Lc0s_Df2
Lc03_Dk2:
    v_smfmac_f32_16x16x64_bf16 v[48:51], v[36:39], a[16:23], v2
    s_waitcnt vmcnt(1)
    v_cmp_u_f32_e64 vcc, v40, v42
    v_smfmac_f32_16x16x64_bf16 v[52:55], v[36:39], a[96:103], v2
    v_smfmac_f32_16x16x64_bf16 v[56:59], v[36:39], a[56:63], v2
    v_smfmac_f32_16x16x64_bf16 v[60:63], v[36:39], a[136:143], v2
    s_cbranch_vccnz Lc0s_Df3
Lc03_Dk3:
    v_smfmac_f32_16x16x64_bf16 v[48:51], v[40:43], a[24:31], v2
    s_waitcnt vmcnt(0)
    v_cmp_u_f32_e64 vcc, v44, v46
    v_smfmac_f32_16x16x64_bf16 v[52:55], v[40:43], a[104:111], v2
    v_smfmac_f32_16x16x64_bf16 v[56:59], v[40:43], a[64:71], v2
    v_smfmac_f32_16x16x64_bf16 v[60:63], v[40:43], a[144:151], v2
    s_cbranch_vccnz Lc0s_Df4
Lc03_Dk4:
    v_smfmac_f32_16x16x64_bf16 v[48:51], v[44:47], a[32:39], v2
    v_smfmac_f32_16x16x64_bf16 v[52:55], v[44:47], a[112:119], v2
    v_smfmac_f32_16x16x64_bf16 v[56:59], v[44:47], a[72:79], v2
    v_smfmac_f32_16x16x64_bf16 v[60:63], v[44:47], a[152:159], v2
Lc03_Ddone:
    v_permlane32_swap_b32 v48, v52
    v_permlane32_swap_b32 v49, v53
    v_permlane32_swap_b32 v50, v54
    v_permlane32_swap_b32_e64 v51, v55
    v_pk_add_f32 v[48:49], v[48:49], v[52:53]
    v_pk_add_f32 v[50:51], v[50:51], v[54:55]
    v_cvt_pk_bf16_f32 v48, v48, v49
    v_cvt_pk_bf16_f32 v49, v50, v51
    ds_write_b64 v3, v[48:49] offset:0
    v_permlane32_swap_b32 v56, v60
    v_permlane32_swap_b32 v57, v61
    v_permlane32_swap_b32 v58, v62
    v_permlane32_swap_b32 v59, v63
    v_pk_add_f32 v[56:57], v[56:57], v[60:61]
    v_pk_add_f32 v[58:59], v[58:59], v[62:63]
    v_cvt_pk_bf16_f32 v56, v56, v57
    v_cvt_pk_bf16_f32 v57, v58, v59
    ds_write_b64 v3, v[56:57] offset:128
    v_smfmac_f32_16x16x64_bf16 v[64:67], v[28:31], a[160:167], v2
    v_smfmac_f32_16x16x64_bf16 v[68:71], v[28:31], a[200:207], v2
Lc03_Dback:
    v_smfmac_f32_16x16x64_bf16 v[64:67], v[32:35], a[168:175], v2
    s_waitcnt lgkmcnt(0)
    s_barrier
    v_smfmac_f32_16x16x64_bf16 v[68:71], v[32:35], a[208:215], v2
    v_smfmac_f32_16x16x64_bf16 v[64:67], v[36:39], a[176:183], v2
    v_smfmac_f32_16x16x64_bf16 v[68:71], v[36:39], a[216:223], v2
    ds_read_b64_tr_b16 v[48:49], v4 offset:0
    ds_read_b64_tr_b16 v[50:51], v4 offset:128
    ds_read_b64_tr_b16 v[52:53], v4 offset:2304
    v_smfmac_f32_16x16x64_bf16 v[64:67], v[40:43], a[184:191], v2
    ds_read_b64_tr_b16 v[54:55], v4 offset:2432
    ds_read_b64_tr_b16 v[56:57], v4 offset:256
    ds_read_b64_tr_b16 v[58:59], v4 offset:384
    v_smfmac_f32_16x16x64_bf16 v[68:71], v[40:43], a[224:231], v2
    ds_read_b64_tr_b16 v[60:61], v4 offset:2560
    ds_read_b64_tr_b16 v[62:63], v4 offset:2688
    v_smfmac_f32_16x16x64_bf16 v[64:67], v[44:47], a[192:199], v2
    v_smfmac_f32_16x16x64_bf16 v[68:71], v[44:47], a[232:239], v2
    s_add_u32 s43, s61, s69
    s_add_u32 s44, s62, s69
    v_add_u32 v143, s40, 1
    s_nop 0
    s_waitcnt lgkmcnt(4)
    v_mfma_f32_16x16x32_bf16 v[112:115], v[52:55], v[48:51], 0
    s_nop 0
    s_waitcnt lgkmcnt(0)
    v_mfma_f32_16x16x32_bf16 v[112:115], v[60:63], v[56:59], v[112:115]
    v_mfma_f32_16x16x32_bf16 v[104:107], v[72:75], v[48:51], 0
    v_mfma_f32_16x16x32_bf16 v[104:107], v[80:83], v[56:59], v[104:107]
    v_mfma_f32_16x16x32_bf16 v[108:111], v[76:79], v[48:51], 0
    v_add_f32_dpp v24, v112, v112 row_ror:8 row_mask:0xf bank_mask:0x3
    v_add_f32_dpp v25, v113, v113 row_ror:8 row_mask:0xf bank_mask:0x3
    v_mfma_f32_16x16x32_bf16 v[108:111], v[84:87], v[56:59], v[108:111]
    v_add_f32_dpp v24, v114, v114 row_ror:8 row_mask:0xf bank_mask:0xc
    v_add_f32_dpp v25, v115, v115 row_ror:8 row_mask:0xf bank_mask:0xc
    v_add_f32_dpp v20, v104, v104 row_ror:8 row_mask:0xf bank_mask:0x3
    v_add_f32_dpp v21, v105, v105 row_ror:8 row_mask:0xf bank_mask:0x3
    v_add_f32_dpp v22, v106, v106 row_ror:8 row_mask:0xf bank_mask:0x3
    v_add_f32_dpp v23, v107, v107 row_ror:8 row_mask:0xf bank_mask:0x3
    v_permlane32_swap_b32 v24, v25
    v_add_f32 v24, v24, v25
    v_add_f32_dpp v20, v108, v108 row_ror:8 row_mask:0xf bank_mask:0xc
    v_add_f32_dpp v21, v109, v109 row_ror:8 row_mask:0xf bank_mask:0xc
    v_add_f32_dpp v22, v110, v110 row_ror:8 row_mask:0xf bank_mask:0xc
    v_add_f32_dpp v23, v111, v111 row_ror:8 row_mask:0xf bank_mask:0xc
    v_permlane32_swap_b32 v64, v68
    v_permlane32_swap_b32 v65, v69
    v_permlane32_swap_b32 v66, v70
    v_permlane32_swap_b32 v67, v71
    v_pk_add_f32 v[64:65], v[64:65], v[68:69]
    v_pk_add_f32 v[66:67], v[66:67], v[70:71]
    v_cvt_pk_bf16_f32 v64, v64, v65
    v_cvt_pk_bf16_f32 v65, v66, v67
    ds_write_b64 v5, v[64:65]
    s_nop 0
    s_nop 2
    buffer_load_dwordx4 v[116:119], v0, s[4:7], s43 offen sc1
    buffer_load_dwordx4 v[122:125], v0, s[4:7], s44 offen sc1
    buffer_load_dword v120, v1, s[4:7], s43 offen offset:1024 sc1
    buffer_load_dword v126, v1, s[4:7], s44 offen offset:1024 sc1
    v_pk_mul_f32 v[20:21], v[20:21], s[34:35]
    v_pk_mul_f32 v[22:23], v[22:23], s[34:35]
    v_mul_f32 v24, s34, v24
    s_cmp_eq_u32 s40, 63
    s_waitcnt lgkmcnt(0)
    s_barrier
    ds_read_b128 v[128:131], v0 offset:4608
    ds_read_b128 v[132:135], v0 offset:5632
    ds_read_b128 v[160:163], v0 offset:5632
    s_cbranch_scc1 Lc03_fin
    s_add_u32 s41, s75, s56
    v_add_u32 v10, s41, v0
    v_mov_b64 v[64:65], 0
    v_mov_b64 v[66:67], 0
    v_mov_b64 v[68:69], 0
    v_mov_b64 v[70:71], 0
    s_nop 5
    buffer_load_dwordx4 v[144:147], v0, s[4:7], s43 offen sc1
    buffer_load_dwordx4 v[150:153], v0, s[4:7], s44 offen sc1
    buffer_load_dword v148, v1, s[4:7], s43 offen offset:1024 sc1
    buffer_load_dword v154, v1, s[4:7], s44 offen offset:1024 sc1
Lc03_A_chk:
    s_nop 0
    s_waitcnt vmcnt(7)
    v_pk_fma_f32 v[104:105], v[116:117], s[34:35], v[20:21]
    v_pk_fma_f32 v[106:107], v[118:119], s[34:35], v[22:23]
    s_nop 0
    s_waitcnt vmcnt(4)
    v_pk_fma_f32 v[104:105], v[122:123], s[34:35], v[104:105]
    v_pk_fma_f32 v[106:107], v[124:125], s[34:35], v[106:107]
    v_fma_f32 v108, v120, s34, v24
    v_maximum3_f32 v164, v104, v105, v106
    v_fmac_f32_e64 v108, s34, v126
    v_maximum3_f32 v164, v164, v107, v108
    v_cmp_u_f32 vcc, v164, v164
    s_add_u32 s42, s75, s55
    v_max_f32_dpp v165, v164, v164 row_ror:8 row_mask:0xf bank_mask:0xf
    v_max_f32_dpp v164, v164, v164 row_ror:8 row_mask:0xf bank_mask:0xf
    s_nop 1
    v_permlane16_swap_b32 v164, v165
    v_max_f32 v166, v164, v165
    v_max_f32 v164, v164, v165
    s_cbranch_vccnz Lc03_A_s
Lc03_A_c:
    buffer_store_dword v143, off, s[4:7], s73
    v_permlane32_swap_b32 v164, v166
    v_max_f32 v164, v164, v166
    v_pk_add_f32 v[104:105], v[104:105], v[164:165] op_sel_hi:[1,0] neg_lo:[0,1] neg_hi:[0,1]
    v_pk_add_f32 v[106:107], v[106:107], v[164:165] op_sel_hi:[1,0] neg_lo:[0,1] neg_hi:[0,1]
    v_exp_f32 v104, v104
    v_exp_f32 v105, v105
    v_exp_f32 v106, v106
    v_cvt_pk_bf16_f32 v136, v104, v105
    v_exp_f32 v107, v107
    v_sub_f32 v108, v108, v164
    v_cvt_pk_bf16_f32 v137, v106, v107
    v_mov_b32_dpp v138, v136 row_shl:8 row_mask:0xf bank_mask:0xf bound_ctrl:0
    v_exp_f32_e64 v140, v108
    v_mov_b32_dpp v139, v137 row_shl:8 row_mask:0xf bank_mask:0xf bound_ctrl:0
    v_cndmask_b32 v30, v136, 0, s[36:37]
    v_cndmask_b32 v31, v137, 0, s[36:37]
    v_cndmask_b32 v136, 0, v136, s[36:37]
    v_cndmask_b32 v137, 0, v137, s[36:37]
    v_mov_b32 v142, v140
    s_nop 0
    v_mfma_f32_16x16x32_bf16 v[112:115], a[240:243], v[136:139], 0
    v_mov_b32_dpp v28, v136 row_shr:8 row_mask:0xf bank_mask:0xf bound_ctrl:0
    v_mov_b32_dpp v29, v137 row_shr:8 row_mask:0xf bank_mask:0xf bound_ctrl:0
    v_mfma_f32_16x16x32_bf16 v[48:51], v[88:91], v[136:139], 0
    v_permlane32_swap_b32_e64 v140, v142
    v_mfma_f32_16x16x32_bf16 v[52:55], v[92:95], v[136:139], 0
    v_cvt_pk_bf16_f32 v140, v140, v142
    s_nop 0
    s_waitcnt lgkmcnt(0)
    v_mfma_f32_16x16x32_bf16 v[48:51], v[96:99], v[28:31], v[48:51]
    v_cndmask_b32 v34, 0, v140, s[36:37]
    v_mov_b32_dpp v35, v140 row_shl:8 row_mask:0xf bank_mask:0xf bound_ctrl:0
    v_mfma_f32_16x16x32_bf16 v[52:55], v[100:103], v[28:31], v[52:55]
    v_mov_b32_dpp v32, v140 row_shr:8 row_mask:0xf bank_mask:0xf bound_ctrl:0
    v_cndmask_b32 v33, v140, 0, s[36:37]
    v_mfma_f32_16x16x16_bf16 v[112:115], a[244:245], v[34:35], v[112:115]
    v_mfma_f32_16x16x16_bf16 v[48:51], v[128:129], v[34:35], v[48:51]
    v_mfma_f32_16x16x16_bf16 v[48:51], v[132:133], v[32:33], v[48:51]
    v_add_f32_dpp v166, v112, v112 row_ror:8 row_mask:0xf bank_mask:0xf
    v_mfma_f32_16x16x16_bf16 v[52:55], v[130:131], v[34:35], v[52:55]
    v_rcp_f32 v166, v166
    v_mfma_f32_16x16x16_bf16 v[52:55], v[134:135], v[32:33], v[52:55]
    v_mul_f32 v48, v48, v166
    v_mul_f32 v49, v49, v166
    v_mul_f32 v50, v50, v166
    v_mul_f32 v51, v51, v166
    v_cvt_pk_bf16_f32 v72, v48, v49
    v_cvt_pk_bf16_f32 v73, v50, v51
    s_nop 1
    v_pk_mul_f32 v[52:53], v[52:53], v[166:167] op_sel_hi:[1,0]
    v_pk_mul_f32 v[54:55], v[54:55], v[166:167] op_sel_hi:[1,0]
    v_cvt_pk_bf16_f32 v74, v52, v53
    v_cvt_pk_bf16_f32 v75, v54, v55
    buffer_store_dwordx4 v[72:75], v0, s[4:7], s42 offen
    s_cmp_ge_u32 s39, 20
    s_barrier
    s_cbranch_scc1 Lc03_sh
    s_nop 10
    buffer_load_dwordx4 v[80:83], v10, s[4:7], s94 offen sc1
    s_add_u32 s41, s40, 1
    s_and_b32 s41, s41, 3
    s_nop 3
    buffer_load_dwordx4 v[84:87], v10, s[4:7], s95 offen sc1
    s_lshl_b32 s41, s41, 14
    s_add_u32 s67, s41, s58
    s_nop 3
    buffer_load_dwordx4 v[88:91], v10, s[4:7], s96 offen sc1
    s_add_u32 s68, s67, 4096
    s_add_u32 s76, s41, s59
    s_nop 3
    buffer_load_dwordx4 v[92:95], v10, s[4:7], s97 offen sc1
    v_and_or_b32 v160, v160, -2, s50
    s_nop 4
    buffer_load_dwordx4 v[96:99], v10, s[4:7], s98 offen sc1
    s_nop 5
    buffer_load_dwordx4 v[100:103], v10, s[4:7], s99 offen sc1
    s_waitcnt vmcnt(4)
    v_cmp_u_f32 vcc, v80, v84
    s_cbranch_vccnz Lc03_Gf0
Lc03_Gk0:
    v_smfmac_f32_16x16x64_bf16 v[64:67], v[80:83], v[168:175], v2
    s_waitcnt vmcnt(2)
    v_cmp_u_f32_e64 vcc, v88, v92
    v_smfmac_f32_16x16x64_bf16 v[68:71], v[80:83], v[176:183], v2
    v_smfmac_f32_16x16x64_bf16 v[64:67], v[84:87], v[184:191], v2
    v_smfmac_f32_16x16x64_bf16 v[68:71], v[84:87], v[192:199], v2
    s_cbranch_vccnz Lc03_Gf1
Lc03_Gk1:
    v_smfmac_f32_16x16x64_bf16 v[64:67], v[88:91], v[200:207], v2
    s_waitcnt vmcnt(1)
    v_cmp_u_f32_e64 vcc, v96, v96
    v_smfmac_f32_16x16x64_bf16 v[68:71], v[88:91], v[208:215], v2
    v_smfmac_f32_16x16x64_bf16 v[64:67], v[92:95], v[216:223], v2
    v_smfmac_f32_16x16x64_bf16 v[68:71], v[92:95], v[224:231], v2
    s_cbranch_vccnz Lc03_Gf2
Lc03_Gk2:
    s_waitcnt vmcnt(0)
    v_cmp_u_f32_e64 vcc, v100, v100
    v_smfmac_f32_16x16x64_bf16 v[64:67], v[96:99], v[232:239], v2
    v_smfmac_f32_16x16x64_bf16 v[68:71], v[96:99], v[240:247], v2
    s_cbranch_vccnz Lc03_Gf3
Lc03_Gk3:
    v_smfmac_f32_16x16x64_bf16 v[64:67], v[100:103], v[248:255], v2
    v_smfmac_f32_16x16x64_bf16 v[68:71], v[100:103], a[248:255], v2
Lc03_Gdone:
    buffer_store_dwordx4 v[160:163], v0, s[4:7], s71 offen
    s_nop 2
    v_cvt_pk_bf16_f32 v64, v64, v65
    v_cvt_pk_bf16_f32 v65, v66, v67
    ds_write_b64 v11, v[64:65] offset:0
    s_nop 0
    v_cvt_pk_bf16_f32 v68, v68, v69
    v_cvt_pk_bf16_f32 v69, v70, v71
    ds_write_b64 v11, v[68:69] offset:256
    s_waitcnt lgkmcnt(0)
    s_barrier
    ds_read_b128 v[80:83], v26 offset:0
    ds_read_b128 v[84:87], v26 offset:512
    buffer_store_dwordx4 v[16:19], v0, s[4:7], s49 offen
    s_waitcnt lgkmcnt(1)
    v_mfma_f32_16x16x32_bf16 v[116:119], v[80:83], v[12:15], 0
    s_waitcnt lgkmcnt(0)
    v_mfma_f32_16x16x32_bf16 v[116:119], v[84:87], v[12:15], v[116:119]
    s_nop 7
    v_cvt_pk_bf16_f32 v164, v116, v117
    v_cvt_pk_bf16_f32 v165, v118, v119
    buffer_store_dwordx2 v[164:165], v7, s[4:7], s70 offen sc1
    buffer_store_dword v16, v1, s[4:7], s49 offen offset:1024
    s_nop 15
    s_nop 15
    s_nop 15
    s_nop 15
    s_nop 4
    v_mov_b64 v[48:49], 0
    v_mov_b64 v[50:51], 0
    v_mov_b64 v[52:53], 0
    v_mov_b64 v[54:55], 0
    v_mov_b64 v[56:57], 0
    v_mov_b64 v[58:59], 0
    v_mov_b64 v[60:61], 0
    v_mov_b64 v[62:63], 0
    v_mov_b64 v[64:65], 0
    v_mov_b64 v[66:67], 0
    v_mov_b64 v[68:69], 0
    v_mov_b64 v[70:71], 0
    s_add_u32 s41, s70, 0
    buffer_load_dwordx4 v[28:31], v8, s[4:7], s41 offen sc1
    s_nop 15
    s_nop 9
    s_add_u32 s41, s70, 81920
    buffer_load_dwordx4 v[32:35], v8, s[4:7], s41 offen sc1
    s_waitcnt vmcnt(1)
    v_mfma_f32_16x16x32_bf16 v[104:107], v[12:15], v[28:31], v[116:119]
    v_cmp_u_f32 vcc, v28, v30
    s_nop 0
    s_nop 3
    s_cbranch_vccnz Lc03_C_t
Lc03_C_c:
    s_nop 0
    v_cvt_pk_bf16_f32 v164, v104, v105
    v_cvt_pk_bf16_f32 v165, v106, v107
    buffer_store_dwordx2 v[164:165], v9, s[4:7], s76 offen
    s_waitcnt vmcnt(2)
Lc03_join:
    s_add_u32 s40, s40, 1
    s_branch Lc03_loop
    s_nop 0
    s_nop 0
    s_nop 0
    s_nop 0
    s_nop 0
    s_nop 0
    s_nop 0
Lc03_fin:
    s_waitcnt lgkmcnt(0)
    v_and_or_b32 v160, v160, -2, s50
    buffer_store_dwordx4 v[160:163], v0, s[4:7], s71 offen
    s_endpgm
    s_nop 0
    s_nop 0
Lc03_A_s:
    buffer_load_dwordx4 v[116:119], v0, s[4:7], s43 offen sc1
    buffer_load_dwordx4 v[122:125], v0, s[4:7], s44 offen sc1
    buffer_load_dword v120, v1, s[4:7], s43 offen offset:1024 sc1
    buffer_load_dword v126, v1, s[4:7], s44 offen offset:1024 sc1
    s_waitcnt vmcnt(7)
    v_pk_fma_f32 v[104:105], v[144:145], s[34:35], v[20:21]
    v_pk_fma_f32 v[106:107], v[146:147], s[34:35], v[22:23]
    s_waitcnt vmcnt(4)
    v_pk_fma_f32 v[104:105], v[150:151], s[34:35], v[104:105]
    v_pk_fma_f32 v[106:107], v[152:153], s[34:35], v[106:107]
    v_fma_f32 v108, v148, s34, v24
    v_maximum3_f32 v164, v104, v105, v106
    v_fmac_f32_e64 v108, s34, v154
    v_maximum3_f32 v164, v164, v107, v108
    v_cmp_u_f32 vcc, v164, v164
    s_nop 0
    v_max_f32_dpp v165, v164, v164 row_ror:8 row_mask:0xf bank_mask:0xf
    v_max_f32_dpp v164, v164, v164 row_ror:8 row_mask:0xf bank_mask:0xf
    s_nop 1
    v_permlane16_swap_b32 v164, v165
    v_max_f32 v166, v164, v165
    v_max_f32_e64 v164, v164, v165
    s_cbranch_vccz Lc03_A_c
    buffer_load_dwordx4 v[144:147], v0, s[4:7], s43 offen sc1
    buffer_load_dwordx4 v[150:153], v0, s[4:7], s44 offen sc1
    buffer_load_dword v148, v1, s[4:7], s43 offen offset:1024 sc1
    buffer_load_dword v154, v1, s[4:7], s44 offen offset:1024 sc1
    s_sub_u32 s12, s12, 1
    s_cbranch_scc1 L_abort
    s_and_b32 s52, s12, 15
    s_cbranch_scc1 Lc03_A_chk
    s_waitcnt vmcnt(0)
    v_cmp_eq_u32 s[32:33], s53, v116
    v_cmp_eq_u32 vcc, s53, v120
    s_nop 0
    s_or_b64 s[32:33], s[32:33], vcc
    v_cmp_eq_u32 vcc, s53, v122
    s_nop 0
    s_or_b64 s[32:33], s[32:33], vcc
    v_cmp_eq_u32 vcc, s53, v126
    s_nop 0
    s_or_b64 s[32:33], s[32:33], vcc
    s_cbranch_scc1 Lc03_A_s
    s_waitcnt vmcnt(3)
    v_pk_fma_f32 v[104:105], v[116:117], s[34:35], v[20:21]
    v_pk_fma_f32 v[106:107], v[118:119], s[34:35], v[22:23]
    s_nop 0
    s_waitcnt vmcnt(0)
    v_pk_fma_f32 v[104:105], v[122:123], s[34:35], v[104:105]
    v_pk_fma_f32 v[106:107], v[124:125], s[34:35], v[106:107]
    v_fma_f32 v108, v120, s34, v24
    v_maximum3_f32 v164, v104, v105, v106
    v_fmac_f32_e64 v108, s34, v126
    v_maximum3_f32 v164, v164, v107, v108
    v_cmp_u_f32 vcc, v164, v164
    s_add_u32 s42, s75, s55
    v_max_f32_dpp v165, v164, v164 row_ror:8 row_mask:0xf bank_mask:0xf
    v_max_f32_dpp v164, v164, v164 row_ror:8 row_mask:0xf bank_mask:0xf
    s_nop 1
    v_permlane16_swap_b32 v164, v165
    v_max_f32 v166, v164, v165
    v_max_f32 v164, v164, v165
    s_branch Lc03_A_c
    s_nop 0
    s_nop 0
    s_nop 0
Lc03_sh:
    s_add_u32 s41, s40, 1
    s_and_b32 s41, s41, 3
    s_lshl_b32 s41, s41, 14
    s_add_u32 s67, s41, s58
    s_add_u32 s68, s67, 4096
    s_add_u32 s76, s41, s59
    v_and_or_b32 v160, v160, -2, s50
    s_nop 15
    s_nop 15
    s_nop 15
    s_nop 15
    s_nop 15
    s_nop 15
    s_nop 15
    s_nop 15
    s_nop 15
    s_nop 15
    s_nop 15
    s_nop 15
    s_nop 11
    s_branch Lc03_Gdone
    s_nop 0
Lc03_Gr0:
    s_waitcnt vmcnt(4)
    v_cmp_u_f32_e64 vcc, v80, v84
    s_cbranch_vccz Lc03_Gk0
Lc03_Gf0:
    buffer_load_dwordx4 v[80:83], v10, s[4:7], s94 offen sc1
    buffer_load_dwordx4 v[84:87], v10, s[4:7], s95 offen sc1
    buffer_load_dwordx4 v[88:91], v10, s[4:7], s96 offen sc1
    buffer_load_dwordx4 v[92:95], v10, s[4:7], s97 offen sc1
    buffer_load_dwordx4 v[96:99], v10, s[4:7], s98 offen sc1
    buffer_load_dwordx4 v[100:103], v10, s[4:7], s99 offen sc1
    s_sub_u32 s12, s12, 1
    s_cbranch_scc1 L_abort
    s_and_b32 s52, s12, 15
    s_cbranch_scc1 Lc03_Gr0
    s_waitcnt vmcnt(0)
    v_cmp_eq_u32 s[32:33], s53, v80
    v_cmp_eq_u32 vcc, s53, v84
    s_nop 0
    s_or_b64 s[32:33], s[32:33], vcc
    s_cbranch_scc1 Lc03_Gf0
    s_branch Lc03_Gk0
    s_nop 0
    s_nop 0
    s_nop 0
    s_nop 0
Lc03_Gr1:
    s_waitcnt vmcnt(2)
    v_cmp_u_f32_e64 vcc, v88, v92
    s_cbranch_vccz Lc03_Gk1
Lc03_Gf1:
    buffer_load_dwordx4 v[88:91], v10, s[4:7], s96 offen sc1
    buffer_load_dwordx4 v[92:95], v10, s[4:7], s97 offen sc1
    buffer_load_dwordx4 v[96:99], v10, s[4:7], s98 offen sc1
    buffer_load_dwordx4 v[100:103], v10, s[4:7], s99 offen sc1
    s_sub_u32 s12, s12, 1
    s_cbranch_scc1 L_abort
    s_and_b32 s52, s12, 15
    s_cbranch_scc1 Lc03_Gr1
    s_waitcnt vmcnt(0)
    v_cmp_eq_u32 s[32:33], s53, v88
    v_cmp_eq_u32 vcc, s53, v92
    s_nop 0
    s_or_b64 s[32:33], s[32:33], vcc
    s_cbranch_scc1 Lc03_Gf1
    s_branch Lc03_Gk1
Lc03_Gr2:
    s_waitcnt vmcnt(1)
    v_cmp_u_f32 vcc, v96, v96
    s_cbranch_vccz Lc03_Gk2
Lc03_Gf2:
    buffer_load_dwordx4 v[96:99], v10, s[4:7], s98 offen sc1
    buffer_load_dwordx4 v[100:103], v10, s[4:7], s99 offen sc1
    s_sub_u32 s12, s12, 1
    s_cbranch_scc1 L_abort
    s_and_b32 s52, s12, 15
    s_cbranch_scc1 Lc03_Gr2
    s_waitcnt vmcnt(0)
    v_cmp_eq_u32 s[32:33], s53, v96
    v_cmp_eq_u32 vcc, s53, v96
    s_nop 0
    s_or_b64 s[32:33], s[32:33], vcc
    s_cbranch_scc1 Lc03_Gf2
    s_branch Lc03_Gk2
    s_nop 0
    s_nop 0
    s_nop 0
    s_nop 0
    s_nop 0
Lc03_Gr3:
    s_waitcnt vmcnt(0)
    v_cmp_u_f32 vcc, v100, v100
    s_cbranch_vccz Lc03_Gk3
Lc03_Gf3:
    buffer_load_dwordx4 v[100:103], v10, s[4:7], s99 offen sc1
    s_sub_u32 s12, s12, 1
    s_cbranch_scc1 L_abort
    s_and_b32 s52, s12, 15
    s_cbranch_scc1 Lc03_Gr3
    s_waitcnt vmcnt(0)
    v_cmp_eq_u32 s[32:33], s53, v100
    v_cmp_eq_u32 vcc, s53, v100
    s_nop 0
    s_or_b64 s[32:33], s[32:33], vcc
    s_cbranch_scc1 Lc03_Gf3
    s_branch Lc03_Gk3
    s_nop 0
    s_nop 0
    s_nop 0
    s_nop 0
    s_nop 0
    s_nop 0
    s_nop 0
Lc03_C_t:
    s_add_u32 s41, s70, 163840
    buffer_load_dwordx4 v[28:31], v8, s[4:7], s41 offen sc1
    s_waitcnt vmcnt(1)
    v_mfma_f32_16x16x32_bf16 v[104:107], v[12:15], v[32:35], v[116:119]
    v_cmp_u_f32 vcc, v32, v34
    s_nop 0
    s_nop 3
    s_cbranch_vccz Lc03_C_c
    s_add_u32 s41, s70, 245760
    buffer_load_dwordx4 v[32:35], v8, s[4:7], s41 offen sc1
    s_waitcnt vmcnt(1)
    v_mfma_f32_16x16x32_bf16 v[104:107], v[12:15], v[28:31], v[116:119]
    v_cmp_u_f32 vcc, v28, v30
    s_nop 4
    s_cbranch_vccz Lc03_C_c
    s_waitcnt vmcnt(0)
    v_mfma_f32_16x16x32_bf16 v[104:107], v[12:15], v[32:35], v[116:119]
    v_cmp_u_f32 vcc, v32, v34
    s_nop 4
    s_cbranch_vccz Lc03_C_c
Lc03_C_x:
    s_add_u32 s41, s70, 0
    buffer_load_dwordx4 v[28:31], v8, s[4:7], s41 offen sc1
    s_sub_u32 s12, s12, 1
    s_cbranch_scc1 L_abort
    s_and_b32 s52, s12, 15
    s_cbranch_scc1 Lc03_C_r
    s_waitcnt vmcnt(0)
    v_cmp_eq_u32 s[32:33], s53, v28
    v_cmp_eq_u32 vcc, s53, v30
    s_nop 0
    s_or_b64 s[32:33], s[32:33], vcc
    s_cbranch_scc1 Lc03_C_x
    v_mfma_f32_16x16x32_bf16 v[104:107], v[12:15], v[28:31], v[116:119]
    s_nop 5
    s_branch Lc03_C_c
    s_nop 0
    s_nop 0
    s_nop 0
Lc03_C_r:
    s_waitcnt vmcnt(0)
    v_mfma_f32_16x16x32_bf16 v[104:107], v[12:15], v[28:31], v[116:119]
    v_cmp_u_f32 vcc, v28, v30
    s_nop 4
    s_cbranch_vccz Lc03_C_c
    s_branch Lc03_C_x
L4_start:
    s_lshr_b32 s38, s10, 5
    s_lshl_b32 s38, s38, 3
    s_and_b32 s39, s10, 7
    s_add_u32 s34, s38, s39
    s_lshr_b32 s35, s13, 1
    s_and_b32 s36, s13, 1
    v_lshlrev_b32 v1, 4, v0
    v_mov_b32 v2, 0
    s_lshl_b32 s38, s34, 2
    s_add_u32 s38, s38, s13
    s_lshl_b32 s38, s38, 6
    s_add_u32 s38, s38, s14
    s_add_u32 s38, s38, 1966080
    s_add_u32 s39, s38, 8192
    s_cmp_eq_u32 s13, 0
    s_cbranch_scc0 L4_novote
    v_mov_b32 v6, 1
    buffer_store_dword v6, v2, s[4:7], s38 offen sc1
    buffer_store_dword v6, v2, s[4:7], s39 offen sc1
    s_mov_b32 s40, 0
    s_waitcnt vmcnt(0)
    s_mov_b32 s84, 0
    s_mov_b32 s85, 0
    s_load_dword s84, s[4:5], s38 glc
    s_load_dword s85, s[4:5], s39 glc
    s_waitcnt lgkmcnt(1)
    s_sub_u32 s41, s85, s84
    s_waitcnt lgkmcnt(0)
    s_add_u32 s40, s40, s41
    s_mov_b32 s84, 0
    s_mov_b32 s85, 0
    s_load_dword s85, s[4:5], s39 glc
    s_load_dword s84, s[4:5], s38 glc
    s_waitcnt lgkmcnt(1)
    s_sub_u32 s41, s85, s84
    s_waitcnt lgkmcnt(0)
    s_add_u32 s40, s40, s41
    s_mov_b32 s84, 0
    s_mov_b32 s85, 0
    s_load_dword s84, s[4:5], s38 glc
    s_load_dword s85, s[4:5], s39 glc
    s_waitcnt lgkmcnt(1)
    s_sub_u32 s41, s85, s84
    s_waitcnt lgkmcnt(0)
    s_add_u32 s40, s40, s41
    s_mov_b32 s84, 0
    s_mov_b32 s85, 0
    s_load_dword s85, s[4:5], s39 glc
    s_load_dword s84, s[4:5], s38 glc
    s_waitcnt lgkmcnt(1)
    s_sub_u32 s41, s85, s84
    s_waitcnt lgkmcnt(0)
    s_add_u32 s40, s40, s41
    s_mov_b32 s84, 0
    s_mov_b32 s85, 0
    s_load_dword s84, s[4:5], s38 glc
    s_load_dword s85, s[4:5], s39 glc
    s_waitcnt lgkmcnt(1)
    s_sub_u32 s41, s85, s84
    s_waitcnt lgkmcnt(0)
    s_add_u32 s40, s40, s41
    s_mov_b32 s84, 0
    s_mov_b32 s85, 0
    s_load_dword s85, s[4:5], s39 glc
    s_load_dword s84, s[4:5], s38 glc
    s_waitcnt lgkmcnt(1)
    s_sub_u32 s41, s85, s84
    s_waitcnt lgkmcnt(0)
    s_add_u32 s40, s40, s41
    s_add_u32 s40, s40, 6
    s_lshl_b32 s40, s40, 16
    s_add_u32 s40, s40, 1
L4_novote:
    s_load_dwordx2 s[88:89], s[0:1], 8
    s_mov_b32 s90, 10240
    s_mov_b32 s91, 0x20000
    v_mov_b32 v16, 0x7f817f81
    v_mov_b32 v17, 0x7f817f81
    v_mov_b32 v18, 0x7f817f81
    v_mov_b32 v19, 0x7f817f81
    s_lshl_b32 s38, s34, 2
    s_add_u32 s38, s38, s13
    v_mov_b64 v[20:21], 0
    v_mov_b64 v[22:23], 0
    s_lshl_b32 s39, s38, 10
    s_add_u32 s39, s39, s14
    s_add_u32 s39, s39, 5505024
    buffer_store_dwordx4 v[20:23], v1, s[4:7], s39 offen sc1
    s_lshl_b32 s39, s38, 7
    s_add_u32 s39, s39, s14
    s_add_u32 s39, s39, 1982464
    s_mov_b64 exec, 0xff
    buffer_store_dwordx4 v[20:23], v1, s[4:7], s39 offen sc1
    s_mov_b64 exec, -1
    s_mul_i32 s39, s38, 13312
    s_add_u32 s39, s39, s14
    buffer_store_dwordx4 v[16:19], v1, s[4:7], s39 offen offset:0 sc1
    buffer_store_dwordx4 v[16:19], v1, s[4:7], s39 offen offset:1024 sc1
    buffer_store_dwordx4 v[16:19], v1, s[4:7], s39 offen offset:2048 sc1
    buffer_store_dwordx4 v[16:19], v1, s[4:7], s39 offen offset:3072 sc1
    s_add_u32 s39, s39, 4096
    buffer_store_dwordx4 v[16:19], v1, s[4:7], s39 offen offset:0 sc1
    buffer_store_dwordx4 v[16:19], v1, s[4:7], s39 offen offset:1024 sc1
    buffer_store_dwordx4 v[16:19], v1, s[4:7], s39 offen offset:2048 sc1
    buffer_store_dwordx4 v[16:19], v1, s[4:7], s39 offen offset:3072 sc1
    s_add_u32 s39, s39, 4096
    buffer_store_dwordx4 v[16:19], v1, s[4:7], s39 offen offset:0 sc1
    buffer_store_dwordx4 v[16:19], v1, s[4:7], s39 offen offset:1024 sc1
    buffer_store_dwordx4 v[16:19], v1, s[4:7], s39 offen offset:2048 sc1
    buffer_store_dwordx4 v[16:19], v1, s[4:7], s39 offen offset:3072 sc1
    s_add_u32 s39, s39, 4096
    buffer_store_dwordx4 v[16:19], v1, s[4:7], s39 offen offset:0 sc1
    s_lshr_b32 s39, s38, 5
    s_mul_i32 s39, s39, 32768
    s_mul_i32 s41, s38, 19456
    s_add_u32 s39, s39, s41
    s_add_u32 s39, s39, s14
    s_add_u32 s39, s39, 2097152
    s_cmp_eq_u32 s11, 0
    s_cbranch_scc0 L4_fg
    buffer_store_dwordx4 v[16:19], v1, s[4:7], s39 offen offset:0
    buffer_store_dwordx4 v[16:19], v1, s[4:7], s39 offen offset:1024
    buffer_store_dwordx4 v[16:19], v1, s[4:7], s39 offen offset:2048
    buffer_store_dwordx4 v[16:19], v1, s[4:7], s39 offen offset:3072
    s_add_u32 s39, s39, 4096
    buffer_store_dwordx4 v[16:19], v1, s[4:7], s39 offen offset:0
    buffer_store_dwordx4 v[16:19], v1, s[4:7], s39 offen offset:1024
    buffer_store_dwordx4 v[16:19], v1, s[4:7], s39 offen offset:2048
    buffer_store_dwordx4 v[16:19], v1, s[4:7], s39 offen offset:3072
    s_add_u32 s39, s39, 4096
    buffer_store_dwordx4 v[16:19], v1, s[4:7], s39 offen offset:0
    buffer_store_dwordx4 v[16:19], v1, s[4:7], s39 offen offset:1024
    buffer_store_dwordx4 v[16:19], v1, s[4:7], s39 offen offset:2048
    buffer_store_dwordx4 v[16:19], v1, s[4:7], s39 offen offset:3072
    s_add_u32 s39, s39, 4096
    buffer_store_dwordx4 v[16:19], v1, s[4:7], s39 offen offset:0
    buffer_store_dwordx4 v[16:19], v1, s[4:7], s39 offen offset:1024
    buffer_store_dwordx4 v[16:19], v1, s[4:7], s39 offen offset:2048
    buffer_store_dwordx4 v[16:19], v1, s[4:7], s39 offen offset:3072
    s_add_u32 s39, s39, 4096
    buffer_store_dwordx4 v[16:19], v1, s[4:7], s39 offen offset:0
    buffer_store_dwordx4 v[16:19], v1, s[4:7], s39 offen offset:1024
    buffer_store_dwordx4 v[16:19], v1, s[4:7], s39 offen offset:2048
    s_branch L4_fx
L4_fg:
    buffer_store_dwordx4 v[16:19], v1, s[4:7], s39 offen offset:0 sc1
    buffer_store_dwordx4 v[16:19], v1, s[4:7], s39 offen offset:1024 sc1
    buffer_store_dwordx4 v[16:19], v1, s[4:7], s39 offen offset:2048 sc1
    buffer_store_dwordx4 v[16:19], v1, s[4:7], s39 offen offset:3072 sc1
    s_add_u32 s39, s39, 4096
    buffer_store_dwordx4 v[16:19], v1, s[4:7], s39 offen offset:0 sc1
    buffer_store_dwordx4 v[16:19], v1, s[4:7], s39 offen offset:1024 sc1
    buffer_store_dwordx4 v[16:19], v1, s[4:7], s39 offen offset:2048 sc1
    buffer_store_dwordx4 v[16:19], v1, s[4:7], s39 offen offset:3072 sc1
    s_add_u32 s39, s39, 4096
    buffer_store_dwordx4 v[16:19], v1, s[4:7], s39 offen offset:0 sc1
    buffer_store_dwordx4 v[16:19], v1, s[4:7], s39 offen offset:1024 sc1
    buffer_store_dwordx4 v[16:19], v1, s[4:7], s39 offen offset:2048 sc1
    buffer_store_dwordx4 v[16:19], v1, s[4:7], s39 offen offset:3072 sc1
    s_add_u32 s39, s39, 4096
    buffer_store_dwordx4 v[16:19], v1, s[4:7], s39 offen offset:0 sc1
    buffer_store_dwordx4 v[16:19], v1, s[4:7], s39 offen offset:1024 sc1
    buffer_store_dwordx4 v[16:19], v1, s[4:7], s39 offen offset:2048 sc1
    buffer_store_dwordx4 v[16:19], v1, s[4:7], s39 offen offset:3072 sc1
    s_add_u32 s39, s39, 4096
    buffer_store_dwordx4 v[16:19], v1, s[4:7], s39 offen offset:0 sc1
    buffer_store_dwordx4 v[16:19], v1, s[4:7], s39 offen offset:1024 sc1
    buffer_store_dwordx4 v[16:19], v1, s[4:7], s39 offen offset:2048 sc1
L4_fx:
    s_and_b32 s39, s34, 7
    s_cbranch_scc1 L4_nod
    v_and_b32 v8, 7, v0
    v_lshrrev_b32 v9, 3, v0
    v_mul_u32_u24 v8, 1280, v8
    v_lshl_add_u32 v8, v9, 4, v8
    s_cmp_eq_u32 s13, 0
    s_cbranch_scc0 L4_ds
    s_waitcnt lgkmcnt(0)
    buffer_load_dwordx4 v[72:75], v8, s[88:91], 0 offen offset:0
    buffer_load_dwordx4 v[76:79], v8, s[88:91], 0 offen offset:128
    buffer_load_dwordx4 v[80:83], v8, s[88:91], 0 offen offset:256
    buffer_load_dwordx4 v[84:87], v8, s[88:91], 0 offen offset:384
    buffer_load_dwordx4 v[88:91], v8, s[88:91], 0 offen offset:512
    buffer_load_dwordx4 v[92:95], v8, s[88:91], 0 offen offset:640
    buffer_load_dwordx4 v[96:99], v8, s[88:91], 0 offen offset:768
    buffer_load_dwordx4 v[100:103], v8, s[88:91], 0 offen offset:896
    buffer_load_dwordx4 v[104:107], v8, s[88:91], 0 offen offset:1024
    buffer_load_dwordx4 v[108:111], v8, s[88:91], 0 offen offset:1152
    v_mov_b32 v9, 0x7fc17fc1
    s_waitcnt vmcnt(0)
    v_cmp_eq_u32 vcc, v16, v72
    s_nop 1
    v_cndmask_b32 v72, v72, v9, vcc
    v_cmp_eq_u32 vcc, v16, v74
    s_nop 1
    v_cndmask_b32 v74, v74, v9, vcc
    v_cmp_eq_u32 vcc, v16, v76
    s_nop 1
    v_cndmask_b32 v76, v76, v9, vcc
    v_cmp_eq_u32 vcc, v16, v78
    s_nop 1
    v_cndmask_b32 v78, v78, v9, vcc
    v_cmp_eq_u32 vcc, v16, v80
    s_nop 1
    v_cndmask_b32 v80, v80, v9, vcc
    v_cmp_eq_u32 vcc, v16, v82
    s_nop 1
    v_cndmask_b32 v82, v82, v9, vcc
    v_cmp_eq_u32 vcc, v16, v84
    s_nop 1
    v_cndmask_b32 v84, v84, v9, vcc
    v_cmp_eq_u32 vcc, v16, v86
    s_nop 1
    v_cndmask_b32 v86, v86, v9, vcc
    v_cmp_eq_u32 vcc, v16, v88
    s_nop 1
    v_cndmask_b32 v88, v88, v9, vcc
    v_cmp_eq_u32 vcc, v16, v90
    s_nop 1
    v_cndmask_b32 v90, v90, v9, vcc
    v_cmp_eq_u32 vcc, v16, v92
    s_nop 1
    v_cndmask_b32 v92, v92, v9, vcc
    v_cmp_eq_u32 vcc, v16, v94
    s_nop 1
    v_cndmask_b32 v94, v94, v9, vcc
    v_cmp_eq_u32 vcc, v16, v96
    s_nop 1
    v_cndmask_b32 v96, v96, v9, vcc
    v_cmp_eq_u32 vcc, v16, v98
    s_nop 1
    v_cndmask_b32 v98, v98, v9, vcc
    v_cmp_eq_u32 vcc, v16, v100
    s_nop 1
    v_cndmask_b32 v100, v100, v9, vcc
    v_cmp_eq_u32 vcc, v16, v102
    s_nop 1
    v_cndmask_b32 v102, v102, v9, vcc
    v_cmp_eq_u32 vcc, v16, v104
    s_nop 1
    v_cndmask_b32 v104, v104, v9, vcc
    v_cmp_eq_u32 vcc, v16, v106
    s_nop 1
    v_cndmask_b32 v106, v106, v9, vcc
    v_cmp_eq_u32 vcc, v16, v108
    s_nop 1
    v_cndmask_b32 v108, v108, v9, vcc
    v_cmp_eq_u32 vcc, v16, v110
    s_nop 1
    v_cndmask_b32 v110, v110, v9, vcc
    s_branch L4_dw
L4_ds:
    v_mov_b64 v[72:73], v[16:17]
    v_mov_b64 v[74:75], v[16:17]
    v_mov_b64 v[76:77], v[16:17]
    v_mov_b64 v[78:79], v[16:17]
    v_mov_b64 v[80:81], v[16:17]
    v_mov_b64 v[82:83], v[16:17]
    v_mov_b64 v[84:85], v[16:17]
    v_mov_b64 v[86:87], v[16:17]
    v_mov_b64 v[88:89], v[16:17]
    v_mov_b64 v[90:91], v[16:17]
    v_mov_b64 v[92:93], v[16:17]
    v_mov_b64 v[94:95], v[16:17]
    v_mov_b64 v[96:97], v[16:17]
    v_mov_b64 v[98:99], v[16:17]
    v_mov_b64 v[100:101], v[16:17]
    v_mov_b64 v[102:103], v[16:17]
    v_mov_b64 v[104:105], v[16:17]
    v_mov_b64 v[106:107], v[16:17]
    v_mov_b64 v[108:109], v[16:17]
    v_mov_b64 v[110:111], v[16:17]
L4_dw:
    s_lshl_b32 s39, s34, 13
    s_lshl_b32 s41, s13, 14
    s_add_u32 s39, s39, s41
    s_add_u32 s39, s39, s14
    s_add_u32 s39, s39, 5242880
    buffer_store_dwordx4 v[72:75], v1, s[4:7], s39 offen offset:0 sc1
    buffer_store_dwordx4 v[76:79], v1, s[4:7], s39 offen offset:1024 sc1
    buffer_store_dwordx4 v[80:83], v1, s[4:7], s39 offen offset:2048 sc1
    buffer_store_dwordx4 v[84:87], v1, s[4:7], s39 offen offset:3072 sc1
    s_add_u32 s39, s39, 4096
    buffer_store_dwordx4 v[88:91], v1, s[4:7], s39 offen offset:0 sc1
    buffer_store_dwordx4 v[92:95], v1, s[4:7], s39 offen offset:1024 sc1
    buffer_store_dwordx4 v[96:99], v1, s[4:7], s39 offen offset:2048 sc1
    buffer_store_dwordx4 v[100:103], v1, s[4:7], s39 offen offset:3072 sc1
    s_add_u32 s39, s39, 4096
    buffer_store_dwordx4 v[104:107], v1, s[4:7], s39 offen offset:0 sc1
    buffer_store_dwordx4 v[108:111], v1, s[4:7], s39 offen offset:1024 sc1
L4_nod:
    s_waitcnt vmcnt(0) lgkmcnt(0)
    s_barrier
    s_cmp_eq_u32 s13, 0
    s_cbranch_scc0 L4_nv
    v_mov_b32 v6, s15
    v_lshlrev_b32 v6, 2, v6
    v_add_u32 v6, 44, v6
    v_mov_b32 v7, s40
    s_mov_b64 exec, 1
    global_atomic_add v6, v7, s[8:9]
    s_mov_b64 exec, -1
L4_nv:
    s_load_dwordx2 s[92:93], s[0:1], 40
    s_mov_b32 s94, 7864320
    s_mov_b32 s95, 0x20000
    s_and_b32 s38, s34, 7
    s_mul_i32 s38, s38, 10240
    s_lshr_b32 s39, s34, 3
    s_lshl_b32 s39, s39, 2
    s_add_u32 s39, s39, s13
    s_mul_i32 s39, s39, 491520
    s_add_u32 s38, s38, s39
    s_waitcnt lgkmcnt(0)
    s_add_u32 s39, s38, 0
    buffer_load_dwordx4 v[128:131], v1, s[92:95], s39 offen offset:0
    buffer_load_dwordx4 v[132:135], v1, s[92:95], s39 offen offset:1024
    buffer_load_dwordx4 v[136:139], v1, s[92:95], s39 offen offset:2048
    buffer_load_dwordx4 v[140:143], v1, s[92:95], s39 offen offset:3072
    s_add_u32 s39, s38, 4096
    buffer_load_dwordx4 v[144:147], v1, s[92:95], s39 offen offset:0
    buffer_load_dwordx4 v[148:151], v1, s[92:95], s39 offen offset:1024
    buffer_load_dwordx4 v[152:155], v1, s[92:95], s39 offen offset:2048
    buffer_load_dwordx4 v[156:159], v1, s[92:95], s39 offen offset:3072
    s_add_u32 s39, s38, 8192
    buffer_load_dwordx4 v[160:163], v1, s[92:95], s39 offen offset:0
    buffer_load_dwordx4 v[164:167], v1, s[92:95], s39 offen offset:1024
    s_add_u32 s39, s38, 81920
    buffer_load_dwordx4 v[168:171], v1, s[92:95], s39 offen offset:0
    buffer_load_dwordx4 v[172:175], v1, s[92:95], s39 offen offset:1024
    buffer_load_dwordx4 v[176:179], v1, s[92:95], s39 offen offset:2048
    buffer_load_dwordx4 v[180:183], v1, s[92:95], s39 offen offset:3072
    s_add_u32 s39, s38, 86016
    buffer_load_dwordx4 v[184:187], v1, s[92:95], s39 offen offset:0
    buffer_load_dwordx4 v[188:191], v1, s[92:95], s39 offen offset:1024
    buffer_load_dwordx4 v[192:195], v1, s[92:95], s39 offen offset:2048
    buffer_load_dwordx4 v[196:199], v1, s[92:95], s39 offen offset:3072
    s_add_u32 s39, s38, 90112
    buffer_load_dwordx4 v[200:203], v1, s[92:95], s39 offen offset:0
    buffer_load_dwordx4 v[204:207], v1, s[92:95], s39 offen offset:1024
    s_add_u32 s39, s38, 163840
    buffer_load_dwordx4 v[208:211], v1, s[92:95], s39 offen offset:0
    buffer_load_dwordx4 v[212:215], v1, s[92:95], s39 offen offset:1024
    buffer_load_dwordx4 v[216:219], v1, s[92:95], s39 offen offset:2048
    buffer_load_dwordx4 v[220:223], v1, s[92:95], s39 offen offset:3072
    s_add_u32 s39, s38, 167936
    buffer_load_dwordx4 v[128:131], v1, s[92:95], s39 offen offset:0
    buffer_load_dwordx4 v[132:135], v1, s[92:95], s39 offen offset:1024
    buffer_load_dwordx4 v[136:139], v1, s[92:95], s39 offen offset:2048
    buffer_load_dwordx4 v[140:143], v1, s[92:95], s39 offen offset:3072
    s_add_u32 s39, s38, 172032
    buffer_load_dwordx4 v[144:147], v1, s[92:95], s39 offen offset:0
    buffer_load_dwordx4 v[148:151], v1, s[92:95], s39 offen offset:1024
    s_add_u32 s39, s38, 245760
    buffer_load_dwordx4 v[152:155], v1, s[92:95], s39 offen offset:0
    buffer_load_dwordx4 v[156:159], v1, s[92:95], s39 offen offset:1024
    buffer_load_dwordx4 v[160:163], v1, s[92:95], s39 offen offset:2048
    buffer_load_dwordx4 v[164:167], v1, s[92:95], s39 offen offset:3072
    s_add_u32 s39, s38, 249856
    buffer_load_dwordx4 v[168:171], v1, s[92:95], s39 offen offset:0
    buffer_load_dwordx4 v[172:175], v1, s[92:95], s39 offen offset:1024
    buffer_load_dwordx4 v[176:179], v1, s[92:95], s39 offen offset:2048
    buffer_load_dwordx4 v[180:183], v1, s[92:95], s39 offen offset:3072
    s_add_u32 s39, s38, 253952
    buffer_load_dwordx4 v[184:187], v1, s[92:95], s39 offen offset:0
    buffer_load_dwordx4 v[188:191], v1, s[92:95], s39 offen offset:1024
    s_add_u32 s39, s38, 327680
    buffer_load_dwordx4 v[192:195], v1, s[92:95], s39 offen offset:0
    buffer_load_dwordx4 v[196:199], v1, s[92:95], s39 offen offset:1024
    buffer_load_dwordx4 v[200:203], v1, s[92:95], s39 offen offset:2048
    buffer_load_dwordx4 v[204:207], v1, s[92:95], s39 offen offset:3072
    s_add_u32 s39, s38, 331776
    buffer_load_dwordx4 v[208:211], v1, s[92:95], s39 offen offset:0
    buffer_load_dwordx4 v[212:215], v1, s[92:95], s39 offen offset:1024
    buffer_load_dwordx4 v[216:219], v1, s[92:95], s39 offen offset:2048
    buffer_load_dwordx4 v[220:223], v1, s[92:95], s39 offen offset:3072
    s_add_u32 s39, s38, 335872
    buffer_load_dwordx4 v[128:131], v1, s[92:95], s39 offen offset:0
    buffer_load_dwordx4 v[132:135], v1, s[92:95], s39 offen offset:1024
    s_add_u32 s39, s38, 409600
    buffer_load_dwordx4 v[136:139], v1, s[92:95], s39 offen offset:0
    buffer_load_dwordx4 v[140:143], v1, s[92:95], s39 offen offset:1024
    buffer_load_dwordx4 v[144:147], v1, s[92:95], s39 offen offset:2048
    buffer_load_dwordx4 v[148:151], v1, s[92:95], s39 offen offset:3072
    s_add_u32 s39, s38, 413696
    buffer_load_dwordx4 v[152:155], v1, s[92:95], s39 offen offset:0
    buffer_load_dwordx4 v[156:159], v1, s[92:95], s39 offen offset:1024
    buffer_load_dwordx4 v[160:163], v1, s[92:95], s39 offen offset:2048
    buffer_load_dwordx4 v[164:167], v1, s[92:95], s39 offen offset:3072
    s_add_u32 s39, s38, 417792
    buffer_load_dwordx4 v[168:171], v1, s[92:95], s39 offen offset:0
    buffer_load_dwordx4 v[172:175], v1, s[92:95], s39 offen offset:1024
    s_waitcnt vmcnt(0)
    s_mul_i32 s38, s34, 12288
    s_lshl_b32 s43, s13, 10
    s_mul_i32 s39, s34, 2445312
    s_add_u32 s42, s39, s43
    s_mul_i32 s39, s36, 6144
    s_add_u32 s39, s39, s38
    s_lshr_b32 s40, s34, 3
    s_mul_i32 s40, s40, 557056
    s_add_u32 s38, s38, s40
    s_add_u32 s38, s38, s14
    s_add_u32 s46, s38, 2228224
    s_lshr_b32 s39, s39, 1
    s_mul_i32 s38, s35, 196608
    s_add_u32 s38, s38, s39
    s_add_u32 s45, s38, 79691776
    s_mul_i32 s51, s36, 5120
    s_add_u32 s51, s51, 2048
    s_mul_i32 s52, s36, 7168
    s_add_u32 s52, s52, 3072
    s_mul_i32 s53, s36, 5120
    s_add_u32 s53, s53, 6144
    s_lshl_b32 s38, s34, 11
    s_add_u32 s38, s38, s14
    s_add_u32 s47, s38, 5505024
    s_lshl_b32 s38, s34, 7
    s_add_u32 s38, s38, s14
    s_add_u32 s49, s38, 5586944
    s_lshl_b32 s38, s35, 6
    s_lshl_b32 s39, s34, 1
    s_add_u32 s38, s38, s39
    s_add_u32 s38, s38, s36
    s_lshl_b32 s38, s38, 7
    s_add_u32 s38, s38, s14
    s_add_u32 s48, s38, 5570560
    v_min_u32 v6, 8, v0
    v_lshlrev_b32 v3, 7, v6
    s_mov_b32 s50, 0x3dd53b95
    v_mov_b32 v5, 0xceabfb8f
    v_and_b32 v6, 15, v0
    s_lshl_b32 s38, s35, 4
    v_add_u32 v6, s38, v6
    v_lshrrev_b32 v7, 4, v0
    v_lshlrev_b32 v7, 2, v7
    v_add_u32 v8, 0, v7
    v_cmp_le_u32 s[16:17], v8, v6
    v_add_u32 v8, 1, v7
    v_cmp_le_u32 s[18:19], v8, v6
    v_add_u32 v8, 2, v7
    v_cmp_le_u32 s[20:21], v8, v6
    v_add_u32 v8, 3, v7
    v_cmp_le_u32 s[22:23], v8, v6
    v_add_u32 v8, 16, v7
    v_cmp_le_u32 s[24:25], v8, v6
    v_add_u32 v8, 17, v7
    v_cmp_le_u32 s[26:27], v8, v6
    v_add_u32 v8, 18, v7
    v_cmp_le_u32 s[28:29], v8, v6
    v_add_u32 v8, 19, v7
    v_cmp_le_u32 s[30:31], v8, v6
    s_mov_b32 s55, 0
    v_lshlrev_b32 v6, 2, v0
    s_branch L4_cm_z
L4_cm:
    global_load_dword v7, v6, s[8:9] sc1
    s_sub_u32 s12, s12, 5
    s_cbranch_scc1 L_abort
L4_cm_e:
    s_add_u32 s85, s15, 11
    s_cmp_lg_u32 s15, 0
    s_waitcnt vmcnt(0)
    s_cbranch_scc1 L4_cm_m
    v_cmp_eq_u32 vcc, -1, v7
    s_nop 0
    s_and_b32 s86, vcc_lo, vcc_hi
    v_cmp_eq_u32 vcc, 0x2000, v7
    s_nop 0
    s_and_b32 s87, vcc_lo, vcc_hi
    s_lshr_b32 s87, s87, 1
    s_and_b32 s86, s86, s87
    s_and_b32 s86, s86, 0x01010101
    s_cmp_eq_u32 s86, 0x01010101
    s_cbranch_scc1 L4_cm_m
    v_readlane_b32 s86, v7, 3
    s_mov_b32 s84, 0
    v_readlane_b32 s87, v7, 1
    s_nop 0
    s_lshr_b32 s87, s87, 8
    s_add_u32 s86, s86, s87
    s_max_u32 s84, s84, s87
    v_readlane_b32 s87, v7, 9
    s_nop 0
    s_lshr_b32 s87, s87, 8
    s_add_u32 s86, s86, s87
    s_max_u32 s84, s84, s87
    v_readlane_b32 s87, v7, 17
    s_nop 0
    s_lshr_b32 s87, s87, 8
    s_add_u32 s86, s86, s87
    s_max_u32 s84, s84, s87
    v_readlane_b32 s87, v7, 25
    s_nop 0
    s_lshr_b32 s87, s87, 8
    s_add_u32 s86, s86, s87
    s_max_u32 s84, s84, s87
    v_readlane_b32 s87, v7, 33
    s_nop 0
    s_lshr_b32 s87, s87, 8
    s_add_u32 s86, s86, s87
    s_max_u32 s84, s84, s87
    v_readlane_b32 s87, v7, 41
    s_nop 0
    s_lshr_b32 s87, s87, 8
    s_add_u32 s86, s86, s87
    s_max_u32 s84, s84, s87
    v_readlane_b32 s87, v7, 49
    s_nop 0
    s_lshr_b32 s87, s87, 8
    s_add_u32 s86, s86, s87
    s_max_u32 s84, s84, s87
    v_readlane_b32 s87, v7, 57
    s_nop 0
    s_lshr_b32 s87, s87, 8
    s_add_u32 s86, s86, s87
    s_max_u32 s84, s84, s87
    s_cmp_eq_u32 s86, 256
    s_cbranch_scc1 L_again
L4_cm_z:
    s_sleep 16
    s_branch L4_cm
L4_cm_m:
    v_readlane_b32 s84, v7, s85
    s_nop 0
    s_and_b32 s86, s84, 0xffff
    s_cmp_eq_u32 s86, 32
    s_cbranch_scc0 L4_cm_z
    v_mov_b32 v112, 0
    s_mov_b32 s37, 0
L4_g1:
    v_cmp_ge_u32 vcc, s37, v112
    s_cbranch_vccz L4_g1_ok
    s_sleep 2
    buffer_load_dword v112, v3, s[4:7], s47 offen sc1
    s_sub_u32 s12, s12, 1
    s_cbranch_scc1 L_abort
    s_waitcnt vmcnt(0)
    s_branch L4_g1
L4_g1_ok:
    s_lshl_b32 s44, s37, 12
    s_add_u32 s44, s44, s42
    s_and_b32 s55, s37, 3
    s_mul_i32 s55, s55, 36864
    s_add_u32 s55, s55, s43
    s_add_u32 m0, s55, 12288
    s_add_u32 s41, s44, 270336
    buffer_load_dwordx4 v1, s[4:7], s41 offen sc1 lds
    s_add_u32 m0, s55, 16384
    s_add_u32 s41, s44, 1085440
    buffer_load_dwordx4 v1, s[4:7], s41 offen sc1 lds
    s_add_u32 m0, s55, 20480
    s_add_u32 s41, s44, 1900544
    buffer_load_dwordx4 v1, s[4:7], s41 offen sc1 lds
    s_add_u32 m0, s55, 24576
    s_add_u32 s41, s44, 540672
    buffer_load_dwordx4 v1, s[4:7], s41 offen sc1 lds
    s_add_u32 m0, s55, 28672
    s_add_u32 s41, s44, 1355776
    buffer_load_dwordx4 v1, s[4:7], s41 offen sc1 lds
    s_add_u32 m0, s55, 32768
    s_add_u32 s41, s44, 2170880
    buffer_load_dwordx4 v1, s[4:7], s41 offen sc1 lds
    s_add_u32 m0, s55, 0
    s_add_u32 s41, s44, 0
    buffer_load_dwordx4 v1, s[4:7], s41 offen sc1 lds
    s_add_u32 m0, s55, 4096
    s_add_u32 s41, s44, 815104
    buffer_load_dwordx4 v1, s[4:7], s41 offen sc1 lds
    s_add_u32 m0, s55, 8192
    s_add_u32 s41, s44, 1630208
    buffer_load_dwordx4 v1, s[4:7], s41 offen sc1 lds
    s_waitcnt vmcnt(0)
    s_barrier
    s_cmp_eq_u32 s13, 0
    s_cbranch_scc0 L4_f2
    v_mov_b32 v6, 1
    s_cmp_eq_u32 s11, 0
    s_cbranch_scc0 L4_f2_g
    buffer_store_dword v6, v2, s[4:7], s49 offen
    s_branch L4_f2
L4_f2_g:
    buffer_store_dword v6, v2, s[4:7], s49 offen sc1
L4_f2:
    s_mov_b32 s37, 1
L4_g3:
    v_cmp_ge_u32 vcc, s37, v112
    s_cbranch_vccz L4_g3_ok
    s_sleep 2
    buffer_load_dword v112, v3, s[4:7], s47 offen sc1
    s_sub_u32 s12, s12, 1
    s_cbranch_scc1 L_abort
    s_waitcnt vmcnt(0)
    s_branch L4_g3
L4_g3_ok:
    s_lshl_b32 s44, s37, 12
    s_add_u32 s44, s44, s42
    s_and_b32 s55, s37, 3
    s_mul_i32 s55, s55, 36864
    s_add_u32 s55, s55, s43
    s_add_u32 m0, s55, 12288
    s_add_u32 s41, s44, 270336
    buffer_load_dwordx4 v1, s[4:7], s41 offen sc1 lds
    s_add_u32 m0, s55, 16384
    s_add_u32 s41, s44, 1085440
    buffer_load_dwordx4 v1, s[4:7], s41 offen sc1 lds
    s_add_u32 m0, s55, 20480
    s_add_u32 s41, s44, 1900544
    buffer_load_dwordx4 v1, s[4:7], s41 offen sc1 lds
    s_add_u32 m0, s55, 24576
    s_add_u32 s41, s44, 540672
    buffer_load_dwordx4 v1, s[4:7], s41 offen sc1 lds
    s_add_u32 m0, s55, 28672
    s_add_u32 s41, s44, 1355776
    buffer_load_dwordx4 v1, s[4:7], s41 offen sc1 lds
    s_add_u32 m0, s55, 32768
    s_add_u32 s41, s44, 2170880
    buffer_load_dwordx4 v1, s[4:7], s41 offen sc1 lds
    s_add_u32 m0, s55, 0
    s_add_u32 s41, s44, 0
    buffer_load_dwordx4 v1, s[4:7], s41 offen sc1 lds
    s_add_u32 m0, s55, 4096
    s_add_u32 s41, s44, 815104
    buffer_load_dwordx4 v1, s[4:7], s41 offen sc1 lds
    s_add_u32 m0, s55, 8192
    s_add_u32 s41, s44, 1630208
    buffer_load_dwordx4 v1, s[4:7], s41 offen sc1 lds
    s_waitcnt vmcnt(0)
    s_barrier
    s_cmp_eq_u32 s13, 0
    s_cbranch_scc0 L4_f4
    v_mov_b32 v6, 2
    s_cmp_eq_u32 s11, 0
    s_cbranch_scc0 L4_f4_g
    buffer_store_dword v6, v2, s[4:7], s49 offen
    s_branch L4_f4
L4_f4_g:
    buffer_store_dword v6, v2, s[4:7], s49 offen sc1
L4_f4:
    s_mov_b32 s37, 2
L4_g5:
    v_cmp_ge_u32 vcc, s37, v112
    s_cbranch_vccz L4_g5_ok
    s_sleep 2
    buffer_load_dword v112, v3, s[4:7], s47 offen sc1
    s_sub_u32 s12, s12, 1
    s_cbranch_scc1 L_abort
    s_waitcnt vmcnt(0)
    s_branch L4_g5
L4_g5_ok:
    s_lshl_b32 s44, s37, 12
    s_add_u32 s44, s44, s42
    s_and_b32 s55, s37, 3
    s_mul_i32 s55, s55, 36864
    s_add_u32 s55, s55, s43
    s_add_u32 m0, s55, 12288
    s_add_u32 s41, s44, 270336
    buffer_load_dwordx4 v1, s[4:7], s41 offen sc1 lds
    s_add_u32 m0, s55, 16384
    s_add_u32 s41, s44, 1085440
    buffer_load_dwordx4 v1, s[4:7], s41 offen sc1 lds
    s_add_u32 m0, s55, 20480
    s_add_u32 s41, s44, 1900544
    buffer_load_dwordx4 v1, s[4:7], s41 offen sc1 lds
    s_add_u32 m0, s55, 24576
    s_add_u32 s41, s44, 540672
    buffer_load_dwordx4 v1, s[4:7], s41 offen sc1 lds
    s_add_u32 m0, s55, 28672
    s_add_u32 s41, s44, 1355776
    buffer_load_dwordx4 v1, s[4:7], s41 offen sc1 lds
    s_add_u32 m0, s55, 32768
    s_add_u32 s41, s44, 2170880
    buffer_load_dwordx4 v1, s[4:7], s41 offen sc1 lds
    s_add_u32 m0, s55, 0
    s_add_u32 s41, s44, 0
    buffer_load_dwordx4 v1, s[4:7], s41 offen sc1 lds
    s_add_u32 m0, s55, 4096
    s_add_u32 s41, s44, 815104
    buffer_load_dwordx4 v1, s[4:7], s41 offen sc1 lds
    s_add_u32 m0, s55, 8192
    s_add_u32 s41, s44, 1630208
    buffer_load_dwordx4 v1, s[4:7], s41 offen sc1 lds
    s_waitcnt vmcnt(0)
    s_barrier
    s_cmp_eq_u32 s13, 0
    s_cbranch_scc0 L4_f6
    v_mov_b32 v6, 3
    s_cmp_eq_u32 s11, 0
    s_cbranch_scc0 L4_f6_g
    buffer_store_dword v6, v2, s[4:7], s49 offen
    s_branch L4_f6
L4_f6_g:
    buffer_store_dword v6, v2, s[4:7], s49 offen sc1
L4_f6:
    s_mov_b32 s37, 0
    s_add_u32 s38, s43, 147456
    v_add_u32 v116, s38, v1
    v_add_u32 v117, 147456, v1
    v_add_u32 v118, s51, v117
    v_add_u32 v119, s52, v117
    v_add_u32 v120, s53, v117
    s_add_u32 s46, s46, s43
    s_mov_b32 s32, s50
    s_mov_b32 s33, s50
    s_and_b32 s38, s37, 3
    s_mul_i32 s39, s38, 98304
    s_add_u32 s54, s39, s46
    s_mul_i32 s38, s38, 36864
    v_add_u32 v113, s38, v1
    v_lshl_add_u32 v114, s35, 10, v113
    s_mul_i32 s39, s36, 6144
    v_add_u32 v115, s39, v113
    ds_read_b128 v[128:131], v114 offset:0
    ds_read_b128 v[152:155], v113 offset:12288
    ds_read_b128 v[156:159], v113 offset:13312
    ds_read_b128 v[132:135], v114 offset:2048
    ds_read_b128 v[160:163], v113 offset:14336
    ds_read_b128 v[164:167], v113 offset:15360
    ds_read_b128 v[136:139], v114 offset:4096
    ds_read_b128 v[168:171], v113 offset:16384
    ds_read_b128 v[172:175], v113 offset:17408
    ds_read_b128 v[140:143], v114 offset:6144
    ds_read_b128 v[176:179], v113 offset:18432
    ds_read_b128 v[180:183], v113 offset:19456
    ds_read_b128 v[144:147], v114 offset:8192
    ds_read_b128 v[184:187], v113 offset:20480
    ds_read_b128 v[188:191], v113 offset:21504
    s_waitcnt lgkmcnt(14)
    ds_read_b128 v[148:151], v114 offset:10240
    s_waitcnt lgkmcnt(14)
    ds_read_b128 v[192:195], v113 offset:22528
    s_waitcnt lgkmcnt(14)
    ds_read_b128 v[196:199], v113 offset:23552
    s_waitcnt lgkmcnt(14)
    ds_read_b128 v[200:203], v115 offset:24576
    s_waitcnt lgkmcnt(14)
    ds_read_b128 v[204:207], v115 offset:25600
    s_waitcnt lgkmcnt(14)
    ds_read_b128 v[208:211], v115 offset:26624
    s_waitcnt lgkmcnt(14)
    ds_read_b128 v[212:215], v115 offset:27648
    s_waitcnt lgkmcnt(14)
    ds_read_b128 v[216:219], v115 offset:28672
    s_waitcnt lgkmcnt(14)
    ds_read_b128 v[220:223], v115 offset:29696
    s_waitcnt lgkmcnt(15)
    v_mfma_f32_16x16x32_bf16 v[52:55], v[152:155], v[128:131], 0
    v_mfma_f32_16x16x32_bf16 v[56:59], v[156:159], v[128:131], 0
    v_mfma_f32_16x16x32_bf16 v[52:55], v[160:163], v[132:135], v[52:55]
    v_mfma_f32_16x16x32_bf16 v[56:59], v[164:167], v[132:135], v[56:59]
    v_mfma_f32_16x16x32_bf16 v[52:55], v[168:171], v[136:139], v[52:55]
    v_mfma_f32_16x16x32_bf16 v[56:59], v[172:175], v[136:139], v[56:59]
    s_waitcnt lgkmcnt(13)
    v_mfma_f32_16x16x32_bf16 v[52:55], v[176:179], v[140:143], v[52:55]
    s_waitcnt lgkmcnt(12)
    v_mfma_f32_16x16x32_bf16 v[56:59], v[180:183], v[140:143], v[56:59]
    s_waitcnt lgkmcnt(10)
    v_mfma_f32_16x16x32_bf16 v[52:55], v[184:187], v[144:147], v[52:55]
    s_waitcnt lgkmcnt(9)
    v_mfma_f32_16x16x32_bf16 v[56:59], v[188:191], v[144:147], v[56:59]
    s_waitcnt lgkmcnt(7)
    v_mfma_f32_16x16x32_bf16 v[52:55], v[192:195], v[148:151], v[52:55]
    s_waitcnt lgkmcnt(6)
    v_mfma_f32_16x16x32_bf16 v[56:59], v[196:199], v[148:151], v[56:59]
    s_waitcnt lgkmcnt(0)
    s_bfe_u32 s38, s37, 0x10002
    v_mov_b32 v4, s38
    s_nop 0
    v_pk_mul_f32 v[52:53], v[52:53], s[32:33]
    v_pk_mul_f32 v[54:55], v[54:55], s[32:33]
    s_nop 1
    v_pk_mul_f32 v[56:57], v[56:57], s[32:33]
    v_pk_mul_f32 v[58:59], v[58:59], s[32:33]
    v_cndmask_b32 v52, v5, v52, s[16:17]
    v_cndmask_b32 v53, v5, v53, s[18:19]
    v_cndmask_b32 v54, v5, v54, s[20:21]
    v_cndmask_b32 v55, v5, v55, s[22:23]
    v_cndmask_b32 v56, v5, v56, s[24:25]
    v_cndmask_b32 v57, v5, v57, s[26:27]
    v_cndmask_b32 v58, v5, v58, s[28:29]
    v_cndmask_b32 v59, v5, v59, s[30:31]
    v_max3_f32 v14, v52, v53, v54
    v_max3_f32 v14, v14, v55, v56
    v_max3_f32 v14, v14, v57, v58
    v_max_f32 v14, v14, v59
L4_it:
    s_add_u32 s40, s37, 3
    s_min_u32 s38, s40, 63
L4_g7:
    v_cmp_ge_u32 vcc, s38, v112
    s_cbranch_vccz L4_g7_ok
    s_sleep 2
    buffer_load_dword v112, v3, s[4:7], s47 offen sc1
    s_sub_u32 s12, s12, 1
    s_cbranch_scc1 L_abort
    s_waitcnt vmcnt(0)
    s_branch L4_g7
L4_g7_ok:
    s_lshl_b32 s44, s40, 12
    s_add_u32 s44, s44, s42
    s_cmp_ge_u32 s40, 64
    s_cselect_b32 s44, 1073741824, s44
    s_and_b32 s55, s40, 3
    s_mul_i32 s55, s55, 36864
    s_add_u32 s55, s55, s43
    s_add_u32 s38, s54, 4096
    s_add_u32 s39, s54, 8192
    s_branch L4_q
L4_p:
    s_sleep 1
    buffer_load_dwordx4 v[96:99], v1, s[4:7], s54 offen sc1
    s_sub_u32 s12, s12, 1
    s_cbranch_scc1 L_abort
    s_waitcnt vmcnt(0)
    v_xor_b32 v6, v96, v4
    v_and_b32 v6, 1, v6
    v_cmp_ne_u32 vcc, 0, v6
    s_cbranch_vccnz L4_p
L4_q:
    buffer_load_dwordx4 v[96:99], v1, s[4:7], s54 offen sc1
    buffer_load_dwordx4 v[100:103], v1, s[4:7], s38 offen sc1
    buffer_load_dwordx4 v[104:107], v1, s[4:7], s39 offen sc1
    s_waitcnt vmcnt(0)
    v_bitop3_b32 v6, v96, v100, v4 bitop3:0x7e
    v_bitop3_b32 v6, v6, v104, v4 bitop3:0xf6
    v_and_b32 v6, 1, v6
    v_cmp_ne_u32 vcc, 0, v6
    s_cbranch_vccnz L4_p
    ds_write_b128 v116, v[96:99] offset:0
    ds_write_b128 v116, v[100:103] offset:4096
    ds_write_b128 v116, v[104:107] offset:8192
    s_waitcnt lgkmcnt(0)
    s_barrier
    ds_read_b128 v[16:19], v117 offset:0
    ds_read_b128 v[20:23], v117 offset:1024
    ds_read_b128 v[24:27], v117 offset:4096
    ds_read_b128 v[28:31], v117 offset:5120
    ds_read_b128 v[32:35], v117 offset:8192
    ds_read_b128 v[36:39], v117 offset:9216
    ds_read_b128 v[40:43], v118
    ds_read_b128 v[44:47], v119
    ds_read_b128 v[48:51], v120
    s_waitcnt lgkmcnt(8)
    v_mfma_f32_16x16x32_bf16 v[60:63], v[16:19], v[128:131], 0
    s_waitcnt lgkmcnt(7)
    v_mfma_f32_16x16x32_bf16 v[60:63], v[20:23], v[132:135], v[60:63]
    s_waitcnt lgkmcnt(6)
    v_mfma_f32_16x16x32_bf16 v[60:63], v[24:27], v[136:139], v[60:63]
    s_waitcnt lgkmcnt(5)
    v_mfma_f32_16x16x32_bf16 v[60:63], v[28:31], v[140:143], v[60:63]
    s_waitcnt lgkmcnt(4)
    v_mfma_f32_16x16x32_bf16 v[60:63], v[32:35], v[144:147], v[60:63]
    s_waitcnt lgkmcnt(3)
    v_mfma_f32_16x16x32_bf16 v[60:63], v[36:39], v[148:151], v[60:63]
    s_nop 7
    v_mov_b64 v[10:11], v[60:61]
    v_mov_b64 v[12:13], v[62:63]
    s_nop 0
    v_permlane32_swap_b32 v60, v10
    v_permlane32_swap_b32 v61, v11
    v_permlane32_swap_b32 v62, v12
    v_permlane32_swap_b32 v63, v13
    v_pk_add_f32 v[60:61], v[60:61], v[10:11]
    v_pk_add_f32 v[62:63], v[62:63], v[12:13]
    v_pk_mul_f32 v[60:61], v[60:61], s[32:33]
    v_pk_mul_f32 v[62:63], v[62:63], s[32:33]
    v_max3_f32 v6, v14, v60, v61
    v_max3_f32 v6, v6, v62, v63
    v_mov_b32 v7, v6
    s_nop 1
    v_permlane16_swap_b32 v6, v7
    v_max_f32 v6, v6, v7
    v_mov_b32 v7, v6
    s_nop 1
    v_permlane32_swap_b32 v6, v7
    v_max_f32 v6, v6, v7
    v_pk_add_f32 v[52:53], v[52:53], v[6:7] op_sel_hi:[1,0] neg_lo:[0,1] neg_hi:[0,1]
    v_pk_add_f32 v[54:55], v[54:55], v[6:7] op_sel_hi:[1,0] neg_lo:[0,1] neg_hi:[0,1]
    v_pk_add_f32 v[56:57], v[56:57], v[6:7] op_sel_hi:[1,0] neg_lo:[0,1] neg_hi:[0,1]
    v_pk_add_f32 v[58:59], v[58:59], v[6:7] op_sel_hi:[1,0] neg_lo:[0,1] neg_hi:[0,1]
    v_pk_add_f32 v[60:61], v[60:61], v[6:7] op_sel_hi:[1,0] neg_lo:[0,1] neg_hi:[0,1]
    v_pk_add_f32 v[62:63], v[62:63], v[6:7] op_sel_hi:[1,0] neg_lo:[0,1] neg_hi:[0,1]
    v_exp_f32 v52, v52
    v_exp_f32 v53, v53
    v_exp_f32 v54, v54
    v_exp_f32 v55, v55
    v_exp_f32 v56, v56
    v_exp_f32 v57, v57
    v_exp_f32 v58, v58
    v_exp_f32 v59, v59
    v_exp_f32 v60, v60
    v_exp_f32 v61, v61
    v_exp_f32 v62, v62
    v_exp_f32 v63, v63
    v_pk_add_f32 v[10:11], v[52:53], v[54:55]
    v_pk_add_f32 v[12:13], v[56:57], v[58:59]
    v_pk_add_f32 v[10:11], v[10:11], v[12:13]
    v_pk_add_f32 v[12:13], v[60:61], v[62:63]
    v_add_f32 v10, v10, v11
    v_add_f32 v12, v12, v13
    v_fma_f32 v8, v12, 0.5, v10
    v_mov_b32 v7, v8
    s_nop 1
    v_permlane16_swap_b32 v8, v7
    v_add_f32 v8, v8, v7
    v_mov_b32 v7, v8
    s_nop 1
    v_permlane32_swap_b32 v8, v7
    v_add_f32 v8, v8, v7
    v_rcp_f32 v8, v8
    s_nop 0
    v_pk_mul_f32 v[52:53], v[52:53], v[8:9] op_sel_hi:[1,0]
    v_pk_mul_f32 v[54:55], v[54:55], v[8:9] op_sel_hi:[1,0]
    v_pk_mul_f32 v[56:57], v[56:57], v[8:9] op_sel_hi:[1,0]
    v_pk_mul_f32 v[58:59], v[58:59], v[8:9] op_sel_hi:[1,0]
    v_pk_mul_f32 v[60:61], v[60:61], v[8:9] op_sel_hi:[1,0]
    v_pk_mul_f32 v[62:63], v[62:63], v[8:9] op_sel_hi:[1,0]
    v_cvt_pk_bf16_f32 v64, v52, v53
    v_cvt_pk_bf16_f32 v65, v54, v55
    v_cvt_pk_bf16_f32 v66, v56, v57
    v_cvt_pk_bf16_f32 v67, v58, v59
    v_cvt_pk_bf16_f32 v68, v60, v61
    v_cvt_pk_bf16_f32 v69, v62, v63
    s_mul_i32 s38, s37, 393216
    s_add_u32 s38, s38, s45
    v_mfma_f32_16x16x32_bf16 v[72:75], v[200:203], v[64:67], 0
    v_mfma_f32_16x16x32_bf16 v[76:79], v[204:207], v[64:67], 0
    s_waitcnt lgkmcnt(2)
    v_mfma_f32_16x16x16_bf16 v[72:75], v[40:41], v[68:69], v[72:75]
    v_mfma_f32_16x16x16_bf16 v[76:79], v[42:43], v[68:69], v[76:79]
    v_mfma_f32_16x16x32_bf16 v[80:83], v[208:211], v[64:67], 0
    v_mfma_f32_16x16x32_bf16 v[84:87], v[212:215], v[64:67], 0
    v_cvt_pk_bf16_f32 v72, v72, v73
    v_cvt_pk_bf16_f32 v73, v74, v75
    s_waitcnt lgkmcnt(1)
    v_mfma_f32_16x16x16_bf16 v[80:83], v[44:45], v[68:69], v[80:83]
    v_cvt_pk_bf16_f32 v74, v76, v77
    v_cvt_pk_bf16_f32 v75, v78, v79
    buffer_store_dwordx4 v[72:75], v1, s[4:7], s38 offen offset:0 sc1
    v_mfma_f32_16x16x16_bf16 v[84:87], v[46:47], v[68:69], v[84:87]
    v_mfma_f32_16x16x32_bf16 v[88:91], v[216:219], v[64:67], 0
    v_mfma_f32_16x16x32_bf16 v[92:95], v[220:223], v[64:67], 0
    v_cvt_pk_bf16_f32 v80, v80, v81
    v_cvt_pk_bf16_f32 v81, v82, v83
    s_waitcnt lgkmcnt(0)
    v_mfma_f32_16x16x16_bf16 v[88:91], v[48:49], v[68:69], v[88:91]
    v_cvt_pk_bf16_f32 v82, v84, v85
    v_cvt_pk_bf16_f32 v83, v86, v87
    buffer_store_dwordx4 v[80:83], v1, s[4:7], s38 offen offset:1024 sc1
    v_mfma_f32_16x16x16_bf16 v[92:95], v[50:51], v[68:69], v[92:95]
    s_nop 3
    v_cvt_pk_bf16_f32 v88, v88, v89
    v_cvt_pk_bf16_f32 v89, v90, v91
    s_nop 1
    v_cvt_pk_bf16_f32 v90, v92, v93
    v_cvt_pk_bf16_f32 v91, v94, v95
    buffer_store_dwordx4 v[88:91], v1, s[4:7], s38 offen offset:2048 sc1
    s_add_u32 s37, s37, 1
    v_mov_b32 v15, s37
    s_cmp_eq_u32 s37, 64
    s_cbranch_scc1 L4_last
    s_add_u32 m0, s55, 12288
    s_add_u32 s41, s44, 270336
    buffer_load_dwordx4 v1, s[4:7], s41 offen sc1 lds
    s_add_u32 m0, s55, 16384
    s_add_u32 s41, s44, 1085440
    buffer_load_dwordx4 v1, s[4:7], s41 offen sc1 lds
    s_add_u32 m0, s55, 20480
    s_add_u32 s41, s44, 1900544
    buffer_load_dwordx4 v1, s[4:7], s41 offen sc1 lds
    s_add_u32 m0, s55, 24576
    s_add_u32 s41, s44, 540672
    buffer_load_dwordx4 v1, s[4:7], s41 offen sc1 lds
    s_add_u32 m0, s55, 28672
    s_add_u32 s41, s44, 1355776
    buffer_load_dwordx4 v1, s[4:7], s41 offen sc1 lds
    s_add_u32 m0, s55, 32768
    s_add_u32 s41, s44, 2170880
    buffer_load_dwordx4 v1, s[4:7], s41 offen sc1 lds
    s_add_u32 m0, s55, 0
    s_add_u32 s41, s44, 0
    buffer_load_dwordx4 v1, s[4:7], s41 offen sc1 lds
    s_add_u32 m0, s55, 4096
    s_add_u32 s41, s44, 815104
    buffer_load_dwordx4 v1, s[4:7], s41 offen sc1 lds
    s_add_u32 m0, s55, 8192
    s_add_u32 s41, s44, 1630208
    buffer_load_dwordx4 v1, s[4:7], s41 offen sc1 lds
    buffer_load_dword v112, v3, s[4:7], s47 offen sc1
    s_and_b32 s38, s37, 3
    s_mul_i32 s39, s38, 98304
    s_add_u32 s54, s39, s46
    s_mul_i32 s38, s38, 36864
    v_add_u32 v113, s38, v1
    v_lshl_add_u32 v114, s35, 10, v113
    s_mul_i32 s39, s36, 6144
    v_add_u32 v115, s39, v113
    ds_read_b128 v[128:131], v114 offset:0
    ds_read_b128 v[152:155], v113 offset:12288
    ds_read_b128 v[156:159], v113 offset:13312
    ds_read_b128 v[132:135], v114 offset:2048
    ds_read_b128 v[160:163], v113 offset:14336
    ds_read_b128 v[164:167], v113 offset:15360
    ds_read_b128 v[136:139], v114 offset:4096
    ds_read_b128 v[168:171], v113 offset:16384
    ds_read_b128 v[172:175], v113 offset:17408
    ds_read_b128 v[140:143], v114 offset:6144
    ds_read_b128 v[176:179], v113 offset:18432
    ds_read_b128 v[180:183], v113 offset:19456
    ds_read_b128 v[144:147], v114 offset:8192
    ds_read_b128 v[184:187], v113 offset:20480
    ds_read_b128 v[188:191], v113 offset:21504
    s_waitcnt lgkmcnt(14)
    ds_read_b128 v[148:151], v114 offset:10240
    s_waitcnt lgkmcnt(14)
    ds_read_b128 v[192:195], v113 offset:22528
    s_waitcnt lgkmcnt(14)
    ds_read_b128 v[196:199], v113 offset:23552
    s_waitcnt lgkmcnt(14)
    ds_read_b128 v[200:203], v115 offset:24576
    s_waitcnt lgkmcnt(14)
    ds_read_b128 v[204:207], v115 offset:25600
    s_waitcnt lgkmcnt(14)
    ds_read_b128 v[208:211], v115 offset:26624
    s_waitcnt lgkmcnt(14)
    ds_read_b128 v[212:215], v115 offset:27648
    s_waitcnt lgkmcnt(14)
    ds_read_b128 v[216:219], v115 offset:28672
    s_waitcnt lgkmcnt(14)
    ds_read_b128 v[220:223], v115 offset:29696
    s_waitcnt lgkmcnt(15)
    v_mfma_f32_16x16x32_bf16 v[52:55], v[152:155], v[128:131], 0
    v_mfma_f32_16x16x32_bf16 v[56:59], v[156:159], v[128:131], 0
    v_mfma_f32_16x16x32_bf16 v[52:55], v[160:163], v[132:135], v[52:55]
    v_mfma_f32_16x16x32_bf16 v[56:59], v[164:167], v[132:135], v[56:59]
    v_mfma_f32_16x16x32_bf16 v[52:55], v[168:171], v[136:139], v[52:55]
    v_mfma_f32_16x16x32_bf16 v[56:59], v[172:175], v[136:139], v[56:59]
    s_waitcnt lgkmcnt(13)
    v_mfma_f32_16x16x32_bf16 v[52:55], v[176:179], v[140:143], v[52:55]
    s_waitcnt lgkmcnt(12)
    v_mfma_f32_16x16x32_bf16 v[56:59], v[180:183], v[140:143], v[56:59]
    s_waitcnt lgkmcnt(10)
    v_mfma_f32_16x16x32_bf16 v[52:55], v[184:187], v[144:147], v[52:55]
    s_waitcnt lgkmcnt(9)
    v_mfma_f32_16x16x32_bf16 v[56:59], v[188:191], v[144:147], v[56:59]
    s_waitcnt lgkmcnt(7)
    v_mfma_f32_16x16x32_bf16 v[52:55], v[192:195], v[148:151], v[52:55]
    s_waitcnt lgkmcnt(6)
    v_mfma_f32_16x16x32_bf16 v[56:59], v[196:199], v[148:151], v[56:59]
    s_waitcnt lgkmcnt(0)
    s_bfe_u32 s38, s37, 0x10002
    v_mov_b32 v4, s38
    s_nop 0
    v_pk_mul_f32 v[52:53], v[52:53], s[32:33]
    v_pk_mul_f32 v[54:55], v[54:55], s[32:33]
    s_nop 1
    v_pk_mul_f32 v[56:57], v[56:57], s[32:33]
    v_pk_mul_f32 v[58:59], v[58:59], s[32:33]
    v_cndmask_b32 v52, v5, v52, s[16:17]
    v_cndmask_b32 v53, v5, v53, s[18:19]
    v_cndmask_b32 v54, v5, v54, s[20:21]
    v_cndmask_b32 v55, v5, v55, s[22:23]
    v_cndmask_b32 v56, v5, v56, s[24:25]
    v_cndmask_b32 v57, v5, v57, s[26:27]
    v_cndmask_b32 v58, v5, v58, s[28:29]
    v_cndmask_b32 v59, v5, v59, s[30:31]
    v_max3_f32 v14, v52, v53, v54
    v_max3_f32 v14, v14, v55, v56
    v_max3_f32 v14, v14, v57, v58
    v_max_f32 v14, v14, v59
L4_last:
    s_waitcnt vmcnt(0)
    buffer_store_dword v15, v2, s[4:7], s48 offen sc1
    s_cmp_eq_u32 s37, 64
    s_cbranch_scc1 L4_end
    s_add_u32 s40, s37, 3
    s_barrier
    s_cmp_eq_u32 s13, 0
    s_cbranch_scc0 L4_f8
    v_mov_b32 v6, s40
    s_cmp_eq_u32 s11, 0
    s_cbranch_scc0 L4_f8_g
    buffer_store_dword v6, v2, s[4:7], s49 offen
    s_branch L4_f8
L4_f8_g:
    buffer_store_dword v6, v2, s[4:7], s49 offen sc1
L4_f8:
    s_branch L4_it
L4_end:
    s_and_b32 s38, s34, 7
    s_or_b32 s38, s38, s13
    s_cbranch_scc1 L4_nwb
    s_waitcnt vmcnt(0)
    buffer_wbl2 sc1
L4_nwb:
    s_endpgm
Lb_start:
    v_lshlrev_b32 v10, 2, v0
    s_branch Lb_c0_z
Lb_c0:
    global_load_dword v11, v10, s[8:9] sc1
    s_sub_u32 s12, s12, 32
    s_cbranch_scc1 L_abort
Lb_c0_e:
    s_add_u32 s85, s15, 11
    s_cmp_lg_u32 s15, 0
    s_waitcnt vmcnt(0)
    s_cbranch_scc1 Lb_c0_m
    v_cmp_eq_u32 vcc, -1, v11
    s_nop 0
    s_and_b32 s86, vcc_lo, vcc_hi
    v_cmp_eq_u32 vcc, 0x2000, v11
    s_nop 0
    s_and_b32 s87, vcc_lo, vcc_hi
    s_lshr_b32 s87, s87, 1
    s_and_b32 s86, s86, s87
    s_and_b32 s86, s86, 0x01010101
    s_cmp_eq_u32 s86, 0x01010101
    s_cbranch_scc1 Lb_c0_m
    v_readlane_b32 s86, v11, 3
    s_mov_b32 s84, 0
    v_readlane_b32 s87, v11, 1
    s_nop 0
    s_lshr_b32 s87, s87, 8
    s_add_u32 s86, s86, s87
    s_max_u32 s84, s84, s87
    v_readlane_b32 s87, v11, 9
    s_nop 0
    s_lshr_b32 s87, s87, 8
    s_add_u32 s86, s86, s87
    s_max_u32 s84, s84, s87
    v_readlane_b32 s87, v11, 17
    s_nop 0
    s_lshr_b32 s87, s87, 8
    s_add_u32 s86, s86, s87
    s_max_u32 s84, s84, s87
    v_readlane_b32 s87, v11, 25
    s_nop 0
    s_lshr_b32 s87, s87, 8
    s_add_u32 s86, s86, s87
    s_max_u32 s84, s84, s87
    v_readlane_b32 s87, v11, 33
    s_nop 0
    s_lshr_b32 s87, s87, 8
    s_add_u32 s86, s86, s87
    s_max_u32 s84, s84, s87
    v_readlane_b32 s87, v11, 41
    s_nop 0
    s_lshr_b32 s87, s87, 8
    s_add_u32 s86, s86, s87
    s_max_u32 s84, s84, s87
    v_readlane_b32 s87, v11, 49
    s_nop 0
    s_lshr_b32 s87, s87, 8
    s_add_u32 s86, s86, s87
    s_max_u32 s84, s84, s87
    v_readlane_b32 s87, v11, 57
    s_nop 0
    s_lshr_b32 s87, s87, 8
    s_add_u32 s86, s86, s87
    s_max_u32 s84, s84, s87
    s_cmp_eq_u32 s86, 256
    s_cbranch_scc1 L_again
Lb_c0_z:
    s_sleep 127
    s_branch Lb_c0
Lb_c0_m:
    v_readlane_b32 s84, v11, s85
    s_nop 0
    s_and_b32 s86, s84, 0xffff
    s_cmp_eq_u32 s86, 32
    s_cbranch_scc0 Lb_c0_z
    s_add_u32 s47, s14, 5505024
Lb_h:
    buffer_load_dword v10, off, s[4:7], s47 sc1
    s_sub_u32 s12, s12, 4
    s_cbranch_scc1 L_abort
    s_waitcnt vmcnt(0)
    v_cmp_gt_u32 vcc, 1, v10
    s_cbranch_vccz Lb_h_ok
    s_sleep 16
    s_branch Lb_h
Lb_h_ok:
    s_lshr_b32 s45, s10, 5
    s_sub_u32 s45, s45, 4
    s_lshl_b32 s45, s45, 2
    s_and_b32 s46, s10, 3
    s_add_u32 s43, s45, s46
    s_load_dwordx2 s[16:17], s[0:1], 64
    s_mov_b32 s18, 2457600
    s_mov_b32 s19, 0x20000
    s_load_dwordx2 s[20:21], s[0:1], 56
    s_mov_b32 s22, 2621440
    s_mov_b32 s23, 0x20000
    s_mov_b64 s[24:25], s[4:5]
    s_mov_b32 s26, 268435456
    s_mov_b32 s27, 0x20000
    s_and_b32 s45, s43, 7
    s_lshr_b32 s46, s43, 3
    s_lshl_b32 s32, s46, 5
    s_add_u32 s33, s32, 32
    s_mov_b32 s31, 0
    s_lshl_b32 s45, s45, 2
    s_add_u32 s45, s45, s13
    s_cmp_ge_u32 s45, 30
    s_cselect_b32 s47, 1073741824, 0
    s_lshl_b32 s45, s45, 7
    s_add_u32 s29, s45, s47
    s_mul_i32 s46, s32, 122880
    s_add_u32 s46, s46, s45
    s_add_u32 s34, s46, 104857600
    s_mov_b32 s35, 122880
    s_mov_b32 s36, 0
    s_mov_b32 s37, 61440
    s_mov_b32 s38, 64
    s_mov_b32 s39, 61504
    s_mov_b32 s28, 3840
    s_mov_b32 s30, 1
    s_mov_b32 s41, 2
    s_mov_b32 s40, 1073741824
    s_mov_b32 s42, 1
    s_mov_b32 s57, 20
    s_and_b32 s48, s43, 3
    s_lshl_b32 s48, s48, 2
    s_add_u32 s58, s48, s13
    v_and_b32 v10, 15, v0
    v_lshrrev_b32 v11, 4, v0
    v_mul_u32_u24 v10, 3840, v10
    v_lshl_add_u32 v10, v11, 4, v10
    v_add_u32 v4, s47, v10
    s_waitcnt lgkmcnt(0)
    s_branch Lg_start
L1_start:
    s_lshr_b32 s45, s10, 5
    s_sub_u32 s45, s45, 4
    s_mul_i32 s45, s45, 18
    s_add_u32 s52, s45, s17
    s_mul_i32 s45, s52, 2731
    s_lshr_b32 s45, s45, 16
    s_mul_i32 s46, s45, 24
    s_sub_u32 s46, s52, s46
    s_lshl_b32 s46, s46, 2
    s_add_u32 s46, s46, s13
    s_add_u32 s45, s45, 1
    s_cmp_eq_u32 s45, 3
    s_cselect_b32 s45, 0, s45
    s_load_dwordx4 s[88:91], s[0:1], 16
    s_load_dwordx2 s[92:93], s[0:1], 32
    s_load_dwordx2 s[20:21], s[0:1], 0
    s_mov_b32 s22, 2621440
    s_mov_b32 s23, 0x20000
    s_waitcnt lgkmcnt(0)
    s_cmp_eq_u32 s45, 1
    s_cselect_b64 s[16:17], s[90:91], s[88:89]
    s_cmp_eq_u32 s45, 2
    s_cselect_b64 s[16:17], s[92:93], s[16:17]
    s_cselect_b32 s41, 1, 0
    s_mov_b32 s18, 7864320
    s_mov_b32 s19, 0x20000
    s_mov_b64 s[24:25], s[4:5]
    s_mov_b32 s26, 268435456
    s_mov_b32 s27, 0x20000
    s_mov_b32 s28, 12288
    s_lshl_b32 s29, s46, 7
    s_mov_b32 s30, 0
    s_mov_b32 s31, 0
    s_mov_b32 s32, 0
    s_mov_b32 s33, 64
    s_mul_i32 s47, s45, 270336
    s_mul_i32 s48, s46, 815104
    s_add_u32 s34, s47, s48
    s_mov_b32 s35, 4096
    s_mov_b32 s36, 0
    s_mov_b32 s37, 1024
    s_mov_b32 s38, 2048
    s_mov_b32 s39, 3072
    s_mul_i32 s47, s46, 21846
    s_lshr_b32 s47, s47, 16
    s_mul_i32 s48, s47, 13
    s_add_u32 s48, s48, s46
    s_mul_i32 s45, s45, 3
    s_add_u32 s48, s48, s45
    s_lshl_b32 s48, s48, 7
    s_add_u32 s48, s48, s14
    s_add_u32 s40, s48, 5505024
    s_mov_b32 s42, 0
    s_mov_b32 s57, 5
    s_and_b32 s45, s10, 31
    s_lshl_b32 s45, s45, 2
    s_add_u32 s58, s45, s13
    v_lshlrev_b32 v4, 4, v0
Lg_start:
    v_lshlrev_b32 v1, 4, v0
    v_mov_b32 v5, 0
    v_lshrrev_b32 v10, 3, v0
    v_and_b32 v11, 7, v0
    v_xor_b32 v11, v11, v10
    v_mul_lo_u32 v10, v10, s28
    v_lshl_add_u32 v2, v11, 4, v10
    v_lshrrev_b32 v10, 4, v0
    v_bfe_u32 v11, v0, 2, 2
    v_and_b32 v12, 3, v0
    v_lshl_add_u32 v10, v10, 3, v11
    s_mul_i32 s54, s13, 20480
    s_add_u32 s54, s54, 81920
    v_lshl_add_u32 v10, v10, 7, s54
    s_cmp_eq_u32 s30, 0
    s_cselect_b64 vcc, -1, 0
    v_lshrrev_b32 v13, 1, v12
    v_add_u32 v13, 0, v13
    v_cndmask_b32 v13, v12, v13, vcc
    v_add_u32 v13, 0, v13
    v_xor_b32 v13, v13, v11
    v_lshl_add_u32 v13, v13, 4, v10
    v_and_b32 v14, 1, v12
    v_cndmask_b32 v14, 0, v14, vcc
    v_lshl_add_u32 v6, v14, 3, v13
    v_lshrrev_b32 v13, 1, v12
    v_add_u32 v13, 2, v13
    v_cndmask_b32 v13, v12, v13, vcc
    v_add_u32 v13, 0, v13
    v_xor_b32 v13, v13, v11
    v_lshl_add_u32 v13, v13, 4, v10
    v_and_b32 v14, 1, v12
    v_cndmask_b32 v14, 1, v14, vcc
    v_lshl_add_u32 v7, v14, 3, v13
    v_lshrrev_b32 v13, 1, v12
    v_add_u32 v13, 0, v13
    v_cndmask_b32 v13, v12, v13, vcc
    v_add_u32 v13, 4, v13
    v_xor_b32 v13, v13, v11
    v_lshl_add_u32 v13, v13, 4, v10
    v_and_b32 v14, 1, v12
    v_cndmask_b32 v14, 0, v14, vcc
    v_lshl_add_u32 v8, v14, 3, v13
    v_lshrrev_b32 v13, 1, v12
    v_add_u32 v13, 2, v13
    v_cndmask_b32 v13, v12, v13, vcc
    v_add_u32 v13, 4, v13
    v_xor_b32 v13, v13, v11
    v_lshl_add_u32 v13, v13, 4, v10
    v_and_b32 v14, 1, v12
    v_cndmask_b32 v14, 1, v14, vcc
    v_lshl_add_u32 v9, v14, 3, v13
    s_and_b32 s45, s13, 1
    s_lshr_b32 s46, s13, 1
    s_lshl_b32 s47, s46, 2
    v_lshrrev_b32 v10, 4, v0
    v_add_u32 v11, s47, v10
    v_and_b32 v12, 7, v0
    v_xor_b32 v11, v11, v12
    v_lshrrev_b32 v12, 3, v0
    v_mul_u32_u24 v12, 1280, v12
    v_lshl_add_u32 v3, v11, 4, v12
    v_and_b32 v11, 15, v0
    v_lshrrev_b32 v12, 1, v11
    v_xor_b32 v12, v12, v10
    v_lshlrev_b32 v11, 7, v11
    v_lshl_add_u32 v15, v12, 4, v11
    s_lshl_b32 s47, s45, 1
    s_add_u32 s47, s47, s46
    s_lshl_b32 s51, s47, 10
    s_mul_i32 s47, s47, 10240
    s_add_u32 s50, s47, s31
    s_mul_i32 s45, s58, s57
    v_add_u32 v10, s45, v0
    v_min_u32 v10, 319, v10
    v_lshlrev_b32 v10, 7, v10
    v_mov_b32 v11, 1073741824
    v_cmp_gt_u32 vcc, s57, v0
    s_nop 1
    v_cndmask_b32 v116, v11, v10, vcc
    s_mov_b32 s44, s32
    s_mov_b32 s49, 0
    s_lshl_b32 s56, s28, 3
    s_mov_b32 s55, s29
    v_add_u32 v112, 0, v15
    v_xor_b32 v113, 64, v112
    v_add_u32 v114, 40960, v15
    v_xor_b32 v115, 64, v114
    s_add_u32 s45, s44, 0
    s_mul_i32 s45, s45, 40960
    s_cmp_eq_u32 s42, 3
    s_cselect_b32 s45, 1073741824, s45
    buffer_load_dword v117, v116, s[20:23], s45 offen sc1
    s_add_u32 s45, s44, 1
    s_mul_i32 s45, s45, 40960
    s_cmp_eq_u32 s42, 3
    s_cselect_b32 s45, 1073741824, s45
    buffer_load_dword v117, v116, s[20:23], s45 offen sc1
    s_add_u32 m0, s54, 0
    s_nop 0
    buffer_load_dwordx4 v2, s[16:19], s55 offen  lds
    s_add_u32 s55, s55, s56
    s_add_u32 m0, s54, 1024
    s_nop 0
    buffer_load_dwordx4 v2, s[16:19], s55 offen  lds
    s_add_u32 s55, s55, s56
    s_add_u32 m0, s54, 2048
    s_nop 0
    buffer_load_dwordx4 v2, s[16:19], s55 offen  lds
    s_add_u32 s55, s55, s56
    s_add_u32 m0, s54, 3072
    s_nop 0
    buffer_load_dwordx4 v2, s[16:19], s55 offen  lds
    s_add_u32 s55, s55, s56
    s_add_u32 m0, s54, 4096
    s_nop 0
    buffer_load_dwordx4 v2, s[16:19], s55 offen  lds
    s_add_u32 s55, s55, s56
    s_add_u32 m0, s54, 5120
    s_nop 0
    buffer_load_dwordx4 v2, s[16:19], s55 offen  lds
    s_add_u32 s55, s55, s56
    s_add_u32 m0, s54, 6144
    s_nop 0
    buffer_load_dwordx4 v2, s[16:19], s55 offen  lds
    s_add_u32 s55, s55, s56
    s_add_u32 m0, s54, 7168
    s_nop 0
    buffer_load_dwordx4 v2, s[16:19], s55 offen  lds
    s_add_u32 s55, s55, s56
    s_cmp_eq_u32 s42, 3
    s_cbranch_scc1 Lg_nx0
    s_sub_u32 s45, s33, 1
    s_min_u32 s45, s45, s44
    s_mul_i32 s45, s45, 40960
    s_add_u32 s45, s45, s50
    s_add_u32 s46, s49, s51
    s_add_u32 m0, s46, 0
    s_nop 0
    buffer_load_dwordx4 v3, s[20:23], s45 offen offset:0 sc1 lds
    s_add_u32 m0, s46, 3968
    s_nop 0
    buffer_load_dwordx4 v3, s[20:23], s45 offen offset:128 sc1 lds
    s_add_u32 m0, s46, 7936
    s_nop 0
    buffer_load_dwordx4 v3, s[20:23], s45 offen offset:256 sc1 lds
    s_add_u32 m0, s46, 11904
    s_nop 0
    buffer_load_dwordx4 v3, s[20:23], s45 offen offset:384 sc1 lds
    s_add_u32 m0, s46, 15872
    s_nop 0
    buffer_load_dwordx4 v3, s[20:23], s45 offen offset:512 sc1 lds
    s_add_u32 m0, s46, 19840
    s_nop 0
    buffer_load_dwordx4 v3, s[20:23], s45 offen offset:640 sc1 lds
    s_add_u32 m0, s46, 23808
    s_nop 0
    buffer_load_dwordx4 v3, s[20:23], s45 offen offset:768 sc1 lds
    s_add_u32 m0, s46, 27776
    s_nop 0
    buffer_load_dwordx4 v3, s[20:23], s45 offen offset:896 sc1 lds
    s_add_u32 m0, s46, 31744
    s_nop 0
    buffer_load_dwordx4 v3, s[20:23], s45 offen offset:1024 sc1 lds
    s_add_u32 m0, s46, 35712
    s_nop 0
    buffer_load_dwordx4 v3, s[20:23], s45 offen offset:1152 sc1 lds
    s_add_u32 s47, s44, 1
    s_mov_b32 s48, 40960
    s_sub_u32 s45, s33, 1
    s_min_u32 s45, s45, s47
    s_mul_i32 s45, s45, 40960
    s_add_u32 s45, s45, s50
    s_add_u32 s46, s48, s51
    s_add_u32 m0, s46, 0
    s_nop 0
    buffer_load_dwordx4 v3, s[20:23], s45 offen offset:0 sc1 lds
    s_add_u32 m0, s46, 3968
    s_nop 0
    buffer_load_dwordx4 v3, s[20:23], s45 offen offset:128 sc1 lds
    s_add_u32 m0, s46, 7936
    s_nop 0
    buffer_load_dwordx4 v3, s[20:23], s45 offen offset:256 sc1 lds
    s_add_u32 m0, s46, 11904
    s_nop 0
    buffer_load_dwordx4 v3, s[20:23], s45 offen offset:384 sc1 lds
    s_add_u32 m0, s46, 15872
    s_nop 0
    buffer_load_dwordx4 v3, s[20:23], s45 offen offset:512 sc1 lds
    s_add_u32 m0, s46, 19840
    s_nop 0
    buffer_load_dwordx4 v3, s[20:23], s45 offen offset:640 sc1 lds
    s_add_u32 m0, s46, 23808
    s_nop 0
    buffer_load_dwordx4 v3, s[20:23], s45 offen offset:768 sc1 lds
    s_add_u32 m0, s46, 27776
    s_nop 0
    buffer_load_dwordx4 v3, s[20:23], s45 offen offset:896 sc1 lds
    s_add_u32 m0, s46, 31744
    s_nop 0
    buffer_load_dwordx4 v3, s[20:23], s45 offen offset:1024 sc1 lds
    s_add_u32 m0, s46, 35712
    s_nop 0
    buffer_load_dwordx4 v3, s[20:23], s45 offen offset:1152 sc1 lds
Lg_nx0:
    s_add_u32 m0, s54, 8192
    s_nop 0
    buffer_load_dwordx4 v2, s[16:19], s55 offen  lds
    s_add_u32 s55, s55, s56
    s_add_u32 m0, s54, 9216
    s_nop 0
    buffer_load_dwordx4 v2, s[16:19], s55 offen  lds
    s_add_u32 s55, s55, s56
    s_add_u32 m0, s54, 10240
    s_nop 0
    buffer_load_dwordx4 v2, s[16:19], s55 offen  lds
    s_add_u32 s55, s55, s56
    s_add_u32 m0, s54, 11264
    s_nop 0
    buffer_load_dwordx4 v2, s[16:19], s55 offen  lds
    s_add_u32 s55, s55, s56
    s_add_u32 m0, s54, 12288
    s_nop 0
    buffer_load_dwordx4 v2, s[16:19], s55 offen  lds
    s_add_u32 s55, s55, s56
    s_add_u32 m0, s54, 13312
    s_nop 0
    buffer_load_dwordx4 v2, s[16:19], s55 offen  lds
    s_add_u32 s55, s55, s56
    s_add_u32 m0, s54, 14336
    s_nop 0
    buffer_load_dwordx4 v2, s[16:19], s55 offen  lds
    s_add_u32 s55, s55, s56
    s_add_u32 m0, s54, 15360
    s_nop 0
    buffer_load_dwordx4 v2, s[16:19], s55 offen  lds
    s_add_u32 s55, s55, s56
    s_add_u32 m0, s54, 16384
    s_nop 0
    buffer_load_dwordx4 v2, s[16:19], s55 offen  lds
    s_add_u32 s55, s55, s56
    s_add_u32 m0, s54, 17408
    s_nop 0
    buffer_load_dwordx4 v2, s[16:19], s55 offen  lds
    s_add_u32 s55, s55, s56
    s_add_u32 m0, s54, 18432
    s_nop 0
    buffer_load_dwordx4 v2, s[16:19], s55 offen  lds
    s_add_u32 s55, s55, s56
    s_add_u32 m0, s54, 19456
    s_nop 0
    buffer_load_dwordx4 v2, s[16:19], s55 offen  lds
    s_add_u32 s55, s55, s56
    s_waitcnt vmcnt(12)
    s_barrier
    ds_read_b64_tr_b16 a[0:1], v6 offset:0
    ds_read_b64_tr_b16 a[2:3], v8 offset:512
    ds_read_b64_tr_b16 a[4:5], v7 offset:0
    ds_read_b64_tr_b16 a[6:7], v9 offset:512
    ds_read_b64_tr_b16 a[8:9], v8 offset:0
    ds_read_b64_tr_b16 a[10:11], v6 offset:512
    ds_read_b64_tr_b16 a[12:13], v9 offset:0
    ds_read_b64_tr_b16 a[14:15], v7 offset:512
    ds_read_b128 v[16:19], v112 offset:0
    ds_read_b128 v[20:23], v112 offset:2048
    ds_read_b128 v[24:27], v114 offset:0
    ds_read_b128 v[28:31], v114 offset:2048
    s_waitcnt lgkmcnt(4)
    s_add_u32 m0, s54, 0
    s_nop 0
    buffer_load_dwordx4 v2, s[16:19], s55 offen  lds
    s_add_u32 s55, s55, s56
    s_add_u32 m0, s54, 1024
    s_nop 0
    buffer_load_dwordx4 v2, s[16:19], s55 offen  lds
    s_add_u32 s55, s55, s56
    s_add_u32 m0, s54, 2048
    s_nop 0
    buffer_load_dwordx4 v2, s[16:19], s55 offen  lds
    s_add_u32 s55, s55, s56
    s_add_u32 m0, s54, 3072
    s_nop 0
    buffer_load_dwordx4 v2, s[16:19], s55 offen  lds
    s_add_u32 s55, s55, s56
    s_cmp_eq_u32 s41, 1
    s_waitcnt lgkmcnt(0)
    s_cbranch_scc1 Lg_pv0
    v_mfma_f32_16x16x32_bf16 v[48:51], a[0:3], v[16:19], 0
    v_mfma_f32_16x16x32_bf16 v[52:55], a[4:7], v[16:19], 0
    v_mfma_f32_16x16x32_bf16 v[64:67], a[8:11], v[16:19], 0
    v_mfma_f32_16x16x32_bf16 v[68:71], a[12:15], v[16:19], 0
    v_mfma_f32_16x16x32_bf16 v[56:59], a[0:3], v[20:23], 0
    v_mfma_f32_16x16x32_bf16 v[60:63], a[4:7], v[20:23], 0
    v_mfma_f32_16x16x32_bf16 v[72:75], a[8:11], v[20:23], 0
    v_mfma_f32_16x16x32_bf16 v[76:79], a[12:15], v[20:23], 0
    v_mfma_f32_16x16x32_bf16 v[80:83], a[0:3], v[24:27], 0
    v_mfma_f32_16x16x32_bf16 v[84:87], a[4:7], v[24:27], 0
    v_mfma_f32_16x16x32_bf16 v[96:99], a[8:11], v[24:27], 0
    v_mfma_f32_16x16x32_bf16 v[100:103], a[12:15], v[24:27], 0
    v_mfma_f32_16x16x32_bf16 v[88:91], a[0:3], v[28:31], 0
    v_mfma_f32_16x16x32_bf16 v[92:95], a[4:7], v[28:31], 0
    v_mfma_f32_16x16x32_bf16 v[104:107], a[8:11], v[28:31], 0
    v_mfma_f32_16x16x32_bf16 v[108:111], a[12:15], v[28:31], 0
    s_branch Lg_px0
Lg_pv0:
    v_mfma_f32_16x16x32_bf16 v[48:51], v[16:19], a[0:3], 0
    v_mfma_f32_16x16x32_bf16 v[56:59], v[16:19], a[4:7], 0
    v_mfma_f32_16x16x32_bf16 v[64:67], v[16:19], a[8:11], 0
    v_mfma_f32_16x16x32_bf16 v[72:75], v[16:19], a[12:15], 0
    v_mfma_f32_16x16x32_bf16 v[52:55], v[20:23], a[0:3], 0
    v_mfma_f32_16x16x32_bf16 v[60:63], v[20:23], a[4:7], 0
    v_mfma_f32_16x16x32_bf16 v[68:71], v[20:23], a[8:11], 0
    v_mfma_f32_16x16x32_bf16 v[76:79], v[20:23], a[12:15], 0
    v_mfma_f32_16x16x32_bf16 v[80:83], v[24:27], a[0:3], 0
    v_mfma_f32_16x16x32_bf16 v[88:91], v[24:27], a[4:7], 0
    v_mfma_f32_16x16x32_bf16 v[96:99], v[24:27], a[8:11], 0
    v_mfma_f32_16x16x32_bf16 v[104:107], v[24:27], a[12:15], 0
    v_mfma_f32_16x16x32_bf16 v[84:87], v[28:31], a[0:3], 0
    v_mfma_f32_16x16x32_bf16 v[92:95], v[28:31], a[4:7], 0
    v_mfma_f32_16x16x32_bf16 v[100:103], v[28:31], a[8:11], 0
    v_mfma_f32_16x16x32_bf16 v[108:111], v[28:31], a[12:15], 0
Lg_px0:
    s_waitcnt vmcnt(16)
    ds_read_b64_tr_b16 a[16:17], v6 offset:4096
    ds_read_b64_tr_b16 a[18:19], v8 offset:4608
    ds_read_b64_tr_b16 a[20:21], v7 offset:4096
    ds_read_b64_tr_b16 a[22:23], v9 offset:4608
    ds_read_b64_tr_b16 a[24:25], v8 offset:4096
    ds_read_b64_tr_b16 a[26:27], v6 offset:4608
    ds_read_b64_tr_b16 a[28:29], v9 offset:4096
    ds_read_b64_tr_b16 a[30:31], v7 offset:4608
    ds_read_b128 v[16:19], v113 offset:0
    ds_read_b128 v[20:23], v113 offset:2048
    ds_read_b128 v[24:27], v115 offset:0
    ds_read_b128 v[28:31], v115 offset:2048
    s_waitcnt lgkmcnt(4)
    s_add_u32 m0, s54, 4096
    s_nop 0
    buffer_load_dwordx4 v2, s[16:19], s55 offen  lds
    s_add_u32 s55, s55, s56
    s_add_u32 m0, s54, 5120
    s_nop 0
    buffer_load_dwordx4 v2, s[16:19], s55 offen  lds
    s_add_u32 s55, s55, s56
    s_add_u32 m0, s54, 6144
    s_nop 0
    buffer_load_dwordx4 v2, s[16:19], s55 offen  lds
    s_add_u32 s55, s55, s56
    s_add_u32 m0, s54, 7168
    s_nop 0
    buffer_load_dwordx4 v2, s[16:19], s55 offen  lds
    s_add_u32 s55, s55, s56
    s_cmp_eq_u32 s41, 1
    s_waitcnt lgkmcnt(0)
    s_cbranch_scc1 Lg_pv1
    v_mfma_f32_16x16x32_bf16 v[48:51], a[16:19], v[16:19], v[48:51]
    v_mfma_f32_16x16x32_bf16 v[52:55], a[20:23], v[16:19], v[52:55]
    v_mfma_f32_16x16x32_bf16 v[64:67], a[24:27], v[16:19], v[64:67]
    v_mfma_f32_16x16x32_bf16 v[68:71], a[28:31], v[16:19], v[68:71]
    v_mfma_f32_16x16x32_bf16 v[56:59], a[16:19], v[20:23], v[56:59]
    v_mfma_f32_16x16x32_bf16 v[60:63], a[20:23], v[20:23], v[60:63]
    v_mfma_f32_16x16x32_bf16 v[72:75], a[24:27], v[20:23], v[72:75]
    v_mfma_f32_16x16x32_bf16 v[76:79], a[28:31], v[20:23], v[76:79]
    v_mfma_f32_16x16x32_bf16 v[80:83], a[16:19], v[24:27], v[80:83]
    v_mfma_f32_16x16x32_bf16 v[84:87], a[20:23], v[24:27], v[84:87]
    v_mfma_f32_16x16x32_bf16 v[96:99], a[24:27], v[24:27], v[96:99]
    v_mfma_f32_16x16x32_bf16 v[100:103], a[28:31], v[24:27], v[100:103]
    v_mfma_f32_16x16x32_bf16 v[88:91], a[16:19], v[28:31], v[88:91]
    v_mfma_f32_16x16x32_bf16 v[92:95], a[20:23], v[28:31], v[92:95]
    v_mfma_f32_16x16x32_bf16 v[104:107], a[24:27], v[28:31], v[104:107]
    v_mfma_f32_16x16x32_bf16 v[108:111], a[28:31], v[28:31], v[108:111]
    s_branch Lg_px1
Lg_pv1:
    v_mfma_f32_16x16x32_bf16 v[48:51], v[16:19], a[16:19], v[48:51]
    v_mfma_f32_16x16x32_bf16 v[56:59], v[16:19], a[20:23], v[56:59]
    v_mfma_f32_16x16x32_bf16 v[64:67], v[16:19], a[24:27], v[64:67]
    v_mfma_f32_16x16x32_bf16 v[72:75], v[16:19], a[28:31], v[72:75]
    v_mfma_f32_16x16x32_bf16 v[52:55], v[20:23], a[16:19], v[52:55]
    v_mfma_f32_16x16x32_bf16 v[60:63], v[20:23], a[20:23], v[60:63]
    v_mfma_f32_16x16x32_bf16 v[68:71], v[20:23], a[24:27], v[68:71]
    v_mfma_f32_16x16x32_bf16 v[76:79], v[20:23], a[28:31], v[76:79]
    v_mfma_f32_16x16x32_bf16 v[80:83], v[24:27], a[16:19], v[80:83]
    v_mfma_f32_16x16x32_bf16 v[88:91], v[24:27], a[20:23], v[88:91]
    v_mfma_f32_16x16x32_bf16 v[96:99], v[24:27], a[24:27], v[96:99]
    v_mfma_f32_16x16x32_bf16 v[104:107], v[24:27], a[28:31], v[104:107]
    v_mfma_f32_16x16x32_bf16 v[84:87], v[28:31], a[16:19], v[84:87]
    v_mfma_f32_16x16x32_bf16 v[92:95], v[28:31], a[20:23], v[92:95]
    v_mfma_f32_16x16x32_bf16 v[100:103], v[28:31], a[24:27], v[100:103]
    v_mfma_f32_16x16x32_bf16 v[108:111], v[28:31], a[28:31], v[108:111]
Lg_px1:
    s_waitcnt vmcnt(16)
    ds_read_b64_tr_b16 a[32:33], v6 offset:8192
    ds_read_b64_tr_b16 a[34:35], v8 offset:8704
    ds_read_b64_tr_b16 a[36:37], v7 offset:8192
    ds_read_b64_tr_b16 a[38:39], v9 offset:8704
    ds_read_b64_tr_b16 a[40:41], v8 offset:8192
    ds_read_b64_tr_b16 a[42:43], v6 offset:8704
    ds_read_b64_tr_b16 a[44:45], v9 offset:8192
    ds_read_b64_tr_b16 a[46:47], v7 offset:8704
    ds_read_b128 v[16:19], v112 offset:4096
    ds_read_b128 v[20:23], v112 offset:6144
    ds_read_b128 v[24:27], v114 offset:4096
    ds_read_b128 v[28:31], v114 offset:6144
    s_waitcnt lgkmcnt(4)
    s_add_u32 m0, s54, 8192
    s_nop 0
    buffer_load_dwordx4 v2, s[16:19], s55 offen  lds
    s_add_u32 s55, s55, s56
    s_add_u32 m0, s54, 9216
    s_nop 0
    buffer_load_dwordx4 v2, s[16:19], s55 offen  lds
    s_add_u32 s55, s55, s56
    s_add_u32 m0, s54, 10240
    s_nop 0
    buffer_load_dwordx4 v2, s[16:19], s55 offen  lds
    s_add_u32 s55, s55, s56
    s_add_u32 m0, s54, 11264
    s_nop 0
    buffer_load_dwordx4 v2, s[16:19], s55 offen  lds
    s_add_u32 s55, s55, s56
    s_cmp_eq_u32 s41, 1
    s_waitcnt lgkmcnt(0)
    s_cbranch_scc1 Lg_pv2
    v_mfma_f32_16x16x32_bf16 v[48:51], a[32:35], v[16:19], v[48:51]
    v_mfma_f32_16x16x32_bf16 v[52:55], a[36:39], v[16:19], v[52:55]
    v_mfma_f32_16x16x32_bf16 v[64:67], a[40:43], v[16:19], v[64:67]
    v_mfma_f32_16x16x32_bf16 v[68:71], a[44:47], v[16:19], v[68:71]
    v_mfma_f32_16x16x32_bf16 v[56:59], a[32:35], v[20:23], v[56:59]
    v_mfma_f32_16x16x32_bf16 v[60:63], a[36:39], v[20:23], v[60:63]
    v_mfma_f32_16x16x32_bf16 v[72:75], a[40:43], v[20:23], v[72:75]
    v_mfma_f32_16x16x32_bf16 v[76:79], a[44:47], v[20:23], v[76:79]
    v_mfma_f32_16x16x32_bf16 v[80:83], a[32:35], v[24:27], v[80:83]
    v_mfma_f32_16x16x32_bf16 v[84:87], a[36:39], v[24:27], v[84:87]
    v_mfma_f32_16x16x32_bf16 v[96:99], a[40:43], v[24:27], v[96:99]
    v_mfma_f32_16x16x32_bf16 v[100:103], a[44:47], v[24:27], v[100:103]
    v_mfma_f32_16x16x32_bf16 v[88:91], a[32:35], v[28:31], v[88:91]
    v_mfma_f32_16x16x32_bf16 v[92:95], a[36:39], v[28:31], v[92:95]
    v_mfma_f32_16x16x32_bf16 v[104:107], a[40:43], v[28:31], v[104:107]
    v_mfma_f32_16x16x32_bf16 v[108:111], a[44:47], v[28:31], v[108:111]
    s_branch Lg_px2
Lg_pv2:
    v_mfma_f32_16x16x32_bf16 v[48:51], v[16:19], a[32:35], v[48:51]
    v_mfma_f32_16x16x32_bf16 v[56:59], v[16:19], a[36:39], v[56:59]
    v_mfma_f32_16x16x32_bf16 v[64:67], v[16:19], a[40:43], v[64:67]
    v_mfma_f32_16x16x32_bf16 v[72:75], v[16:19], a[44:47], v[72:75]
    v_mfma_f32_16x16x32_bf16 v[52:55], v[20:23], a[32:35], v[52:55]
    v_mfma_f32_16x16x32_bf16 v[60:63], v[20:23], a[36:39], v[60:63]
    v_mfma_f32_16x16x32_bf16 v[68:71], v[20:23], a[40:43], v[68:71]
    v_mfma_f32_16x16x32_bf16 v[76:79], v[20:23], a[44:47], v[76:79]
    v_mfma_f32_16x16x32_bf16 v[80:83], v[24:27], a[32:35], v[80:83]
    v_mfma_f32_16x16x32_bf16 v[88:91], v[24:27], a[36:39], v[88:91]
    v_mfma_f32_16x16x32_bf16 v[96:99], v[24:27], a[40:43], v[96:99]
    v_mfma_f32_16x16x32_bf16 v[104:107], v[24:27], a[44:47], v[104:107]
    v_mfma_f32_16x16x32_bf16 v[84:87], v[28:31], a[32:35], v[84:87]
    v_mfma_f32_16x16x32_bf16 v[92:95], v[28:31], a[36:39], v[92:95]
    v_mfma_f32_16x16x32_bf16 v[100:103], v[28:31], a[40:43], v[100:103]
    v_mfma_f32_16x16x32_bf16 v[108:111], v[28:31], a[44:47], v[108:111]
Lg_px2:
    s_waitcnt vmcnt(16)
    ds_read_b64_tr_b16 a[48:49], v6 offset:12288
    ds_read_b64_tr_b16 a[50:51], v8 offset:12800
    ds_read_b64_tr_b16 a[52:53], v7 offset:12288
    ds_read_b64_tr_b16 a[54:55], v9 offset:12800
    ds_read_b64_tr_b16 a[56:57], v8 offset:12288
    ds_read_b64_tr_b16 a[58:59], v6 offset:12800
    ds_read_b64_tr_b16 a[60:61], v9 offset:12288
    ds_read_b64_tr_b16 a[62:63], v7 offset:12800
    ds_read_b128 v[16:19], v113 offset:4096
    ds_read_b128 v[20:23], v113 offset:6144
    ds_read_b128 v[24:27], v115 offset:4096
    ds_read_b128 v[28:31], v115 offset:6144
    s_waitcnt lgkmcnt(4)
    s_add_u32 m0, s54, 12288
    s_nop 0
    buffer_load_dwordx4 v2, s[16:19], s55 offen  lds
    s_add_u32 s55, s55, s56
    s_add_u32 m0, s54, 13312
    s_nop 0
    buffer_load_dwordx4 v2, s[16:19], s55 offen  lds
    s_add_u32 s55, s55, s56
    s_add_u32 m0, s54, 14336
    s_nop 0
    buffer_load_dwordx4 v2, s[16:19], s55 offen  lds
    s_add_u32 s55, s55, s56
    s_add_u32 m0, s54, 15360
    s_nop 0
    buffer_load_dwordx4 v2, s[16:19], s55 offen  lds
    s_add_u32 s55, s55, s56
    s_cmp_eq_u32 s41, 1
    s_waitcnt lgkmcnt(0)
    s_cbranch_scc1 Lg_pv3
    v_mfma_f32_16x16x32_bf16 v[48:51], a[48:51], v[16:19], v[48:51]
    v_mfma_f32_16x16x32_bf16 v[52:55], a[52:55], v[16:19], v[52:55]
    v_mfma_f32_16x16x32_bf16 v[64:67], a[56:59], v[16:19], v[64:67]
    v_mfma_f32_16x16x32_bf16 v[68:71], a[60:63], v[16:19], v[68:71]
    v_mfma_f32_16x16x32_bf16 v[56:59], a[48:51], v[20:23], v[56:59]
    v_mfma_f32_16x16x32_bf16 v[60:63], a[52:55], v[20:23], v[60:63]
    v_mfma_f32_16x16x32_bf16 v[72:75], a[56:59], v[20:23], v[72:75]
    v_mfma_f32_16x16x32_bf16 v[76:79], a[60:63], v[20:23], v[76:79]
    v_mfma_f32_16x16x32_bf16 v[80:83], a[48:51], v[24:27], v[80:83]
    v_mfma_f32_16x16x32_bf16 v[84:87], a[52:55], v[24:27], v[84:87]
    v_mfma_f32_16x16x32_bf16 v[96:99], a[56:59], v[24:27], v[96:99]
    v_mfma_f32_16x16x32_bf16 v[100:103], a[60:63], v[24:27], v[100:103]
    v_mfma_f32_16x16x32_bf16 v[88:91], a[48:51], v[28:31], v[88:91]
    v_mfma_f32_16x16x32_bf16 v[92:95], a[52:55], v[28:31], v[92:95]
    v_mfma_f32_16x16x32_bf16 v[104:107], a[56:59], v[28:31], v[104:107]
    v_mfma_f32_16x16x32_bf16 v[108:111], a[60:63], v[28:31], v[108:111]
    s_branch Lg_px3
Lg_pv3:
    v_mfma_f32_16x16x32_bf16 v[48:51], v[16:19], a[48:51], v[48:51]
    v_mfma_f32_16x16x32_bf16 v[56:59], v[16:19], a[52:55], v[56:59]
    v_mfma_f32_16x16x32_bf16 v[64:67], v[16:19], a[56:59], v[64:67]
    v_mfma_f32_16x16x32_bf16 v[72:75], v[16:19], a[60:63], v[72:75]
    v_mfma_f32_16x16x32_bf16 v[52:55], v[20:23], a[48:51], v[52:55]
    v_mfma_f32_16x16x32_bf16 v[60:63], v[20:23], a[52:55], v[60:63]
    v_mfma_f32_16x16x32_bf16 v[68:71], v[20:23], a[56:59], v[68:71]
    v_mfma_f32_16x16x32_bf16 v[76:79], v[20:23], a[60:63], v[76:79]
    v_mfma_f32_16x16x32_bf16 v[80:83], v[24:27], a[48:51], v[80:83]
    v_mfma_f32_16x16x32_bf16 v[88:91], v[24:27], a[52:55], v[88:91]
    v_mfma_f32_16x16x32_bf16 v[96:99], v[24:27], a[56:59], v[96:99]
    v_mfma_f32_16x16x32_bf16 v[104:107], v[24:27], a[60:63], v[104:107]
    v_mfma_f32_16x16x32_bf16 v[84:87], v[28:31], a[48:51], v[84:87]
    v_mfma_f32_16x16x32_bf16 v[92:95], v[28:31], a[52:55], v[92:95]
    v_mfma_f32_16x16x32_bf16 v[100:103], v[28:31], a[56:59], v[100:103]
    v_mfma_f32_16x16x32_bf16 v[108:111], v[28:31], a[60:63], v[108:111]
Lg_px3:
    s_waitcnt vmcnt(16)
    ds_read_b64_tr_b16 a[64:65], v6 offset:16384
    ds_read_b64_tr_b16 a[66:67], v8 offset:16896
    ds_read_b64_tr_b16 a[68:69], v7 offset:16384
    ds_read_b64_tr_b16 a[70:71], v9 offset:16896
    ds_read_b64_tr_b16 a[72:73], v8 offset:16384
    ds_read_b64_tr_b16 a[74:75], v6 offset:16896
    ds_read_b64_tr_b16 a[76:77], v9 offset:16384
    ds_read_b64_tr_b16 a[78:79], v7 offset:16896
    ds_read_b128 v[16:19], v112 offset:8192
    ds_read_b128 v[20:23], v112 offset:10240
    ds_read_b128 v[24:27], v114 offset:8192
    ds_read_b128 v[28:31], v114 offset:10240
    s_waitcnt lgkmcnt(4)
    s_add_u32 m0, s54, 16384
    s_nop 0
    buffer_load_dwordx4 v2, s[16:19], s55 offen  lds
    s_add_u32 s55, s55, s56
    s_add_u32 m0, s54, 17408
    s_nop 0
    buffer_load_dwordx4 v2, s[16:19], s55 offen  lds
    s_add_u32 s55, s55, s56
    s_add_u32 m0, s54, 18432
    s_nop 0
    buffer_load_dwordx4 v2, s[16:19], s55 offen  lds
    s_add_u32 s55, s55, s56
    s_add_u32 m0, s54, 19456
    s_nop 0
    buffer_load_dwordx4 v2, s[16:19], s55 offen  lds
    s_add_u32 s55, s55, s56
    s_cmp_eq_u32 s41, 1
    s_waitcnt lgkmcnt(0)
    s_cbranch_scc1 Lg_pv4
    v_mfma_f32_16x16x32_bf16 v[48:51], a[64:67], v[16:19], v[48:51]
    v_mfma_f32_16x16x32_bf16 v[52:55], a[68:71], v[16:19], v[52:55]
    v_mfma_f32_16x16x32_bf16 v[64:67], a[72:75], v[16:19], v[64:67]
    v_mfma_f32_16x16x32_bf16 v[68:71], a[76:79], v[16:19], v[68:71]
    v_mfma_f32_16x16x32_bf16 v[56:59], a[64:67], v[20:23], v[56:59]
    v_mfma_f32_16x16x32_bf16 v[60:63], a[68:71], v[20:23], v[60:63]
    v_mfma_f32_16x16x32_bf16 v[72:75], a[72:75], v[20:23], v[72:75]
    v_mfma_f32_16x16x32_bf16 v[76:79], a[76:79], v[20:23], v[76:79]
    v_mfma_f32_16x16x32_bf16 v[80:83], a[64:67], v[24:27], v[80:83]
    v_mfma_f32_16x16x32_bf16 v[84:87], a[68:71], v[24:27], v[84:87]
    v_mfma_f32_16x16x32_bf16 v[96:99], a[72:75], v[24:27], v[96:99]
    v_mfma_f32_16x16x32_bf16 v[100:103], a[76:79], v[24:27], v[100:103]
    v_mfma_f32_16x16x32_bf16 v[88:91], a[64:67], v[28:31], v[88:91]
    v_mfma_f32_16x16x32_bf16 v[92:95], a[68:71], v[28:31], v[92:95]
    v_mfma_f32_16x16x32_bf16 v[104:107], a[72:75], v[28:31], v[104:107]
    v_mfma_f32_16x16x32_bf16 v[108:111], a[76:79], v[28:31], v[108:111]
    s_branch Lg_px4
Lg_pv4:
    v_mfma_f32_16x16x32_bf16 v[48:51], v[16:19], a[64:67], v[48:51]
    v_mfma_f32_16x16x32_bf16 v[56:59], v[16:19], a[68:71], v[56:59]
    v_mfma_f32_16x16x32_bf16 v[64:67], v[16:19], a[72:75], v[64:67]
    v_mfma_f32_16x16x32_bf16 v[72:75], v[16:19], a[76:79], v[72:75]
    v_mfma_f32_16x16x32_bf16 v[52:55], v[20:23], a[64:67], v[52:55]
    v_mfma_f32_16x16x32_bf16 v[60:63], v[20:23], a[68:71], v[60:63]
    v_mfma_f32_16x16x32_bf16 v[68:71], v[20:23], a[72:75], v[68:71]
    v_mfma_f32_16x16x32_bf16 v[76:79], v[20:23], a[76:79], v[76:79]
    v_mfma_f32_16x16x32_bf16 v[80:83], v[24:27], a[64:67], v[80:83]
    v_mfma_f32_16x16x32_bf16 v[88:91], v[24:27], a[68:71], v[88:91]
    v_mfma_f32_16x16x32_bf16 v[96:99], v[24:27], a[72:75], v[96:99]
    v_mfma_f32_16x16x32_bf16 v[104:107], v[24:27], a[76:79], v[104:107]
    v_mfma_f32_16x16x32_bf16 v[84:87], v[28:31], a[64:67], v[84:87]
    v_mfma_f32_16x16x32_bf16 v[92:95], v[28:31], a[68:71], v[92:95]
    v_mfma_f32_16x16x32_bf16 v[100:103], v[28:31], a[72:75], v[100:103]
    v_mfma_f32_16x16x32_bf16 v[108:111], v[28:31], a[76:79], v[108:111]
Lg_px4:
    s_waitcnt vmcnt(16)
    ds_read_b64_tr_b16 a[80:81], v6 offset:0
    ds_read_b64_tr_b16 a[82:83], v8 offset:512
    ds_read_b64_tr_b16 a[84:85], v7 offset:0
    ds_read_b64_tr_b16 a[86:87], v9 offset:512
    ds_read_b64_tr_b16 a[88:89], v8 offset:0
    ds_read_b64_tr_b16 a[90:91], v6 offset:512
    ds_read_b64_tr_b16 a[92:93], v9 offset:0
    ds_read_b64_tr_b16 a[94:95], v7 offset:512
    ds_read_b128 v[16:19], v113 offset:8192
    ds_read_b128 v[20:23], v113 offset:10240
    ds_read_b128 v[24:27], v115 offset:8192
    ds_read_b128 v[28:31], v115 offset:10240
    s_waitcnt lgkmcnt(4)
    s_add_u32 m0, s54, 0
    s_nop 0
    buffer_load_dwordx4 v2, s[16:19], s55 offen  lds
    s_add_u32 s55, s55, s56
    s_add_u32 m0, s54, 1024
    s_nop 0
    buffer_load_dwordx4 v2, s[16:19], s55 offen  lds
    s_add_u32 s55, s55, s56
    s_add_u32 m0, s54, 2048
    s_nop 0
    buffer_load_dwordx4 v2, s[16:19], s55 offen  lds
    s_add_u32 s55, s55, s56
    s_add_u32 m0, s54, 3072
    s_nop 0
    buffer_load_dwordx4 v2, s[16:19], s55 offen  lds
    s_add_u32 s55, s55, s56
    s_cmp_eq_u32 s41, 1
    s_waitcnt lgkmcnt(0)
    s_cbranch_scc1 Lg_pv5
    v_mfma_f32_16x16x32_bf16 v[48:51], a[80:83], v[16:19], v[48:51]
    v_mfma_f32_16x16x32_bf16 v[52:55], a[84:87], v[16:19], v[52:55]
    v_mfma_f32_16x16x32_bf16 v[64:67], a[88:91], v[16:19], v[64:67]
    v_mfma_f32_16x16x32_bf16 v[68:71], a[92:95], v[16:19], v[68:71]
    v_mfma_f32_16x16x32_bf16 v[56:59], a[80:83], v[20:23], v[56:59]
    v_mfma_f32_16x16x32_bf16 v[60:63], a[84:87], v[20:23], v[60:63]
    v_mfma_f32_16x16x32_bf16 v[72:75], a[88:91], v[20:23], v[72:75]
    v_mfma_f32_16x16x32_bf16 v[76:79], a[92:95], v[20:23], v[76:79]
    v_mfma_f32_16x16x32_bf16 v[80:83], a[80:83], v[24:27], v[80:83]
    v_mfma_f32_16x16x32_bf16 v[84:87], a[84:87], v[24:27], v[84:87]
    v_mfma_f32_16x16x32_bf16 v[96:99], a[88:91], v[24:27], v[96:99]
    v_mfma_f32_16x16x32_bf16 v[100:103], a[92:95], v[24:27], v[100:103]
    v_mfma_f32_16x16x32_bf16 v[88:91], a[80:83], v[28:31], v[88:91]
    v_mfma_f32_16x16x32_bf16 v[92:95], a[84:87], v[28:31], v[92:95]
    v_mfma_f32_16x16x32_bf16 v[104:107], a[88:91], v[28:31], v[104:107]
    v_mfma_f32_16x16x32_bf16 v[108:111], a[92:95], v[28:31], v[108:111]
    s_branch Lg_px5
Lg_pv5:
    v_mfma_f32_16x16x32_bf16 v[48:51], v[16:19], a[80:83], v[48:51]
    v_mfma_f32_16x16x32_bf16 v[56:59], v[16:19], a[84:87], v[56:59]
    v_mfma_f32_16x16x32_bf16 v[64:67], v[16:19], a[88:91], v[64:67]
    v_mfma_f32_16x16x32_bf16 v[72:75], v[16:19], a[92:95], v[72:75]
    v_mfma_f32_16x16x32_bf16 v[52:55], v[20:23], a[80:83], v[52:55]
    v_mfma_f32_16x16x32_bf16 v[60:63], v[20:23], a[84:87], v[60:63]
    v_mfma_f32_16x16x32_bf16 v[68:71], v[20:23], a[88:91], v[68:71]
    v_mfma_f32_16x16x32_bf16 v[76:79], v[20:23], a[92:95], v[76:79]
    v_mfma_f32_16x16x32_bf16 v[80:83], v[24:27], a[80:83], v[80:83]
    v_mfma_f32_16x16x32_bf16 v[88:91], v[24:27], a[84:87], v[88:91]
    v_mfma_f32_16x16x32_bf16 v[96:99], v[24:27], a[88:91], v[96:99]
    v_mfma_f32_16x16x32_bf16 v[104:107], v[24:27], a[92:95], v[104:107]
    v_mfma_f32_16x16x32_bf16 v[84:87], v[28:31], a[80:83], v[84:87]
    v_mfma_f32_16x16x32_bf16 v[92:95], v[28:31], a[84:87], v[92:95]
    v_mfma_f32_16x16x32_bf16 v[100:103], v[28:31], a[88:91], v[100:103]
    v_mfma_f32_16x16x32_bf16 v[108:111], v[28:31], a[92:95], v[108:111]
Lg_px5:
    s_waitcnt vmcnt(16)
    ds_read_b64_tr_b16 a[96:97], v6 offset:4096
    ds_read_b64_tr_b16 a[98:99], v8 offset:4608
    ds_read_b64_tr_b16 a[100:101], v7 offset:4096
    ds_read_b64_tr_b16 a[102:103], v9 offset:4608
    ds_read_b64_tr_b16 a[104:105], v8 offset:4096
    ds_read_b64_tr_b16 a[106:107], v6 offset:4608
    ds_read_b64_tr_b16 a[108:109], v9 offset:4096
    ds_read_b64_tr_b16 a[110:111], v7 offset:4608
    ds_read_b128 v[16:19], v112 offset:12288
    ds_read_b128 v[20:23], v112 offset:14336
    ds_read_b128 v[24:27], v114 offset:12288
    ds_read_b128 v[28:31], v114 offset:14336
    s_waitcnt lgkmcnt(4)
    s_add_u32 s45, s44, 2
    s_mul_i32 s45, s45, 40960
    s_cmp_eq_u32 s42, 3
    s_cselect_b32 s45, 1073741824, s45
    buffer_load_dword v117, v116, s[20:23], s45 offen sc1
    s_add_u32 m0, s54, 4096
    s_nop 0
    buffer_load_dwordx4 v2, s[16:19], s55 offen  lds
    s_add_u32 s55, s55, s56
    s_add_u32 m0, s54, 5120
    s_nop 0
    buffer_load_dwordx4 v2, s[16:19], s55 offen  lds
    s_add_u32 s55, s55, s56
    s_add_u32 m0, s54, 6144
    s_nop 0
    buffer_load_dwordx4 v2, s[16:19], s55 offen  lds
    s_add_u32 s55, s55, s56
    s_add_u32 m0, s54, 7168
    s_nop 0
    buffer_load_dwordx4 v2, s[16:19], s55 offen  lds
    s_add_u32 s55, s55, s56
    s_cmp_eq_u32 s41, 1
    s_waitcnt lgkmcnt(0)
    s_cbranch_scc1 Lg_pv6
    v_mfma_f32_16x16x32_bf16 v[48:51], a[96:99], v[16:19], v[48:51]
    v_mfma_f32_16x16x32_bf16 v[52:55], a[100:103], v[16:19], v[52:55]
    v_mfma_f32_16x16x32_bf16 v[64:67], a[104:107], v[16:19], v[64:67]
    v_mfma_f32_16x16x32_bf16 v[68:71], a[108:111], v[16:19], v[68:71]
    v_mfma_f32_16x16x32_bf16 v[56:59], a[96:99], v[20:23], v[56:59]
    v_mfma_f32_16x16x32_bf16 v[60:63], a[100:103], v[20:23], v[60:63]
    v_mfma_f32_16x16x32_bf16 v[72:75], a[104:107], v[20:23], v[72:75]
    v_mfma_f32_16x16x32_bf16 v[76:79], a[108:111], v[20:23], v[76:79]
    v_mfma_f32_16x16x32_bf16 v[80:83], a[96:99], v[24:27], v[80:83]
    v_mfma_f32_16x16x32_bf16 v[84:87], a[100:103], v[24:27], v[84:87]
    v_mfma_f32_16x16x32_bf16 v[96:99], a[104:107], v[24:27], v[96:99]
    v_mfma_f32_16x16x32_bf16 v[100:103], a[108:111], v[24:27], v[100:103]
    v_mfma_f32_16x16x32_bf16 v[88:91], a[96:99], v[28:31], v[88:91]
    v_mfma_f32_16x16x32_bf16 v[92:95], a[100:103], v[28:31], v[92:95]
    v_mfma_f32_16x16x32_bf16 v[104:107], a[104:107], v[28:31], v[104:107]
    v_mfma_f32_16x16x32_bf16 v[108:111], a[108:111], v[28:31], v[108:111]
    s_branch Lg_px6
Lg_pv6:
    v_mfma_f32_16x16x32_bf16 v[48:51], v[16:19], a[96:99], v[48:51]
    v_mfma_f32_16x16x32_bf16 v[56:59], v[16:19], a[100:103], v[56:59]
    v_mfma_f32_16x16x32_bf16 v[64:67], v[16:19], a[104:107], v[64:67]
    v_mfma_f32_16x16x32_bf16 v[72:75], v[16:19], a[108:111], v[72:75]
    v_mfma_f32_16x16x32_bf16 v[52:55], v[20:23], a[96:99], v[52:55]
    v_mfma_f32_16x16x32_bf16 v[60:63], v[20:23], a[100:103], v[60:63]
    v_mfma_f32_16x16x32_bf16 v[68:71], v[20:23], a[104:107], v[68:71]
    v_mfma_f32_16x16x32_bf16 v[76:79], v[20:23], a[108:111], v[76:79]
    v_mfma_f32_16x16x32_bf16 v[80:83], v[24:27], a[96:99], v[80:83]
    v_mfma_f32_16x16x32_bf16 v[88:91], v[24:27], a[100:103], v[88:91]
    v_mfma_f32_16x16x32_bf16 v[96:99], v[24:27], a[104:107], v[96:99]
    v_mfma_f32_16x16x32_bf16 v[104:107], v[24:27], a[108:111], v[104:107]
    v_mfma_f32_16x16x32_bf16 v[84:87], v[28:31], a[96:99], v[84:87]
    v_mfma_f32_16x16x32_bf16 v[92:95], v[28:31], a[100:103], v[92:95]
    v_mfma_f32_16x16x32_bf16 v[100:103], v[28:31], a[104:107], v[100:103]
    v_mfma_f32_16x16x32_bf16 v[108:111], v[28:31], a[108:111], v[108:111]
Lg_px6:
    s_waitcnt vmcnt(16)
    ds_read_b64_tr_b16 a[112:113], v6 offset:8192
    ds_read_b64_tr_b16 a[114:115], v8 offset:8704
    ds_read_b64_tr_b16 a[116:117], v7 offset:8192
    ds_read_b64_tr_b16 a[118:119], v9 offset:8704
    ds_read_b64_tr_b16 a[120:121], v8 offset:8192
    ds_read_b64_tr_b16 a[122:123], v6 offset:8704
    ds_read_b64_tr_b16 a[124:125], v9 offset:8192
    ds_read_b64_tr_b16 a[126:127], v7 offset:8704
    ds_read_b128 v[16:19], v113 offset:12288
    ds_read_b128 v[20:23], v113 offset:14336
    ds_read_b128 v[24:27], v115 offset:12288
    ds_read_b128 v[28:31], v115 offset:14336
    s_waitcnt lgkmcnt(4)
    s_add_u32 m0, s54, 8192
    s_nop 0
    buffer_load_dwordx4 v2, s[16:19], s55 offen  lds
    s_add_u32 s55, s55, s56
    s_add_u32 m0, s54, 9216
    s_nop 0
    buffer_load_dwordx4 v2, s[16:19], s55 offen  lds
    s_add_u32 s55, s55, s56
    s_add_u32 m0, s54, 10240
    s_nop 0
    buffer_load_dwordx4 v2, s[16:19], s55 offen  lds
    s_add_u32 s55, s55, s56
    s_add_u32 m0, s54, 11264
    s_nop 0
    buffer_load_dwordx4 v2, s[16:19], s55 offen  lds
    s_add_u32 s55, s55, s56
    s_cmp_eq_u32 s41, 1
    s_waitcnt lgkmcnt(0)
    s_cbranch_scc1 Lg_pv7
    v_mfma_f32_16x16x32_bf16 v[48:51], a[112:115], v[16:19], v[48:51]
    v_mfma_f32_16x16x32_bf16 v[52:55], a[116:119], v[16:19], v[52:55]
    v_mfma_f32_16x16x32_bf16 v[64:67], a[120:123], v[16:19], v[64:67]
    v_mfma_f32_16x16x32_bf16 v[68:71], a[124:127], v[16:19], v[68:71]
    v_mfma_f32_16x16x32_bf16 v[56:59], a[112:115], v[20:23], v[56:59]
    v_mfma_f32_16x16x32_bf16 v[60:63], a[116:119], v[20:23], v[60:63]
    v_mfma_f32_16x16x32_bf16 v[72:75], a[120:123], v[20:23], v[72:75]
    v_mfma_f32_16x16x32_bf16 v[76:79], a[124:127], v[20:23], v[76:79]
    v_mfma_f32_16x16x32_bf16 v[80:83], a[112:115], v[24:27], v[80:83]
    v_mfma_f32_16x16x32_bf16 v[84:87], a[116:119], v[24:27], v[84:87]
    v_mfma_f32_16x16x32_bf16 v[96:99], a[120:123], v[24:27], v[96:99]
    v_mfma_f32_16x16x32_bf16 v[100:103], a[124:127], v[24:27], v[100:103]
    v_mfma_f32_16x16x32_bf16 v[88:91], a[112:115], v[28:31], v[88:91]
    v_mfma_f32_16x16x32_bf16 v[92:95], a[116:119], v[28:31], v[92:95]
    v_mfma_f32_16x16x32_bf16 v[104:107], a[120:123], v[28:31], v[104:107]
    v_mfma_f32_16x16x32_bf16 v[108:111], a[124:127], v[28:31], v[108:111]
    s_branch Lg_px7
Lg_pv7:
    v_mfma_f32_16x16x32_bf16 v[48:51], v[16:19], a[112:115], v[48:51]
    v_mfma_f32_16x16x32_bf16 v[56:59], v[16:19], a[116:119], v[56:59]
    v_mfma_f32_16x16x32_bf16 v[64:67], v[16:19], a[120:123], v[64:67]
    v_mfma_f32_16x16x32_bf16 v[72:75], v[16:19], a[124:127], v[72:75]
    v_mfma_f32_16x16x32_bf16 v[52:55], v[20:23], a[112:115], v[52:55]
    v_mfma_f32_16x16x32_bf16 v[60:63], v[20:23], a[116:119], v[60:63]
    v_mfma_f32_16x16x32_bf16 v[68:71], v[20:23], a[120:123], v[68:71]
    v_mfma_f32_16x16x32_bf16 v[76:79], v[20:23], a[124:127], v[76:79]
    v_mfma_f32_16x16x32_bf16 v[80:83], v[24:27], a[112:115], v[80:83]
    v_mfma_f32_16x16x32_bf16 v[88:91], v[24:27], a[116:119], v[88:91]
    v_mfma_f32_16x16x32_bf16 v[96:99], v[24:27], a[120:123], v[96:99]
    v_mfma_f32_16x16x32_bf16 v[104:107], v[24:27], a[124:127], v[104:107]
    v_mfma_f32_16x16x32_bf16 v[84:87], v[28:31], a[112:115], v[84:87]
    v_mfma_f32_16x16x32_bf16 v[92:95], v[28:31], a[116:119], v[92:95]
    v_mfma_f32_16x16x32_bf16 v[100:103], v[28:31], a[120:123], v[100:103]
    v_mfma_f32_16x16x32_bf16 v[108:111], v[28:31], a[124:127], v[108:111]
Lg_px7:
    s_waitcnt vmcnt(16)
    ds_read_b64_tr_b16 a[128:129], v6 offset:12288
    ds_read_b64_tr_b16 a[130:131], v8 offset:12800
    ds_read_b64_tr_b16 a[132:133], v7 offset:12288
    ds_read_b64_tr_b16 a[134:135], v9 offset:12800
    ds_read_b64_tr_b16 a[136:137], v8 offset:12288
    ds_read_b64_tr_b16 a[138:139], v6 offset:12800
    ds_read_b64_tr_b16 a[140:141], v9 offset:12288
    ds_read_b64_tr_b16 a[142:143], v7 offset:12800
    ds_read_b128 v[16:19], v112 offset:16384
    ds_read_b128 v[20:23], v112 offset:18432
    ds_read_b128 v[24:27], v114 offset:16384
    ds_read_b128 v[28:31], v114 offset:18432
    s_waitcnt lgkmcnt(4)
    s_add_u32 s45, s44, 3
    s_mul_i32 s45, s45, 40960
    s_cmp_eq_u32 s42, 3
    s_cselect_b32 s45, 1073741824, s45
    buffer_load_dword v117, v116, s[20:23], s45 offen sc1
    s_add_u32 m0, s54, 12288
    s_nop 0
    buffer_load_dwordx4 v2, s[16:19], s55 offen  lds
    s_add_u32 s55, s55, s56
    s_add_u32 m0, s54, 13312
    s_nop 0
    buffer_load_dwordx4 v2, s[16:19], s55 offen  lds
    s_add_u32 s55, s55, s56
    s_add_u32 m0, s54, 14336
    s_nop 0
    buffer_load_dwordx4 v2, s[16:19], s55 offen  lds
    s_add_u32 s55, s55, s56
    s_add_u32 m0, s54, 15360
    s_nop 0
    buffer_load_dwordx4 v2, s[16:19], s55 offen  lds
    s_add_u32 s55, s55, s56
    s_cmp_eq_u32 s41, 1
    s_waitcnt lgkmcnt(0)
    s_cbranch_scc1 Lg_pv8
    v_mfma_f32_16x16x32_bf16 v[48:51], a[128:131], v[16:19], v[48:51]
    v_mfma_f32_16x16x32_bf16 v[52:55], a[132:135], v[16:19], v[52:55]
    v_mfma_f32_16x16x32_bf16 v[64:67], a[136:139], v[16:19], v[64:67]
    v_mfma_f32_16x16x32_bf16 v[68:71], a[140:143], v[16:19], v[68:71]
    v_mfma_f32_16x16x32_bf16 v[56:59], a[128:131], v[20:23], v[56:59]
    v_mfma_f32_16x16x32_bf16 v[60:63], a[132:135], v[20:23], v[60:63]
    v_mfma_f32_16x16x32_bf16 v[72:75], a[136:139], v[20:23], v[72:75]
    v_mfma_f32_16x16x32_bf16 v[76:79], a[140:143], v[20:23], v[76:79]
    v_mfma_f32_16x16x32_bf16 v[80:83], a[128:131], v[24:27], v[80:83]
    v_mfma_f32_16x16x32_bf16 v[84:87], a[132:135], v[24:27], v[84:87]
    v_mfma_f32_16x16x32_bf16 v[96:99], a[136:139], v[24:27], v[96:99]
    v_mfma_f32_16x16x32_bf16 v[100:103], a[140:143], v[24:27], v[100:103]
    v_mfma_f32_16x16x32_bf16 v[88:91], a[128:131], v[28:31], v[88:91]
    v_mfma_f32_16x16x32_bf16 v[92:95], a[132:135], v[28:31], v[92:95]
    v_mfma_f32_16x16x32_bf16 v[104:107], a[136:139], v[28:31], v[104:107]
    v_mfma_f32_16x16x32_bf16 v[108:111], a[140:143], v[28:31], v[108:111]
    s_branch Lg_px8
Lg_pv8:
    v_mfma_f32_16x16x32_bf16 v[48:51], v[16:19], a[128:131], v[48:51]
    v_mfma_f32_16x16x32_bf16 v[56:59], v[16:19], a[132:135], v[56:59]
    v_mfma_f32_16x16x32_bf16 v[64:67], v[16:19], a[136:139], v[64:67]
    v_mfma_f32_16x16x32_bf16 v[72:75], v[16:19], a[140:143], v[72:75]
    v_mfma_f32_16x16x32_bf16 v[52:55], v[20:23], a[128:131], v[52:55]
    v_mfma_f32_16x16x32_bf16 v[60:63], v[20:23], a[132:135], v[60:63]
    v_mfma_f32_16x16x32_bf16 v[68:71], v[20:23], a[136:139], v[68:71]
    v_mfma_f32_16x16x32_bf16 v[76:79], v[20:23], a[140:143], v[76:79]
    v_mfma_f32_16x16x32_bf16 v[80:83], v[24:27], a[128:131], v[80:83]
    v_mfma_f32_16x16x32_bf16 v[88:91], v[24:27], a[132:135], v[88:91]
    v_mfma_f32_16x16x32_bf16 v[96:99], v[24:27], a[136:139], v[96:99]
    v_mfma_f32_16x16x32_bf16 v[104:107], v[24:27], a[140:143], v[104:107]
    v_mfma_f32_16x16x32_bf16 v[84:87], v[28:31], a[128:131], v[84:87]
    v_mfma_f32_16x16x32_bf16 v[92:95], v[28:31], a[132:135], v[92:95]
    v_mfma_f32_16x16x32_bf16 v[100:103], v[28:31], a[136:139], v[100:103]
    v_mfma_f32_16x16x32_bf16 v[108:111], v[28:31], a[140:143], v[108:111]
Lg_px8:
    s_waitcnt vmcnt(16)
    ds_read_b64_tr_b16 a[144:145], v6 offset:16384
    ds_read_b64_tr_b16 a[146:147], v8 offset:16896
    ds_read_b64_tr_b16 a[148:149], v7 offset:16384
    ds_read_b64_tr_b16 a[150:151], v9 offset:16896
    ds_read_b64_tr_b16 a[152:153], v8 offset:16384
    ds_read_b64_tr_b16 a[154:155], v6 offset:16896
    ds_read_b64_tr_b16 a[156:157], v9 offset:16384
    ds_read_b64_tr_b16 a[158:159], v7 offset:16896
    ds_read_b128 v[16:19], v113 offset:16384
    ds_read_b128 v[20:23], v113 offset:18432
    ds_read_b128 v[24:27], v115 offset:16384
    ds_read_b128 v[28:31], v115 offset:18432
    s_waitcnt lgkmcnt(4)
    s_add_u32 m0, s54, 16384
    s_nop 0
    buffer_load_dwordx4 v2, s[16:19], s55 offen  lds
    s_add_u32 s55, s55, s56
    s_add_u32 m0, s54, 17408
    s_nop 0
    buffer_load_dwordx4 v2, s[16:19], s55 offen  lds
    s_add_u32 s55, s55, s56
    s_add_u32 m0, s54, 18432
    s_nop 0
    buffer_load_dwordx4 v2, s[16:19], s55 offen  lds
    s_add_u32 s55, s55, s56
    s_add_u32 m0, s54, 19456
    s_nop 0
    buffer_load_dwordx4 v2, s[16:19], s55 offen  lds
    s_add_u32 s55, s55, s56
    s_cmp_eq_u32 s41, 1
    s_waitcnt lgkmcnt(0)
    s_cbranch_scc1 Lg_pv9
    v_mfma_f32_16x16x32_bf16 v[48:51], a[144:147], v[16:19], v[48:51]
    v_mfma_f32_16x16x32_bf16 v[52:55], a[148:151], v[16:19], v[52:55]
    v_mfma_f32_16x16x32_bf16 v[64:67], a[152:155], v[16:19], v[64:67]
    v_mfma_f32_16x16x32_bf16 v[68:71], a[156:159], v[16:19], v[68:71]
    v_mfma_f32_16x16x32_bf16 v[56:59], a[144:147], v[20:23], v[56:59]
    v_mfma_f32_16x16x32_bf16 v[60:63], a[148:151], v[20:23], v[60:63]
    v_mfma_f32_16x16x32_bf16 v[72:75], a[152:155], v[20:23], v[72:75]
    v_mfma_f32_16x16x32_bf16 v[76:79], a[156:159], v[20:23], v[76:79]
    v_mfma_f32_16x16x32_bf16 v[80:83], a[144:147], v[24:27], v[80:83]
    v_mfma_f32_16x16x32_bf16 v[84:87], a[148:151], v[24:27], v[84:87]
    v_mfma_f32_16x16x32_bf16 v[96:99], a[152:155], v[24:27], v[96:99]
    v_mfma_f32_16x16x32_bf16 v[100:103], a[156:159], v[24:27], v[100:103]
    v_mfma_f32_16x16x32_bf16 v[88:91], a[144:147], v[28:31], v[88:91]
    v_mfma_f32_16x16x32_bf16 v[92:95], a[148:151], v[28:31], v[92:95]
    v_mfma_f32_16x16x32_bf16 v[104:107], a[152:155], v[28:31], v[104:107]
    v_mfma_f32_16x16x32_bf16 v[108:111], a[156:159], v[28:31], v[108:111]
    s_branch Lg_px9
Lg_pv9:
    v_mfma_f32_16x16x32_bf16 v[48:51], v[16:19], a[144:147], v[48:51]
    v_mfma_f32_16x16x32_bf16 v[56:59], v[16:19], a[148:151], v[56:59]
    v_mfma_f32_16x16x32_bf16 v[64:67], v[16:19], a[152:155], v[64:67]
    v_mfma_f32_16x16x32_bf16 v[72:75], v[16:19], a[156:159], v[72:75]
    v_mfma_f32_16x16x32_bf16 v[52:55], v[20:23], a[144:147], v[52:55]
    v_mfma_f32_16x16x32_bf16 v[60:63], v[20:23], a[148:151], v[60:63]
    v_mfma_f32_16x16x32_bf16 v[68:71], v[20:23], a[152:155], v[68:71]
    v_mfma_f32_16x16x32_bf16 v[76:79], v[20:23], a[156:159], v[76:79]
    v_mfma_f32_16x16x32_bf16 v[80:83], v[24:27], a[144:147], v[80:83]
    v_mfma_f32_16x16x32_bf16 v[88:91], v[24:27], a[148:151], v[88:91]
    v_mfma_f32_16x16x32_bf16 v[96:99], v[24:27], a[152:155], v[96:99]
    v_mfma_f32_16x16x32_bf16 v[104:107], v[24:27], a[156:159], v[104:107]
    v_mfma_f32_16x16x32_bf16 v[84:87], v[28:31], a[144:147], v[84:87]
    v_mfma_f32_16x16x32_bf16 v[92:95], v[28:31], a[148:151], v[92:95]
    v_mfma_f32_16x16x32_bf16 v[100:103], v[28:31], a[152:155], v[100:103]
    v_mfma_f32_16x16x32_bf16 v[108:111], v[28:31], a[156:159], v[108:111]
Lg_px9:
    s_waitcnt vmcnt(16)
    ds_read_b64_tr_b16 a[160:161], v6 offset:0
    ds_read_b64_tr_b16 a[162:163], v8 offset:512
    ds_read_b64_tr_b16 a[164:165], v7 offset:0
    ds_read_b64_tr_b16 a[166:167], v9 offset:512
    ds_read_b64_tr_b16 a[168:169], v8 offset:0
    ds_read_b64_tr_b16 a[170:171], v6 offset:512
    ds_read_b64_tr_b16 a[172:173], v9 offset:0
    ds_read_b64_tr_b16 a[174:175], v7 offset:512
    ds_read_b128 v[16:19], v112 offset:20480
    ds_read_b128 v[20:23], v112 offset:22528
    ds_read_b128 v[24:27], v114 offset:20480
    ds_read_b128 v[28:31], v114 offset:22528
    s_waitcnt lgkmcnt(4)
    s_add_u32 s45, s44, 4
    s_mul_i32 s45, s45, 40960
    s_cmp_eq_u32 s42, 3
    s_cselect_b32 s45, 1073741824, s45
    buffer_load_dword v117, v116, s[20:23], s45 offen sc1
    s_add_u32 m0, s54, 0
    s_nop 0
    buffer_load_dwordx4 v2, s[16:19], s55 offen  lds
    s_add_u32 s55, s55, s56
    s_add_u32 m0, s54, 1024
    s_nop 0
    buffer_load_dwordx4 v2, s[16:19], s55 offen  lds
    s_add_u32 s55, s55, s56
    s_add_u32 m0, s54, 2048
    s_nop 0
    buffer_load_dwordx4 v2, s[16:19], s55 offen  lds
    s_add_u32 s55, s55, s56
    s_add_u32 m0, s54, 3072
    s_nop 0
    buffer_load_dwordx4 v2, s[16:19], s55 offen  lds
    s_add_u32 s55, s55, s56
    s_cmp_eq_u32 s41, 1
    s_waitcnt lgkmcnt(0)
    s_cbranch_scc1 Lg_pv10
    v_mfma_f32_16x16x32_bf16 v[48:51], a[160:163], v[16:19], v[48:51]
    v_mfma_f32_16x16x32_bf16 v[52:55], a[164:167], v[16:19], v[52:55]
    v_mfma_f32_16x16x32_bf16 v[64:67], a[168:171], v[16:19], v[64:67]
    v_mfma_f32_16x16x32_bf16 v[68:71], a[172:175], v[16:19], v[68:71]
    v_mfma_f32_16x16x32_bf16 v[56:59], a[160:163], v[20:23], v[56:59]
    v_mfma_f32_16x16x32_bf16 v[60:63], a[164:167], v[20:23], v[60:63]
    v_mfma_f32_16x16x32_bf16 v[72:75], a[168:171], v[20:23], v[72:75]
    v_mfma_f32_16x16x32_bf16 v[76:79], a[172:175], v[20:23], v[76:79]
    v_mfma_f32_16x16x32_bf16 v[80:83], a[160:163], v[24:27], v[80:83]
    v_mfma_f32_16x16x32_bf16 v[84:87], a[164:167], v[24:27], v[84:87]
    v_mfma_f32_16x16x32_bf16 v[96:99], a[168:171], v[24:27], v[96:99]
    v_mfma_f32_16x16x32_bf16 v[100:103], a[172:175], v[24:27], v[100:103]
    v_mfma_f32_16x16x32_bf16 v[88:91], a[160:163], v[28:31], v[88:91]
    v_mfma_f32_16x16x32_bf16 v[92:95], a[164:167], v[28:31], v[92:95]
    v_mfma_f32_16x16x32_bf16 v[104:107], a[168:171], v[28:31], v[104:107]
    v_mfma_f32_16x16x32_bf16 v[108:111], a[172:175], v[28:31], v[108:111]
    s_branch Lg_px10
Lg_pv10:
    v_mfma_f32_16x16x32_bf16 v[48:51], v[16:19], a[160:163], v[48:51]
    v_mfma_f32_16x16x32_bf16 v[56:59], v[16:19], a[164:167], v[56:59]
    v_mfma_f32_16x16x32_bf16 v[64:67], v[16:19], a[168:171], v[64:67]
    v_mfma_f32_16x16x32_bf16 v[72:75], v[16:19], a[172:175], v[72:75]
    v_mfma_f32_16x16x32_bf16 v[52:55], v[20:23], a[160:163], v[52:55]
    v_mfma_f32_16x16x32_bf16 v[60:63], v[20:23], a[164:167], v[60:63]
    v_mfma_f32_16x16x32_bf16 v[68:71], v[20:23], a[168:171], v[68:71]
    v_mfma_f32_16x16x32_bf16 v[76:79], v[20:23], a[172:175], v[76:79]
    v_mfma_f32_16x16x32_bf16 v[80:83], v[24:27], a[160:163], v[80:83]
    v_mfma_f32_16x16x32_bf16 v[88:91], v[24:27], a[164:167], v[88:91]
    v_mfma_f32_16x16x32_bf16 v[96:99], v[24:27], a[168:171], v[96:99]
    v_mfma_f32_16x16x32_bf16 v[104:107], v[24:27], a[172:175], v[104:107]
    v_mfma_f32_16x16x32_bf16 v[84:87], v[28:31], a[160:163], v[84:87]
    v_mfma_f32_16x16x32_bf16 v[92:95], v[28:31], a[164:167], v[92:95]
    v_mfma_f32_16x16x32_bf16 v[100:103], v[28:31], a[168:171], v[100:103]
    v_mfma_f32_16x16x32_bf16 v[108:111], v[28:31], a[172:175], v[108:111]
Lg_px10:
    s_waitcnt vmcnt(16)
    ds_read_b64_tr_b16 a[176:177], v6 offset:4096
    ds_read_b64_tr_b16 a[178:179], v8 offset:4608
    ds_read_b64_tr_b16 a[180:181], v7 offset:4096
    ds_read_b64_tr_b16 a[182:183], v9 offset:4608
    ds_read_b64_tr_b16 a[184:185], v8 offset:4096
    ds_read_b64_tr_b16 a[186:187], v6 offset:4608
    ds_read_b64_tr_b16 a[188:189], v9 offset:4096
    ds_read_b64_tr_b16 a[190:191], v7 offset:4608
    ds_read_b128 v[16:19], v113 offset:20480
    ds_read_b128 v[20:23], v113 offset:22528
    ds_read_b128 v[24:27], v115 offset:20480
    ds_read_b128 v[28:31], v115 offset:22528
    s_waitcnt lgkmcnt(4)
    s_add_u32 m0, s54, 4096
    s_nop 0
    buffer_load_dwordx4 v2, s[16:19], s55 offen  lds
    s_add_u32 s55, s55, s56
    s_add_u32 m0, s54, 5120
    s_nop 0
    buffer_load_dwordx4 v2, s[16:19], s55 offen  lds
    s_add_u32 s55, s55, s56
    s_add_u32 m0, s54, 6144
    s_nop 0
    buffer_load_dwordx4 v2, s[16:19], s55 offen  lds
    s_add_u32 s55, s55, s56
    s_add_u32 m0, s54, 7168
    s_nop 0
    buffer_load_dwordx4 v2, s[16:19], s55 offen  lds
    s_add_u32 s55, s55, s56
    s_cmp_eq_u32 s41, 1
    s_waitcnt lgkmcnt(0)
    s_cbranch_scc1 Lg_pv11
    v_mfma_f32_16x16x32_bf16 v[48:51], a[176:179], v[16:19], v[48:51]
    v_mfma_f32_16x16x32_bf16 v[52:55], a[180:183], v[16:19], v[52:55]
    v_mfma_f32_16x16x32_bf16 v[64:67], a[184:187], v[16:19], v[64:67]
    v_mfma_f32_16x16x32_bf16 v[68:71], a[188:191], v[16:19], v[68:71]
    v_mfma_f32_16x16x32_bf16 v[56:59], a[176:179], v[20:23], v[56:59]
    v_mfma_f32_16x16x32_bf16 v[60:63], a[180:183], v[20:23], v[60:63]
    v_mfma_f32_16x16x32_bf16 v[72:75], a[184:187], v[20:23], v[72:75]
    v_mfma_f32_16x16x32_bf16 v[76:79], a[188:191], v[20:23], v[76:79]
    v_mfma_f32_16x16x32_bf16 v[80:83], a[176:179], v[24:27], v[80:83]
    v_mfma_f32_16x16x32_bf16 v[84:87], a[180:183], v[24:27], v[84:87]
    v_mfma_f32_16x16x32_bf16 v[96:99], a[184:187], v[24:27], v[96:99]
    v_mfma_f32_16x16x32_bf16 v[100:103], a[188:191], v[24:27], v[100:103]
    v_mfma_f32_16x16x32_bf16 v[88:91], a[176:179], v[28:31], v[88:91]
    v_mfma_f32_16x16x32_bf16 v[92:95], a[180:183], v[28:31], v[92:95]
    v_mfma_f32_16x16x32_bf16 v[104:107], a[184:187], v[28:31], v[104:107]
    v_mfma_f32_16x16x32_bf16 v[108:111], a[188:191], v[28:31], v[108:111]
    s_branch Lg_px11
Lg_pv11:
    v_mfma_f32_16x16x32_bf16 v[48:51], v[16:19], a[176:179], v[48:51]
    v_mfma_f32_16x16x32_bf16 v[56:59], v[16:19], a[180:183], v[56:59]
    v_mfma_f32_16x16x32_bf16 v[64:67], v[16:19], a[184:187], v[64:67]
    v_mfma_f32_16x16x32_bf16 v[72:75], v[16:19], a[188:191], v[72:75]
    v_mfma_f32_16x16x32_bf16 v[52:55], v[20:23], a[176:179], v[52:55]
    v_mfma_f32_16x16x32_bf16 v[60:63], v[20:23], a[180:183], v[60:63]
    v_mfma_f32_16x16x32_bf16 v[68:71], v[20:23], a[184:187], v[68:71]
    v_mfma_f32_16x16x32_bf16 v[76:79], v[20:23], a[188:191], v[76:79]
    v_mfma_f32_16x16x32_bf16 v[80:83], v[24:27], a[176:179], v[80:83]
    v_mfma_f32_16x16x32_bf16 v[88:91], v[24:27], a[180:183], v[88:91]
    v_mfma_f32_16x16x32_bf16 v[96:99], v[24:27], a[184:187], v[96:99]
    v_mfma_f32_16x16x32_bf16 v[104:107], v[24:27], a[188:191], v[104:107]
    v_mfma_f32_16x16x32_bf16 v[84:87], v[28:31], a[176:179], v[84:87]
    v_mfma_f32_16x16x32_bf16 v[92:95], v[28:31], a[180:183], v[92:95]
    v_mfma_f32_16x16x32_bf16 v[100:103], v[28:31], a[184:187], v[100:103]
    v_mfma_f32_16x16x32_bf16 v[108:111], v[28:31], a[188:191], v[108:111]
Lg_px11:
    s_waitcnt vmcnt(16)
    ds_read_b64_tr_b16 a[192:193], v6 offset:8192
    ds_read_b64_tr_b16 a[194:195], v8 offset:8704
    ds_read_b64_tr_b16 a[196:197], v7 offset:8192
    ds_read_b64_tr_b16 a[198:199], v9 offset:8704
    ds_read_b64_tr_b16 a[200:201], v8 offset:8192
    ds_read_b64_tr_b16 a[202:203], v6 offset:8704
    ds_read_b64_tr_b16 a[204:205], v9 offset:8192
    ds_read_b64_tr_b16 a[206:207], v7 offset:8704
    ds_read_b128 v[16:19], v112 offset:24576
    ds_read_b128 v[20:23], v112 offset:26624
    ds_read_b128 v[24:27], v114 offset:24576
    ds_read_b128 v[28:31], v114 offset:26624
    s_waitcnt lgkmcnt(4)
    s_add_u32 s45, s44, 5
    s_mul_i32 s45, s45, 40960
    s_cmp_eq_u32 s42, 3
    s_cselect_b32 s45, 1073741824, s45
    buffer_load_dword v117, v116, s[20:23], s45 offen sc1
    s_add_u32 m0, s54, 8192
    s_nop 0
    buffer_load_dwordx4 v2, s[16:19], s55 offen  lds
    s_add_u32 s55, s55, s56
    s_add_u32 m0, s54, 9216
    s_nop 0
    buffer_load_dwordx4 v2, s[16:19], s55 offen  lds
    s_add_u32 s55, s55, s56
    s_add_u32 m0, s54, 10240
    s_nop 0
    buffer_load_dwordx4 v2, s[16:19], s55 offen  lds
    s_add_u32 s55, s55, s56
    s_add_u32 m0, s54, 11264
    s_nop 0
    buffer_load_dwordx4 v2, s[16:19], s55 offen  lds
    s_add_u32 s55, s55, s56
    s_cmp_eq_u32 s41, 1
    s_waitcnt lgkmcnt(0)
    s_cbranch_scc1 Lg_pv12
    v_mfma_f32_16x16x32_bf16 v[48:51], a[192:195], v[16:19], v[48:51]
    v_mfma_f32_16x16x32_bf16 v[52:55], a[196:199], v[16:19], v[52:55]
    v_mfma_f32_16x16x32_bf16 v[64:67], a[200:203], v[16:19], v[64:67]
    v_mfma_f32_16x16x32_bf16 v[68:71], a[204:207], v[16:19], v[68:71]
    v_mfma_f32_16x16x32_bf16 v[56:59], a[192:195], v[20:23], v[56:59]
    v_mfma_f32_16x16x32_bf16 v[60:63], a[196:199], v[20:23], v[60:63]
    v_mfma_f32_16x16x32_bf16 v[72:75], a[200:203], v[20:23], v[72:75]
    v_mfma_f32_16x16x32_bf16 v[76:79], a[204:207], v[20:23], v[76:79]
    v_mfma_f32_16x16x32_bf16 v[80:83], a[192:195], v[24:27], v[80:83]
    v_mfma_f32_16x16x32_bf16 v[84:87], a[196:199], v[24:27], v[84:87]
    v_mfma_f32_16x16x32_bf16 v[96:99], a[200:203], v[24:27], v[96:99]
    v_mfma_f32_16x16x32_bf16 v[100:103], a[204:207], v[24:27], v[100:103]
    v_mfma_f32_16x16x32_bf16 v[88:91], a[192:195], v[28:31], v[88:91]
    v_mfma_f32_16x16x32_bf16 v[92:95], a[196:199], v[28:31], v[92:95]
    v_mfma_f32_16x16x32_bf16 v[104:107], a[200:203], v[28:31], v[104:107]
    v_mfma_f32_16x16x32_bf16 v[108:111], a[204:207], v[28:31], v[108:111]
    s_branch Lg_px12
Lg_pv12:
    v_mfma_f32_16x16x32_bf16 v[48:51], v[16:19], a[192:195], v[48:51]
    v_mfma_f32_16x16x32_bf16 v[56:59], v[16:19], a[196:199], v[56:59]
    v_mfma_f32_16x16x32_bf16 v[64:67], v[16:19], a[200:203], v[64:67]
    v_mfma_f32_16x16x32_bf16 v[72:75], v[16:19], a[204:207], v[72:75]
    v_mfma_f32_16x16x32_bf16 v[52:55], v[20:23], a[192:195], v[52:55]
    v_mfma_f32_16x16x32_bf16 v[60:63], v[20:23], a[196:199], v[60:63]
    v_mfma_f32_16x16x32_bf16 v[68:71], v[20:23], a[200:203], v[68:71]
    v_mfma_f32_16x16x32_bf16 v[76:79], v[20:23], a[204:207], v[76:79]
    v_mfma_f32_16x16x32_bf16 v[80:83], v[24:27], a[192:195], v[80:83]
    v_mfma_f32_16x16x32_bf16 v[88:91], v[24:27], a[196:199], v[88:91]
    v_mfma_f32_16x16x32_bf16 v[96:99], v[24:27], a[200:203], v[96:99]
    v_mfma_f32_16x16x32_bf16 v[104:107], v[24:27], a[204:207], v[104:107]
    v_mfma_f32_16x16x32_bf16 v[84:87], v[28:31], a[192:195], v[84:87]
    v_mfma_f32_16x16x32_bf16 v[92:95], v[28:31], a[196:199], v[92:95]
    v_mfma_f32_16x16x32_bf16 v[100:103], v[28:31], a[200:203], v[100:103]
    v_mfma_f32_16x16x32_bf16 v[108:111], v[28:31], a[204:207], v[108:111]
Lg_px12:
    s_waitcnt vmcnt(16)
    ds_read_b64_tr_b16 a[208:209], v6 offset:12288
    ds_read_b64_tr_b16 a[210:211], v8 offset:12800
    ds_read_b64_tr_b16 a[212:213], v7 offset:12288
    ds_read_b64_tr_b16 a[214:215], v9 offset:12800
    ds_read_b64_tr_b16 a[216:217], v8 offset:12288
    ds_read_b64_tr_b16 a[218:219], v6 offset:12800
    ds_read_b64_tr_b16 a[220:221], v9 offset:12288
    ds_read_b64_tr_b16 a[222:223], v7 offset:12800
    ds_read_b128 v[16:19], v113 offset:24576
    ds_read_b128 v[20:23], v113 offset:26624
    ds_read_b128 v[24:27], v115 offset:24576
    ds_read_b128 v[28:31], v115 offset:26624
    s_waitcnt lgkmcnt(4)
    s_add_u32 m0, s54, 12288
    s_nop 0
    buffer_load_dwordx4 v2, s[16:19], s55 offen  lds
    s_add_u32 s55, s55, s56
    s_add_u32 m0, s54, 13312
    s_nop 0
    buffer_load_dwordx4 v2, s[16:19], s55 offen  lds
    s_add_u32 s55, s55, s56
    s_add_u32 m0, s54, 14336
    s_nop 0
    buffer_load_dwordx4 v2, s[16:19], s55 offen  lds
    s_add_u32 s55, s55, s56
    s_add_u32 m0, s54, 15360
    s_nop 0
    buffer_load_dwordx4 v2, s[16:19], s55 offen  lds
    s_add_u32 s55, s55, s56
    s_cmp_eq_u32 s41, 1
    s_waitcnt lgkmcnt(0)
    s_cbranch_scc1 Lg_pv13
    v_mfma_f32_16x16x32_bf16 v[48:51], a[208:211], v[16:19], v[48:51]
    v_mfma_f32_16x16x32_bf16 v[52:55], a[212:215], v[16:19], v[52:55]
    v_mfma_f32_16x16x32_bf16 v[64:67], a[216:219], v[16:19], v[64:67]
    v_mfma_f32_16x16x32_bf16 v[68:71], a[220:223], v[16:19], v[68:71]
    v_mfma_f32_16x16x32_bf16 v[56:59], a[208:211], v[20:23], v[56:59]
    v_mfma_f32_16x16x32_bf16 v[60:63], a[212:215], v[20:23], v[60:63]
    v_mfma_f32_16x16x32_bf16 v[72:75], a[216:219], v[20:23], v[72:75]
    v_mfma_f32_16x16x32_bf16 v[76:79], a[220:223], v[20:23], v[76:79]
    v_mfma_f32_16x16x32_bf16 v[80:83], a[208:211], v[24:27], v[80:83]
    v_mfma_f32_16x16x32_bf16 v[84:87], a[212:215], v[24:27], v[84:87]
    v_mfma_f32_16x16x32_bf16 v[96:99], a[216:219], v[24:27], v[96:99]
    v_mfma_f32_16x16x32_bf16 v[100:103], a[220:223], v[24:27], v[100:103]
    v_mfma_f32_16x16x32_bf16 v[88:91], a[208:211], v[28:31], v[88:91]
    v_mfma_f32_16x16x32_bf16 v[92:95], a[212:215], v[28:31], v[92:95]
    v_mfma_f32_16x16x32_bf16 v[104:107], a[216:219], v[28:31], v[104:107]
    v_mfma_f32_16x16x32_bf16 v[108:111], a[220:223], v[28:31], v[108:111]
    s_branch Lg_px13
Lg_pv13:
    v_mfma_f32_16x16x32_bf16 v[48:51], v[16:19], a[208:211], v[48:51]
    v_mfma_f32_16x16x32_bf16 v[56:59], v[16:19], a[212:215], v[56:59]
    v_mfma_f32_16x16x32_bf16 v[64:67], v[16:19], a[216:219], v[64:67]
    v_mfma_f32_16x16x32_bf16 v[72:75], v[16:19], a[220:223], v[72:75]
    v_mfma_f32_16x16x32_bf16 v[52:55], v[20:23], a[208:211], v[52:55]
    v_mfma_f32_16x16x32_bf16 v[60:63], v[20:23], a[212:215], v[60:63]
    v_mfma_f32_16x16x32_bf16 v[68:71], v[20:23], a[216:219], v[68:71]
    v_mfma_f32_16x16x32_bf16 v[76:79], v[20:23], a[220:223], v[76:79]
    v_mfma_f32_16x16x32_bf16 v[80:83], v[24:27], a[208:211], v[80:83]
    v_mfma_f32_16x16x32_bf16 v[88:91], v[24:27], a[212:215], v[88:91]
    v_mfma_f32_16x16x32_bf16 v[96:99], v[24:27], a[216:219], v[96:99]
    v_mfma_f32_16x16x32_bf16 v[104:107], v[24:27], a[220:223], v[104:107]
    v_mfma_f32_16x16x32_bf16 v[84:87], v[28:31], a[208:211], v[84:87]
    v_mfma_f32_16x16x32_bf16 v[92:95], v[28:31], a[212:215], v[92:95]
    v_mfma_f32_16x16x32_bf16 v[100:103], v[28:31], a[216:219], v[100:103]
    v_mfma_f32_16x16x32_bf16 v[108:111], v[28:31], a[220:223], v[108:111]
Lg_px13:
    s_waitcnt vmcnt(16)
    ds_read_b64_tr_b16 a[224:225], v6 offset:16384
    ds_read_b64_tr_b16 a[226:227], v8 offset:16896
    ds_read_b64_tr_b16 a[228:229], v7 offset:16384
    ds_read_b64_tr_b16 a[230:231], v9 offset:16896
    ds_read_b64_tr_b16 a[232:233], v8 offset:16384
    ds_read_b64_tr_b16 a[234:235], v6 offset:16896
    ds_read_b64_tr_b16 a[236:237], v9 offset:16384
    ds_read_b64_tr_b16 a[238:239], v7 offset:16896
    ds_read_b128 v[16:19], v112 offset:28672
    ds_read_b128 v[20:23], v112 offset:30720
    ds_read_b128 v[24:27], v114 offset:28672
    ds_read_b128 v[28:31], v114 offset:30720
    s_waitcnt lgkmcnt(4)
    v_lshlrev_b32 v118, 2, v0
    global_load_dword v119, v118, s[8:9] sc1
    s_add_u32 m0, s54, 16384
    s_nop 0
    buffer_load_dwordx4 v2, s[16:19], s55 offen  lds
    s_add_u32 s55, s55, s56
    s_add_u32 m0, s54, 17408
    s_nop 0
    buffer_load_dwordx4 v2, s[16:19], s55 offen  lds
    s_add_u32 s55, s55, s56
    s_add_u32 m0, s54, 18432
    s_nop 0
    buffer_load_dwordx4 v2, s[16:19], s55 offen  lds
    s_add_u32 s55, s55, s56
    s_add_u32 m0, s54, 19456
    s_nop 0
    buffer_load_dwordx4 v2, s[16:19], s55 offen  lds
    s_add_u32 s55, s55, s56
    s_cmp_eq_u32 s41, 1
    s_waitcnt lgkmcnt(0)
    s_cbranch_scc1 Lg_pv14
    v_mfma_f32_16x16x32_bf16 v[48:51], a[224:227], v[16:19], v[48:51]
    v_mfma_f32_16x16x32_bf16 v[52:55], a[228:231], v[16:19], v[52:55]
    v_mfma_f32_16x16x32_bf16 v[64:67], a[232:235], v[16:19], v[64:67]
    v_mfma_f32_16x16x32_bf16 v[68:71], a[236:239], v[16:19], v[68:71]
    v_mfma_f32_16x16x32_bf16 v[56:59], a[224:227], v[20:23], v[56:59]
    v_mfma_f32_16x16x32_bf16 v[60:63], a[228:231], v[20:23], v[60:63]
    v_mfma_f32_16x16x32_bf16 v[72:75], a[232:235], v[20:23], v[72:75]
    v_mfma_f32_16x16x32_bf16 v[76:79], a[236:239], v[20:23], v[76:79]
    v_mfma_f32_16x16x32_bf16 v[80:83], a[224:227], v[24:27], v[80:83]
    v_mfma_f32_16x16x32_bf16 v[84:87], a[228:231], v[24:27], v[84:87]
    v_mfma_f32_16x16x32_bf16 v[96:99], a[232:235], v[24:27], v[96:99]
    v_mfma_f32_16x16x32_bf16 v[100:103], a[236:239], v[24:27], v[100:103]
    v_mfma_f32_16x16x32_bf16 v[88:91], a[224:227], v[28:31], v[88:91]
    v_mfma_f32_16x16x32_bf16 v[92:95], a[228:231], v[28:31], v[92:95]
    v_mfma_f32_16x16x32_bf16 v[104:107], a[232:235], v[28:31], v[104:107]
    v_mfma_f32_16x16x32_bf16 v[108:111], a[236:239], v[28:31], v[108:111]
    s_branch Lg_px14
Lg_pv14:
    v_mfma_f32_16x16x32_bf16 v[48:51], v[16:19], a[224:227], v[48:51]
    v_mfma_f32_16x16x32_bf16 v[56:59], v[16:19], a[228:231], v[56:59]
    v_mfma_f32_16x16x32_bf16 v[64:67], v[16:19], a[232:235], v[64:67]
    v_mfma_f32_16x16x32_bf16 v[72:75], v[16:19], a[236:239], v[72:75]
    v_mfma_f32_16x16x32_bf16 v[52:55], v[20:23], a[224:227], v[52:55]
    v_mfma_f32_16x16x32_bf16 v[60:63], v[20:23], a[228:231], v[60:63]
    v_mfma_f32_16x16x32_bf16 v[68:71], v[20:23], a[232:235], v[68:71]
    v_mfma_f32_16x16x32_bf16 v[76:79], v[20:23], a[236:239], v[76:79]
    v_mfma_f32_16x16x32_bf16 v[80:83], v[24:27], a[224:227], v[80:83]
    v_mfma_f32_16x16x32_bf16 v[88:91], v[24:27], a[228:231], v[88:91]
    v_mfma_f32_16x16x32_bf16 v[96:99], v[24:27], a[232:235], v[96:99]
    v_mfma_f32_16x16x32_bf16 v[104:107], v[24:27], a[236:239], v[104:107]
    v_mfma_f32_16x16x32_bf16 v[84:87], v[28:31], a[224:227], v[84:87]
    v_mfma_f32_16x16x32_bf16 v[92:95], v[28:31], a[228:231], v[92:95]
    v_mfma_f32_16x16x32_bf16 v[100:103], v[28:31], a[232:235], v[100:103]
    v_mfma_f32_16x16x32_bf16 v[108:111], v[28:31], a[236:239], v[108:111]
Lg_px14:
    s_waitcnt vmcnt(16)
    ds_read_b64_tr_b16 a[240:241], v6 offset:0
    ds_read_b64_tr_b16 a[242:243], v8 offset:512
    ds_read_b64_tr_b16 a[244:245], v7 offset:0
    ds_read_b64_tr_b16 a[246:247], v9 offset:512
    ds_read_b64_tr_b16 a[248:249], v8 offset:0
    ds_read_b64_tr_b16 a[250:251], v6 offset:512
    ds_read_b64_tr_b16 a[252:253], v9 offset:0
    ds_read_b64_tr_b16 a[254:255], v7 offset:512
    ds_read_b128 v[16:19], v113 offset:28672
    ds_read_b128 v[20:23], v113 offset:30720
    ds_read_b128 v[24:27], v115 offset:28672
    ds_read_b128 v[28:31], v115 offset:30720
    s_waitcnt lgkmcnt(4)
    s_cmp_eq_u32 s41, 1
    s_waitcnt lgkmcnt(0)
    s_cbranch_scc1 Lg_pv15
    v_mfma_f32_16x16x32_bf16 v[48:51], a[240:243], v[16:19], v[48:51]
    v_mfma_f32_16x16x32_bf16 v[52:55], a[244:247], v[16:19], v[52:55]
    v_mfma_f32_16x16x32_bf16 v[64:67], a[248:251], v[16:19], v[64:67]
    v_mfma_f32_16x16x32_bf16 v[68:71], a[252:255], v[16:19], v[68:71]
    v_mfma_f32_16x16x32_bf16 v[56:59], a[240:243], v[20:23], v[56:59]
    v_mfma_f32_16x16x32_bf16 v[60:63], a[244:247], v[20:23], v[60:63]
    v_mfma_f32_16x16x32_bf16 v[72:75], a[248:251], v[20:23], v[72:75]
    v_mfma_f32_16x16x32_bf16 v[76:79], a[252:255], v[20:23], v[76:79]
    v_mfma_f32_16x16x32_bf16 v[80:83], a[240:243], v[24:27], v[80:83]
    v_mfma_f32_16x16x32_bf16 v[84:87], a[244:247], v[24:27], v[84:87]
    v_mfma_f32_16x16x32_bf16 v[96:99], a[248:251], v[24:27], v[96:99]
    v_mfma_f32_16x16x32_bf16 v[100:103], a[252:255], v[24:27], v[100:103]
    v_mfma_f32_16x16x32_bf16 v[88:91], a[240:243], v[28:31], v[88:91]
    v_mfma_f32_16x16x32_bf16 v[92:95], a[244:247], v[28:31], v[92:95]
    v_mfma_f32_16x16x32_bf16 v[104:107], a[248:251], v[28:31], v[104:107]
    v_mfma_f32_16x16x32_bf16 v[108:111], a[252:255], v[28:31], v[108:111]
    s_branch Lg_px15
Lg_pv15:
    v_mfma_f32_16x16x32_bf16 v[48:51], v[16:19], a[240:243], v[48:51]
    v_mfma_f32_16x16x32_bf16 v[56:59], v[16:19], a[244:247], v[56:59]
    v_mfma_f32_16x16x32_bf16 v[64:67], v[16:19], a[248:251], v[64:67]
    v_mfma_f32_16x16x32_bf16 v[72:75], v[16:19], a[252:255], v[72:75]
    v_mfma_f32_16x16x32_bf16 v[52:55], v[20:23], a[240:243], v[52:55]
    v_mfma_f32_16x16x32_bf16 v[60:63], v[20:23], a[244:247], v[60:63]
    v_mfma_f32_16x16x32_bf16 v[68:71], v[20:23], a[248:251], v[68:71]
    v_mfma_f32_16x16x32_bf16 v[76:79], v[20:23], a[252:255], v[76:79]
    v_mfma_f32_16x16x32_bf16 v[80:83], v[24:27], a[240:243], v[80:83]
    v_mfma_f32_16x16x32_bf16 v[88:91], v[24:27], a[244:247], v[88:91]
    v_mfma_f32_16x16x32_bf16 v[96:99], v[24:27], a[248:251], v[96:99]
    v_mfma_f32_16x16x32_bf16 v[104:107], v[24:27], a[252:255], v[104:107]
    v_mfma_f32_16x16x32_bf16 v[84:87], v[28:31], a[240:243], v[84:87]
    v_mfma_f32_16x16x32_bf16 v[92:95], v[28:31], a[244:247], v[92:95]
    v_mfma_f32_16x16x32_bf16 v[100:103], v[28:31], a[248:251], v[100:103]
    v_mfma_f32_16x16x32_bf16 v[108:111], v[28:31], a[252:255], v[108:111]
Lg_px15:
    s_waitcnt vmcnt(12)
    ds_read_b64_tr_b16 v[192:193], v6 offset:4096
    ds_read_b64_tr_b16 v[194:195], v8 offset:4608
    ds_read_b64_tr_b16 v[196:197], v7 offset:4096
    ds_read_b64_tr_b16 v[198:199], v9 offset:4608
    ds_read_b64_tr_b16 v[200:201], v8 offset:4096
    ds_read_b64_tr_b16 v[202:203], v6 offset:4608
    ds_read_b64_tr_b16 v[204:205], v9 offset:4096
    ds_read_b64_tr_b16 v[206:207], v7 offset:4608
    ds_read_b128 v[16:19], v112 offset:32768
    ds_read_b128 v[20:23], v112 offset:34816
    ds_read_b128 v[24:27], v114 offset:32768
    ds_read_b128 v[28:31], v114 offset:34816
    s_waitcnt lgkmcnt(4)
    s_cmp_eq_u32 s41, 1
    s_waitcnt lgkmcnt(0)
    s_cbranch_scc1 Lg_pv16
    v_mfma_f32_16x16x32_bf16 v[48:51], v[192:195], v[16:19], v[48:51]
    v_mfma_f32_16x16x32_bf16 v[52:55], v[196:199], v[16:19], v[52:55]
    v_mfma_f32_16x16x32_bf16 v[64:67], v[200:203], v[16:19], v[64:67]
    v_mfma_f32_16x16x32_bf16 v[68:71], v[204:207], v[16:19], v[68:71]
    v_mfma_f32_16x16x32_bf16 v[56:59], v[192:195], v[20:23], v[56:59]
    v_mfma_f32_16x16x32_bf16 v[60:63], v[196:199], v[20:23], v[60:63]
    v_mfma_f32_16x16x32_bf16 v[72:75], v[200:203], v[20:23], v[72:75]
    v_mfma_f32_16x16x32_bf16 v[76:79], v[204:207], v[20:23], v[76:79]
    v_mfma_f32_16x16x32_bf16 v[80:83], v[192:195], v[24:27], v[80:83]
    v_mfma_f32_16x16x32_bf16 v[84:87], v[196:199], v[24:27], v[84:87]
    v_mfma_f32_16x16x32_bf16 v[96:99], v[200:203], v[24:27], v[96:99]
    v_mfma_f32_16x16x32_bf16 v[100:103], v[204:207], v[24:27], v[100:103]
    v_mfma_f32_16x16x32_bf16 v[88:91], v[192:195], v[28:31], v[88:91]
    v_mfma_f32_16x16x32_bf16 v[92:95], v[196:199], v[28:31], v[92:95]
    v_mfma_f32_16x16x32_bf16 v[104:107], v[200:203], v[28:31], v[104:107]
    v_mfma_f32_16x16x32_bf16 v[108:111], v[204:207], v[28:31], v[108:111]
    s_branch Lg_px16
Lg_pv16:
    v_mfma_f32_16x16x32_bf16 v[48:51], v[16:19], v[192:195], v[48:51]
    v_mfma_f32_16x16x32_bf16 v[56:59], v[16:19], v[196:199], v[56:59]
    v_mfma_f32_16x16x32_bf16 v[64:67], v[16:19], v[200:203], v[64:67]
    v_mfma_f32_16x16x32_bf16 v[72:75], v[16:19], v[204:207], v[72:75]
    v_mfma_f32_16x16x32_bf16 v[52:55], v[20:23], v[192:195], v[52:55]
    v_mfma_f32_16x16x32_bf16 v[60:63], v[20:23], v[196:199], v[60:63]
    v_mfma_f32_16x16x32_bf16 v[68:71], v[20:23], v[200:203], v[68:71]
    v_mfma_f32_16x16x32_bf16 v[76:79], v[20:23], v[204:207], v[76:79]
    v_mfma_f32_16x16x32_bf16 v[80:83], v[24:27], v[192:195], v[80:83]
    v_mfma_f32_16x16x32_bf16 v[88:91], v[24:27], v[196:199], v[88:91]
    v_mfma_f32_16x16x32_bf16 v[96:99], v[24:27], v[200:203], v[96:99]
    v_mfma_f32_16x16x32_bf16 v[104:107], v[24:27], v[204:207], v[104:107]
    v_mfma_f32_16x16x32_bf16 v[84:87], v[28:31], v[192:195], v[84:87]
    v_mfma_f32_16x16x32_bf16 v[92:95], v[28:31], v[196:199], v[92:95]
    v_mfma_f32_16x16x32_bf16 v[100:103], v[28:31], v[200:203], v[100:103]
    v_mfma_f32_16x16x32_bf16 v[108:111], v[28:31], v[204:207], v[108:111]
Lg_px16:
    s_waitcnt vmcnt(8)
    ds_read_b64_tr_b16 v[208:209], v6 offset:8192
    ds_read_b64_tr_b16 v[210:211], v8 offset:8704
    ds_read_b64_tr_b16 v[212:213], v7 offset:8192
    ds_read_b64_tr_b16 v[214:215], v9 offset:8704
    ds_read_b64_tr_b16 v[216:217], v8 offset:8192
    ds_read_b64_tr_b16 v[218:219], v6 offset:8704
    ds_read_b64_tr_b16 v[220:221], v9 offset:8192
    ds_read_b64_tr_b16 v[222:223], v7 offset:8704
    ds_read_b128 v[16:19], v113 offset:32768
    ds_read_b128 v[20:23], v113 offset:34816
    ds_read_b128 v[24:27], v115 offset:32768
    ds_read_b128 v[28:31], v115 offset:34816
    s_waitcnt lgkmcnt(4)
    s_cmp_eq_u32 s41, 1
    s_waitcnt lgkmcnt(0)
    s_cbranch_scc1 Lg_pv17
    v_mfma_f32_16x16x32_bf16 v[48:51], v[208:211], v[16:19], v[48:51]
    v_mfma_f32_16x16x32_bf16 v[52:55], v[212:215], v[16:19], v[52:55]
    v_mfma_f32_16x16x32_bf16 v[64:67], v[216:219], v[16:19], v[64:67]
    v_mfma_f32_16x16x32_bf16 v[68:71], v[220:223], v[16:19], v[68:71]
    v_mfma_f32_16x16x32_bf16 v[56:59], v[208:211], v[20:23], v[56:59]
    v_mfma_f32_16x16x32_bf16 v[60:63], v[212:215], v[20:23], v[60:63]
    v_mfma_f32_16x16x32_bf16 v[72:75], v[216:219], v[20:23], v[72:75]
    v_mfma_f32_16x16x32_bf16 v[76:79], v[220:223], v[20:23], v[76:79]
    v_mfma_f32_16x16x32_bf16 v[80:83], v[208:211], v[24:27], v[80:83]
    v_mfma_f32_16x16x32_bf16 v[84:87], v[212:215], v[24:27], v[84:87]
    v_mfma_f32_16x16x32_bf16 v[96:99], v[216:219], v[24:27], v[96:99]
    v_mfma_f32_16x16x32_bf16 v[100:103], v[220:223], v[24:27], v[100:103]
    v_mfma_f32_16x16x32_bf16 v[88:91], v[208:211], v[28:31], v[88:91]
    v_mfma_f32_16x16x32_bf16 v[92:95], v[212:215], v[28:31], v[92:95]
    v_mfma_f32_16x16x32_bf16 v[104:107], v[216:219], v[28:31], v[104:107]
    v_mfma_f32_16x16x32_bf16 v[108:111], v[220:223], v[28:31], v[108:111]
    s_branch Lg_px17
Lg_pv17:
    v_mfma_f32_16x16x32_bf16 v[48:51], v[16:19], v[208:211], v[48:51]
    v_mfma_f32_16x16x32_bf16 v[56:59], v[16:19], v[212:215], v[56:59]
    v_mfma_f32_16x16x32_bf16 v[64:67], v[16:19], v[216:219], v[64:67]
    v_mfma_f32_16x16x32_bf16 v[72:75], v[16:19], v[220:223], v[72:75]
    v_mfma_f32_16x16x32_bf16 v[52:55], v[20:23], v[208:211], v[52:55]
    v_mfma_f32_16x16x32_bf16 v[60:63], v[20:23], v[212:215], v[60:63]
    v_mfma_f32_16x16x32_bf16 v[68:71], v[20:23], v[216:219], v[68:71]
    v_mfma_f32_16x16x32_bf16 v[76:79], v[20:23], v[220:223], v[76:79]
    v_mfma_f32_16x16x32_bf16 v[80:83], v[24:27], v[208:211], v[80:83]
    v_mfma_f32_16x16x32_bf16 v[88:91], v[24:27], v[212:215], v[88:91]
    v_mfma_f32_16x16x32_bf16 v[96:99], v[24:27], v[216:219], v[96:99]
    v_mfma_f32_16x16x32_bf16 v[104:107], v[24:27], v[220:223], v[104:107]
    v_mfma_f32_16x16x32_bf16 v[84:87], v[28:31], v[208:211], v[84:87]
    v_mfma_f32_16x16x32_bf16 v[92:95], v[28:31], v[212:215], v[92:95]
    v_mfma_f32_16x16x32_bf16 v[100:103], v[28:31], v[216:219], v[100:103]
    v_mfma_f32_16x16x32_bf16 v[108:111], v[28:31], v[220:223], v[108:111]
Lg_px17:
    s_waitcnt vmcnt(4)
    ds_read_b64_tr_b16 v[224:225], v6 offset:12288
    ds_read_b64_tr_b16 v[226:227], v8 offset:12800
    ds_read_b64_tr_b16 v[228:229], v7 offset:12288
    ds_read_b64_tr_b16 v[230:231], v9 offset:12800
    ds_read_b64_tr_b16 v[232:233], v8 offset:12288
    ds_read_b64_tr_b16 v[234:235], v6 offset:12800
    ds_read_b64_tr_b16 v[236:237], v9 offset:12288
    ds_read_b64_tr_b16 v[238:239], v7 offset:12800
    ds_read_b128 v[16:19], v112 offset:36864
    ds_read_b128 v[20:23], v112 offset:38912
    ds_read_b128 v[24:27], v114 offset:36864
    ds_read_b128 v[28:31], v114 offset:38912
    s_waitcnt lgkmcnt(4)
    s_cmp_eq_u32 s41, 1
    s_waitcnt lgkmcnt(0)
    s_cbranch_scc1 Lg_pv18
    v_mfma_f32_16x16x32_bf16 v[48:51], v[224:227], v[16:19], v[48:51]
    v_mfma_f32_16x16x32_bf16 v[52:55], v[228:231], v[16:19], v[52:55]
    v_mfma_f32_16x16x32_bf16 v[64:67], v[232:235], v[16:19], v[64:67]
    v_mfma_f32_16x16x32_bf16 v[68:71], v[236:239], v[16:19], v[68:71]
    v_mfma_f32_16x16x32_bf16 v[56:59], v[224:227], v[20:23], v[56:59]
    v_mfma_f32_16x16x32_bf16 v[60:63], v[228:231], v[20:23], v[60:63]
    v_mfma_f32_16x16x32_bf16 v[72:75], v[232:235], v[20:23], v[72:75]
    v_mfma_f32_16x16x32_bf16 v[76:79], v[236:239], v[20:23], v[76:79]
    v_mfma_f32_16x16x32_bf16 v[80:83], v[224:227], v[24:27], v[80:83]
    v_mfma_f32_16x16x32_bf16 v[84:87], v[228:231], v[24:27], v[84:87]
    v_mfma_f32_16x16x32_bf16 v[96:99], v[232:235], v[24:27], v[96:99]
    v_mfma_f32_16x16x32_bf16 v[100:103], v[236:239], v[24:27], v[100:103]
    v_mfma_f32_16x16x32_bf16 v[88:91], v[224:227], v[28:31], v[88:91]
    v_mfma_f32_16x16x32_bf16 v[92:95], v[228:231], v[28:31], v[92:95]
    v_mfma_f32_16x16x32_bf16 v[104:107], v[232:235], v[28:31], v[104:107]
    v_mfma_f32_16x16x32_bf16 v[108:111], v[236:239], v[28:31], v[108:111]
    s_branch Lg_px18
Lg_pv18:
    v_mfma_f32_16x16x32_bf16 v[48:51], v[16:19], v[224:227], v[48:51]
    v_mfma_f32_16x16x32_bf16 v[56:59], v[16:19], v[228:231], v[56:59]
    v_mfma_f32_16x16x32_bf16 v[64:67], v[16:19], v[232:235], v[64:67]
    v_mfma_f32_16x16x32_bf16 v[72:75], v[16:19], v[236:239], v[72:75]
    v_mfma_f32_16x16x32_bf16 v[52:55], v[20:23], v[224:227], v[52:55]
    v_mfma_f32_16x16x32_bf16 v[60:63], v[20:23], v[228:231], v[60:63]
    v_mfma_f32_16x16x32_bf16 v[68:71], v[20:23], v[232:235], v[68:71]
    v_mfma_f32_16x16x32_bf16 v[76:79], v[20:23], v[236:239], v[76:79]
    v_mfma_f32_16x16x32_bf16 v[80:83], v[24:27], v[224:227], v[80:83]
    v_mfma_f32_16x16x32_bf16 v[88:91], v[24:27], v[228:231], v[88:91]
    v_mfma_f32_16x16x32_bf16 v[96:99], v[24:27], v[232:235], v[96:99]
    v_mfma_f32_16x16x32_bf16 v[104:107], v[24:27], v[236:239], v[104:107]
    v_mfma_f32_16x16x32_bf16 v[84:87], v[28:31], v[224:227], v[84:87]
    v_mfma_f32_16x16x32_bf16 v[92:95], v[28:31], v[228:231], v[92:95]
    v_mfma_f32_16x16x32_bf16 v[100:103], v[28:31], v[232:235], v[100:103]
    v_mfma_f32_16x16x32_bf16 v[108:111], v[28:31], v[236:239], v[108:111]
Lg_px18:
    s_waitcnt vmcnt(0)
    ds_read_b64_tr_b16 v[240:241], v6 offset:16384
    ds_read_b64_tr_b16 v[242:243], v8 offset:16896
    ds_read_b64_tr_b16 v[244:245], v7 offset:16384
    ds_read_b64_tr_b16 v[246:247], v9 offset:16896
    ds_read_b64_tr_b16 v[248:249], v8 offset:16384
    ds_read_b64_tr_b16 v[250:251], v6 offset:16896
    ds_read_b64_tr_b16 v[252:253], v9 offset:16384
    ds_read_b64_tr_b16 v[254:255], v7 offset:16896
    ds_read_b128 v[16:19], v113 offset:36864
    ds_read_b128 v[20:23], v113 offset:38912
    ds_read_b128 v[24:27], v115 offset:36864
    ds_read_b128 v[28:31], v115 offset:38912
    s_waitcnt lgkmcnt(4)
    s_cmp_eq_u32 s41, 1
    s_waitcnt lgkmcnt(0)
    s_cbranch_scc1 Lg_pv19
    v_mfma_f32_16x16x32_bf16 v[48:51], v[240:243], v[16:19], v[48:51]
    v_mfma_f32_16x16x32_bf16 v[52:55], v[244:247], v[16:19], v[52:55]
    v_mfma_f32_16x16x32_bf16 v[64:67], v[248:251], v[16:19], v[64:67]
    v_mfma_f32_16x16x32_bf16 v[68:71], v[252:255], v[16:19], v[68:71]
    v_mfma_f32_16x16x32_bf16 v[56:59], v[240:243], v[20:23], v[56:59]
    v_mfma_f32_16x16x32_bf16 v[60:63], v[244:247], v[20:23], v[60:63]
    v_mfma_f32_16x16x32_bf16 v[72:75], v[248:251], v[20:23], v[72:75]
    v_mfma_f32_16x16x32_bf16 v[76:79], v[252:255], v[20:23], v[76:79]
    v_mfma_f32_16x16x32_bf16 v[80:83], v[240:243], v[24:27], v[80:83]
    v_mfma_f32_16x16x32_bf16 v[84:87], v[244:247], v[24:27], v[84:87]
    v_mfma_f32_16x16x32_bf16 v[96:99], v[248:251], v[24:27], v[96:99]
    v_mfma_f32_16x16x32_bf16 v[100:103], v[252:255], v[24:27], v[100:103]
    v_mfma_f32_16x16x32_bf16 v[88:91], v[240:243], v[28:31], v[88:91]
    v_mfma_f32_16x16x32_bf16 v[92:95], v[244:247], v[28:31], v[92:95]
    v_mfma_f32_16x16x32_bf16 v[104:107], v[248:251], v[28:31], v[104:107]
    v_mfma_f32_16x16x32_bf16 v[108:111], v[252:255], v[28:31], v[108:111]
    s_branch Lg_px19
Lg_pv19:
    v_mfma_f32_16x16x32_bf16 v[48:51], v[16:19], v[240:243], v[48:51]
    v_mfma_f32_16x16x32_bf16 v[56:59], v[16:19], v[244:247], v[56:59]
    v_mfma_f32_16x16x32_bf16 v[64:67], v[16:19], v[248:251], v[64:67]
    v_mfma_f32_16x16x32_bf16 v[72:75], v[16:19], v[252:255], v[72:75]
    v_mfma_f32_16x16x32_bf16 v[52:55], v[20:23], v[240:243], v[52:55]
    v_mfma_f32_16x16x32_bf16 v[60:63], v[20:23], v[244:247], v[60:63]
    v_mfma_f32_16x16x32_bf16 v[68:71], v[20:23], v[248:251], v[68:71]
    v_mfma_f32_16x16x32_bf16 v[76:79], v[20:23], v[252:255], v[76:79]
    v_mfma_f32_16x16x32_bf16 v[80:83], v[24:27], v[240:243], v[80:83]
    v_mfma_f32_16x16x32_bf16 v[88:91], v[24:27], v[244:247], v[88:91]
    v_mfma_f32_16x16x32_bf16 v[96:99], v[24:27], v[248:251], v[96:99]
    v_mfma_f32_16x16x32_bf16 v[104:107], v[24:27], v[252:255], v[104:107]
    v_mfma_f32_16x16x32_bf16 v[84:87], v[28:31], v[240:243], v[84:87]
    v_mfma_f32_16x16x32_bf16 v[92:95], v[28:31], v[244:247], v[92:95]
    v_mfma_f32_16x16x32_bf16 v[100:103], v[28:31], v[248:251], v[100:103]
    v_mfma_f32_16x16x32_bf16 v[108:111], v[28:31], v[252:255], v[108:111]
Lg_px19:
    s_cmp_eq_u32 s42, 3
    s_cbranch_scc1 Lg_w3
    s_branch Lg_cm_e
Lg_cm:
    global_load_dword v119, v118, s[8:9] sc1
    s_sub_u32 s12, s12, 1
    s_cbranch_scc1 L_abort
Lg_cm_e:
    s_add_u32 s85, s15, 11
    s_cmp_lg_u32 s15, 0
    s_waitcnt vmcnt(0)
    s_cbranch_scc1 Lg_cm_m
    v_cmp_eq_u32 vcc, -1, v119
    s_nop 0
    s_and_b32 s86, vcc_lo, vcc_hi
    v_cmp_eq_u32 vcc, 0x2000, v119
    s_nop 0
    s_and_b32 s87, vcc_lo, vcc_hi
    s_lshr_b32 s87, s87, 1
    s_and_b32 s86, s86, s87
    s_and_b32 s86, s86, 0x01010101
    s_cmp_eq_u32 s86, 0x01010101
    s_cbranch_scc1 Lg_cm_m
    v_readlane_b32 s86, v119, 3
    s_mov_b32 s84, 0
    v_readlane_b32 s87, v119, 1
    s_nop 0
    s_lshr_b32 s87, s87, 8
    s_add_u32 s86, s86, s87
    s_max_u32 s84, s84, s87
    v_readlane_b32 s87, v119, 9
    s_nop 0
    s_lshr_b32 s87, s87, 8
    s_add_u32 s86, s86, s87
    s_max_u32 s84, s84, s87
    v_readlane_b32 s87, v119, 17
    s_nop 0
    s_lshr_b32 s87, s87, 8
    s_add_u32 s86, s86, s87
    s_max_u32 s84, s84, s87
    v_readlane_b32 s87, v119, 25
    s_nop 0
    s_lshr_b32 s87, s87, 8
    s_add_u32 s86, s86, s87
    s_max_u32 s84, s84, s87
    v_readlane_b32 s87, v119, 33
    s_nop 0
    s_lshr_b32 s87, s87, 8
    s_add_u32 s86, s86, s87
    s_max_u32 s84, s84, s87
    v_readlane_b32 s87, v119, 41
    s_nop 0
    s_lshr_b32 s87, s87, 8
    s_add_u32 s86, s86, s87
    s_max_u32 s84, s84, s87
    v_readlane_b32 s87, v119, 49
    s_nop 0
    s_lshr_b32 s87, s87, 8
    s_add_u32 s86, s86, s87
    s_max_u32 s84, s84, s87
    v_readlane_b32 s87, v119, 57
    s_nop 0
    s_lshr_b32 s87, s87, 8
    s_add_u32 s86, s86, s87
    s_max_u32 s84, s84, s87
    s_cmp_eq_u32 s86, 256
    s_cbranch_scc1 L_again
Lg_cm_z:
    s_sleep 4
    s_branch Lg_cm
Lg_cm_m:
    v_readlane_b32 s84, v119, s85
    s_nop 0
    s_and_b32 s86, s84, 0xffff
    s_cmp_eq_u32 s86, 32
    s_cbranch_scc0 Lg_cm_z
    s_branch Lg_w0
Lg_w3:
    v_mov_b32 v10, 108
Lg_b2:
    global_load_dword v11, v10, s[8:9] sc1
    s_sub_u32 s12, s12, 1
    s_cbranch_scc1 L_abort
    s_waitcnt vmcnt(0)
    v_cmp_eq_u32 vcc, 16, v11
    s_cbranch_vccnz Lg_b2_ok
    s_sleep 8
    s_branch Lg_b2
Lg_b2_ok:
    s_sub_u32 s45, s33, 1
    s_min_u32 s45, s45, s44
    s_mul_i32 s45, s45, 40960
    s_add_u32 s45, s45, s50
    s_add_u32 s46, s49, s51
    s_add_u32 m0, s46, 0
    s_nop 0
    buffer_load_dwordx4 v3, s[20:23], s45 offen offset:0 sc1 lds
    s_add_u32 m0, s46, 3968
    s_nop 0
    buffer_load_dwordx4 v3, s[20:23], s45 offen offset:128 sc1 lds
    s_add_u32 m0, s46, 7936
    s_nop 0
    buffer_load_dwordx4 v3, s[20:23], s45 offen offset:256 sc1 lds
    s_add_u32 m0, s46, 11904
    s_nop 0
    buffer_load_dwordx4 v3, s[20:23], s45 offen offset:384 sc1 lds
    s_add_u32 m0, s46, 15872
    s_nop 0
    buffer_load_dwordx4 v3, s[20:23], s45 offen offset:512 sc1 lds
    s_add_u32 m0, s46, 19840
    s_nop 0
    buffer_load_dwordx4 v3, s[20:23], s45 offen offset:640 sc1 lds
    s_add_u32 m0, s46, 23808
    s_nop 0
    buffer_load_dwordx4 v3, s[20:23], s45 offen offset:768 sc1 lds
    s_add_u32 m0, s46, 27776
    s_nop 0
    buffer_load_dwordx4 v3, s[20:23], s45 offen offset:896 sc1 lds
    s_add_u32 m0, s46, 31744
    s_nop 0
    buffer_load_dwordx4 v3, s[20:23], s45 offen offset:1024 sc1 lds
    s_add_u32 m0, s46, 35712
    s_nop 0
    buffer_load_dwordx4 v3, s[20:23], s45 offen offset:1152 sc1 lds
    s_add_u32 s47, s44, 1
    s_mov_b32 s48, 40960
    s_sub_u32 s45, s33, 1
    s_min_u32 s45, s45, s47
    s_mul_i32 s45, s45, 40960
    s_add_u32 s45, s45, s50
    s_add_u32 s46, s48, s51
    s_add_u32 m0, s46, 0
    s_nop 0
    buffer_load_dwordx4 v3, s[20:23], s45 offen offset:0 sc1 lds
    s_add_u32 m0, s46, 3968
    s_nop 0
    buffer_load_dwordx4 v3, s[20:23], s45 offen offset:128 sc1 lds
    s_add_u32 m0, s46, 7936
    s_nop 0
    buffer_load_dwordx4 v3, s[20:23], s45 offen offset:256 sc1 lds
    s_add_u32 m0, s46, 11904
    s_nop 0
    buffer_load_dwordx4 v3, s[20:23], s45 offen offset:384 sc1 lds
    s_add_u32 m0, s46, 15872
    s_nop 0
    buffer_load_dwordx4 v3, s[20:23], s45 offen offset:512 sc1 lds
    s_add_u32 m0, s46, 19840
    s_nop 0
    buffer_load_dwordx4 v3, s[20:23], s45 offen offset:640 sc1 lds
    s_add_u32 m0, s46, 23808
    s_nop 0
    buffer_load_dwordx4 v3, s[20:23], s45 offen offset:768 sc1 lds
    s_add_u32 m0, s46, 27776
    s_nop 0
    buffer_load_dwordx4 v3, s[20:23], s45 offen offset:896 sc1 lds
    s_add_u32 m0, s46, 31744
    s_nop 0
    buffer_load_dwordx4 v3, s[20:23], s45 offen offset:1024 sc1 lds
    s_add_u32 m0, s46, 35712
    s_nop 0
    buffer_load_dwordx4 v3, s[20:23], s45 offen offset:1152 sc1 lds
    s_waitcnt vmcnt(10)
    s_branch Lg_Rp
Lg_w0:
    s_mov_b32 s53, s34
    s_cmp_eq_u32 s41, 1
    s_cbranch_scc1 Lg_Vf
    s_cmp_eq_u32 s41, 2
    s_cbranch_scc1 Lg_Rf
Lg_Kf:
    v_cvt_pk_bf16_f32 v48, v48, v49
    v_cvt_pk_bf16_f32 v49, v50, v51
    v_cvt_pk_bf16_f32 v50, v52, v53
    v_cvt_pk_bf16_f32 v51, v54, v55
    s_add_u32 s48, s53, s36
    buffer_store_dwordx4 v[48:51], v4, s[24:27], s48 offen sc1
    v_cvt_pk_bf16_f32 v56, v56, v57
    v_cvt_pk_bf16_f32 v57, v58, v59
    v_cvt_pk_bf16_f32 v58, v60, v61
    v_cvt_pk_bf16_f32 v59, v62, v63
    s_add_u32 s48, s53, s37
    buffer_store_dwordx4 v[56:59], v4, s[24:27], s48 offen sc1
    v_cvt_pk_bf16_f32 v64, v64, v65
    v_cvt_pk_bf16_f32 v65, v66, v67
    v_cvt_pk_bf16_f32 v66, v68, v69
    v_cvt_pk_bf16_f32 v67, v70, v71
    s_add_u32 s48, s53, s38
    buffer_store_dwordx4 v[64:67], v4, s[24:27], s48 offen sc1
    v_cvt_pk_bf16_f32 v72, v72, v73
    v_cvt_pk_bf16_f32 v73, v74, v75
    v_cvt_pk_bf16_f32 v74, v76, v77
    v_cvt_pk_bf16_f32 v75, v78, v79
    s_add_u32 s48, s53, s39
    buffer_store_dwordx4 v[72:75], v4, s[24:27], s48 offen sc1
    s_add_u32 s53, s53, s35
    v_cvt_pk_bf16_f32 v80, v80, v81
    v_cvt_pk_bf16_f32 v81, v82, v83
    v_cvt_pk_bf16_f32 v82, v84, v85
    v_cvt_pk_bf16_f32 v83, v86, v87
    s_add_u32 s48, s53, s36
    buffer_store_dwordx4 v[80:83], v4, s[24:27], s48 offen sc1
    v_cvt_pk_bf16_f32 v88, v88, v89
    v_cvt_pk_bf16_f32 v89, v90, v91
    v_cvt_pk_bf16_f32 v90, v92, v93
    v_cvt_pk_bf16_f32 v91, v94, v95
    s_add_u32 s48, s53, s37
    buffer_store_dwordx4 v[88:91], v4, s[24:27], s48 offen sc1
    v_cvt_pk_bf16_f32 v96, v96, v97
    v_cvt_pk_bf16_f32 v97, v98, v99
    v_cvt_pk_bf16_f32 v98, v100, v101
    v_cvt_pk_bf16_f32 v99, v102, v103
    s_add_u32 s48, s53, s38
    buffer_store_dwordx4 v[96:99], v4, s[24:27], s48 offen sc1
    v_cvt_pk_bf16_f32 v104, v104, v105
    v_cvt_pk_bf16_f32 v105, v106, v107
    v_cvt_pk_bf16_f32 v106, v108, v109
    v_cvt_pk_bf16_f32 v107, v110, v111
    s_add_u32 s48, s53, s39
    buffer_store_dwordx4 v[104:107], v4, s[24:27], s48 offen sc1
    s_add_u32 s44, s44, 2
    s_mov_b32 s49, 81920
    s_barrier
    s_sub_u32 s45, s33, 1
    s_min_u32 s45, s45, s44
    s_mul_i32 s45, s45, 40960
    s_add_u32 s45, s45, s50
    s_add_u32 s46, s49, s51
    s_add_u32 m0, s46, 0
    s_nop 0
    buffer_load_dwordx4 v3, s[20:23], s45 offen offset:0 sc1 lds
    s_add_u32 m0, s46, 3968
    s_nop 0
    buffer_load_dwordx4 v3, s[20:23], s45 offen offset:128 sc1 lds
    s_add_u32 m0, s46, 7936
    s_nop 0
    buffer_load_dwordx4 v3, s[20:23], s45 offen offset:256 sc1 lds
    s_add_u32 m0, s46, 11904
    s_nop 0
    buffer_load_dwordx4 v3, s[20:23], s45 offen offset:384 sc1 lds
    s_add_u32 m0, s46, 15872
    s_nop 0
    buffer_load_dwordx4 v3, s[20:23], s45 offen offset:512 sc1 lds
    s_add_u32 m0, s46, 19840
    s_nop 0
    buffer_load_dwordx4 v3, s[20:23], s45 offen offset:640 sc1 lds
    s_add_u32 m0, s46, 23808
    s_nop 0
    buffer_load_dwordx4 v3, s[20:23], s45 offen offset:768 sc1 lds
    s_add_u32 m0, s46, 27776
    s_nop 0
    buffer_load_dwordx4 v3, s[20:23], s45 offen offset:896 sc1 lds
    s_add_u32 m0, s46, 31744
    s_nop 0
    buffer_load_dwordx4 v3, s[20:23], s45 offen offset:1024 sc1 lds
    s_add_u32 m0, s46, 35712
    s_nop 0
    buffer_load_dwordx4 v3, s[20:23], s45 offen offset:1152 sc1 lds
    s_waitcnt vmcnt(10)
    v_mov_b32 v10, s44
    buffer_store_dword v10, v5, s[4:7], s40 offen sc1
    s_add_u32 s47, s44, 1
    s_mov_b32 s48, 0
    s_sub_u32 s45, s33, 1
    s_min_u32 s45, s45, s47
    s_mul_i32 s45, s45, 40960
    s_add_u32 s45, s45, s50
    s_add_u32 s46, s48, s51
    s_add_u32 m0, s46, 0
    s_nop 0
    buffer_load_dwordx4 v3, s[20:23], s45 offen offset:0 sc1 lds
    s_add_u32 m0, s46, 3968
    s_nop 0
    buffer_load_dwordx4 v3, s[20:23], s45 offen offset:128 sc1 lds
    s_add_u32 m0, s46, 7936
    s_nop 0
    buffer_load_dwordx4 v3, s[20:23], s45 offen offset:256 sc1 lds
    s_add_u32 m0, s46, 11904
    s_nop 0
    buffer_load_dwordx4 v3, s[20:23], s45 offen offset:384 sc1 lds
    s_add_u32 m0, s46, 15872
    s_nop 0
    buffer_load_dwordx4 v3, s[20:23], s45 offen offset:512 sc1 lds
    s_add_u32 m0, s46, 19840
    s_nop 0
    buffer_load_dwordx4 v3, s[20:23], s45 offen offset:640 sc1 lds
    s_add_u32 m0, s46, 23808
    s_nop 0
    buffer_load_dwordx4 v3, s[20:23], s45 offen offset:768 sc1 lds
    s_add_u32 m0, s46, 27776
    s_nop 0
    buffer_load_dwordx4 v3, s[20:23], s45 offen offset:896 sc1 lds
    s_add_u32 m0, s46, 31744
    s_nop 0
    buffer_load_dwordx4 v3, s[20:23], s45 offen offset:1024 sc1 lds
    s_add_u32 m0, s46, 35712
    s_nop 0
    buffer_load_dwordx4 v3, s[20:23], s45 offen offset:1152 sc1 lds
    s_waitcnt vmcnt(11)
Lg_Kp:
    s_mov_b32 s53, 1073741824
    v_add_u32 v112, s49, v15
    v_xor_b32 v113, 64, v112
    s_barrier
    ds_read_b128 v[16:19], v112 offset:0
    ds_read_b128 v[20:23], v112 offset:2048
    ds_read_b128 v[24:27], v113 offset:0
    ds_read_b128 v[28:31], v113 offset:2048
    ds_read_b128 v[32:35], v112 offset:4096
    ds_read_b128 v[36:39], v112 offset:6144
Lg_K0:
    s_waitcnt lgkmcnt(5)
    v_mfma_f32_16x16x32_bf16 v[48:51], a[0:3], v[16:19], 0
    v_mfma_f32_16x16x32_bf16 v[52:55], a[4:7], v[16:19], 0
    v_mfma_f32_16x16x32_bf16 v[64:67], a[8:11], v[16:19], 0
    v_cvt_pk_bf16_f32 v80, v80, v81
    v_cvt_pk_bf16_f32 v81, v82, v83
    v_mfma_f32_16x16x32_bf16 v[68:71], a[12:15], v[16:19], 0
    ds_read_b128 v[40:43], v113 offset:4096
    s_waitcnt lgkmcnt(5)
    v_mfma_f32_16x16x32_bf16 v[56:59], a[0:3], v[20:23], 0
    v_cvt_pk_bf16_f32 v82, v84, v85
    v_cvt_pk_bf16_f32 v83, v86, v87
    v_mfma_f32_16x16x32_bf16 v[60:63], a[4:7], v[20:23], 0
    s_add_u32 s48, s53, s36
    buffer_store_dwordx4 v[80:83], v4, s[24:27], s48 offen sc1
    v_mfma_f32_16x16x32_bf16 v[72:75], a[8:11], v[20:23], 0
    v_mfma_f32_16x16x32_bf16 v[76:79], a[12:15], v[20:23], 0
    ds_read_b128 v[44:47], v113 offset:6144
    s_waitcnt lgkmcnt(5)
    v_mfma_f32_16x16x32_bf16 v[48:51], a[16:19], v[24:27], v[48:51]
    v_mfma_f32_16x16x32_bf16 v[52:55], a[20:23], v[24:27], v[52:55]
    v_mfma_f32_16x16x32_bf16 v[64:67], a[24:27], v[24:27], v[64:67]
    v_mfma_f32_16x16x32_bf16 v[68:71], a[28:31], v[24:27], v[68:71]
    ds_read_b128 v[16:19], v112 offset:8192
    s_waitcnt lgkmcnt(5)
    v_mfma_f32_16x16x32_bf16 v[56:59], a[16:19], v[28:31], v[56:59]
    v_mfma_f32_16x16x32_bf16 v[60:63], a[20:23], v[28:31], v[60:63]
    v_cvt_pk_bf16_f32 v88, v88, v89
    v_cvt_pk_bf16_f32 v89, v90, v91
    v_mfma_f32_16x16x32_bf16 v[72:75], a[24:27], v[28:31], v[72:75]
    v_cvt_pk_bf16_f32 v90, v92, v93
    v_cvt_pk_bf16_f32 v91, v94, v95
    v_mfma_f32_16x16x32_bf16 v[76:79], a[28:31], v[28:31], v[76:79]
    ds_read_b128 v[20:23], v112 offset:10240
    s_waitcnt lgkmcnt(5)
    v_mfma_f32_16x16x32_bf16 v[48:51], a[32:35], v[32:35], v[48:51]
    s_add_u32 s48, s53, s37
    buffer_store_dwordx4 v[88:91], v4, s[24:27], s48 offen sc1
    v_mfma_f32_16x16x32_bf16 v[52:55], a[36:39], v[32:35], v[52:55]
    v_mfma_f32_16x16x32_bf16 v[64:67], a[40:43], v[32:35], v[64:67]
    v_mfma_f32_16x16x32_bf16 v[68:71], a[44:47], v[32:35], v[68:71]
    ds_read_b128 v[24:27], v113 offset:8192
    s_waitcnt lgkmcnt(5)
    v_mfma_f32_16x16x32_bf16 v[56:59], a[32:35], v[36:39], v[56:59]
    v_mfma_f32_16x16x32_bf16 v[60:63], a[36:39], v[36:39], v[60:63]
    v_mfma_f32_16x16x32_bf16 v[72:75], a[40:43], v[36:39], v[72:75]
    v_mfma_f32_16x16x32_bf16 v[76:79], a[44:47], v[36:39], v[76:79]
    ds_read_b128 v[28:31], v113 offset:10240
    s_waitcnt lgkmcnt(5)
    v_mfma_f32_16x16x32_bf16 v[48:51], a[48:51], v[40:43], v[48:51]
    v_cvt_pk_bf16_f32 v96, v96, v97
    v_cvt_pk_bf16_f32 v97, v98, v99
    v_mfma_f32_16x16x32_bf16 v[52:55], a[52:55], v[40:43], v[52:55]
    v_cvt_pk_bf16_f32 v98, v100, v101
    v_cvt_pk_bf16_f32 v99, v102, v103
    v_mfma_f32_16x16x32_bf16 v[64:67], a[56:59], v[40:43], v[64:67]
    s_add_u32 s48, s53, s38
    buffer_store_dwordx4 v[96:99], v4, s[24:27], s48 offen sc1
    v_mfma_f32_16x16x32_bf16 v[68:71], a[60:63], v[40:43], v[68:71]
    ds_read_b128 v[32:35], v112 offset:12288
    s_waitcnt lgkmcnt(5)
    v_mfma_f32_16x16x32_bf16 v[56:59], a[48:51], v[44:47], v[56:59]
    v_mfma_f32_16x16x32_bf16 v[60:63], a[52:55], v[44:47], v[60:63]
    v_mfma_f32_16x16x32_bf16 v[72:75], a[56:59], v[44:47], v[72:75]
    v_mfma_f32_16x16x32_bf16 v[76:79], a[60:63], v[44:47], v[76:79]
    ds_read_b128 v[36:39], v112 offset:14336
    s_waitcnt lgkmcnt(5)
    v_mfma_f32_16x16x32_bf16 v[48:51], a[64:67], v[16:19], v[48:51]
    v_mfma_f32_16x16x32_bf16 v[52:55], a[68:71], v[16:19], v[52:55]
    v_mfma_f32_16x16x32_bf16 v[64:67], a[72:75], v[16:19], v[64:67]
    v_cvt_pk_bf16_f32 v104, v104, v105
    v_cvt_pk_bf16_f32 v105, v106, v107
    v_mfma_f32_16x16x32_bf16 v[68:71], a[76:79], v[16:19], v[68:71]
    ds_read_b128 v[40:43], v113 offset:12288
    s_waitcnt lgkmcnt(5)
    v_mfma_f32_16x16x32_bf16 v[56:59], a[64:67], v[20:23], v[56:59]
    v_cvt_pk_bf16_f32 v106, v108, v109
    v_cvt_pk_bf16_f32 v107, v110, v111
    v_mfma_f32_16x16x32_bf16 v[60:63], a[68:71], v[20:23], v[60:63]
    s_add_u32 s48, s53, s39
    buffer_store_dwordx4 v[104:107], v4, s[24:27], s48 offen sc1
    v_mfma_f32_16x16x32_bf16 v[72:75], a[72:75], v[20:23], v[72:75]
    v_mfma_f32_16x16x32_bf16 v[76:79], a[76:79], v[20:23], v[76:79]
    ds_read_b128 v[44:47], v113 offset:14336
    s_waitcnt lgkmcnt(5)
    v_mfma_f32_16x16x32_bf16 v[48:51], a[80:83], v[24:27], v[48:51]
    v_mfma_f32_16x16x32_bf16 v[52:55], a[84:87], v[24:27], v[52:55]
    v_mfma_f32_16x16x32_bf16 v[64:67], a[88:91], v[24:27], v[64:67]
    v_mfma_f32_16x16x32_bf16 v[68:71], a[92:95], v[24:27], v[68:71]
    ds_read_b128 v[16:19], v112 offset:16384
    s_waitcnt lgkmcnt(5)
    v_mfma_f32_16x16x32_bf16 v[56:59], a[80:83], v[28:31], v[56:59]
    v_mfma_f32_16x16x32_bf16 v[60:63], a[84:87], v[28:31], v[60:63]
    s_sub_u32 s47, s49, 40960
    s_cselect_b32 s52, 81920, s47
    s_add_u32 s47, s44, 2
    v_mfma_f32_16x16x32_bf16 v[72:75], a[88:91], v[28:31], v[72:75]
    s_sub_u32 s45, s33, 1
    s_min_u32 s45, s45, s47
    v_mfma_f32_16x16x32_bf16 v[76:79], a[92:95], v[28:31], v[76:79]
    ds_read_b128 v[20:23], v112 offset:18432
    s_waitcnt lgkmcnt(5)
    v_mfma_f32_16x16x32_bf16 v[48:51], a[96:99], v[32:35], v[48:51]
    s_mul_i32 s45, s45, 40960
    s_add_u32 s45, s45, s50
    v_mfma_f32_16x16x32_bf16 v[52:55], a[100:103], v[32:35], v[52:55]
    s_add_u32 s46, s52, s51
    s_sub_u32 s48, s44, s32
    v_mfma_f32_16x16x32_bf16 v[64:67], a[104:107], v[32:35], v[64:67]
    s_mul_i32 s48, s48, s35
    s_add_u32 s53, s48, s34
    v_mfma_f32_16x16x32_bf16 v[68:71], a[108:111], v[32:35], v[68:71]
    ds_read_b128 v[24:27], v113 offset:16384
    s_waitcnt lgkmcnt(5)
    v_mfma_f32_16x16x32_bf16 v[56:59], a[96:99], v[36:39], v[56:59]
    s_add_u32 s49, s49, 40960
    s_cmp_eq_u32 s49, 122880
    s_cselect_b32 s49, 0, s49
    v_mfma_f32_16x16x32_bf16 v[60:63], a[100:103], v[36:39], v[60:63]
    v_add_u32 v114, s49, v15
    v_xor_b32 v115, 64, v114
    v_mfma_f32_16x16x32_bf16 v[72:75], a[104:107], v[36:39], v[72:75]
    s_sub_u32 s48, s33, 1
    s_add_u32 s59, s44, 4
    v_mfma_f32_16x16x32_bf16 v[76:79], a[108:111], v[36:39], v[76:79]
    ds_read_b128 v[28:31], v113 offset:18432
    s_waitcnt lgkmcnt(5)
    v_mfma_f32_16x16x32_bf16 v[48:51], a[112:115], v[40:43], v[48:51]
    s_min_u32 s48, s48, s59
    s_mul_i32 s48, s48, 40960
    v_mfma_f32_16x16x32_bf16 v[52:55], a[116:119], v[40:43], v[52:55]
    s_add_u32 s59, s48, s31
    v_mfma_f32_16x16x32_bf16 v[64:67], a[120:123], v[40:43], v[64:67]
    v_mfma_f32_16x16x32_bf16 v[68:71], a[124:127], v[40:43], v[68:71]
    ds_read_b128 v[32:35], v112 offset:20480
    s_waitcnt lgkmcnt(5)
    v_mfma_f32_16x16x32_bf16 v[56:59], a[112:115], v[44:47], v[56:59]
    v_mfma_f32_16x16x32_bf16 v[60:63], a[116:119], v[44:47], v[60:63]
    v_mfma_f32_16x16x32_bf16 v[72:75], a[120:123], v[44:47], v[72:75]
    v_mfma_f32_16x16x32_bf16 v[76:79], a[124:127], v[44:47], v[76:79]
    ds_read_b128 v[36:39], v112 offset:22528
    s_waitcnt lgkmcnt(5)
    v_mfma_f32_16x16x32_bf16 v[48:51], a[128:131], v[16:19], v[48:51]
    v_mfma_f32_16x16x32_bf16 v[52:55], a[132:135], v[16:19], v[52:55]
    v_mfma_f32_16x16x32_bf16 v[64:67], a[136:139], v[16:19], v[64:67]
    v_mfma_f32_16x16x32_bf16 v[68:71], a[140:143], v[16:19], v[68:71]
    ds_read_b128 v[40:43], v113 offset:20480
    s_waitcnt lgkmcnt(5)
    v_mfma_f32_16x16x32_bf16 v[56:59], a[128:131], v[20:23], v[56:59]
    v_mfma_f32_16x16x32_bf16 v[60:63], a[132:135], v[20:23], v[60:63]
    v_mfma_f32_16x16x32_bf16 v[72:75], a[136:139], v[20:23], v[72:75]
    v_mfma_f32_16x16x32_bf16 v[76:79], a[140:143], v[20:23], v[76:79]
    ds_read_b128 v[44:47], v113 offset:22528
    s_waitcnt lgkmcnt(5)
    v_mfma_f32_16x16x32_bf16 v[48:51], a[144:147], v[24:27], v[48:51]
    v_mfma_f32_16x16x32_bf16 v[52:55], a[148:151], v[24:27], v[52:55]
    v_mfma_f32_16x16x32_bf16 v[64:67], a[152:155], v[24:27], v[64:67]
    v_mfma_f32_16x16x32_bf16 v[68:71], a[156:159], v[24:27], v[68:71]
    ds_read_b128 v[16:19], v112 offset:24576
    s_waitcnt lgkmcnt(5)
    v_mfma_f32_16x16x32_bf16 v[56:59], a[144:147], v[28:31], v[56:59]
    v_mfma_f32_16x16x32_bf16 v[60:63], a[148:151], v[28:31], v[60:63]
    v_mfma_f32_16x16x32_bf16 v[72:75], a[152:155], v[28:31], v[72:75]
    v_mfma_f32_16x16x32_bf16 v[76:79], a[156:159], v[28:31], v[76:79]
    ds_read_b128 v[20:23], v112 offset:26624
    s_waitcnt lgkmcnt(5)
    v_mfma_f32_16x16x32_bf16 v[48:51], a[160:163], v[32:35], v[48:51]
    v_mfma_f32_16x16x32_bf16 v[52:55], a[164:167], v[32:35], v[52:55]
    v_mfma_f32_16x16x32_bf16 v[64:67], a[168:171], v[32:35], v[64:67]
    v_mfma_f32_16x16x32_bf16 v[68:71], a[172:175], v[32:35], v[68:71]
    ds_read_b128 v[24:27], v113 offset:24576
    s_waitcnt lgkmcnt(5)
    v_mfma_f32_16x16x32_bf16 v[56:59], a[160:163], v[36:39], v[56:59]
    v_mfma_f32_16x16x32_bf16 v[60:63], a[164:167], v[36:39], v[60:63]
    v_mfma_f32_16x16x32_bf16 v[72:75], a[168:171], v[36:39], v[72:75]
    v_mfma_f32_16x16x32_bf16 v[76:79], a[172:175], v[36:39], v[76:79]
    ds_read_b128 v[28:31], v113 offset:26624
    s_waitcnt lgkmcnt(5)
    v_mfma_f32_16x16x32_bf16 v[48:51], a[176:179], v[40:43], v[48:51]
    v_mfma_f32_16x16x32_bf16 v[52:55], a[180:183], v[40:43], v[52:55]
    v_mfma_f32_16x16x32_bf16 v[64:67], a[184:187], v[40:43], v[64:67]
    v_mfma_f32_16x16x32_bf16 v[68:71], a[188:191], v[40:43], v[68:71]
    ds_read_b128 v[32:35], v112 offset:28672
    s_waitcnt lgkmcnt(5)
    v_mfma_f32_16x16x32_bf16 v[56:59], a[176:179], v[44:47], v[56:59]
    v_mfma_f32_16x16x32_bf16 v[60:63], a[180:183], v[44:47], v[60:63]
    v_mfma_f32_16x16x32_bf16 v[72:75], a[184:187], v[44:47], v[72:75]
    v_mfma_f32_16x16x32_bf16 v[76:79], a[188:191], v[44:47], v[76:79]
    ds_read_b128 v[36:39], v112 offset:30720
    s_waitcnt lgkmcnt(5)
    v_mfma_f32_16x16x32_bf16 v[48:51], a[192:195], v[16:19], v[48:51]
    v_mfma_f32_16x16x32_bf16 v[52:55], a[196:199], v[16:19], v[52:55]
    v_mfma_f32_16x16x32_bf16 v[64:67], a[200:203], v[16:19], v[64:67]
    v_mfma_f32_16x16x32_bf16 v[68:71], a[204:207], v[16:19], v[68:71]
    ds_read_b128 v[40:43], v113 offset:28672
    s_waitcnt lgkmcnt(5)
    v_mfma_f32_16x16x32_bf16 v[56:59], a[192:195], v[20:23], v[56:59]
    v_mfma_f32_16x16x32_bf16 v[60:63], a[196:199], v[20:23], v[60:63]
    v_mfma_f32_16x16x32_bf16 v[72:75], a[200:203], v[20:23], v[72:75]
    v_mfma_f32_16x16x32_bf16 v[76:79], a[204:207], v[20:23], v[76:79]
    ds_read_b128 v[44:47], v113 offset:30720
    s_waitcnt lgkmcnt(5)
    v_mfma_f32_16x16x32_bf16 v[48:51], a[208:211], v[24:27], v[48:51]
    s_waitcnt vmcnt(0)
    s_barrier
    v_mfma_f32_16x16x32_bf16 v[52:55], a[212:215], v[24:27], v[52:55]
    v_mov_b32 v10, s44
    buffer_store_dword v10, v5, s[4:7], s40 offen sc1
    v_mfma_f32_16x16x32_bf16 v[64:67], a[216:219], v[24:27], v[64:67]
    s_add_u32 s44, s44, 1
    v_mfma_f32_16x16x32_bf16 v[68:71], a[220:223], v[24:27], v[68:71]
    ds_read_b128 v[16:19], v112 offset:32768
    s_waitcnt lgkmcnt(5)
    v_mfma_f32_16x16x32_bf16 v[56:59], a[208:211], v[28:31], v[56:59]
    s_add_u32 m0, s46, 0
    v_mfma_f32_16x16x32_bf16 v[60:63], a[212:215], v[28:31], v[60:63]
    buffer_load_dwordx4 v3, s[20:23], s45 offen offset:0 sc1 lds
    v_mfma_f32_16x16x32_bf16 v[72:75], a[216:219], v[28:31], v[72:75]
    v_mfma_f32_16x16x32_bf16 v[76:79], a[220:223], v[28:31], v[76:79]
    ds_read_b128 v[20:23], v112 offset:34816
    s_waitcnt lgkmcnt(5)
    v_mfma_f32_16x16x32_bf16 v[48:51], a[224:227], v[32:35], v[48:51]
    s_add_u32 m0, s46, 3968
    v_mfma_f32_16x16x32_bf16 v[52:55], a[228:231], v[32:35], v[52:55]
    buffer_load_dwordx4 v3, s[20:23], s45 offen offset:128 sc1 lds
    v_mfma_f32_16x16x32_bf16 v[64:67], a[232:235], v[32:35], v[64:67]
    v_mfma_f32_16x16x32_bf16 v[68:71], a[236:239], v[32:35], v[68:71]
    ds_read_b128 v[24:27], v113 offset:32768
    s_waitcnt lgkmcnt(5)
    v_mfma_f32_16x16x32_bf16 v[56:59], a[224:227], v[36:39], v[56:59]
    s_add_u32 m0, s46, 7936
    v_mfma_f32_16x16x32_bf16 v[60:63], a[228:231], v[36:39], v[60:63]
    buffer_load_dwordx4 v3, s[20:23], s45 offen offset:256 sc1 lds
    v_mfma_f32_16x16x32_bf16 v[72:75], a[232:235], v[36:39], v[72:75]
    v_mfma_f32_16x16x32_bf16 v[76:79], a[236:239], v[36:39], v[76:79]
    ds_read_b128 v[28:31], v113 offset:34816
    s_waitcnt lgkmcnt(5)
    v_mfma_f32_16x16x32_bf16 v[48:51], a[240:243], v[40:43], v[48:51]
    s_add_u32 m0, s46, 11904
    v_mfma_f32_16x16x32_bf16 v[52:55], a[244:247], v[40:43], v[52:55]
    buffer_load_dwordx4 v3, s[20:23], s45 offen offset:384 sc1 lds
    v_mfma_f32_16x16x32_bf16 v[64:67], a[248:251], v[40:43], v[64:67]
    v_mfma_f32_16x16x32_bf16 v[68:71], a[252:255], v[40:43], v[68:71]
    ds_read_b128 v[32:35], v112 offset:36864
    s_waitcnt lgkmcnt(5)
    v_mfma_f32_16x16x32_bf16 v[56:59], a[240:243], v[44:47], v[56:59]
    s_add_u32 m0, s46, 15872
    v_mfma_f32_16x16x32_bf16 v[60:63], a[244:247], v[44:47], v[60:63]
    buffer_load_dwordx4 v3, s[20:23], s45 offen offset:512 sc1 lds
    v_mfma_f32_16x16x32_bf16 v[72:75], a[248:251], v[44:47], v[72:75]
    v_mfma_f32_16x16x32_bf16 v[76:79], a[252:255], v[44:47], v[76:79]
    ds_read_b128 v[36:39], v112 offset:38912
    s_waitcnt lgkmcnt(5)
    v_mfma_f32_16x16x32_bf16 v[48:51], v[192:195], v[16:19], v[48:51]
    s_add_u32 m0, s46, 19840
    v_mfma_f32_16x16x32_bf16 v[52:55], v[196:199], v[16:19], v[52:55]
    buffer_load_dwordx4 v3, s[20:23], s45 offen offset:640 sc1 lds
    v_mfma_f32_16x16x32_bf16 v[64:67], v[200:203], v[16:19], v[64:67]
    v_mfma_f32_16x16x32_bf16 v[68:71], v[204:207], v[16:19], v[68:71]
    ds_read_b128 v[40:43], v113 offset:36864
    s_waitcnt lgkmcnt(5)
    v_mfma_f32_16x16x32_bf16 v[56:59], v[192:195], v[20:23], v[56:59]
    s_add_u32 m0, s46, 23808
    v_mfma_f32_16x16x32_bf16 v[60:63], v[196:199], v[20:23], v[60:63]
    buffer_load_dwordx4 v3, s[20:23], s45 offen offset:768 sc1 lds
    v_mfma_f32_16x16x32_bf16 v[72:75], v[200:203], v[20:23], v[72:75]
    v_mfma_f32_16x16x32_bf16 v[76:79], v[204:207], v[20:23], v[76:79]
    ds_read_b128 v[44:47], v113 offset:38912
    s_waitcnt lgkmcnt(5)
    v_mfma_f32_16x16x32_bf16 v[48:51], v[208:211], v[24:27], v[48:51]
    s_add_u32 m0, s46, 27776
    v_mfma_f32_16x16x32_bf16 v[52:55], v[212:215], v[24:27], v[52:55]
    buffer_load_dwordx4 v3, s[20:23], s45 offen offset:896 sc1 lds
    v_mfma_f32_16x16x32_bf16 v[64:67], v[216:219], v[24:27], v[64:67]
    v_mfma_f32_16x16x32_bf16 v[68:71], v[220:223], v[24:27], v[68:71]
    ds_read_b128 v[16:19], v114 offset:0
    s_waitcnt lgkmcnt(5)
    v_mfma_f32_16x16x32_bf16 v[56:59], v[208:211], v[28:31], v[56:59]
    s_add_u32 m0, s46, 31744
    v_mfma_f32_16x16x32_bf16 v[60:63], v[212:215], v[28:31], v[60:63]
    buffer_load_dwordx4 v3, s[20:23], s45 offen offset:1024 sc1 lds
    v_mfma_f32_16x16x32_bf16 v[72:75], v[216:219], v[28:31], v[72:75]
    v_mfma_f32_16x16x32_bf16 v[76:79], v[220:223], v[28:31], v[76:79]
    ds_read_b128 v[20:23], v114 offset:2048
    s_waitcnt lgkmcnt(5)
    v_mfma_f32_16x16x32_bf16 v[48:51], v[224:227], v[32:35], v[48:51]
    s_add_u32 m0, s46, 35712
    v_mfma_f32_16x16x32_bf16 v[52:55], v[228:231], v[32:35], v[52:55]
    buffer_load_dwordx4 v3, s[20:23], s45 offen offset:1152 sc1 lds
    v_mfma_f32_16x16x32_bf16 v[64:67], v[232:235], v[32:35], v[64:67]
    v_mfma_f32_16x16x32_bf16 v[68:71], v[236:239], v[32:35], v[68:71]
    ds_read_b128 v[24:27], v115 offset:0
    s_waitcnt lgkmcnt(5)
    v_mfma_f32_16x16x32_bf16 v[56:59], v[224:227], v[36:39], v[56:59]
    buffer_load_dword v117, v116, s[20:23], s59 offen sc1
    v_mfma_f32_16x16x32_bf16 v[60:63], v[228:231], v[36:39], v[60:63]
    v_mfma_f32_16x16x32_bf16 v[72:75], v[232:235], v[36:39], v[72:75]
    v_mfma_f32_16x16x32_bf16 v[76:79], v[236:239], v[36:39], v[76:79]
    ds_read_b128 v[28:31], v115 offset:2048
    s_waitcnt lgkmcnt(5)
    v_mfma_f32_16x16x32_bf16 v[48:51], v[240:243], v[40:43], v[48:51]
    v_mfma_f32_16x16x32_bf16 v[52:55], v[244:247], v[40:43], v[52:55]
    v_mfma_f32_16x16x32_bf16 v[64:67], v[248:251], v[40:43], v[64:67]
    v_mfma_f32_16x16x32_bf16 v[68:71], v[252:255], v[40:43], v[68:71]
    ds_read_b128 v[32:35], v114 offset:4096
    s_waitcnt lgkmcnt(5)
    v_mfma_f32_16x16x32_bf16 v[56:59], v[240:243], v[44:47], v[56:59]
    v_mfma_f32_16x16x32_bf16 v[60:63], v[244:247], v[44:47], v[60:63]
    v_mfma_f32_16x16x32_bf16 v[72:75], v[248:251], v[44:47], v[72:75]
    s_cmp_lt_u32 s44, s33
    v_mfma_f32_16x16x32_bf16 v[76:79], v[252:255], v[44:47], v[76:79]
    ds_read_b128 v[36:39], v114 offset:6144
    s_cbranch_scc0 Lg_Ke0
Lg_K1:
    s_waitcnt lgkmcnt(5)
    v_mfma_f32_16x16x32_bf16 v[80:83], a[0:3], v[16:19], 0
    v_mfma_f32_16x16x32_bf16 v[84:87], a[4:7], v[16:19], 0
    v_mfma_f32_16x16x32_bf16 v[96:99], a[8:11], v[16:19], 0
    v_cvt_pk_bf16_f32 v48, v48, v49
    v_cvt_pk_bf16_f32 v49, v50, v51
    v_mfma_f32_16x16x32_bf16 v[100:103], a[12:15], v[16:19], 0
    ds_read_b128 v[40:43], v115 offset:4096
    s_waitcnt lgkmcnt(5)
    v_mfma_f32_16x16x32_bf16 v[88:91], a[0:3], v[20:23], 0
    v_cvt_pk_bf16_f32 v50, v52, v53
    v_cvt_pk_bf16_f32 v51, v54, v55
    v_mfma_f32_16x16x32_bf16 v[92:95], a[4:7], v[20:23], 0
    s_add_u32 s48, s53, s36
    buffer_store_dwordx4 v[48:51], v4, s[24:27], s48 offen sc1
    v_mfma_f32_16x16x32_bf16 v[104:107], a[8:11], v[20:23], 0
    v_mfma_f32_16x16x32_bf16 v[108:111], a[12:15], v[20:23], 0
    ds_read_b128 v[44:47], v115 offset:6144
    s_waitcnt lgkmcnt(5)
    v_mfma_f32_16x16x32_bf16 v[80:83], a[16:19], v[24:27], v[80:83]
    v_mfma_f32_16x16x32_bf16 v[84:87], a[20:23], v[24:27], v[84:87]
    v_mfma_f32_16x16x32_bf16 v[96:99], a[24:27], v[24:27], v[96:99]
    v_mfma_f32_16x16x32_bf16 v[100:103], a[28:31], v[24:27], v[100:103]
    ds_read_b128 v[16:19], v114 offset:8192
    s_waitcnt lgkmcnt(5)
    v_mfma_f32_16x16x32_bf16 v[88:91], a[16:19], v[28:31], v[88:91]
    v_mfma_f32_16x16x32_bf16 v[92:95], a[20:23], v[28:31], v[92:95]
    v_cvt_pk_bf16_f32 v56, v56, v57
    v_cvt_pk_bf16_f32 v57, v58, v59
    v_mfma_f32_16x16x32_bf16 v[104:107], a[24:27], v[28:31], v[104:107]
    v_cvt_pk_bf16_f32 v58, v60, v61
    v_cvt_pk_bf16_f32 v59, v62, v63
    v_mfma_f32_16x16x32_bf16 v[108:111], a[28:31], v[28:31], v[108:111]
    ds_read_b128 v[20:23], v114 offset:10240
    s_waitcnt lgkmcnt(5)
    v_mfma_f32_16x16x32_bf16 v[80:83], a[32:35], v[32:35], v[80:83]
    s_add_u32 s48, s53, s37
    buffer_store_dwordx4 v[56:59], v4, s[24:27], s48 offen sc1
    v_mfma_f32_16x16x32_bf16 v[84:87], a[36:39], v[32:35], v[84:87]
    v_mfma_f32_16x16x32_bf16 v[96:99], a[40:43], v[32:35], v[96:99]
    v_mfma_f32_16x16x32_bf16 v[100:103], a[44:47], v[32:35], v[100:103]
    ds_read_b128 v[24:27], v115 offset:8192
    s_waitcnt lgkmcnt(5)
    v_mfma_f32_16x16x32_bf16 v[88:91], a[32:35], v[36:39], v[88:91]
    v_mfma_f32_16x16x32_bf16 v[92:95], a[36:39], v[36:39], v[92:95]
    v_mfma_f32_16x16x32_bf16 v[104:107], a[40:43], v[36:39], v[104:107]
    v_mfma_f32_16x16x32_bf16 v[108:111], a[44:47], v[36:39], v[108:111]
    ds_read_b128 v[28:31], v115 offset:10240
    s_waitcnt lgkmcnt(5)
    v_mfma_f32_16x16x32_bf16 v[80:83], a[48:51], v[40:43], v[80:83]
    v_cvt_pk_bf16_f32 v64, v64, v65
    v_cvt_pk_bf16_f32 v65, v66, v67
    v_mfma_f32_16x16x32_bf16 v[84:87], a[52:55], v[40:43], v[84:87]
    v_cvt_pk_bf16_f32 v66, v68, v69
    v_cvt_pk_bf16_f32 v67, v70, v71
    v_mfma_f32_16x16x32_bf16 v[96:99], a[56:59], v[40:43], v[96:99]
    s_add_u32 s48, s53, s38
    buffer_store_dwordx4 v[64:67], v4, s[24:27], s48 offen sc1
    v_mfma_f32_16x16x32_bf16 v[100:103], a[60:63], v[40:43], v[100:103]
    ds_read_b128 v[32:35], v114 offset:12288
    s_waitcnt lgkmcnt(5)
    v_mfma_f32_16x16x32_bf16 v[88:91], a[48:51], v[44:47], v[88:91]
    v_mfma_f32_16x16x32_bf16 v[92:95], a[52:55], v[44:47], v[92:95]
    v_mfma_f32_16x16x32_bf16 v[104:107], a[56:59], v[44:47], v[104:107]
    v_mfma_f32_16x16x32_bf16 v[108:111], a[60:63], v[44:47], v[108:111]
    ds_read_b128 v[36:39], v114 offset:14336
    s_waitcnt lgkmcnt(5)
    v_mfma_f32_16x16x32_bf16 v[80:83], a[64:67], v[16:19], v[80:83]
    v_mfma_f32_16x16x32_bf16 v[84:87], a[68:71], v[16:19], v[84:87]
    v_mfma_f32_16x16x32_bf16 v[96:99], a[72:75], v[16:19], v[96:99]
    v_cvt_pk_bf16_f32 v72, v72, v73
    v_cvt_pk_bf16_f32 v73, v74, v75
    v_mfma_f32_16x16x32_bf16 v[100:103], a[76:79], v[16:19], v[100:103]
    ds_read_b128 v[40:43], v115 offset:12288
    s_waitcnt lgkmcnt(5)
    v_mfma_f32_16x16x32_bf16 v[88:91], a[64:67], v[20:23], v[88:91]
    v_cvt_pk_bf16_f32 v74, v76, v77
    v_cvt_pk_bf16_f32 v75, v78, v79
    v_mfma_f32_16x16x32_bf16 v[92:95], a[68:71], v[20:23], v[92:95]
    s_add_u32 s48, s53, s39
    buffer_store_dwordx4 v[72:75], v4, s[24:27], s48 offen sc1
    v_mfma_f32_16x16x32_bf16 v[104:107], a[72:75], v[20:23], v[104:107]
    v_mfma_f32_16x16x32_bf16 v[108:111], a[76:79], v[20:23], v[108:111]
    ds_read_b128 v[44:47], v115 offset:14336
    s_waitcnt lgkmcnt(5)
    v_mfma_f32_16x16x32_bf16 v[80:83], a[80:83], v[24:27], v[80:83]
    v_mfma_f32_16x16x32_bf16 v[84:87], a[84:87], v[24:27], v[84:87]
    v_mfma_f32_16x16x32_bf16 v[96:99], a[88:91], v[24:27], v[96:99]
    v_mfma_f32_16x16x32_bf16 v[100:103], a[92:95], v[24:27], v[100:103]
    ds_read_b128 v[16:19], v114 offset:16384
    s_waitcnt lgkmcnt(5)
    v_mfma_f32_16x16x32_bf16 v[88:91], a[80:83], v[28:31], v[88:91]
    v_mfma_f32_16x16x32_bf16 v[92:95], a[84:87], v[28:31], v[92:95]
    s_sub_u32 s47, s49, 40960
    s_cselect_b32 s52, 81920, s47
    s_add_u32 s47, s44, 2
    v_mfma_f32_16x16x32_bf16 v[104:107], a[88:91], v[28:31], v[104:107]
    s_sub_u32 s45, s33, 1
    s_min_u32 s45, s45, s47
    v_mfma_f32_16x16x32_bf16 v[108:111], a[92:95], v[28:31], v[108:111]
    ds_read_b128 v[20:23], v114 offset:18432
    s_waitcnt lgkmcnt(5)
    v_mfma_f32_16x16x32_bf16 v[80:83], a[96:99], v[32:35], v[80:83]
    s_mul_i32 s45, s45, 40960
    s_add_u32 s45, s45, s50
    v_mfma_f32_16x16x32_bf16 v[84:87], a[100:103], v[32:35], v[84:87]
    s_add_u32 s46, s52, s51
    s_sub_u32 s48, s44, s32
    v_mfma_f32_16x16x32_bf16 v[96:99], a[104:107], v[32:35], v[96:99]
    s_mul_i32 s48, s48, s35
    s_add_u32 s53, s48, s34
    v_mfma_f32_16x16x32_bf16 v[100:103], a[108:111], v[32:35], v[100:103]
    ds_read_b128 v[24:27], v115 offset:16384
    s_waitcnt lgkmcnt(5)
    v_mfma_f32_16x16x32_bf16 v[88:91], a[96:99], v[36:39], v[88:91]
    s_add_u32 s49, s49, 40960
    s_cmp_eq_u32 s49, 122880
    s_cselect_b32 s49, 0, s49
    v_mfma_f32_16x16x32_bf16 v[92:95], a[100:103], v[36:39], v[92:95]
    v_add_u32 v112, s49, v15
    v_xor_b32 v113, 64, v112
    v_mfma_f32_16x16x32_bf16 v[104:107], a[104:107], v[36:39], v[104:107]
    s_sub_u32 s48, s33, 1
    s_add_u32 s59, s44, 4
    v_mfma_f32_16x16x32_bf16 v[108:111], a[108:111], v[36:39], v[108:111]
    ds_read_b128 v[28:31], v115 offset:18432
    s_waitcnt lgkmcnt(5)
    v_mfma_f32_16x16x32_bf16 v[80:83], a[112:115], v[40:43], v[80:83]
    s_min_u32 s48, s48, s59
    s_mul_i32 s48, s48, 40960
    v_mfma_f32_16x16x32_bf16 v[84:87], a[116:119], v[40:43], v[84:87]
    s_add_u32 s59, s48, s31
    v_mfma_f32_16x16x32_bf16 v[96:99], a[120:123], v[40:43], v[96:99]
    v_mfma_f32_16x16x32_bf16 v[100:103], a[124:127], v[40:43], v[100:103]
    ds_read_b128 v[32:35], v114 offset:20480
    s_waitcnt lgkmcnt(5)
    v_mfma_f32_16x16x32_bf16 v[88:91], a[112:115], v[44:47], v[88:91]
    v_mfma_f32_16x16x32_bf16 v[92:95], a[116:119], v[44:47], v[92:95]
    v_mfma_f32_16x16x32_bf16 v[104:107], a[120:123], v[44:47], v[104:107]
    v_mfma_f32_16x16x32_bf16 v[108:111], a[124:127], v[44:47], v[108:111]
    ds_read_b128 v[36:39], v114 offset:22528
    s_waitcnt lgkmcnt(5)
    v_mfma_f32_16x16x32_bf16 v[80:83], a[128:131], v[16:19], v[80:83]
    v_mfma_f32_16x16x32_bf16 v[84:87], a[132:135], v[16:19], v[84:87]
    v_mfma_f32_16x16x32_bf16 v[96:99], a[136:139], v[16:19], v[96:99]
    v_mfma_f32_16x16x32_bf16 v[100:103], a[140:143], v[16:19], v[100:103]
    ds_read_b128 v[40:43], v115 offset:20480
    s_waitcnt lgkmcnt(5)
    v_mfma_f32_16x16x32_bf16 v[88:91], a[128:131], v[20:23], v[88:91]
    v_mfma_f32_16x16x32_bf16 v[92:95], a[132:135], v[20:23], v[92:95]
    v_mfma_f32_16x16x32_bf16 v[104:107], a[136:139], v[20:23], v[104:107]
    v_mfma_f32_16x16x32_bf16 v[108:111], a[140:143], v[20:23], v[108:111]
    ds_read_b128 v[44:47], v115 offset:22528
    s_waitcnt lgkmcnt(5)
    v_mfma_f32_16x16x32_bf16 v[80:83], a[144:147], v[24:27], v[80:83]
    v_mfma_f32_16x16x32_bf16 v[84:87], a[148:151], v[24:27], v[84:87]
    v_mfma_f32_16x16x32_bf16 v[96:99], a[152:155], v[24:27], v[96:99]
    v_mfma_f32_16x16x32_bf16 v[100:103], a[156:159], v[24:27], v[100:103]
    ds_read_b128 v[16:19], v114 offset:24576
    s_waitcnt lgkmcnt(5)
    v_mfma_f32_16x16x32_bf16 v[88:91], a[144:147], v[28:31], v[88:91]
    v_mfma_f32_16x16x32_bf16 v[92:95], a[148:151], v[28:31], v[92:95]
    v_mfma_f32_16x16x32_bf16 v[104:107], a[152:155], v[28:31], v[104:107]
    v_mfma_f32_16x16x32_bf16 v[108:111], a[156:159], v[28:31], v[108:111]
    ds_read_b128 v[20:23], v114 offset:26624
    s_waitcnt lgkmcnt(5)
    v_mfma_f32_16x16x32_bf16 v[80:83], a[160:163], v[32:35], v[80:83]
    v_mfma_f32_16x16x32_bf16 v[84:87], a[164:167], v[32:35], v[84:87]
    v_mfma_f32_16x16x32_bf16 v[96:99], a[168:171], v[32:35], v[96:99]
    v_mfma_f32_16x16x32_bf16 v[100:103], a[172:175], v[32:35], v[100:103]
    ds_read_b128 v[24:27], v115 offset:24576
    s_waitcnt lgkmcnt(5)
    v_mfma_f32_16x16x32_bf16 v[88:91], a[160:163], v[36:39], v[88:91]
    v_mfma_f32_16x16x32_bf16 v[92:95], a[164:167], v[36:39], v[92:95]
    v_mfma_f32_16x16x32_bf16 v[104:107], a[168:171], v[36:39], v[104:107]
    v_mfma_f32_16x16x32_bf16 v[108:111], a[172:175], v[36:39], v[108:111]
    ds_read_b128 v[28:31], v115 offset:26624
    s_waitcnt lgkmcnt(5)
    v_mfma_f32_16x16x32_bf16 v[80:83], a[176:179], v[40:43], v[80:83]
    v_mfma_f32_16x16x32_bf16 v[84:87], a[180:183], v[40:43], v[84:87]
    v_mfma_f32_16x16x32_bf16 v[96:99], a[184:187], v[40:43], v[96:99]
    v_mfma_f32_16x16x32_bf16 v[100:103], a[188:191], v[40:43], v[100:103]
    ds_read_b128 v[32:35], v114 offset:28672
    s_waitcnt lgkmcnt(5)
    v_mfma_f32_16x16x32_bf16 v[88:91], a[176:179], v[44:47], v[88:91]
    v_mfma_f32_16x16x32_bf16 v[92:95], a[180:183], v[44:47], v[92:95]
    v_mfma_f32_16x16x32_bf16 v[104:107], a[184:187], v[44:47], v[104:107]
    v_mfma_f32_16x16x32_bf16 v[108:111], a[188:191], v[44:47], v[108:111]
    ds_read_b128 v[36:39], v114 offset:30720
    s_waitcnt lgkmcnt(5)
    v_mfma_f32_16x16x32_bf16 v[80:83], a[192:195], v[16:19], v[80:83]
    v_mfma_f32_16x16x32_bf16 v[84:87], a[196:199], v[16:19], v[84:87]
    v_mfma_f32_16x16x32_bf16 v[96:99], a[200:203], v[16:19], v[96:99]
    v_mfma_f32_16x16x32_bf16 v[100:103], a[204:207], v[16:19], v[100:103]
    ds_read_b128 v[40:43], v115 offset:28672
    s_waitcnt lgkmcnt(5)
    v_mfma_f32_16x16x32_bf16 v[88:91], a[192:195], v[20:23], v[88:91]
    v_mfma_f32_16x16x32_bf16 v[92:95], a[196:199], v[20:23], v[92:95]
    v_mfma_f32_16x16x32_bf16 v[104:107], a[200:203], v[20:23], v[104:107]
    v_mfma_f32_16x16x32_bf16 v[108:111], a[204:207], v[20:23], v[108:111]
    ds_read_b128 v[44:47], v115 offset:30720
    s_waitcnt lgkmcnt(5)
    v_mfma_f32_16x16x32_bf16 v[80:83], a[208:211], v[24:27], v[80:83]
    s_waitcnt vmcnt(0)
    s_barrier
    v_mfma_f32_16x16x32_bf16 v[84:87], a[212:215], v[24:27], v[84:87]
    v_mov_b32 v10, s44
    buffer_store_dword v10, v5, s[4:7], s40 offen sc1
    v_mfma_f32_16x16x32_bf16 v[96:99], a[216:219], v[24:27], v[96:99]
    s_add_u32 s44, s44, 1
    v_mfma_f32_16x16x32_bf16 v[100:103], a[220:223], v[24:27], v[100:103]
    ds_read_b128 v[16:19], v114 offset:32768
    s_waitcnt lgkmcnt(5)
    v_mfma_f32_16x16x32_bf16 v[88:91], a[208:211], v[28:31], v[88:91]
    s_add_u32 m0, s46, 0
    v_mfma_f32_16x16x32_bf16 v[92:95], a[212:215], v[28:31], v[92:95]
    buffer_load_dwordx4 v3, s[20:23], s45 offen offset:0 sc1 lds
    v_mfma_f32_16x16x32_bf16 v[104:107], a[216:219], v[28:31], v[104:107]
    v_mfma_f32_16x16x32_bf16 v[108:111], a[220:223], v[28:31], v[108:111]
    ds_read_b128 v[20:23], v114 offset:34816
    s_waitcnt lgkmcnt(5)
    v_mfma_f32_16x16x32_bf16 v[80:83], a[224:227], v[32:35], v[80:83]
    s_add_u32 m0, s46, 3968
    v_mfma_f32_16x16x32_bf16 v[84:87], a[228:231], v[32:35], v[84:87]
    buffer_load_dwordx4 v3, s[20:23], s45 offen offset:128 sc1 lds
    v_mfma_f32_16x16x32_bf16 v[96:99], a[232:235], v[32:35], v[96:99]
    v_mfma_f32_16x16x32_bf16 v[100:103], a[236:239], v[32:35], v[100:103]
    ds_read_b128 v[24:27], v115 offset:32768
    s_waitcnt lgkmcnt(5)
    v_mfma_f32_16x16x32_bf16 v[88:91], a[224:227], v[36:39], v[88:91]
    s_add_u32 m0, s46, 7936
    v_mfma_f32_16x16x32_bf16 v[92:95], a[228:231], v[36:39], v[92:95]
    buffer_load_dwordx4 v3, s[20:23], s45 offen offset:256 sc1 lds
    v_mfma_f32_16x16x32_bf16 v[104:107], a[232:235], v[36:39], v[104:107]
    v_mfma_f32_16x16x32_bf16 v[108:111], a[236:239], v[36:39], v[108:111]
    ds_read_b128 v[28:31], v115 offset:34816
    s_waitcnt lgkmcnt(5)
    v_mfma_f32_16x16x32_bf16 v[80:83], a[240:243], v[40:43], v[80:83]
    s_add_u32 m0, s46, 11904
    v_mfma_f32_16x16x32_bf16 v[84:87], a[244:247], v[40:43], v[84:87]
    buffer_load_dwordx4 v3, s[20:23], s45 offen offset:384 sc1 lds
    v_mfma_f32_16x16x32_bf16 v[96:99], a[248:251], v[40:43], v[96:99]
    v_mfma_f32_16x16x32_bf16 v[100:103], a[252:255], v[40:43], v[100:103]
    ds_read_b128 v[32:35], v114 offset:36864
    s_waitcnt lgkmcnt(5)
    v_mfma_f32_16x16x32_bf16 v[88:91], a[240:243], v[44:47], v[88:91]
    s_add_u32 m0, s46, 15872
    v_mfma_f32_16x16x32_bf16 v[92:95], a[244:247], v[44:47], v[92:95]
    buffer_load_dwordx4 v3, s[20:23], s45 offen offset:512 sc1 lds
    v_mfma_f32_16x16x32_bf16 v[104:107], a[248:251], v[44:47], v[104:107]
    v_mfma_f32_16x16x32_bf16 v[108:111], a[252:255], v[44:47], v[108:111]
    ds_read_b128 v[36:39], v114 offset:38912
    s_waitcnt lgkmcnt(5)
    v_mfma_f32_16x16x32_bf16 v[80:83], v[192:195], v[16:19], v[80:83]
    s_add_u32 m0, s46, 19840
    v_mfma_f32_16x16x32_bf16 v[84:87], v[196:199], v[16:19], v[84:87]
    buffer_load_dwordx4 v3, s[20:23], s45 offen offset:640 sc1 lds
    v_mfma_f32_16x16x32_bf16 v[96:99], v[200:203], v[16:19], v[96:99]
    v_mfma_f32_16x16x32_bf16 v[100:103], v[204:207], v[16:19], v[100:103]
    ds_read_b128 v[40:43], v115 offset:36864
    s_waitcnt lgkmcnt(5)
    v_mfma_f32_16x16x32_bf16 v[88:91], v[192:195], v[20:23], v[88:91]
    s_add_u32 m0, s46, 23808
    v_mfma_f32_16x16x32_bf16 v[92:95], v[196:199], v[20:23], v[92:95]
    buffer_load_dwordx4 v3, s[20:23], s45 offen offset:768 sc1 lds
    v_mfma_f32_16x16x32_bf16 v[104:107], v[200:203], v[20:23], v[104:107]
    v_mfma_f32_16x16x32_bf16 v[108:111], v[204:207], v[20:23], v[108:111]
    ds_read_b128 v[44:47], v115 offset:38912
    s_waitcnt lgkmcnt(5)
    v_mfma_f32_16x16x32_bf16 v[80:83], v[208:211], v[24:27], v[80:83]
    s_add_u32 m0, s46, 27776
    v_mfma_f32_16x16x32_bf16 v[84:87], v[212:215], v[24:27], v[84:87]
    buffer_load_dwordx4 v3, s[20:23], s45 offen offset:896 sc1 lds
    v_mfma_f32_16x16x32_bf16 v[96:99], v[216:219], v[24:27], v[96:99]
    v_mfma_f32_16x16x32_bf16 v[100:103], v[220:223], v[24:27], v[100:103]
    ds_read_b128 v[16:19], v112 offset:0
    s_waitcnt lgkmcnt(5)
    v_mfma_f32_16x16x32_bf16 v[88:91], v[208:211], v[28:31], v[88:91]
    s_add_u32 m0, s46, 31744
    v_mfma_f32_16x16x32_bf16 v[92:95], v[212:215], v[28:31], v[92:95]
    buffer_load_dwordx4 v3, s[20:23], s45 offen offset:1024 sc1 lds
    v_mfma_f32_16x16x32_bf16 v[104:107], v[216:219], v[28:31], v[104:107]
    v_mfma_f32_16x16x32_bf16 v[108:111], v[220:223], v[28:31], v[108:111]
    ds_read_b128 v[20:23], v112 offset:2048
    s_waitcnt lgkmcnt(5)
    v_mfma_f32_16x16x32_bf16 v[80:83], v[224:227], v[32:35], v[80:83]
    s_add_u32 m0, s46, 35712
    v_mfma_f32_16x16x32_bf16 v[84:87], v[228:231], v[32:35], v[84:87]
    buffer_load_dwordx4 v3, s[20:23], s45 offen offset:1152 sc1 lds
    v_mfma_f32_16x16x32_bf16 v[96:99], v[232:235], v[32:35], v[96:99]
    v_mfma_f32_16x16x32_bf16 v[100:103], v[236:239], v[32:35], v[100:103]
    ds_read_b128 v[24:27], v113 offset:0
    s_waitcnt lgkmcnt(5)
    v_mfma_f32_16x16x32_bf16 v[88:91], v[224:227], v[36:39], v[88:91]
    buffer_load_dword v117, v116, s[20:23], s59 offen sc1
    v_mfma_f32_16x16x32_bf16 v[92:95], v[228:231], v[36:39], v[92:95]
    v_mfma_f32_16x16x32_bf16 v[104:107], v[232:235], v[36:39], v[104:107]
    v_mfma_f32_16x16x32_bf16 v[108:111], v[236:239], v[36:39], v[108:111]
    ds_read_b128 v[28:31], v113 offset:2048
    s_waitcnt lgkmcnt(5)
    v_mfma_f32_16x16x32_bf16 v[80:83], v[240:243], v[40:43], v[80:83]
    v_mfma_f32_16x16x32_bf16 v[84:87], v[244:247], v[40:43], v[84:87]
    v_mfma_f32_16x16x32_bf16 v[96:99], v[248:251], v[40:43], v[96:99]
    v_mfma_f32_16x16x32_bf16 v[100:103], v[252:255], v[40:43], v[100:103]
    ds_read_b128 v[32:35], v112 offset:4096
    s_waitcnt lgkmcnt(5)
    v_mfma_f32_16x16x32_bf16 v[88:91], v[240:243], v[44:47], v[88:91]
    v_mfma_f32_16x16x32_bf16 v[92:95], v[244:247], v[44:47], v[92:95]
    v_mfma_f32_16x16x32_bf16 v[104:107], v[248:251], v[44:47], v[104:107]
    s_cmp_lt_u32 s44, s33
    v_mfma_f32_16x16x32_bf16 v[108:111], v[252:255], v[44:47], v[108:111]
    ds_read_b128 v[36:39], v112 offset:6144
    s_cbranch_scc1 Lg_K0
Lg_Ke1:
    v_cvt_pk_bf16_f32 v80, v80, v81
    v_cvt_pk_bf16_f32 v81, v82, v83
    v_cvt_pk_bf16_f32 v82, v84, v85
    v_cvt_pk_bf16_f32 v83, v86, v87
    s_add_u32 s48, s53, s36
    buffer_store_dwordx4 v[80:83], v4, s[24:27], s48 offen sc1
    v_cvt_pk_bf16_f32 v88, v88, v89
    v_cvt_pk_bf16_f32 v89, v90, v91
    v_cvt_pk_bf16_f32 v90, v92, v93
    v_cvt_pk_bf16_f32 v91, v94, v95
    s_add_u32 s48, s53, s37
    buffer_store_dwordx4 v[88:91], v4, s[24:27], s48 offen sc1
    v_cvt_pk_bf16_f32 v96, v96, v97
    v_cvt_pk_bf16_f32 v97, v98, v99
    v_cvt_pk_bf16_f32 v98, v100, v101
    v_cvt_pk_bf16_f32 v99, v102, v103
    s_add_u32 s48, s53, s38
    buffer_store_dwordx4 v[96:99], v4, s[24:27], s48 offen sc1
    v_cvt_pk_bf16_f32 v104, v104, v105
    v_cvt_pk_bf16_f32 v105, v106, v107
    v_cvt_pk_bf16_f32 v106, v108, v109
    v_cvt_pk_bf16_f32 v107, v110, v111
    s_add_u32 s48, s53, s39
    buffer_store_dwordx4 v[104:107], v4, s[24:27], s48 offen sc1
    s_branch Lg_end
Lg_Ke0:
    v_cvt_pk_bf16_f32 v48, v48, v49
    v_cvt_pk_bf16_f32 v49, v50, v51
    v_cvt_pk_bf16_f32 v50, v52, v53
    v_cvt_pk_bf16_f32 v51, v54, v55
    s_add_u32 s48, s53, s36
    buffer_store_dwordx4 v[48:51], v4, s[24:27], s48 offen sc1
    v_cvt_pk_bf16_f32 v56, v56, v57
    v_cvt_pk_bf16_f32 v57, v58, v59
    v_cvt_pk_bf16_f32 v58, v60, v61
    v_cvt_pk_bf16_f32 v59, v62, v63
    s_add_u32 s48, s53, s37
    buffer_store_dwordx4 v[56:59], v4, s[24:27], s48 offen sc1
    v_cvt_pk_bf16_f32 v64, v64, v65
    v_cvt_pk_bf16_f32 v65, v66, v67
    v_cvt_pk_bf16_f32 v66, v68, v69
    v_cvt_pk_bf16_f32 v67, v70, v71
    s_add_u32 s48, s53, s38
    buffer_store_dwordx4 v[64:67], v4, s[24:27], s48 offen sc1
    v_cvt_pk_bf16_f32 v72, v72, v73
    v_cvt_pk_bf16_f32 v73, v74, v75
    v_cvt_pk_bf16_f32 v74, v76, v77
    v_cvt_pk_bf16_f32 v75, v78, v79
    s_add_u32 s48, s53, s39
    buffer_store_dwordx4 v[72:75], v4, s[24:27], s48 offen sc1
    s_branch Lg_end
Lg_Vf:
    v_cvt_pk_bf16_f32 v48, v48, v49
    v_cvt_pk_bf16_f32 v49, v50, v51
    v_cvt_pk_bf16_f32 v50, v52, v53
    v_cvt_pk_bf16_f32 v51, v54, v55
    s_add_u32 s48, s53, s36
    buffer_store_dwordx4 v[48:51], v4, s[24:27], s48 offen sc1
    v_cvt_pk_bf16_f32 v56, v56, v57
    v_cvt_pk_bf16_f32 v57, v58, v59
    v_cvt_pk_bf16_f32 v58, v60, v61
    v_cvt_pk_bf16_f32 v59, v62, v63
    s_add_u32 s48, s53, s37
    buffer_store_dwordx4 v[56:59], v4, s[24:27], s48 offen sc1
    v_cvt_pk_bf16_f32 v64, v64, v65
    v_cvt_pk_bf16_f32 v65, v66, v67
    v_cvt_pk_bf16_f32 v66, v68, v69
    v_cvt_pk_bf16_f32 v67, v70, v71
    s_add_u32 s48, s53, s38
    buffer_store_dwordx4 v[64:67], v4, s[24:27], s48 offen sc1
    v_cvt_pk_bf16_f32 v72, v72, v73
    v_cvt_pk_bf16_f32 v73, v74, v75
    v_cvt_pk_bf16_f32 v74, v76, v77
    v_cvt_pk_bf16_f32 v75, v78, v79
    s_add_u32 s48, s53, s39
    buffer_store_dwordx4 v[72:75], v4, s[24:27], s48 offen sc1
    s_add_u32 s53, s53, s35
    v_cvt_pk_bf16_f32 v80, v80, v81
    v_cvt_pk_bf16_f32 v81, v82, v83
    v_cvt_pk_bf16_f32 v82, v84, v85
    v_cvt_pk_bf16_f32 v83, v86, v87
    s_add_u32 s48, s53, s36
    buffer_store_dwordx4 v[80:83], v4, s[24:27], s48 offen sc1
    v_cvt_pk_bf16_f32 v88, v88, v89
    v_cvt_pk_bf16_f32 v89, v90, v91
    v_cvt_pk_bf16_f32 v90, v92, v93
    v_cvt_pk_bf16_f32 v91, v94, v95
    s_add_u32 s48, s53, s37
    buffer_store_dwordx4 v[88:91], v4, s[24:27], s48 offen sc1
    v_cvt_pk_bf16_f32 v96, v96, v97
    v_cvt_pk_bf16_f32 v97, v98, v99
    v_cvt_pk_bf16_f32 v98, v100, v101
    v_cvt_pk_bf16_f32 v99, v102, v103
    s_add_u32 s48, s53, s38
    buffer_store_dwordx4 v[96:99], v4, s[24:27], s48 offen sc1
    v_cvt_pk_bf16_f32 v104, v104, v105
    v_cvt_pk_bf16_f32 v105, v106, v107
    v_cvt_pk_bf16_f32 v106, v108, v109
    v_cvt_pk_bf16_f32 v107, v110, v111
    s_add_u32 s48, s53, s39
    buffer_store_dwordx4 v[104:107], v4, s[24:27], s48 offen sc1
    s_add_u32 s44, s44, 2
    s_mov_b32 s49, 81920
    s_barrier
    s_sub_u32 s45, s33, 1
    s_min_u32 s45, s45, s44
    s_mul_i32 s45, s45, 40960
    s_add_u32 s45, s45, s50
    s_add_u32 s46, s49, s51
    s_add_u32 m0, s46, 0
    s_nop 0
    buffer_load_dwordx4 v3, s[20:23], s45 offen offset:0 sc1 lds
    s_add_u32 m0, s46, 3968
    s_nop 0
    buffer_load_dwordx4 v3, s[20:23], s45 offen offset:128 sc1 lds
    s_add_u32 m0, s46, 7936
    s_nop 0
    buffer_load_dwordx4 v3, s[20:23], s45 offen offset:256 sc1 lds
    s_add_u32 m0, s46, 11904
    s_nop 0
    buffer_load_dwordx4 v3, s[20:23], s45 offen offset:384 sc1 lds
    s_add_u32 m0, s46, 15872
    s_nop 0
    buffer_load_dwordx4 v3, s[20:23], s45 offen offset:512 sc1 lds
    s_add_u32 m0, s46, 19840
    s_nop 0
    buffer_load_dwordx4 v3, s[20:23], s45 offen offset:640 sc1 lds
    s_add_u32 m0, s46, 23808
    s_nop 0
    buffer_load_dwordx4 v3, s[20:23], s45 offen offset:768 sc1 lds
    s_add_u32 m0, s46, 27776
    s_nop 0
    buffer_load_dwordx4 v3, s[20:23], s45 offen offset:896 sc1 lds
    s_add_u32 m0, s46, 31744
    s_nop 0
    buffer_load_dwordx4 v3, s[20:23], s45 offen offset:1024 sc1 lds
    s_add_u32 m0, s46, 35712
    s_nop 0
    buffer_load_dwordx4 v3, s[20:23], s45 offen offset:1152 sc1 lds
    s_waitcnt vmcnt(10)
    v_mov_b32 v10, s44
    buffer_store_dword v10, v5, s[4:7], s40 offen sc1
    s_add_u32 s47, s44, 1
    s_mov_b32 s48, 0
    s_sub_u32 s45, s33, 1
    s_min_u32 s45, s45, s47
    s_mul_i32 s45, s45, 40960
    s_add_u32 s45, s45, s50
    s_add_u32 s46, s48, s51
    s_add_u32 m0, s46, 0
    s_nop 0
    buffer_load_dwordx4 v3, s[20:23], s45 offen offset:0 sc1 lds
    s_add_u32 m0, s46, 3968
    s_nop 0
    buffer_load_dwordx4 v3, s[20:23], s45 offen offset:128 sc1 lds
    s_add_u32 m0, s46, 7936
    s_nop 0
    buffer_load_dwordx4 v3, s[20:23], s45 offen offset:256 sc1 lds
    s_add_u32 m0, s46, 11904
    s_nop 0
    buffer_load_dwordx4 v3, s[20:23], s45 offen offset:384 sc1 lds
    s_add_u32 m0, s46, 15872
    s_nop 0
    buffer_load_dwordx4 v3, s[20:23], s45 offen offset:512 sc1 lds
    s_add_u32 m0, s46, 19840
    s_nop 0
    buffer_load_dwordx4 v3, s[20:23], s45 offen offset:640 sc1 lds
    s_add_u32 m0, s46, 23808
    s_nop 0
    buffer_load_dwordx4 v3, s[20:23], s45 offen offset:768 sc1 lds
    s_add_u32 m0, s46, 27776
    s_nop 0
    buffer_load_dwordx4 v3, s[20:23], s45 offen offset:896 sc1 lds
    s_add_u32 m0, s46, 31744
    s_nop 0
    buffer_load_dwordx4 v3, s[20:23], s45 offen offset:1024 sc1 lds
    s_add_u32 m0, s46, 35712
    s_nop 0
    buffer_load_dwordx4 v3, s[20:23], s45 offen offset:1152 sc1 lds
    s_waitcnt vmcnt(11)
Lg_Vp:
    s_mov_b32 s53, 1073741824
    v_add_u32 v112, s49, v15
    v_xor_b32 v113, 64, v112
    s_barrier
    ds_read_b128 v[16:19], v112 offset:0
    ds_read_b128 v[20:23], v112 offset:2048
    ds_read_b128 v[24:27], v113 offset:0
    ds_read_b128 v[28:31], v113 offset:2048
    ds_read_b128 v[32:35], v112 offset:4096
    ds_read_b128 v[36:39], v112 offset:6144
Lg_V0:
    s_waitcnt lgkmcnt(5)
    v_mfma_f32_16x16x32_bf16 v[48:51], v[16:19], a[0:3], 0
    v_mfma_f32_16x16x32_bf16 v[56:59], v[16:19], a[4:7], 0
    v_mfma_f32_16x16x32_bf16 v[64:67], v[16:19], a[8:11], 0
    v_cvt_pk_bf16_f32 v80, v80, v81
    v_cvt_pk_bf16_f32 v81, v82, v83
    v_mfma_f32_16x16x32_bf16 v[72:75], v[16:19], a[12:15], 0
    ds_read_b128 v[40:43], v113 offset:4096
    s_waitcnt lgkmcnt(5)
    v_mfma_f32_16x16x32_bf16 v[52:55], v[20:23], a[0:3], 0
    v_cvt_pk_bf16_f32 v82, v84, v85
    v_cvt_pk_bf16_f32 v83, v86, v87
    v_mfma_f32_16x16x32_bf16 v[60:63], v[20:23], a[4:7], 0
    s_add_u32 s48, s53, s36
    buffer_store_dwordx4 v[80:83], v4, s[24:27], s48 offen sc1
    v_mfma_f32_16x16x32_bf16 v[68:71], v[20:23], a[8:11], 0
    v_mfma_f32_16x16x32_bf16 v[76:79], v[20:23], a[12:15], 0
    ds_read_b128 v[44:47], v113 offset:6144
    s_waitcnt lgkmcnt(5)
    v_mfma_f32_16x16x32_bf16 v[48:51], v[24:27], a[16:19], v[48:51]
    v_mfma_f32_16x16x32_bf16 v[56:59], v[24:27], a[20:23], v[56:59]
    v_mfma_f32_16x16x32_bf16 v[64:67], v[24:27], a[24:27], v[64:67]
    v_mfma_f32_16x16x32_bf16 v[72:75], v[24:27], a[28:31], v[72:75]
    ds_read_b128 v[16:19], v112 offset:8192
    s_waitcnt lgkmcnt(5)
    v_mfma_f32_16x16x32_bf16 v[52:55], v[28:31], a[16:19], v[52:55]
    v_mfma_f32_16x16x32_bf16 v[60:63], v[28:31], a[20:23], v[60:63]
    v_cvt_pk_bf16_f32 v88, v88, v89
    v_cvt_pk_bf16_f32 v89, v90, v91
    v_mfma_f32_16x16x32_bf16 v[68:71], v[28:31], a[24:27], v[68:71]
    v_cvt_pk_bf16_f32 v90, v92, v93
    v_cvt_pk_bf16_f32 v91, v94, v95
    v_mfma_f32_16x16x32_bf16 v[76:79], v[28:31], a[28:31], v[76:79]
    ds_read_b128 v[20:23], v112 offset:10240
    s_waitcnt lgkmcnt(5)
    v_mfma_f32_16x16x32_bf16 v[48:51], v[32:35], a[32:35], v[48:51]
    s_add_u32 s48, s53, s37
    buffer_store_dwordx4 v[88:91], v4, s[24:27], s48 offen sc1
    v_mfma_f32_16x16x32_bf16 v[56:59], v[32:35], a[36:39], v[56:59]
    v_mfma_f32_16x16x32_bf16 v[64:67], v[32:35], a[40:43], v[64:67]
    v_mfma_f32_16x16x32_bf16 v[72:75], v[32:35], a[44:47], v[72:75]
    ds_read_b128 v[24:27], v113 offset:8192
    s_waitcnt lgkmcnt(5)
    v_mfma_f32_16x16x32_bf16 v[52:55], v[36:39], a[32:35], v[52:55]
    v_mfma_f32_16x16x32_bf16 v[60:63], v[36:39], a[36:39], v[60:63]
    v_mfma_f32_16x16x32_bf16 v[68:71], v[36:39], a[40:43], v[68:71]
    v_mfma_f32_16x16x32_bf16 v[76:79], v[36:39], a[44:47], v[76:79]
    ds_read_b128 v[28:31], v113 offset:10240
    s_waitcnt lgkmcnt(5)
    v_mfma_f32_16x16x32_bf16 v[48:51], v[40:43], a[48:51], v[48:51]
    v_cvt_pk_bf16_f32 v96, v96, v97
    v_cvt_pk_bf16_f32 v97, v98, v99
    v_mfma_f32_16x16x32_bf16 v[56:59], v[40:43], a[52:55], v[56:59]
    v_cvt_pk_bf16_f32 v98, v100, v101
    v_cvt_pk_bf16_f32 v99, v102, v103
    v_mfma_f32_16x16x32_bf16 v[64:67], v[40:43], a[56:59], v[64:67]
    s_add_u32 s48, s53, s38
    buffer_store_dwordx4 v[96:99], v4, s[24:27], s48 offen sc1
    v_mfma_f32_16x16x32_bf16 v[72:75], v[40:43], a[60:63], v[72:75]
    ds_read_b128 v[32:35], v112 offset:12288
    s_waitcnt lgkmcnt(5)
    v_mfma_f32_16x16x32_bf16 v[52:55], v[44:47], a[48:51], v[52:55]
    v_mfma_f32_16x16x32_bf16 v[60:63], v[44:47], a[52:55], v[60:63]
    v_mfma_f32_16x16x32_bf16 v[68:71], v[44:47], a[56:59], v[68:71]
    v_mfma_f32_16x16x32_bf16 v[76:79], v[44:47], a[60:63], v[76:79]
    ds_read_b128 v[36:39], v112 offset:14336
    s_waitcnt lgkmcnt(5)
    v_mfma_f32_16x16x32_bf16 v[48:51], v[16:19], a[64:67], v[48:51]
    v_mfma_f32_16x16x32_bf16 v[56:59], v[16:19], a[68:71], v[56:59]
    v_mfma_f32_16x16x32_bf16 v[64:67], v[16:19], a[72:75], v[64:67]
    v_cvt_pk_bf16_f32 v104, v104, v105
    v_cvt_pk_bf16_f32 v105, v106, v107
    v_mfma_f32_16x16x32_bf16 v[72:75], v[16:19], a[76:79], v[72:75]
    ds_read_b128 v[40:43], v113 offset:12288
    s_waitcnt lgkmcnt(5)
    v_mfma_f32_16x16x32_bf16 v[52:55], v[20:23], a[64:67], v[52:55]
    v_cvt_pk_bf16_f32 v106, v108, v109
    v_cvt_pk_bf16_f32 v107, v110, v111
    v_mfma_f32_16x16x32_bf16 v[60:63], v[20:23], a[68:71], v[60:63]
    s_add_u32 s48, s53, s39
    buffer_store_dwordx4 v[104:107], v4, s[24:27], s48 offen sc1
    v_mfma_f32_16x16x32_bf16 v[68:71], v[20:23], a[72:75], v[68:71]
    v_mfma_f32_16x16x32_bf16 v[76:79], v[20:23], a[76:79], v[76:79]
    ds_read_b128 v[44:47], v113 offset:14336
    s_waitcnt lgkmcnt(5)
    v_mfma_f32_16x16x32_bf16 v[48:51], v[24:27], a[80:83], v[48:51]
    v_mfma_f32_16x16x32_bf16 v[56:59], v[24:27], a[84:87], v[56:59]
    v_mfma_f32_16x16x32_bf16 v[64:67], v[24:27], a[88:91], v[64:67]
    v_mfma_f32_16x16x32_bf16 v[72:75], v[24:27], a[92:95], v[72:75]
    ds_read_b128 v[16:19], v112 offset:16384
    s_waitcnt lgkmcnt(5)
    v_mfma_f32_16x16x32_bf16 v[52:55], v[28:31], a[80:83], v[52:55]
    v_mfma_f32_16x16x32_bf16 v[60:63], v[28:31], a[84:87], v[60:63]
    s_sub_u32 s47, s49, 40960
    s_cselect_b32 s52, 81920, s47
    s_add_u32 s47, s44, 2
    v_mfma_f32_16x16x32_bf16 v[68:71], v[28:31], a[88:91], v[68:71]
    s_sub_u32 s45, s33, 1
    s_min_u32 s45, s45, s47
    v_mfma_f32_16x16x32_bf16 v[76:79], v[28:31], a[92:95], v[76:79]
    ds_read_b128 v[20:23], v112 offset:18432
    s_waitcnt lgkmcnt(5)
    v_mfma_f32_16x16x32_bf16 v[48:51], v[32:35], a[96:99], v[48:51]
    s_mul_i32 s45, s45, 40960
    s_add_u32 s45, s45, s50
    v_mfma_f32_16x16x32_bf16 v[56:59], v[32:35], a[100:103], v[56:59]
    s_add_u32 s46, s52, s51
    s_sub_u32 s48, s44, s32
    v_mfma_f32_16x16x32_bf16 v[64:67], v[32:35], a[104:107], v[64:67]
    s_mul_i32 s48, s48, s35
    s_add_u32 s53, s48, s34
    v_mfma_f32_16x16x32_bf16 v[72:75], v[32:35], a[108:111], v[72:75]
    ds_read_b128 v[24:27], v113 offset:16384
    s_waitcnt lgkmcnt(5)
    v_mfma_f32_16x16x32_bf16 v[52:55], v[36:39], a[96:99], v[52:55]
    s_add_u32 s49, s49, 40960
    s_cmp_eq_u32 s49, 122880
    s_cselect_b32 s49, 0, s49
    v_mfma_f32_16x16x32_bf16 v[60:63], v[36:39], a[100:103], v[60:63]
    v_add_u32 v114, s49, v15
    v_xor_b32 v115, 64, v114
    v_mfma_f32_16x16x32_bf16 v[68:71], v[36:39], a[104:107], v[68:71]
    s_sub_u32 s48, s33, 1
    s_add_u32 s59, s44, 4
    v_mfma_f32_16x16x32_bf16 v[76:79], v[36:39], a[108:111], v[76:79]
    ds_read_b128 v[28:31], v113 offset:18432
    s_waitcnt lgkmcnt(5)
    v_mfma_f32_16x16x32_bf16 v[48:51], v[40:43], a[112:115], v[48:51]
    s_min_u32 s48, s48, s59
    s_mul_i32 s48, s48, 40960
    v_mfma_f32_16x16x32_bf16 v[56:59], v[40:43], a[116:119], v[56:59]
    s_add_u32 s59, s48, s31
    v_mfma_f32_16x16x32_bf16 v[64:67], v[40:43], a[120:123], v[64:67]
    v_mfma_f32_16x16x32_bf16 v[72:75], v[40:43], a[124:127], v[72:75]
    ds_read_b128 v[32:35], v112 offset:20480
    s_waitcnt lgkmcnt(5)
    v_mfma_f32_16x16x32_bf16 v[52:55], v[44:47], a[112:115], v[52:55]
    v_mfma_f32_16x16x32_bf16 v[60:63], v[44:47], a[116:119], v[60:63]
    v_mfma_f32_16x16x32_bf16 v[68:71], v[44:47], a[120:123], v[68:71]
    v_mfma_f32_16x16x32_bf16 v[76:79], v[44:47], a[124:127], v[76:79]
    ds_read_b128 v[36:39], v112 offset:22528
    s_waitcnt lgkmcnt(5)
    v_mfma_f32_16x16x32_bf16 v[48:51], v[16:19], a[128:131], v[48:51]
    v_mfma_f32_16x16x32_bf16 v[56:59], v[16:19], a[132:135], v[56:59]
    v_mfma_f32_16x16x32_bf16 v[64:67], v[16:19], a[136:139], v[64:67]
    v_mfma_f32_16x16x32_bf16 v[72:75], v[16:19], a[140:143], v[72:75]
    ds_read_b128 v[40:43], v113 offset:20480
    s_waitcnt lgkmcnt(5)
    v_mfma_f32_16x16x32_bf16 v[52:55], v[20:23], a[128:131], v[52:55]
    v_mfma_f32_16x16x32_bf16 v[60:63], v[20:23], a[132:135], v[60:63]
    v_mfma_f32_16x16x32_bf16 v[68:71], v[20:23], a[136:139], v[68:71]
    v_mfma_f32_16x16x32_bf16 v[76:79], v[20:23], a[140:143], v[76:79]
    ds_read_b128 v[44:47], v113 offset:22528
    s_waitcnt lgkmcnt(5)
    v_mfma_f32_16x16x32_bf16 v[48:51], v[24:27], a[144:147], v[48:51]
    v_mfma_f32_16x16x32_bf16 v[56:59], v[24:27], a[148:151], v[56:59]
    v_mfma_f32_16x16x32_bf16 v[64:67], v[24:27], a[152:155], v[64:67]
    v_mfma_f32_16x16x32_bf16 v[72:75], v[24:27], a[156:159], v[72:75]
    ds_read_b128 v[16:19], v112 offset:24576
    s_waitcnt lgkmcnt(5)
    v_mfma_f32_16x16x32_bf16 v[52:55], v[28:31], a[144:147], v[52:55]
    v_mfma_f32_16x16x32_bf16 v[60:63], v[28:31], a[148:151], v[60:63]
    v_mfma_f32_16x16x32_bf16 v[68:71], v[28:31], a[152:155], v[68:71]
    v_mfma_f32_16x16x32_bf16 v[76:79], v[28:31], a[156:159], v[76:79]
    ds_read_b128 v[20:23], v112 offset:26624
    s_waitcnt lgkmcnt(5)
    v_mfma_f32_16x16x32_bf16 v[48:51], v[32:35], a[160:163], v[48:51]
    v_mfma_f32_16x16x32_bf16 v[56:59], v[32:35], a[164:167], v[56:59]
    v_mfma_f32_16x16x32_bf16 v[64:67], v[32:35], a[168:171], v[64:67]
    v_mfma_f32_16x16x32_bf16 v[72:75], v[32:35], a[172:175], v[72:75]
    ds_read_b128 v[24:27], v113 offset:24576
    s_waitcnt lgkmcnt(5)
    v_mfma_f32_16x16x32_bf16 v[52:55], v[36:39], a[160:163], v[52:55]
    v_mfma_f32_16x16x32_bf16 v[60:63], v[36:39], a[164:167], v[60:63]
    v_mfma_f32_16x16x32_bf16 v[68:71], v[36:39], a[168:171], v[68:71]
    v_mfma_f32_16x16x32_bf16 v[76:79], v[36:39], a[172:175], v[76:79]
    ds_read_b128 v[28:31], v113 offset:26624
    s_waitcnt lgkmcnt(5)
    v_mfma_f32_16x16x32_bf16 v[48:51], v[40:43], a[176:179], v[48:51]
    v_mfma_f32_16x16x32_bf16 v[56:59], v[40:43], a[180:183], v[56:59]
    v_mfma_f32_16x16x32_bf16 v[64:67], v[40:43], a[184:187], v[64:67]
    v_mfma_f32_16x16x32_bf16 v[72:75], v[40:43], a[188:191], v[72:75]
    ds_read_b128 v[32:35], v112 offset:28672
    s_waitcnt lgkmcnt(5)
    v_mfma_f32_16x16x32_bf16 v[52:55], v[44:47], a[176:179], v[52:55]
    v_mfma_f32_16x16x32_bf16 v[60:63], v[44:47], a[180:183], v[60:63]
    v_mfma_f32_16x16x32_bf16 v[68:71], v[44:47], a[184:187], v[68:71]
    v_mfma_f32_16x16x32_bf16 v[76:79], v[44:47], a[188:191], v[76:79]
    ds_read_b128 v[36:39], v112 offset:30720
    s_waitcnt lgkmcnt(5)
    v_mfma_f32_16x16x32_bf16 v[48:51], v[16:19], a[192:195], v[48:51]
    v_mfma_f32_16x16x32_bf16 v[56:59], v[16:19], a[196:199], v[56:59]
    v_mfma_f32_16x16x32_bf16 v[64:67], v[16:19], a[200:203], v[64:67]
    v_mfma_f32_16x16x32_bf16 v[72:75], v[16:19], a[204:207], v[72:75]
    ds_read_b128 v[40:43], v113 offset:28672
    s_waitcnt lgkmcnt(5)
    v_mfma_f32_16x16x32_bf16 v[52:55], v[20:23], a[192:195], v[52:55]
    v_mfma_f32_16x16x32_bf16 v[60:63], v[20:23], a[196:199], v[60:63]
    v_mfma_f32_16x16x32_bf16 v[68:71], v[20:23], a[200:203], v[68:71]
    v_mfma_f32_16x16x32_bf16 v[76:79], v[20:23], a[204:207], v[76:79]
    ds_read_b128 v[44:47], v113 offset:30720
    s_waitcnt lgkmcnt(5)
    v_mfma_f32_16x16x32_bf16 v[48:51], v[24:27], a[208:211], v[48:51]
    s_waitcnt vmcnt(0)
    s_barrier
    v_mfma_f32_16x16x32_bf16 v[56:59], v[24:27], a[212:215], v[56:59]
    v_mov_b32 v10, s44
    buffer_store_dword v10, v5, s[4:7], s40 offen sc1
    v_mfma_f32_16x16x32_bf16 v[64:67], v[24:27], a[216:219], v[64:67]
    s_add_u32 s44, s44, 1
    v_mfma_f32_16x16x32_bf16 v[72:75], v[24:27], a[220:223], v[72:75]
    ds_read_b128 v[16:19], v112 offset:32768
    s_waitcnt lgkmcnt(5)
    v_mfma_f32_16x16x32_bf16 v[52:55], v[28:31], a[208:211], v[52:55]
    s_add_u32 m0, s46, 0
    v_mfma_f32_16x16x32_bf16 v[60:63], v[28:31], a[212:215], v[60:63]
    buffer_load_dwordx4 v3, s[20:23], s45 offen offset:0 sc1 lds
    v_mfma_f32_16x16x32_bf16 v[68:71], v[28:31], a[216:219], v[68:71]
    v_mfma_f32_16x16x32_bf16 v[76:79], v[28:31], a[220:223], v[76:79]
    ds_read_b128 v[20:23], v112 offset:34816
    s_waitcnt lgkmcnt(5)
    v_mfma_f32_16x16x32_bf16 v[48:51], v[32:35], a[224:227], v[48:51]
    s_add_u32 m0, s46, 3968
    v_mfma_f32_16x16x32_bf16 v[56:59], v[32:35], a[228:231], v[56:59]
    buffer_load_dwordx4 v3, s[20:23], s45 offen offset:128 sc1 lds
    v_mfma_f32_16x16x32_bf16 v[64:67], v[32:35], a[232:235], v[64:67]
    v_mfma_f32_16x16x32_bf16 v[72:75], v[32:35], a[236:239], v[72:75]
    ds_read_b128 v[24:27], v113 offset:32768
    s_waitcnt lgkmcnt(5)
    v_mfma_f32_16x16x32_bf16 v[52:55], v[36:39], a[224:227], v[52:55]
    s_add_u32 m0, s46, 7936
    v_mfma_f32_16x16x32_bf16 v[60:63], v[36:39], a[228:231], v[60:63]
    buffer_load_dwordx4 v3, s[20:23], s45 offen offset:256 sc1 lds
    v_mfma_f32_16x16x32_bf16 v[68:71], v[36:39], a[232:235], v[68:71]
    v_mfma_f32_16x16x32_bf16 v[76:79], v[36:39], a[236:239], v[76:79]
    ds_read_b128 v[28:31], v113 offset:34816
    s_waitcnt lgkmcnt(5)
    v_mfma_f32_16x16x32_bf16 v[48:51], v[40:43], a[240:243], v[48:51]
    s_add_u32 m0, s46, 11904
    v_mfma_f32_16x16x32_bf16 v[56:59], v[40:43], a[244:247], v[56:59]
    buffer_load_dwordx4 v3, s[20:23], s45 offen offset:384 sc1 lds
    v_mfma_f32_16x16x32_bf16 v[64:67], v[40:43], a[248:251], v[64:67]
    v_mfma_f32_16x16x32_bf16 v[72:75], v[40:43], a[252:255], v[72:75]
    ds_read_b128 v[32:35], v112 offset:36864
    s_waitcnt lgkmcnt(5)
    v_mfma_f32_16x16x32_bf16 v[52:55], v[44:47], a[240:243], v[52:55]
    s_add_u32 m0, s46, 15872
    v_mfma_f32_16x16x32_bf16 v[60:63], v[44:47], a[244:247], v[60:63]
    buffer_load_dwordx4 v3, s[20:23], s45 offen offset:512 sc1 lds
    v_mfma_f32_16x16x32_bf16 v[68:71], v[44:47], a[248:251], v[68:71]
    v_mfma_f32_16x16x32_bf16 v[76:79], v[44:47], a[252:255], v[76:79]
    ds_read_b128 v[36:39], v112 offset:38912
    s_waitcnt lgkmcnt(5)
    v_mfma_f32_16x16x32_bf16 v[48:51], v[16:19], v[192:195], v[48:51]
    s_add_u32 m0, s46, 19840
    v_mfma_f32_16x16x32_bf16 v[56:59], v[16:19], v[196:199], v[56:59]
    buffer_load_dwordx4 v3, s[20:23], s45 offen offset:640 sc1 lds
    v_mfma_f32_16x16x32_bf16 v[64:67], v[16:19], v[200:203], v[64:67]
    v_mfma_f32_16x16x32_bf16 v[72:75], v[16:19], v[204:207], v[72:75]
    ds_read_b128 v[40:43], v113 offset:36864
    s_waitcnt lgkmcnt(5)
    v_mfma_f32_16x16x32_bf16 v[52:55], v[20:23], v[192:195], v[52:55]
    s_add_u32 m0, s46, 23808
    v_mfma_f32_16x16x32_bf16 v[60:63], v[20:23], v[196:199], v[60:63]
    buffer_load_dwordx4 v3, s[20:23], s45 offen offset:768 sc1 lds
    v_mfma_f32_16x16x32_bf16 v[68:71], v[20:23], v[200:203], v[68:71]
    v_mfma_f32_16x16x32_bf16 v[76:79], v[20:23], v[204:207], v[76:79]
    ds_read_b128 v[44:47], v113 offset:38912
    s_waitcnt lgkmcnt(5)
    v_mfma_f32_16x16x32_bf16 v[48:51], v[24:27], v[208:211], v[48:51]
    s_add_u32 m0, s46, 27776
    v_mfma_f32_16x16x32_bf16 v[56:59], v[24:27], v[212:215], v[56:59]
    buffer_load_dwordx4 v3, s[20:23], s45 offen offset:896 sc1 lds
    v_mfma_f32_16x16x32_bf16 v[64:67], v[24:27], v[216:219], v[64:67]
    v_mfma_f32_16x16x32_bf16 v[72:75], v[24:27], v[220:223], v[72:75]
    ds_read_b128 v[16:19], v114 offset:0
    s_waitcnt lgkmcnt(5)
    v_mfma_f32_16x16x32_bf16 v[52:55], v[28:31], v[208:211], v[52:55]
    s_add_u32 m0, s46, 31744
    v_mfma_f32_16x16x32_bf16 v[60:63], v[28:31], v[212:215], v[60:63]
    buffer_load_dwordx4 v3, s[20:23], s45 offen offset:1024 sc1 lds
    v_mfma_f32_16x16x32_bf16 v[68:71], v[28:31], v[216:219], v[68:71]
    v_mfma_f32_16x16x32_bf16 v[76:79], v[28:31], v[220:223], v[76:79]
    ds_read_b128 v[20:23], v114 offset:2048
    s_waitcnt lgkmcnt(5)
    v_mfma_f32_16x16x32_bf16 v[48:51], v[32:35], v[224:227], v[48:51]
    s_add_u32 m0, s46, 35712
    v_mfma_f32_16x16x32_bf16 v[56:59], v[32:35], v[228:231], v[56:59]
    buffer_load_dwordx4 v3, s[20:23], s45 offen offset:1152 sc1 lds
    v_mfma_f32_16x16x32_bf16 v[64:67], v[32:35], v[232:235], v[64:67]
    v_mfma_f32_16x16x32_bf16 v[72:75], v[32:35], v[236:239], v[72:75]
    ds_read_b128 v[24:27], v115 offset:0
    s_waitcnt lgkmcnt(5)
    v_mfma_f32_16x16x32_bf16 v[52:55], v[36:39], v[224:227], v[52:55]
    buffer_load_dword v117, v116, s[20:23], s59 offen sc1
    v_mfma_f32_16x16x32_bf16 v[60:63], v[36:39], v[228:231], v[60:63]
    v_mfma_f32_16x16x32_bf16 v[68:71], v[36:39], v[232:235], v[68:71]
    v_mfma_f32_16x16x32_bf16 v[76:79], v[36:39], v[236:239], v[76:79]
    ds_read_b128 v[28:31], v115 offset:2048
    s_waitcnt lgkmcnt(5)
    v_mfma_f32_16x16x32_bf16 v[48:51], v[40:43], v[240:243], v[48:51]
    v_mfma_f32_16x16x32_bf16 v[56:59], v[40:43], v[244:247], v[56:59]
    v_mfma_f32_16x16x32_bf16 v[64:67], v[40:43], v[248:251], v[64:67]
    v_mfma_f32_16x16x32_bf16 v[72:75], v[40:43], v[252:255], v[72:75]
    ds_read_b128 v[32:35], v114 offset:4096
    s_waitcnt lgkmcnt(5)
    v_mfma_f32_16x16x32_bf16 v[52:55], v[44:47], v[240:243], v[52:55]
    v_mfma_f32_16x16x32_bf16 v[60:63], v[44:47], v[244:247], v[60:63]
    v_mfma_f32_16x16x32_bf16 v[68:71], v[44:47], v[248:251], v[68:71]
    s_cmp_lt_u32 s44, s33
    v_mfma_f32_16x16x32_bf16 v[76:79], v[44:47], v[252:255], v[76:79]
    ds_read_b128 v[36:39], v114 offset:6144
    s_cbranch_scc0 Lg_Ve0
Lg_V1:
    s_waitcnt lgkmcnt(5)
    v_mfma_f32_16x16x32_bf16 v[80:83], v[16:19], a[0:3], 0
    v_mfma_f32_16x16x32_bf16 v[88:91], v[16:19], a[4:7], 0
    v_mfma_f32_16x16x32_bf16 v[96:99], v[16:19], a[8:11], 0
    v_cvt_pk_bf16_f32 v48, v48, v49
    v_cvt_pk_bf16_f32 v49, v50, v51
    v_mfma_f32_16x16x32_bf16 v[104:107], v[16:19], a[12:15], 0
    ds_read_b128 v[40:43], v115 offset:4096
    s_waitcnt lgkmcnt(5)
    v_mfma_f32_16x16x32_bf16 v[84:87], v[20:23], a[0:3], 0
    v_cvt_pk_bf16_f32 v50, v52, v53
    v_cvt_pk_bf16_f32 v51, v54, v55
    v_mfma_f32_16x16x32_bf16 v[92:95], v[20:23], a[4:7], 0
    s_add_u32 s48, s53, s36
    buffer_store_dwordx4 v[48:51], v4, s[24:27], s48 offen sc1
    v_mfma_f32_16x16x32_bf16 v[100:103], v[20:23], a[8:11], 0
    v_mfma_f32_16x16x32_bf16 v[108:111], v[20:23], a[12:15], 0
    ds_read_b128 v[44:47], v115 offset:6144
    s_waitcnt lgkmcnt(5)
    v_mfma_f32_16x16x32_bf16 v[80:83], v[24:27], a[16:19], v[80:83]
    v_mfma_f32_16x16x32_bf16 v[88:91], v[24:27], a[20:23], v[88:91]
    v_mfma_f32_16x16x32_bf16 v[96:99], v[24:27], a[24:27], v[96:99]
    v_mfma_f32_16x16x32_bf16 v[104:107], v[24:27], a[28:31], v[104:107]
    ds_read_b128 v[16:19], v114 offset:8192
    s_waitcnt lgkmcnt(5)
    v_mfma_f32_16x16x32_bf16 v[84:87], v[28:31], a[16:19], v[84:87]
    v_mfma_f32_16x16x32_bf16 v[92:95], v[28:31], a[20:23], v[92:95]
    v_cvt_pk_bf16_f32 v56, v56, v57
    v_cvt_pk_bf16_f32 v57, v58, v59
    v_mfma_f32_16x16x32_bf16 v[100:103], v[28:31], a[24:27], v[100:103]
    v_cvt_pk_bf16_f32 v58, v60, v61
    v_cvt_pk_bf16_f32 v59, v62, v63
    v_mfma_f32_16x16x32_bf16 v[108:111], v[28:31], a[28:31], v[108:111]
    ds_read_b128 v[20:23], v114 offset:10240
    s_waitcnt lgkmcnt(5)
    v_mfma_f32_16x16x32_bf16 v[80:83], v[32:35], a[32:35], v[80:83]
    s_add_u32 s48, s53, s37
    buffer_store_dwordx4 v[56:59], v4, s[24:27], s48 offen sc1
    v_mfma_f32_16x16x32_bf16 v[88:91], v[32:35], a[36:39], v[88:91]
    v_mfma_f32_16x16x32_bf16 v[96:99], v[32:35], a[40:43], v[96:99]
    v_mfma_f32_16x16x32_bf16 v[104:107], v[32:35], a[44:47], v[104:107]
    ds_read_b128 v[24:27], v115 offset:8192
    s_waitcnt lgkmcnt(5)
    v_mfma_f32_16x16x32_bf16 v[84:87], v[36:39], a[32:35], v[84:87]
    v_mfma_f32_16x16x32_bf16 v[92:95], v[36:39], a[36:39], v[92:95]
    v_mfma_f32_16x16x32_bf16 v[100:103], v[36:39], a[40:43], v[100:103]
    v_mfma_f32_16x16x32_bf16 v[108:111], v[36:39], a[44:47], v[108:111]
    ds_read_b128 v[28:31], v115 offset:10240
    s_waitcnt lgkmcnt(5)
    v_mfma_f32_16x16x32_bf16 v[80:83], v[40:43], a[48:51], v[80:83]
    v_cvt_pk_bf16_f32 v64, v64, v65
    v_cvt_pk_bf16_f32 v65, v66, v67
    v_mfma_f32_16x16x32_bf16 v[88:91], v[40:43], a[52:55], v[88:91]
    v_cvt_pk_bf16_f32 v66, v68, v69
    v_cvt_pk_bf16_f32 v67, v70, v71
    v_mfma_f32_16x16x32_bf16 v[96:99], v[40:43], a[56:59], v[96:99]
    s_add_u32 s48, s53, s38
    buffer_store_dwordx4 v[64:67], v4, s[24:27], s48 offen sc1
    v_mfma_f32_16x16x32_bf16 v[104:107], v[40:43], a[60:63], v[104:107]
    ds_read_b128 v[32:35], v114 offset:12288
    s_waitcnt lgkmcnt(5)
    v_mfma_f32_16x16x32_bf16 v[84:87], v[44:47], a[48:51], v[84:87]
    v_mfma_f32_16x16x32_bf16 v[92:95], v[44:47], a[52:55], v[92:95]
    v_mfma_f32_16x16x32_bf16 v[100:103], v[44:47], a[56:59], v[100:103]
    v_mfma_f32_16x16x32_bf16 v[108:111], v[44:47], a[60:63], v[108:111]
    ds_read_b128 v[36:39], v114 offset:14336
    s_waitcnt lgkmcnt(5)
    v_mfma_f32_16x16x32_bf16 v[80:83], v[16:19], a[64:67], v[80:83]
    v_mfma_f32_16x16x32_bf16 v[88:91], v[16:19], a[68:71], v[88:91]
    v_mfma_f32_16x16x32_bf16 v[96:99], v[16:19], a[72:75], v[96:99]
    v_cvt_pk_bf16_f32 v72, v72, v73
    v_cvt_pk_bf16_f32 v73, v74, v75
    v_mfma_f32_16x16x32_bf16 v[104:107], v[16:19], a[76:79], v[104:107]
    ds_read_b128 v[40:43], v115 offset:12288
    s_waitcnt lgkmcnt(5)
    v_mfma_f32_16x16x32_bf16 v[84:87], v[20:23], a[64:67], v[84:87]
    v_cvt_pk_bf16_f32 v74, v76, v77
    v_cvt_pk_bf16_f32 v75, v78, v79
    v_mfma_f32_16x16x32_bf16 v[92:95], v[20:23], a[68:71], v[92:95]
    s_add_u32 s48, s53, s39
    buffer_store_dwordx4 v[72:75], v4, s[24:27], s48 offen sc1
    v_mfma_f32_16x16x32_bf16 v[100:103], v[20:23], a[72:75], v[100:103]
    v_mfma_f32_16x16x32_bf16 v[108:111], v[20:23], a[76:79], v[108:111]
    ds_read_b128 v[44:47], v115 offset:14336
    s_waitcnt lgkmcnt(5)
    v_mfma_f32_16x16x32_bf16 v[80:83], v[24:27], a[80:83], v[80:83]
    v_mfma_f32_16x16x32_bf16 v[88:91], v[24:27], a[84:87], v[88:91]
    v_mfma_f32_16x16x32_bf16 v[96:99], v[24:27], a[88:91], v[96:99]
    v_mfma_f32_16x16x32_bf16 v[104:107], v[24:27], a[92:95], v[104:107]
    ds_read_b128 v[16:19], v114 offset:16384
    s_waitcnt lgkmcnt(5)
    v_mfma_f32_16x16x32_bf16 v[84:87], v[28:31], a[80:83], v[84:87]
    v_mfma_f32_16x16x32_bf16 v[92:95], v[28:31], a[84:87], v[92:95]
    s_sub_u32 s47, s49, 40960
    s_cselect_b32 s52, 81920, s47
    s_add_u32 s47, s44, 2
    v_mfma_f32_16x16x32_bf16 v[100:103], v[28:31], a[88:91], v[100:103]
    s_sub_u32 s45, s33, 1
    s_min_u32 s45, s45, s47
    v_mfma_f32_16x16x32_bf16 v[108:111], v[28:31], a[92:95], v[108:111]
    ds_read_b128 v[20:23], v114 offset:18432
    s_waitcnt lgkmcnt(5)
    v_mfma_f32_16x16x32_bf16 v[80:83], v[32:35], a[96:99], v[80:83]
    s_mul_i32 s45, s45, 40960
    s_add_u32 s45, s45, s50
    v_mfma_f32_16x16x32_bf16 v[88:91], v[32:35], a[100:103], v[88:91]
    s_add_u32 s46, s52, s51
    s_sub_u32 s48, s44, s32
    v_mfma_f32_16x16x32_bf16 v[96:99], v[32:35], a[104:107], v[96:99]
    s_mul_i32 s48, s48, s35
    s_add_u32 s53, s48, s34
    v_mfma_f32_16x16x32_bf16 v[104:107], v[32:35], a[108:111], v[104:107]
    ds_read_b128 v[24:27], v115 offset:16384
    s_waitcnt lgkmcnt(5)
    v_mfma_f32_16x16x32_bf16 v[84:87], v[36:39], a[96:99], v[84:87]
    s_add_u32 s49, s49, 40960
    s_cmp_eq_u32 s49, 122880
    s_cselect_b32 s49, 0, s49
    v_mfma_f32_16x16x32_bf16 v[92:95], v[36:39], a[100:103], v[92:95]
    v_add_u32 v112, s49, v15
    v_xor_b32 v113, 64, v112
    v_mfma_f32_16x16x32_bf16 v[100:103], v[36:39], a[104:107], v[100:103]
    s_sub_u32 s48, s33, 1
    s_add_u32 s59, s44, 4
    v_mfma_f32_16x16x32_bf16 v[108:111], v[36:39], a[108:111], v[108:111]
    ds_read_b128 v[28:31], v115 offset:18432
    s_waitcnt lgkmcnt(5)
    v_mfma_f32_16x16x32_bf16 v[80:83], v[40:43], a[112:115], v[80:83]
    s_min_u32 s48, s48, s59
    s_mul_i32 s48, s48, 40960
    v_mfma_f32_16x16x32_bf16 v[88:91], v[40:43], a[116:119], v[88:91]
    s_add_u32 s59, s48, s31
    v_mfma_f32_16x16x32_bf16 v[96:99], v[40:43], a[120:123], v[96:99]
    v_mfma_f32_16x16x32_bf16 v[104:107], v[40:43], a[124:127], v[104:107]
    ds_read_b128 v[32:35], v114 offset:20480
    s_waitcnt lgkmcnt(5)
    v_mfma_f32_16x16x32_bf16 v[84:87], v[44:47], a[112:115], v[84:87]
    v_mfma_f32_16x16x32_bf16 v[92:95], v[44:47], a[116:119], v[92:95]
    v_mfma_f32_16x16x32_bf16 v[100:103], v[44:47], a[120:123], v[100:103]
    v_mfma_f32_16x16x32_bf16 v[108:111], v[44:47], a[124:127], v[108:111]
    ds_read_b128 v[36:39], v114 offset:22528
    s_waitcnt lgkmcnt(5)
    v_mfma_f32_16x16x32_bf16 v[80:83], v[16:19], a[128:131], v[80:83]
    v_mfma_f32_16x16x32_bf16 v[88:91], v[16:19], a[132:135], v[88:91]
    v_mfma_f32_16x16x32_bf16 v[96:99], v[16:19], a[136:139], v[96:99]
    v_mfma_f32_16x16x32_bf16 v[104:107], v[16:19], a[140:143], v[104:107]
    ds_read_b128 v[40:43], v115 offset:20480
    s_waitcnt lgkmcnt(5)
    v_mfma_f32_16x16x32_bf16 v[84:87], v[20:23], a[128:131], v[84:87]
    v_mfma_f32_16x16x32_bf16 v[92:95], v[20:23], a[132:135], v[92:95]
    v_mfma_f32_16x16x32_bf16 v[100:103], v[20:23], a[136:139], v[100:103]
    v_mfma_f32_16x16x32_bf16 v[108:111], v[20:23], a[140:143], v[108:111]
    ds_read_b128 v[44:47], v115 offset:22528
    s_waitcnt lgkmcnt(5)
    v_mfma_f32_16x16x32_bf16 v[80:83], v[24:27], a[144:147], v[80:83]
    v_mfma_f32_16x16x32_bf16 v[88:91], v[24:27], a[148:151], v[88:91]
    v_mfma_f32_16x16x32_bf16 v[96:99], v[24:27], a[152:155], v[96:99]
    v_mfma_f32_16x16x32_bf16 v[104:107], v[24:27], a[156:159], v[104:107]
    ds_read_b128 v[16:19], v114 offset:24576
    s_waitcnt lgkmcnt(5)
    v_mfma_f32_16x16x32_bf16 v[84:87], v[28:31], a[144:147], v[84:87]
    v_mfma_f32_16x16x32_bf16 v[92:95], v[28:31], a[148:151], v[92:95]
    v_mfma_f32_16x16x32_bf16 v[100:103], v[28:31], a[152:155], v[100:103]
    v_mfma_f32_16x16x32_bf16 v[108:111], v[28:31], a[156:159], v[108:111]
    ds_read_b128 v[20:23], v114 offset:26624
    s_waitcnt lgkmcnt(5)
    v_mfma_f32_16x16x32_bf16 v[80:83], v[32:35], a[160:163], v[80:83]
    v_mfma_f32_16x16x32_bf16 v[88:91], v[32:35], a[164:167], v[88:91]
    v_mfma_f32_16x16x32_bf16 v[96:99], v[32:35], a[168:171], v[96:99]
    v_mfma_f32_16x16x32_bf16 v[104:107], v[32:35], a[172:175], v[104:107]
    ds_read_b128 v[24:27], v115 offset:24576
    s_waitcnt lgkmcnt(5)
    v_mfma_f32_16x16x32_bf16 v[84:87], v[36:39], a[160:163], v[84:87]
    v_mfma_f32_16x16x32_bf16 v[92:95], v[36:39], a[164:167], v[92:95]
    v_mfma_f32_16x16x32_bf16 v[100:103], v[36:39], a[168:171], v[100:103]
    v_mfma_f32_16x16x32_bf16 v[108:111], v[36:39], a[172:175], v[108:111]
    ds_read_b128 v[28:31], v115 offset:26624
    s_waitcnt lgkmcnt(5)
    v_mfma_f32_16x16x32_bf16 v[80:83], v[40:43], a[176:179], v[80:83]
    v_mfma_f32_16x16x32_bf16 v[88:91], v[40:43], a[180:183], v[88:91]
    v_mfma_f32_16x16x32_bf16 v[96:99], v[40:43], a[184:187], v[96:99]
    v_mfma_f32_16x16x32_bf16 v[104:107], v[40:43], a[188:191], v[104:107]
    ds_read_b128 v[32:35], v114 offset:28672
    s_waitcnt lgkmcnt(5)
    v_mfma_f32_16x16x32_bf16 v[84:87], v[44:47], a[176:179], v[84:87]
    v_mfma_f32_16x16x32_bf16 v[92:95], v[44:47], a[180:183], v[92:95]
    v_mfma_f32_16x16x32_bf16 v[100:103], v[44:47], a[184:187], v[100:103]
    v_mfma_f32_16x16x32_bf16 v[108:111], v[44:47], a[188:191], v[108:111]
    ds_read_b128 v[36:39], v114 offset:30720
    s_waitcnt lgkmcnt(5)
    v_mfma_f32_16x16x32_bf16 v[80:83], v[16:19], a[192:195], v[80:83]
    v_mfma_f32_16x16x32_bf16 v[88:91], v[16:19], a[196:199], v[88:91]
    v_mfma_f32_16x16x32_bf16 v[96:99], v[16:19], a[200:203], v[96:99]
    v_mfma_f32_16x16x32_bf16 v[104:107], v[16:19], a[204:207], v[104:107]
    ds_read_b128 v[40:43], v115 offset:28672
    s_waitcnt lgkmcnt(5)
    v_mfma_f32_16x16x32_bf16 v[84:87], v[20:23], a[192:195], v[84:87]
    v_mfma_f32_16x16x32_bf16 v[92:95], v[20:23], a[196:199], v[92:95]
    v_mfma_f32_16x16x32_bf16 v[100:103], v[20:23], a[200:203], v[100:103]
    v_mfma_f32_16x16x32_bf16 v[108:111], v[20:23], a[204:207], v[108:111]
    ds_read_b128 v[44:47], v115 offset:30720
    s_waitcnt lgkmcnt(5)
    v_mfma_f32_16x16x32_bf16 v[80:83], v[24:27], a[208:211], v[80:83]
    s_waitcnt vmcnt(0)
    s_barrier
    v_mfma_f32_16x16x32_bf16 v[88:91], v[24:27], a[212:215], v[88:91]
    v_mov_b32 v10, s44
    buffer_store_dword v10, v5, s[4:7], s40 offen sc1
    v_mfma_f32_16x16x32_bf16 v[96:99], v[24:27], a[216:219], v[96:99]
    s_add_u32 s44, s44, 1
    v_mfma_f32_16x16x32_bf16 v[104:107], v[24:27], a[220:223], v[104:107]
    ds_read_b128 v[16:19], v114 offset:32768
    s_waitcnt lgkmcnt(5)
    v_mfma_f32_16x16x32_bf16 v[84:87], v[28:31], a[208:211], v[84:87]
    s_add_u32 m0, s46, 0
    v_mfma_f32_16x16x32_bf16 v[92:95], v[28:31], a[212:215], v[92:95]
    buffer_load_dwordx4 v3, s[20:23], s45 offen offset:0 sc1 lds
    v_mfma_f32_16x16x32_bf16 v[100:103], v[28:31], a[216:219], v[100:103]
    v_mfma_f32_16x16x32_bf16 v[108:111], v[28:31], a[220:223], v[108:111]
    ds_read_b128 v[20:23], v114 offset:34816
    s_waitcnt lgkmcnt(5)
    v_mfma_f32_16x16x32_bf16 v[80:83], v[32:35], a[224:227], v[80:83]
    s_add_u32 m0, s46, 3968
    v_mfma_f32_16x16x32_bf16 v[88:91], v[32:35], a[228:231], v[88:91]
    buffer_load_dwordx4 v3, s[20:23], s45 offen offset:128 sc1 lds
    v_mfma_f32_16x16x32_bf16 v[96:99], v[32:35], a[232:235], v[96:99]
    v_mfma_f32_16x16x32_bf16 v[104:107], v[32:35], a[236:239], v[104:107]
    ds_read_b128 v[24:27], v115 offset:32768
    s_waitcnt lgkmcnt(5)
    v_mfma_f32_16x16x32_bf16 v[84:87], v[36:39], a[224:227], v[84:87]
    s_add_u32 m0, s46, 7936
    v_mfma_f32_16x16x32_bf16 v[92:95], v[36:39], a[228:231], v[92:95]
    buffer_load_dwordx4 v3, s[20:23], s45 offen offset:256 sc1 lds
    v_mfma_f32_16x16x32_bf16 v[100:103], v[36:39], a[232:235], v[100:103]
    v_mfma_f32_16x16x32_bf16 v[108:111], v[36:39], a[236:239], v[108:111]
    ds_read_b128 v[28:31], v115 offset:34816
    s_waitcnt lgkmcnt(5)
    v_mfma_f32_16x16x32_bf16 v[80:83], v[40:43], a[240:243], v[80:83]
    s_add_u32 m0, s46, 11904
    v_mfma_f32_16x16x32_bf16 v[88:91], v[40:43], a[244:247], v[88:91]
    buffer_load_dwordx4 v3, s[20:23], s45 offen offset:384 sc1 lds
    v_mfma_f32_16x16x32_bf16 v[96:99], v[40:43], a[248:251], v[96:99]
    v_mfma_f32_16x16x32_bf16 v[104:107], v[40:43], a[252:255], v[104:107]
    ds_read_b128 v[32:35], v114 offset:36864
    s_waitcnt lgkmcnt(5)
    v_mfma_f32_16x16x32_bf16 v[84:87], v[44:47], a[240:243], v[84:87]
    s_add_u32 m0, s46, 15872
    v_mfma_f32_16x16x32_bf16 v[92:95], v[44:47], a[244:247], v[92:95]
    buffer_load_dwordx4 v3, s[20:23], s45 offen offset:512 sc1 lds
    v_mfma_f32_16x16x32_bf16 v[100:103], v[44:47], a[248:251], v[100:103]
    v_mfma_f32_16x16x32_bf16 v[108:111], v[44:47], a[252:255], v[108:111]
    ds_read_b128 v[36:39], v114 offset:38912
    s_waitcnt lgkmcnt(5)
    v_mfma_f32_16x16x32_bf16 v[80:83], v[16:19], v[192:195], v[80:83]
    s_add_u32 m0, s46, 19840
    v_mfma_f32_16x16x32_bf16 v[88:91], v[16:19], v[196:199], v[88:91]
    buffer_load_dwordx4 v3, s[20:23], s45 offen offset:640 sc1 lds
    v_mfma_f32_16x16x32_bf16 v[96:99], v[16:19], v[200:203], v[96:99]
    v_mfma_f32_16x16x32_bf16 v[104:107], v[16:19], v[204:207], v[104:107]
    ds_read_b128 v[40:43], v115 offset:36864
    s_waitcnt lgkmcnt(5)
    v_mfma_f32_16x16x32_bf16 v[84:87], v[20:23], v[192:195], v[84:87]
    s_add_u32 m0, s46, 23808
    v_mfma_f32_16x16x32_bf16 v[92:95], v[20:23], v[196:199], v[92:95]
    buffer_load_dwordx4 v3, s[20:23], s45 offen offset:768 sc1 lds
    v_mfma_f32_16x16x32_bf16 v[100:103], v[20:23], v[200:203], v[100:103]
    v_mfma_f32_16x16x32_bf16 v[108:111], v[20:23], v[204:207], v[108:111]
    ds_read_b128 v[44:47], v115 offset:38912
    s_waitcnt lgkmcnt(5)
    v_mfma_f32_16x16x32_bf16 v[80:83], v[24:27], v[208:211], v[80:83]
    s_add_u32 m0, s46, 27776
    v_mfma_f32_16x16x32_bf16 v[88:91], v[24:27], v[212:215], v[88:91]
    buffer_load_dwordx4 v3, s[20:23], s45 offen offset:896 sc1 lds
    v_mfma_f32_16x16x32_bf16 v[96:99], v[24:27], v[216:219], v[96:99]
    v_mfma_f32_16x16x32_bf16 v[104:107], v[24:27], v[220:223], v[104:107]
    ds_read_b128 v[16:19], v112 offset:0
    s_waitcnt lgkmcnt(5)
    v_mfma_f32_16x16x32_bf16 v[84:87], v[28:31], v[208:211], v[84:87]
    s_add_u32 m0, s46, 31744
    v_mfma_f32_16x16x32_bf16 v[92:95], v[28:31], v[212:215], v[92:95]
    buffer_load_dwordx4 v3, s[20:23], s45 offen offset:1024 sc1 lds
    v_mfma_f32_16x16x32_bf16 v[100:103], v[28:31], v[216:219], v[100:103]
    v_mfma_f32_16x16x32_bf16 v[108:111], v[28:31], v[220:223], v[108:111]
    ds_read_b128 v[20:23], v112 offset:2048
    s_waitcnt lgkmcnt(5)
    v_mfma_f32_16x16x32_bf16 v[80:83], v[32:35], v[224:227], v[80:83]
    s_add_u32 m0, s46, 35712
    v_mfma_f32_16x16x32_bf16 v[88:91], v[32:35], v[228:231], v[88:91]
    buffer_load_dwordx4 v3, s[20:23], s45 offen offset:1152 sc1 lds
    v_mfma_f32_16x16x32_bf16 v[96:99], v[32:35], v[232:235], v[96:99]
    v_mfma_f32_16x16x32_bf16 v[104:107], v[32:35], v[236:239], v[104:107]
    ds_read_b128 v[24:27], v113 offset:0
    s_waitcnt lgkmcnt(5)
    v_mfma_f32_16x16x32_bf16 v[84:87], v[36:39], v[224:227], v[84:87]
    buffer_load_dword v117, v116, s[20:23], s59 offen sc1
    v_mfma_f32_16x16x32_bf16 v[92:95], v[36:39], v[228:231], v[92:95]
    v_mfma_f32_16x16x32_bf16 v[100:103], v[36:39], v[232:235], v[100:103]
    v_mfma_f32_16x16x32_bf16 v[108:111], v[36:39], v[236:239], v[108:111]
    ds_read_b128 v[28:31], v113 offset:2048
    s_waitcnt lgkmcnt(5)
    v_mfma_f32_16x16x32_bf16 v[80:83], v[40:43], v[240:243], v[80:83]
    v_mfma_f32_16x16x32_bf16 v[88:91], v[40:43], v[244:247], v[88:91]
    v_mfma_f32_16x16x32_bf16 v[96:99], v[40:43], v[248:251], v[96:99]
    v_mfma_f32_16x16x32_bf16 v[104:107], v[40:43], v[252:255], v[104:107]
    ds_read_b128 v[32:35], v112 offset:4096
    s_waitcnt lgkmcnt(5)
    v_mfma_f32_16x16x32_bf16 v[84:87], v[44:47], v[240:243], v[84:87]
    v_mfma_f32_16x16x32_bf16 v[92:95], v[44:47], v[244:247], v[92:95]
    v_mfma_f32_16x16x32_bf16 v[100:103], v[44:47], v[248:251], v[100:103]
    s_cmp_lt_u32 s44, s33
    v_mfma_f32_16x16x32_bf16 v[108:111], v[44:47], v[252:255], v[108:111]
    ds_read_b128 v[36:39], v112 offset:6144
    s_cbranch_scc1 Lg_V0
Lg_Ve1:
    v_cvt_pk_bf16_f32 v80, v80, v81
    v_cvt_pk_bf16_f32 v81, v82, v83
    v_cvt_pk_bf16_f32 v82, v84, v85
    v_cvt_pk_bf16_f32 v83, v86, v87
    s_add_u32 s48, s53, s36
    buffer_store_dwordx4 v[80:83], v4, s[24:27], s48 offen sc1
    v_cvt_pk_bf16_f32 v88, v88, v89
    v_cvt_pk_bf16_f32 v89, v90, v91
    v_cvt_pk_bf16_f32 v90, v92, v93
    v_cvt_pk_bf16_f32 v91, v94, v95
    s_add_u32 s48, s53, s37
    buffer_store_dwordx4 v[88:91], v4, s[24:27], s48 offen sc1
    v_cvt_pk_bf16_f32 v96, v96, v97
    v_cvt_pk_bf16_f32 v97, v98, v99
    v_cvt_pk_bf16_f32 v98, v100, v101
    v_cvt_pk_bf16_f32 v99, v102, v103
    s_add_u32 s48, s53, s38
    buffer_store_dwordx4 v[96:99], v4, s[24:27], s48 offen sc1
    v_cvt_pk_bf16_f32 v104, v104, v105
    v_cvt_pk_bf16_f32 v105, v106, v107
    v_cvt_pk_bf16_f32 v106, v108, v109
    v_cvt_pk_bf16_f32 v107, v110, v111
    s_add_u32 s48, s53, s39
    buffer_store_dwordx4 v[104:107], v4, s[24:27], s48 offen sc1
    s_branch Lg_end
Lg_Ve0:
    v_cvt_pk_bf16_f32 v48, v48, v49
    v_cvt_pk_bf16_f32 v49, v50, v51
    v_cvt_pk_bf16_f32 v50, v52, v53
    v_cvt_pk_bf16_f32 v51, v54, v55
    s_add_u32 s48, s53, s36
    buffer_store_dwordx4 v[48:51], v4, s[24:27], s48 offen sc1
    v_cvt_pk_bf16_f32 v56, v56, v57
    v_cvt_pk_bf16_f32 v57, v58, v59
    v_cvt_pk_bf16_f32 v58, v60, v61
    v_cvt_pk_bf16_f32 v59, v62, v63
    s_add_u32 s48, s53, s37
    buffer_store_dwordx4 v[56:59], v4, s[24:27], s48 offen sc1
    v_cvt_pk_bf16_f32 v64, v64, v65
    v_cvt_pk_bf16_f32 v65, v66, v67
    v_cvt_pk_bf16_f32 v66, v68, v69
    v_cvt_pk_bf16_f32 v67, v70, v71
    s_add_u32 s48, s53, s38
    buffer_store_dwordx4 v[64:67], v4, s[24:27], s48 offen sc1
    v_cvt_pk_bf16_f32 v72, v72, v73
    v_cvt_pk_bf16_f32 v73, v74, v75
    v_cvt_pk_bf16_f32 v74, v76, v77
    v_cvt_pk_bf16_f32 v75, v78, v79
    s_add_u32 s48, s53, s39
    buffer_store_dwordx4 v[72:75], v4, s[24:27], s48 offen sc1
    s_branch Lg_end
Lg_Rf:
    v_cvt_pk_bf16_f32 v48, v48, v49
    v_cvt_pk_bf16_f32 v49, v50, v51
    v_cvt_pk_bf16_f32 v50, v52, v53
    v_cvt_pk_bf16_f32 v51, v54, v55
    s_add_u32 s48, s53, s36
    buffer_store_dwordx4 v[48:51], v4, s[24:27], s48 offen
    v_cvt_pk_bf16_f32 v56, v56, v57
    v_cvt_pk_bf16_f32 v57, v58, v59
    v_cvt_pk_bf16_f32 v58, v60, v61
    v_cvt_pk_bf16_f32 v59, v62, v63
    s_add_u32 s48, s53, s37
    buffer_store_dwordx4 v[56:59], v4, s[24:27], s48 offen
    v_cvt_pk_bf16_f32 v64, v64, v65
    v_cvt_pk_bf16_f32 v65, v66, v67
    v_cvt_pk_bf16_f32 v66, v68, v69
    v_cvt_pk_bf16_f32 v67, v70, v71
    s_add_u32 s48, s53, s38
    buffer_store_dwordx4 v[64:67], v4, s[24:27], s48 offen
    v_cvt_pk_bf16_f32 v72, v72, v73
    v_cvt_pk_bf16_f32 v73, v74, v75
    v_cvt_pk_bf16_f32 v74, v76, v77
    v_cvt_pk_bf16_f32 v75, v78, v79
    s_add_u32 s48, s53, s39
    buffer_store_dwordx4 v[72:75], v4, s[24:27], s48 offen
    s_add_u32 s53, s53, s35
    v_cvt_pk_bf16_f32 v80, v80, v81
    v_cvt_pk_bf16_f32 v81, v82, v83
    v_cvt_pk_bf16_f32 v82, v84, v85
    v_cvt_pk_bf16_f32 v83, v86, v87
    s_add_u32 s48, s53, s36
    buffer_store_dwordx4 v[80:83], v4, s[24:27], s48 offen
    v_cvt_pk_bf16_f32 v88, v88, v89
    v_cvt_pk_bf16_f32 v89, v90, v91
    v_cvt_pk_bf16_f32 v90, v92, v93
    v_cvt_pk_bf16_f32 v91, v94, v95
    s_add_u32 s48, s53, s37
    buffer_store_dwordx4 v[88:91], v4, s[24:27], s48 offen
    v_cvt_pk_bf16_f32 v96, v96, v97
    v_cvt_pk_bf16_f32 v97, v98, v99
    v_cvt_pk_bf16_f32 v98, v100, v101
    v_cvt_pk_bf16_f32 v99, v102, v103
    s_add_u32 s48, s53, s38
    buffer_store_dwordx4 v[96:99], v4, s[24:27], s48 offen
    v_cvt_pk_bf16_f32 v104, v104, v105
    v_cvt_pk_bf16_f32 v105, v106, v107
    v_cvt_pk_bf16_f32 v106, v108, v109
    v_cvt_pk_bf16_f32 v107, v110, v111
    s_add_u32 s48, s53, s39
    buffer_store_dwordx4 v[104:107], v4, s[24:27], s48 offen
    s_add_u32 s44, s44, 2
    s_mov_b32 s49, 81920
    s_barrier
    s_sub_u32 s45, s33, 1
    s_min_u32 s45, s45, s44
    s_mul_i32 s45, s45, 40960
    s_add_u32 s45, s45, s50
    s_add_u32 s46, s49, s51
    s_add_u32 m0, s46, 0
    s_nop 0
    buffer_load_dwordx4 v3, s[20:23], s45 offen offset:0 sc1 lds
    s_add_u32 m0, s46, 3968
    s_nop 0
    buffer_load_dwordx4 v3, s[20:23], s45 offen offset:128 sc1 lds
    s_add_u32 m0, s46, 7936
    s_nop 0
    buffer_load_dwordx4 v3, s[20:23], s45 offen offset:256 sc1 lds
    s_add_u32 m0, s46, 11904
    s_nop 0
    buffer_load_dwordx4 v3, s[20:23], s45 offen offset:384 sc1 lds
    s_add_u32 m0, s46, 15872
    s_nop 0
    buffer_load_dwordx4 v3, s[20:23], s45 offen offset:512 sc1 lds
    s_add_u32 m0, s46, 19840
    s_nop 0
    buffer_load_dwordx4 v3, s[20:23], s45 offen offset:640 sc1 lds
    s_add_u32 m0, s46, 23808
    s_nop 0
    buffer_load_dwordx4 v3, s[20:23], s45 offen offset:768 sc1 lds
    s_add_u32 m0, s46, 27776
    s_nop 0
    buffer_load_dwordx4 v3, s[20:23], s45 offen offset:896 sc1 lds
    s_add_u32 m0, s46, 31744
    s_nop 0
    buffer_load_dwordx4 v3, s[20:23], s45 offen offset:1024 sc1 lds
    s_add_u32 m0, s46, 35712
    s_nop 0
    buffer_load_dwordx4 v3, s[20:23], s45 offen offset:1152 sc1 lds
    s_waitcnt vmcnt(10)
    v_mov_b32 v10, s44
    buffer_store_dword v10, v5, s[4:7], s40 offen sc1
    s_add_u32 s47, s44, 1
    s_mov_b32 s48, 0
    s_sub_u32 s45, s33, 1
    s_min_u32 s45, s45, s47
    s_mul_i32 s45, s45, 40960
    s_add_u32 s45, s45, s50
    s_add_u32 s46, s48, s51
    s_add_u32 m0, s46, 0
    s_nop 0
    buffer_load_dwordx4 v3, s[20:23], s45 offen offset:0 sc1 lds
    s_add_u32 m0, s46, 3968
    s_nop 0
    buffer_load_dwordx4 v3, s[20:23], s45 offen offset:128 sc1 lds
    s_add_u32 m0, s46, 7936
    s_nop 0
    buffer_load_dwordx4 v3, s[20:23], s45 offen offset:256 sc1 lds
    s_add_u32 m0, s46, 11904
    s_nop 0
    buffer_load_dwordx4 v3, s[20:23], s45 offen offset:384 sc1 lds
    s_add_u32 m0, s46, 15872
    s_nop 0
    buffer_load_dwordx4 v3, s[20:23], s45 offen offset:512 sc1 lds
    s_add_u32 m0, s46, 19840
    s_nop 0
    buffer_load_dwordx4 v3, s[20:23], s45 offen offset:640 sc1 lds
    s_add_u32 m0, s46, 23808
    s_nop 0
    buffer_load_dwordx4 v3, s[20:23], s45 offen offset:768 sc1 lds
    s_add_u32 m0, s46, 27776
    s_nop 0
    buffer_load_dwordx4 v3, s[20:23], s45 offen offset:896 sc1 lds
    s_add_u32 m0, s46, 31744
    s_nop 0
    buffer_load_dwordx4 v3, s[20:23], s45 offen offset:1024 sc1 lds
    s_add_u32 m0, s46, 35712
    s_nop 0
    buffer_load_dwordx4 v3, s[20:23], s45 offen offset:1152 sc1 lds
    s_waitcnt vmcnt(11)
Lg_Rp:
    s_mov_b32 s53, 1073741824
    v_add_u32 v112, s49, v15
    v_xor_b32 v113, 64, v112
    s_barrier
    ds_read_b128 v[16:19], v112 offset:0
    ds_read_b128 v[20:23], v112 offset:2048
    ds_read_b128 v[24:27], v113 offset:0
    ds_read_b128 v[28:31], v113 offset:2048
    ds_read_b128 v[32:35], v112 offset:4096
    ds_read_b128 v[36:39], v112 offset:6144
Lg_R0:
    s_waitcnt lgkmcnt(5)
    v_mfma_f32_16x16x32_bf16 v[48:51], a[0:3], v[16:19], 0
    v_mfma_f32_16x16x32_bf16 v[52:55], a[4:7], v[16:19], 0
    v_mfma_f32_16x16x32_bf16 v[64:67], a[8:11], v[16:19], 0
    v_cvt_pk_bf16_f32 v80, v80, v81
    v_cvt_pk_bf16_f32 v81, v82, v83
    v_mfma_f32_16x16x32_bf16 v[68:71], a[12:15], v[16:19], 0
    ds_read_b128 v[40:43], v113 offset:4096
    s_waitcnt lgkmcnt(5)
    v_mfma_f32_16x16x32_bf16 v[56:59], a[0:3], v[20:23], 0
    v_cvt_pk_bf16_f32 v82, v84, v85
    v_cvt_pk_bf16_f32 v83, v86, v87
    v_mfma_f32_16x16x32_bf16 v[60:63], a[4:7], v[20:23], 0
    s_add_u32 s48, s53, s36
    buffer_store_dwordx4 v[80:83], v4, s[24:27], s48 offen
    v_mfma_f32_16x16x32_bf16 v[72:75], a[8:11], v[20:23], 0
    v_mfma_f32_16x16x32_bf16 v[76:79], a[12:15], v[20:23], 0
    ds_read_b128 v[44:47], v113 offset:6144
    s_waitcnt lgkmcnt(5)
    v_mfma_f32_16x16x32_bf16 v[48:51], a[16:19], v[24:27], v[48:51]
    v_mfma_f32_16x16x32_bf16 v[52:55], a[20:23], v[24:27], v[52:55]
    v_mfma_f32_16x16x32_bf16 v[64:67], a[24:27], v[24:27], v[64:67]
    v_mfma_f32_16x16x32_bf16 v[68:71], a[28:31], v[24:27], v[68:71]
    ds_read_b128 v[16:19], v112 offset:8192
    s_waitcnt lgkmcnt(5)
    v_mfma_f32_16x16x32_bf16 v[56:59], a[16:19], v[28:31], v[56:59]
    v_mfma_f32_16x16x32_bf16 v[60:63], a[20:23], v[28:31], v[60:63]
    v_cvt_pk_bf16_f32 v88, v88, v89
    v_cvt_pk_bf16_f32 v89, v90, v91
    v_mfma_f32_16x16x32_bf16 v[72:75], a[24:27], v[28:31], v[72:75]
    v_cvt_pk_bf16_f32 v90, v92, v93
    v_cvt_pk_bf16_f32 v91, v94, v95
    v_mfma_f32_16x16x32_bf16 v[76:79], a[28:31], v[28:31], v[76:79]
    ds_read_b128 v[20:23], v112 offset:10240
    s_waitcnt lgkmcnt(5)
    v_mfma_f32_16x16x32_bf16 v[48:51], a[32:35], v[32:35], v[48:51]
    s_add_u32 s48, s53, s37
    buffer_store_dwordx4 v[88:91], v4, s[24:27], s48 offen
    v_mfma_f32_16x16x32_bf16 v[52:55], a[36:39], v[32:35], v[52:55]
    v_mfma_f32_16x16x32_bf16 v[64:67], a[40:43], v[32:35], v[64:67]
    v_mfma_f32_16x16x32_bf16 v[68:71], a[44:47], v[32:35], v[68:71]
    ds_read_b128 v[24:27], v113 offset:8192
    s_waitcnt lgkmcnt(5)
    v_mfma_f32_16x16x32_bf16 v[56:59], a[32:35], v[36:39], v[56:59]
    v_mfma_f32_16x16x32_bf16 v[60:63], a[36:39], v[36:39], v[60:63]
    v_mfma_f32_16x16x32_bf16 v[72:75], a[40:43], v[36:39], v[72:75]
    v_mfma_f32_16x16x32_bf16 v[76:79], a[44:47], v[36:39], v[76:79]
    ds_read_b128 v[28:31], v113 offset:10240
    s_waitcnt lgkmcnt(5)
    v_mfma_f32_16x16x32_bf16 v[48:51], a[48:51], v[40:43], v[48:51]
    v_cvt_pk_bf16_f32 v96, v96, v97
    v_cvt_pk_bf16_f32 v97, v98, v99
    v_mfma_f32_16x16x32_bf16 v[52:55], a[52:55], v[40:43], v[52:55]
    v_cvt_pk_bf16_f32 v98, v100, v101
    v_cvt_pk_bf16_f32 v99, v102, v103
    v_mfma_f32_16x16x32_bf16 v[64:67], a[56:59], v[40:43], v[64:67]
    s_add_u32 s48, s53, s38
    buffer_store_dwordx4 v[96:99], v4, s[24:27], s48 offen
    v_mfma_f32_16x16x32_bf16 v[68:71], a[60:63], v[40:43], v[68:71]
    ds_read_b128 v[32:35], v112 offset:12288
    s_waitcnt lgkmcnt(5)
    v_mfma_f32_16x16x32_bf16 v[56:59], a[48:51], v[44:47], v[56:59]
    v_mfma_f32_16x16x32_bf16 v[60:63], a[52:55], v[44:47], v[60:63]
    v_mfma_f32_16x16x32_bf16 v[72:75], a[56:59], v[44:47], v[72:75]
    v_mfma_f32_16x16x32_bf16 v[76:79], a[60:63], v[44:47], v[76:79]
    ds_read_b128 v[36:39], v112 offset:14336
    s_waitcnt lgkmcnt(5)
    v_mfma_f32_16x16x32_bf16 v[48:51], a[64:67], v[16:19], v[48:51]
    v_mfma_f32_16x16x32_bf16 v[52:55], a[68:71], v[16:19], v[52:55]
    v_mfma_f32_16x16x32_bf16 v[64:67], a[72:75], v[16:19], v[64:67]
    v_cvt_pk_bf16_f32 v104, v104, v105
    v_cvt_pk_bf16_f32 v105, v106, v107
    v_mfma_f32_16x16x32_bf16 v[68:71], a[76:79], v[16:19], v[68:71]
    ds_read_b128 v[40:43], v113 offset:12288
    s_waitcnt lgkmcnt(5)
    v_mfma_f32_16x16x32_bf16 v[56:59], a[64:67], v[20:23], v[56:59]
    v_cvt_pk_bf16_f32 v106, v108, v109
    v_cvt_pk_bf16_f32 v107, v110, v111
    v_mfma_f32_16x16x32_bf16 v[60:63], a[68:71], v[20:23], v[60:63]
    s_add_u32 s48, s53, s39
    buffer_store_dwordx4 v[104:107], v4, s[24:27], s48 offen
    v_mfma_f32_16x16x32_bf16 v[72:75], a[72:75], v[20:23], v[72:75]
    v_mfma_f32_16x16x32_bf16 v[76:79], a[76:79], v[20:23], v[76:79]
    ds_read_b128 v[44:47], v113 offset:14336
    s_waitcnt lgkmcnt(5)
    v_mfma_f32_16x16x32_bf16 v[48:51], a[80:83], v[24:27], v[48:51]
    v_mfma_f32_16x16x32_bf16 v[52:55], a[84:87], v[24:27], v[52:55]
    v_mfma_f32_16x16x32_bf16 v[64:67], a[88:91], v[24:27], v[64:67]
    v_mfma_f32_16x16x32_bf16 v[68:71], a[92:95], v[24:27], v[68:71]
    ds_read_b128 v[16:19], v112 offset:16384
    s_waitcnt lgkmcnt(5)
    v_mfma_f32_16x16x32_bf16 v[56:59], a[80:83], v[28:31], v[56:59]
    v_mfma_f32_16x16x32_bf16 v[60:63], a[84:87], v[28:31], v[60:63]
    s_sub_u32 s47, s49, 40960
    s_cselect_b32 s52, 81920, s47
    s_add_u32 s47, s44, 2
    v_mfma_f32_16x16x32_bf16 v[72:75], a[88:91], v[28:31], v[72:75]
    s_sub_u32 s45, s33, 1
    s_min_u32 s45, s45, s47
    v_mfma_f32_16x16x32_bf16 v[76:79], a[92:95], v[28:31], v[76:79]
    ds_read_b128 v[20:23], v112 offset:18432
    s_waitcnt lgkmcnt(5)
    v_mfma_f32_16x16x32_bf16 v[48:51], a[96:99], v[32:35], v[48:51]
    s_mul_i32 s45, s45, 40960
    s_add_u32 s45, s45, s50
    v_mfma_f32_16x16x32_bf16 v[52:55], a[100:103], v[32:35], v[52:55]
    s_add_u32 s46, s52, s51
    s_sub_u32 s48, s44, s32
    v_mfma_f32_16x16x32_bf16 v[64:67], a[104:107], v[32:35], v[64:67]
    s_mul_i32 s48, s48, s35
    s_add_u32 s53, s48, s34
    v_mfma_f32_16x16x32_bf16 v[68:71], a[108:111], v[32:35], v[68:71]
    ds_read_b128 v[24:27], v113 offset:16384
    s_waitcnt lgkmcnt(5)
    v_mfma_f32_16x16x32_bf16 v[56:59], a[96:99], v[36:39], v[56:59]
    s_add_u32 s49, s49, 40960
    s_cmp_eq_u32 s49, 122880
    s_cselect_b32 s49, 0, s49
    v_mfma_f32_16x16x32_bf16 v[60:63], a[100:103], v[36:39], v[60:63]
    v_add_u32 v114, s49, v15
    v_xor_b32 v115, 64, v114
    v_mfma_f32_16x16x32_bf16 v[72:75], a[104:107], v[36:39], v[72:75]
    s_sub_u32 s48, s33, 1
    s_add_u32 s59, s44, 4
    v_mfma_f32_16x16x32_bf16 v[76:79], a[108:111], v[36:39], v[76:79]
    ds_read_b128 v[28:31], v113 offset:18432
    s_waitcnt lgkmcnt(5)
    v_mfma_f32_16x16x32_bf16 v[48:51], a[112:115], v[40:43], v[48:51]
    s_min_u32 s48, s48, s59
    s_mul_i32 s48, s48, 40960
    v_mfma_f32_16x16x32_bf16 v[52:55], a[116:119], v[40:43], v[52:55]
    s_add_u32 s59, s48, s31
    v_mfma_f32_16x16x32_bf16 v[64:67], a[120:123], v[40:43], v[64:67]
    v_mfma_f32_16x16x32_bf16 v[68:71], a[124:127], v[40:43], v[68:71]
    ds_read_b128 v[32:35], v112 offset:20480
    s_waitcnt lgkmcnt(5)
    v_mfma_f32_16x16x32_bf16 v[56:59], a[112:115], v[44:47], v[56:59]
    v_mfma_f32_16x16x32_bf16 v[60:63], a[116:119], v[44:47], v[60:63]
    v_mfma_f32_16x16x32_bf16 v[72:75], a[120:123], v[44:47], v[72:75]
    v_mfma_f32_16x16x32_bf16 v[76:79], a[124:127], v[44:47], v[76:79]
    ds_read_b128 v[36:39], v112 offset:22528
    s_waitcnt lgkmcnt(5)
    v_mfma_f32_16x16x32_bf16 v[48:51], a[128:131], v[16:19], v[48:51]
    v_mfma_f32_16x16x32_bf16 v[52:55], a[132:135], v[16:19], v[52:55]
    v_mfma_f32_16x16x32_bf16 v[64:67], a[136:139], v[16:19], v[64:67]
    v_mfma_f32_16x16x32_bf16 v[68:71], a[140:143], v[16:19], v[68:71]
    ds_read_b128 v[40:43], v113 offset:20480
    s_waitcnt lgkmcnt(5)
    v_mfma_f32_16x16x32_bf16 v[56:59], a[128:131], v[20:23], v[56:59]
    v_mfma_f32_16x16x32_bf16 v[60:63], a[132:135], v[20:23], v[60:63]
    v_mfma_f32_16x16x32_bf16 v[72:75], a[136:139], v[20:23], v[72:75]
    v_mfma_f32_16x16x32_bf16 v[76:79], a[140:143], v[20:23], v[76:79]
    ds_read_b128 v[44:47], v113 offset:22528
    s_waitcnt lgkmcnt(5)
    v_mfma_f32_16x16x32_bf16 v[48:51], a[144:147], v[24:27], v[48:51]
    v_mfma_f32_16x16x32_bf16 v[52:55], a[148:151], v[24:27], v[52:55]
    v_mfma_f32_16x16x32_bf16 v[64:67], a[152:155], v[24:27], v[64:67]
    v_mfma_f32_16x16x32_bf16 v[68:71], a[156:159], v[24:27], v[68:71]
    ds_read_b128 v[16:19], v112 offset:24576
    s_waitcnt lgkmcnt(5)
    v_mfma_f32_16x16x32_bf16 v[56:59], a[144:147], v[28:31], v[56:59]
    v_mfma_f32_16x16x32_bf16 v[60:63], a[148:151], v[28:31], v[60:63]
    v_mfma_f32_16x16x32_bf16 v[72:75], a[152:155], v[28:31], v[72:75]
    v_mfma_f32_16x16x32_bf16 v[76:79], a[156:159], v[28:31], v[76:79]
    ds_read_b128 v[20:23], v112 offset:26624
    s_waitcnt lgkmcnt(5)
    v_mfma_f32_16x16x32_bf16 v[48:51], a[160:163], v[32:35], v[48:51]
    v_mfma_f32_16x16x32_bf16 v[52:55], a[164:167], v[32:35], v[52:55]
    v_mfma_f32_16x16x32_bf16 v[64:67], a[168:171], v[32:35], v[64:67]
    v_mfma_f32_16x16x32_bf16 v[68:71], a[172:175], v[32:35], v[68:71]
    ds_read_b128 v[24:27], v113 offset:24576
    s_waitcnt lgkmcnt(5)
    v_mfma_f32_16x16x32_bf16 v[56:59], a[160:163], v[36:39], v[56:59]
    v_mfma_f32_16x16x32_bf16 v[60:63], a[164:167], v[36:39], v[60:63]
    v_mfma_f32_16x16x32_bf16 v[72:75], a[168:171], v[36:39], v[72:75]
    v_mfma_f32_16x16x32_bf16 v[76:79], a[172:175], v[36:39], v[76:79]
    ds_read_b128 v[28:31], v113 offset:26624
    s_waitcnt lgkmcnt(5)
    v_mfma_f32_16x16x32_bf16 v[48:51], a[176:179], v[40:43], v[48:51]
    v_mfma_f32_16x16x32_bf16 v[52:55], a[180:183], v[40:43], v[52:55]
    v_mfma_f32_16x16x32_bf16 v[64:67], a[184:187], v[40:43], v[64:67]
    v_mfma_f32_16x16x32_bf16 v[68:71], a[188:191], v[40:43], v[68:71]
    ds_read_b128 v[32:35], v112 offset:28672
    s_waitcnt lgkmcnt(5)
    v_mfma_f32_16x16x32_bf16 v[56:59], a[176:179], v[44:47], v[56:59]
    v_mfma_f32_16x16x32_bf16 v[60:63], a[180:183], v[44:47], v[60:63]
    v_mfma_f32_16x16x32_bf16 v[72:75], a[184:187], v[44:47], v[72:75]
    v_mfma_f32_16x16x32_bf16 v[76:79], a[188:191], v[44:47], v[76:79]
    ds_read_b128 v[36:39], v112 offset:30720
    s_waitcnt lgkmcnt(5)
    v_mfma_f32_16x16x32_bf16 v[48:51], a[192:195], v[16:19], v[48:51]
    v_mfma_f32_16x16x32_bf16 v[52:55], a[196:199], v[16:19], v[52:55]
    v_mfma_f32_16x16x32_bf16 v[64:67], a[200:203], v[16:19], v[64:67]
    v_mfma_f32_16x16x32_bf16 v[68:71], a[204:207], v[16:19], v[68:71]
    ds_read_b128 v[40:43], v113 offset:28672
    s_waitcnt lgkmcnt(5)
    v_mfma_f32_16x16x32_bf16 v[56:59], a[192:195], v[20:23], v[56:59]
    v_mfma_f32_16x16x32_bf16 v[60:63], a[196:199], v[20:23], v[60:63]
    v_mfma_f32_16x16x32_bf16 v[72:75], a[200:203], v[20:23], v[72:75]
    v_mfma_f32_16x16x32_bf16 v[76:79], a[204:207], v[20:23], v[76:79]
    ds_read_b128 v[44:47], v113 offset:30720
    s_waitcnt lgkmcnt(5)
    v_mfma_f32_16x16x32_bf16 v[48:51], a[208:211], v[24:27], v[48:51]
    s_waitcnt vmcnt(0)
    s_barrier
    v_mfma_f32_16x16x32_bf16 v[52:55], a[212:215], v[24:27], v[52:55]
    v_mov_b32 v10, s44
    buffer_store_dword v10, v5, s[4:7], s40 offen sc1
    v_mfma_f32_16x16x32_bf16 v[64:67], a[216:219], v[24:27], v[64:67]
    s_add_u32 s44, s44, 1
    v_mfma_f32_16x16x32_bf16 v[68:71], a[220:223], v[24:27], v[68:71]
    ds_read_b128 v[16:19], v112 offset:32768
    s_waitcnt lgkmcnt(5)
    v_mfma_f32_16x16x32_bf16 v[56:59], a[208:211], v[28:31], v[56:59]
    s_add_u32 m0, s46, 0
    v_mfma_f32_16x16x32_bf16 v[60:63], a[212:215], v[28:31], v[60:63]
    buffer_load_dwordx4 v3, s[20:23], s45 offen offset:0 sc1 lds
    v_mfma_f32_16x16x32_bf16 v[72:75], a[216:219], v[28:31], v[72:75]
    v_mfma_f32_16x16x32_bf16 v[76:79], a[220:223], v[28:31], v[76:79]
    ds_read_b128 v[20:23], v112 offset:34816
    s_waitcnt lgkmcnt(5)
    v_mfma_f32_16x16x32_bf16 v[48:51], a[224:227], v[32:35], v[48:51]
    s_add_u32 m0, s46, 3968
    v_mfma_f32_16x16x32_bf16 v[52:55], a[228:231], v[32:35], v[52:55]
    buffer_load_dwordx4 v3, s[20:23], s45 offen offset:128 sc1 lds
    v_mfma_f32_16x16x32_bf16 v[64:67], a[232:235], v[32:35], v[64:67]
    v_mfma_f32_16x16x32_bf16 v[68:71], a[236:239], v[32:35], v[68:71]
    ds_read_b128 v[24:27], v113 offset:32768
    s_waitcnt lgkmcnt(5)
    v_mfma_f32_16x16x32_bf16 v[56:59], a[224:227], v[36:39], v[56:59]
    s_add_u32 m0, s46, 7936
    v_mfma_f32_16x16x32_bf16 v[60:63], a[228:231], v[36:39], v[60:63]
    buffer_load_dwordx4 v3, s[20:23], s45 offen offset:256 sc1 lds
    v_mfma_f32_16x16x32_bf16 v[72:75], a[232:235], v[36:39], v[72:75]
    v_mfma_f32_16x16x32_bf16 v[76:79], a[236:239], v[36:39], v[76:79]
    ds_read_b128 v[28:31], v113 offset:34816
    s_waitcnt lgkmcnt(5)
    v_mfma_f32_16x16x32_bf16 v[48:51], a[240:243], v[40:43], v[48:51]
    s_add_u32 m0, s46, 11904
    v_mfma_f32_16x16x32_bf16 v[52:55], a[244:247], v[40:43], v[52:55]
    buffer_load_dwordx4 v3, s[20:23], s45 offen offset:384 sc1 lds
    v_mfma_f32_16x16x32_bf16 v[64:67], a[248:251], v[40:43], v[64:67]
    v_mfma_f32_16x16x32_bf16 v[68:71], a[252:255], v[40:43], v[68:71]
    ds_read_b128 v[32:35], v112 offset:36864
    s_waitcnt lgkmcnt(5)
    v_mfma_f32_16x16x32_bf16 v[56:59], a[240:243], v[44:47], v[56:59]
    s_add_u32 m0, s46, 15872
    v_mfma_f32_16x16x32_bf16 v[60:63], a[244:247], v[44:47], v[60:63]
    buffer_load_dwordx4 v3, s[20:23], s45 offen offset:512 sc1 lds
    v_mfma_f32_16x16x32_bf16 v[72:75], a[248:251], v[44:47], v[72:75]
    v_mfma_f32_16x16x32_bf16 v[76:79], a[252:255], v[44:47], v[76:79]
    ds_read_b128 v[36:39], v112 offset:38912
    s_waitcnt lgkmcnt(5)
    v_mfma_f32_16x16x32_bf16 v[48:51], v[192:195], v[16:19], v[48:51]
    s_add_u32 m0, s46, 19840
    v_mfma_f32_16x16x32_bf16 v[52:55], v[196:199], v[16:19], v[52:55]
    buffer_load_dwordx4 v3, s[20:23], s45 offen offset:640 sc1 lds
    v_mfma_f32_16x16x32_bf16 v[64:67], v[200:203], v[16:19], v[64:67]
    v_mfma_f32_16x16x32_bf16 v[68:71], v[204:207], v[16:19], v[68:71]
    ds_read_b128 v[40:43], v113 offset:36864
    s_waitcnt lgkmcnt(5)
    v_mfma_f32_16x16x32_bf16 v[56:59], v[192:195], v[20:23], v[56:59]
    s_add_u32 m0, s46, 23808
    v_mfma_f32_16x16x32_bf16 v[60:63], v[196:199], v[20:23], v[60:63]
    buffer_load_dwordx4 v3, s[20:23], s45 offen offset:768 sc1 lds
    v_mfma_f32_16x16x32_bf16 v[72:75], v[200:203], v[20:23], v[72:75]
    v_mfma_f32_16x16x32_bf16 v[76:79], v[204:207], v[20:23], v[76:79]
    ds_read_b128 v[44:47], v113 offset:38912
    s_waitcnt lgkmcnt(5)
    v_mfma_f32_16x16x32_bf16 v[48:51], v[208:211], v[24:27], v[48:51]
    s_add_u32 m0, s46, 27776
    v_mfma_f32_16x16x32_bf16 v[52:55], v[212:215], v[24:27], v[52:55]
    buffer_load_dwordx4 v3, s[20:23], s45 offen offset:896 sc1 lds
    v_mfma_f32_16x16x32_bf16 v[64:67], v[216:219], v[24:27], v[64:67]
    v_mfma_f32_16x16x32_bf16 v[68:71], v[220:223], v[24:27], v[68:71]
    ds_read_b128 v[16:19], v114 offset:0
    s_waitcnt lgkmcnt(5)
    v_mfma_f32_16x16x32_bf16 v[56:59], v[208:211], v[28:31], v[56:59]
    s_add_u32 m0, s46, 31744
    v_mfma_f32_16x16x32_bf16 v[60:63], v[212:215], v[28:31], v[60:63]
    buffer_load_dwordx4 v3, s[20:23], s45 offen offset:1024 sc1 lds
    v_mfma_f32_16x16x32_bf16 v[72:75], v[216:219], v[28:31], v[72:75]
    v_mfma_f32_16x16x32_bf16 v[76:79], v[220:223], v[28:31], v[76:79]
    ds_read_b128 v[20:23], v114 offset:2048
    s_waitcnt lgkmcnt(5)
    v_mfma_f32_16x16x32_bf16 v[48:51], v[224:227], v[32:35], v[48:51]
    s_add_u32 m0, s46, 35712
    v_mfma_f32_16x16x32_bf16 v[52:55], v[228:231], v[32:35], v[52:55]
    buffer_load_dwordx4 v3, s[20:23], s45 offen offset:1152 sc1 lds
    v_mfma_f32_16x16x32_bf16 v[64:67], v[232:235], v[32:35], v[64:67]
    v_mfma_f32_16x16x32_bf16 v[68:71], v[236:239], v[32:35], v[68:71]
    ds_read_b128 v[24:27], v115 offset:0
    s_waitcnt lgkmcnt(5)
    v_mfma_f32_16x16x32_bf16 v[56:59], v[224:227], v[36:39], v[56:59]
    buffer_load_dword v117, v116, s[20:23], s59 offen sc1
    v_mfma_f32_16x16x32_bf16 v[60:63], v[228:231], v[36:39], v[60:63]
    v_mfma_f32_16x16x32_bf16 v[72:75], v[232:235], v[36:39], v[72:75]
    v_mfma_f32_16x16x32_bf16 v[76:79], v[236:239], v[36:39], v[76:79]
    ds_read_b128 v[28:31], v115 offset:2048
    s_waitcnt lgkmcnt(5)
    v_mfma_f32_16x16x32_bf16 v[48:51], v[240:243], v[40:43], v[48:51]
    v_mfma_f32_16x16x32_bf16 v[52:55], v[244:247], v[40:43], v[52:55]
    v_mfma_f32_16x16x32_bf16 v[64:67], v[248:251], v[40:43], v[64:67]
    v_mfma_f32_16x16x32_bf16 v[68:71], v[252:255], v[40:43], v[68:71]
    ds_read_b128 v[32:35], v114 offset:4096
    s_waitcnt lgkmcnt(5)
    v_mfma_f32_16x16x32_bf16 v[56:59], v[240:243], v[44:47], v[56:59]
    v_mfma_f32_16x16x32_bf16 v[60:63], v[244:247], v[44:47], v[60:63]
    v_mfma_f32_16x16x32_bf16 v[72:75], v[248:251], v[44:47], v[72:75]
    s_cmp_lt_u32 s44, s33
    v_mfma_f32_16x16x32_bf16 v[76:79], v[252:255], v[44:47], v[76:79]
    ds_read_b128 v[36:39], v114 offset:6144
    s_cbranch_scc0 Lg_Re0
Lg_R1:
    s_waitcnt lgkmcnt(5)
    v_mfma_f32_16x16x32_bf16 v[80:83], a[0:3], v[16:19], 0
    v_mfma_f32_16x16x32_bf16 v[84:87], a[4:7], v[16:19], 0
    v_mfma_f32_16x16x32_bf16 v[96:99], a[8:11], v[16:19], 0
    v_cvt_pk_bf16_f32 v48, v48, v49
    v_cvt_pk_bf16_f32 v49, v50, v51
    v_mfma_f32_16x16x32_bf16 v[100:103], a[12:15], v[16:19], 0
    ds_read_b128 v[40:43], v115 offset:4096
    s_waitcnt lgkmcnt(5)
    v_mfma_f32_16x16x32_bf16 v[88:91], a[0:3], v[20:23], 0
    v_cvt_pk_bf16_f32 v50, v52, v53
    v_cvt_pk_bf16_f32 v51, v54, v55
    v_mfma_f32_16x16x32_bf16 v[92:95], a[4:7], v[20:23], 0
    s_add_u32 s48, s53, s36
    buffer_store_dwordx4 v[48:51], v4, s[24:27], s48 offen
    v_mfma_f32_16x16x32_bf16 v[104:107], a[8:11], v[20:23], 0
    v_mfma_f32_16x16x32_bf16 v[108:111], a[12:15], v[20:23], 0
    ds_read_b128 v[44:47], v115 offset:6144
    s_waitcnt lgkmcnt(5)
    v_mfma_f32_16x16x32_bf16 v[80:83], a[16:19], v[24:27], v[80:83]
    v_mfma_f32_16x16x32_bf16 v[84:87], a[20:23], v[24:27], v[84:87]
    v_mfma_f32_16x16x32_bf16 v[96:99], a[24:27], v[24:27], v[96:99]
    v_mfma_f32_16x16x32_bf16 v[100:103], a[28:31], v[24:27], v[100:103]
    ds_read_b128 v[16:19], v114 offset:8192
    s_waitcnt lgkmcnt(5)
    v_mfma_f32_16x16x32_bf16 v[88:91], a[16:19], v[28:31], v[88:91]
    v_mfma_f32_16x16x32_bf16 v[92:95], a[20:23], v[28:31], v[92:95]
    v_cvt_pk_bf16_f32 v56, v56, v57
    v_cvt_pk_bf16_f32 v57, v58, v59
    v_mfma_f32_16x16x32_bf16 v[104:107], a[24:27], v[28:31], v[104:107]
    v_cvt_pk_bf16_f32 v58, v60, v61
    v_cvt_pk_bf16_f32 v59, v62, v63
    v_mfma_f32_16x16x32_bf16 v[108:111], a[28:31], v[28:31], v[108:111]
    ds_read_b128 v[20:23], v114 offset:10240
    s_waitcnt lgkmcnt(5)
    v_mfma_f32_16x16x32_bf16 v[80:83], a[32:35], v[32:35], v[80:83]
    s_add_u32 s48, s53, s37
    buffer_store_dwordx4 v[56:59], v4, s[24:27], s48 offen
    v_mfma_f32_16x16x32_bf16 v[84:87], a[36:39], v[32:35], v[84:87]
    v_mfma_f32_16x16x32_bf16 v[96:99], a[40:43], v[32:35], v[96:99]
    v_mfma_f32_16x16x32_bf16 v[100:103], a[44:47], v[32:35], v[100:103]
    ds_read_b128 v[24:27], v115 offset:8192
    s_waitcnt lgkmcnt(5)
    v_mfma_f32_16x16x32_bf16 v[88:91], a[32:35], v[36:39], v[88:91]
    v_mfma_f32_16x16x32_bf16 v[92:95], a[36:39], v[36:39], v[92:95]
    v_mfma_f32_16x16x32_bf16 v[104:107], a[40:43], v[36:39], v[104:107]
    v_mfma_f32_16x16x32_bf16 v[108:111], a[44:47], v[36:39], v[108:111]
    ds_read_b128 v[28:31], v115 offset:10240
    s_waitcnt lgkmcnt(5)
    v_mfma_f32_16x16x32_bf16 v[80:83], a[48:51], v[40:43], v[80:83]
    v_cvt_pk_bf16_f32 v64, v64, v65
    v_cvt_pk_bf16_f32 v65, v66, v67
    v_mfma_f32_16x16x32_bf16 v[84:87], a[52:55], v[40:43], v[84:87]
    v_cvt_pk_bf16_f32 v66, v68, v69
    v_cvt_pk_bf16_f32 v67, v70, v71
    v_mfma_f32_16x16x32_bf16 v[96:99], a[56:59], v[40:43], v[96:99]
    s_add_u32 s48, s53, s38
    buffer_store_dwordx4 v[64:67], v4, s[24:27], s48 offen
    v_mfma_f32_16x16x32_bf16 v[100:103], a[60:63], v[40:43], v[100:103]
    ds_read_b128 v[32:35], v114 offset:12288
    s_waitcnt lgkmcnt(5)
    v_mfma_f32_16x16x32_bf16 v[88:91], a[48:51], v[44:47], v[88:91]
    v_mfma_f32_16x16x32_bf16 v[92:95], a[52:55], v[44:47], v[92:95]
    v_mfma_f32_16x16x32_bf16 v[104:107], a[56:59], v[44:47], v[104:107]
    v_mfma_f32_16x16x32_bf16 v[108:111], a[60:63], v[44:47], v[108:111]
    ds_read_b128 v[36:39], v114 offset:14336
    s_waitcnt lgkmcnt(5)
    v_mfma_f32_16x16x32_bf16 v[80:83], a[64:67], v[16:19], v[80:83]
    v_mfma_f32_16x16x32_bf16 v[84:87], a[68:71], v[16:19], v[84:87]
    v_mfma_f32_16x16x32_bf16 v[96:99], a[72:75], v[16:19], v[96:99]
    v_cvt_pk_bf16_f32 v72, v72, v73
    v_cvt_pk_bf16_f32 v73, v74, v75
    v_mfma_f32_16x16x32_bf16 v[100:103], a[76:79], v[16:19], v[100:103]
    ds_read_b128 v[40:43], v115 offset:12288
    s_waitcnt lgkmcnt(5)
    v_mfma_f32_16x16x32_bf16 v[88:91], a[64:67], v[20:23], v[88:91]
    v_cvt_pk_bf16_f32 v74, v76, v77
    v_cvt_pk_bf16_f32 v75, v78, v79
    v_mfma_f32_16x16x32_bf16 v[92:95], a[68:71], v[20:23], v[92:95]
    s_add_u32 s48, s53, s39
    buffer_store_dwordx4 v[72:75], v4, s[24:27], s48 offen
    v_mfma_f32_16x16x32_bf16 v[104:107], a[72:75], v[20:23], v[104:107]
    v_mfma_f32_16x16x32_bf16 v[108:111], a[76:79], v[20:23], v[108:111]
    ds_read_b128 v[44:47], v115 offset:14336
    s_waitcnt lgkmcnt(5)
    v_mfma_f32_16x16x32_bf16 v[80:83], a[80:83], v[24:27], v[80:83]
    v_mfma_f32_16x16x32_bf16 v[84:87], a[84:87], v[24:27], v[84:87]
    v_mfma_f32_16x16x32_bf16 v[96:99], a[88:91], v[24:27], v[96:99]
    v_mfma_f32_16x16x32_bf16 v[100:103], a[92:95], v[24:27], v[100:103]
    ds_read_b128 v[16:19], v114 offset:16384
    s_waitcnt lgkmcnt(5)
    v_mfma_f32_16x16x32_bf16 v[88:91], a[80:83], v[28:31], v[88:91]
    v_mfma_f32_16x16x32_bf16 v[92:95], a[84:87], v[28:31], v[92:95]
    s_sub_u32 s47, s49, 40960
    s_cselect_b32 s52, 81920, s47
    s_add_u32 s47, s44, 2
    v_mfma_f32_16x16x32_bf16 v[104:107], a[88:91], v[28:31], v[104:107]
    s_sub_u32 s45, s33, 1
    s_min_u32 s45, s45, s47
    v_mfma_f32_16x16x32_bf16 v[108:111], a[92:95], v[28:31], v[108:111]
    ds_read_b128 v[20:23], v114 offset:18432
    s_waitcnt lgkmcnt(5)
    v_mfma_f32_16x16x32_bf16 v[80:83], a[96:99], v[32:35], v[80:83]
    s_mul_i32 s45, s45, 40960
    s_add_u32 s45, s45, s50
    v_mfma_f32_16x16x32_bf16 v[84:87], a[100:103], v[32:35], v[84:87]
    s_add_u32 s46, s52, s51
    s_sub_u32 s48, s44, s32
    v_mfma_f32_16x16x32_bf16 v[96:99], a[104:107], v[32:35], v[96:99]
    s_mul_i32 s48, s48, s35
    s_add_u32 s53, s48, s34
    v_mfma_f32_16x16x32_bf16 v[100:103], a[108:111], v[32:35], v[100:103]
    ds_read_b128 v[24:27], v115 offset:16384
    s_waitcnt lgkmcnt(5)
    v_mfma_f32_16x16x32_bf16 v[88:91], a[96:99], v[36:39], v[88:91]
    s_add_u32 s49, s49, 40960
    s_cmp_eq_u32 s49, 122880
    s_cselect_b32 s49, 0, s49
    v_mfma_f32_16x16x32_bf16 v[92:95], a[100:103], v[36:39], v[92:95]
    v_add_u32 v112, s49, v15
    v_xor_b32 v113, 64, v112
    v_mfma_f32_16x16x32_bf16 v[104:107], a[104:107], v[36:39], v[104:107]
    s_sub_u32 s48, s33, 1
    s_add_u32 s59, s44, 4
    v_mfma_f32_16x16x32_bf16 v[108:111], a[108:111], v[36:39], v[108:111]
    ds_read_b128 v[28:31], v115 offset:18432
    s_waitcnt lgkmcnt(5)
    v_mfma_f32_16x16x32_bf16 v[80:83], a[112:115], v[40:43], v[80:83]
    s_min_u32 s48, s48, s59
    s_mul_i32 s48, s48, 40960
    v_mfma_f32_16x16x32_bf16 v[84:87], a[116:119], v[40:43], v[84:87]
    s_add_u32 s59, s48, s31
    v_mfma_f32_16x16x32_bf16 v[96:99], a[120:123], v[40:43], v[96:99]
    v_mfma_f32_16x16x32_bf16 v[100:103], a[124:127], v[40:43], v[100:103]
    ds_read_b128 v[32:35], v114 offset:20480
    s_waitcnt lgkmcnt(5)
    v_mfma_f32_16x16x32_bf16 v[88:91], a[112:115], v[44:47], v[88:91]
    v_mfma_f32_16x16x32_bf16 v[92:95], a[116:119], v[44:47], v[92:95]
    v_mfma_f32_16x16x32_bf16 v[104:107], a[120:123], v[44:47], v[104:107]
    v_mfma_f32_16x16x32_bf16 v[108:111], a[124:127], v[44:47], v[108:111]
    ds_read_b128 v[36:39], v114 offset:22528
    s_waitcnt lgkmcnt(5)
    v_mfma_f32_16x16x32_bf16 v[80:83], a[128:131], v[16:19], v[80:83]
    v_mfma_f32_16x16x32_bf16 v[84:87], a[132:135], v[16:19], v[84:87]
    v_mfma_f32_16x16x32_bf16 v[96:99], a[136:139], v[16:19], v[96:99]
    v_mfma_f32_16x16x32_bf16 v[100:103], a[140:143], v[16:19], v[100:103]
    ds_read_b128 v[40:43], v115 offset:20480
    s_waitcnt lgkmcnt(5)
    v_mfma_f32_16x16x32_bf16 v[88:91], a[128:131], v[20:23], v[88:91]
    v_mfma_f32_16x16x32_bf16 v[92:95], a[132:135], v[20:23], v[92:95]
    v_mfma_f32_16x16x32_bf16 v[104:107], a[136:139], v[20:23], v[104:107]
    v_mfma_f32_16x16x32_bf16 v[108:111], a[140:143], v[20:23], v[108:111]
    ds_read_b128 v[44:47], v115 offset:22528
    s_waitcnt lgkmcnt(5)
    v_mfma_f32_16x16x32_bf16 v[80:83], a[144:147], v[24:27], v[80:83]
    v_mfma_f32_16x16x32_bf16 v[84:87], a[148:151], v[24:27], v[84:87]
    v_mfma_f32_16x16x32_bf16 v[96:99], a[152:155], v[24:27], v[96:99]
    v_mfma_f32_16x16x32_bf16 v[100:103], a[156:159], v[24:27], v[100:103]
    ds_read_b128 v[16:19], v114 offset:24576
    s_waitcnt lgkmcnt(5)
    v_mfma_f32_16x16x32_bf16 v[88:91], a[144:147], v[28:31], v[88:91]
    v_mfma_f32_16x16x32_bf16 v[92:95], a[148:151], v[28:31], v[92:95]
    v_mfma_f32_16x16x32_bf16 v[104:107], a[152:155], v[28:31], v[104:107]
    v_mfma_f32_16x16x32_bf16 v[108:111], a[156:159], v[28:31], v[108:111]
    ds_read_b128 v[20:23], v114 offset:26624
    s_waitcnt lgkmcnt(5)
    v_mfma_f32_16x16x32_bf16 v[80:83], a[160:163], v[32:35], v[80:83]
    v_mfma_f32_16x16x32_bf16 v[84:87], a[164:167], v[32:35], v[84:87]
    v_mfma_f32_16x16x32_bf16 v[96:99], a[168:171], v[32:35], v[96:99]
    v_mfma_f32_16x16x32_bf16 v[100:103], a[172:175], v[32:35], v[100:103]
    ds_read_b128 v[24:27], v115 offset:24576
    s_waitcnt lgkmcnt(5)
    v_mfma_f32_16x16x32_bf16 v[88:91], a[160:163], v[36:39], v[88:91]
    v_mfma_f32_16x16x32_bf16 v[92:95], a[164:167], v[36:39], v[92:95]
    v_mfma_f32_16x16x32_bf16 v[104:107], a[168:171], v[36:39], v[104:107]
    v_mfma_f32_16x16x32_bf16 v[108:111], a[172:175], v[36:39], v[108:111]
    ds_read_b128 v[28:31], v115 offset:26624
    s_waitcnt lgkmcnt(5)
    v_mfma_f32_16x16x32_bf16 v[80:83], a[176:179], v[40:43], v[80:83]
    v_mfma_f32_16x16x32_bf16 v[84:87], a[180:183], v[40:43], v[84:87]
    v_mfma_f32_16x16x32_bf16 v[96:99], a[184:187], v[40:43], v[96:99]
    v_mfma_f32_16x16x32_bf16 v[100:103], a[188:191], v[40:43], v[100:103]
    ds_read_b128 v[32:35], v114 offset:28672
    s_waitcnt lgkmcnt(5)
    v_mfma_f32_16x16x32_bf16 v[88:91], a[176:179], v[44:47], v[88:91]
    v_mfma_f32_16x16x32_bf16 v[92:95], a[180:183], v[44:47], v[92:95]
    v_mfma_f32_16x16x32_bf16 v[104:107], a[184:187], v[44:47], v[104:107]
    v_mfma_f32_16x16x32_bf16 v[108:111], a[188:191], v[44:47], v[108:111]
    ds_read_b128 v[36:39], v114 offset:30720
    s_waitcnt lgkmcnt(5)
    v_mfma_f32_16x16x32_bf16 v[80:83], a[192:195], v[16:19], v[80:83]
    v_mfma_f32_16x16x32_bf16 v[84:87], a[196:199], v[16:19], v[84:87]
    v_mfma_f32_16x16x32_bf16 v[96:99], a[200:203], v[16:19], v[96:99]
    v_mfma_f32_16x16x32_bf16 v[100:103], a[204:207], v[16:19], v[100:103]
    ds_read_b128 v[40:43], v115 offset:28672
    s_waitcnt lgkmcnt(5)
    v_mfma_f32_16x16x32_bf16 v[88:91], a[192:195], v[20:23], v[88:91]
    v_mfma_f32_16x16x32_bf16 v[92:95], a[196:199], v[20:23], v[92:95]
    v_mfma_f32_16x16x32_bf16 v[104:107], a[200:203], v[20:23], v[104:107]
    v_mfma_f32_16x16x32_bf16 v[108:111], a[204:207], v[20:23], v[108:111]
    ds_read_b128 v[44:47], v115 offset:30720
    s_waitcnt lgkmcnt(5)
    v_mfma_f32_16x16x32_bf16 v[80:83], a[208:211], v[24:27], v[80:83]
    s_waitcnt vmcnt(0)
    s_barrier
    v_mfma_f32_16x16x32_bf16 v[84:87], a[212:215], v[24:27], v[84:87]
    v_mov_b32 v10, s44
    buffer_store_dword v10, v5, s[4:7], s40 offen sc1
    v_mfma_f32_16x16x32_bf16 v[96:99], a[216:219], v[24:27], v[96:99]
    s_add_u32 s44, s44, 1
    v_mfma_f32_16x16x32_bf16 v[100:103], a[220:223], v[24:27], v[100:103]
    ds_read_b128 v[16:19], v114 offset:32768
    s_waitcnt lgkmcnt(5)
    v_mfma_f32_16x16x32_bf16 v[88:91], a[208:211], v[28:31], v[88:91]
    s_add_u32 m0, s46, 0
    v_mfma_f32_16x16x32_bf16 v[92:95], a[212:215], v[28:31], v[92:95]
    buffer_load_dwordx4 v3, s[20:23], s45 offen offset:0 sc1 lds
    v_mfma_f32_16x16x32_bf16 v[104:107], a[216:219], v[28:31], v[104:107]
    v_mfma_f32_16x16x32_bf16 v[108:111], a[220:223], v[28:31], v[108:111]
    ds_read_b128 v[20:23], v114 offset:34816
    s_waitcnt lgkmcnt(5)
    v_mfma_f32_16x16x32_bf16 v[80:83], a[224:227], v[32:35], v[80:83]
    s_add_u32 m0, s46, 3968
    v_mfma_f32_16x16x32_bf16 v[84:87], a[228:231], v[32:35], v[84:87]
    buffer_load_dwordx4 v3, s[20:23], s45 offen offset:128 sc1 lds
    v_mfma_f32_16x16x32_bf16 v[96:99], a[232:235], v[32:35], v[96:99]
    v_mfma_f32_16x16x32_bf16 v[100:103], a[236:239], v[32:35], v[100:103]
    ds_read_b128 v[24:27], v115 offset:32768
    s_waitcnt lgkmcnt(5)
    v_mfma_f32_16x16x32_bf16 v[88:91], a[224:227], v[36:39], v[88:91]
    s_add_u32 m0, s46, 7936
    v_mfma_f32_16x16x32_bf16 v[92:95], a[228:231], v[36:39], v[92:95]
    buffer_load_dwordx4 v3, s[20:23], s45 offen offset:256 sc1 lds
    v_mfma_f32_16x16x32_bf16 v[104:107], a[232:235], v[36:39], v[104:107]
    v_mfma_f32_16x16x32_bf16 v[108:111], a[236:239], v[36:39], v[108:111]
    ds_read_b128 v[28:31], v115 offset:34816
    s_waitcnt lgkmcnt(5)
    v_mfma_f32_16x16x32_bf16 v[80:83], a[240:243], v[40:43], v[80:83]
    s_add_u32 m0, s46, 11904
    v_mfma_f32_16x16x32_bf16 v[84:87], a[244:247], v[40:43], v[84:87]
    buffer_load_dwordx4 v3, s[20:23], s45 offen offset:384 sc1 lds
    v_mfma_f32_16x16x32_bf16 v[96:99], a[248:251], v[40:43], v[96:99]
    v_mfma_f32_16x16x32_bf16 v[100:103], a[252:255], v[40:43], v[100:103]
    ds_read_b128 v[32:35], v114 offset:36864
    s_waitcnt lgkmcnt(5)
    v_mfma_f32_16x16x32_bf16 v[88:91], a[240:243], v[44:47], v[88:91]
    s_add_u32 m0, s46, 15872
    v_mfma_f32_16x16x32_bf16 v[92:95], a[244:247], v[44:47], v[92:95]
    buffer_load_dwordx4 v3, s[20:23], s45 offen offset:512 sc1 lds
    v_mfma_f32_16x16x32_bf16 v[104:107], a[248:251], v[44:47], v[104:107]
    v_mfma_f32_16x16x32_bf16 v[108:111], a[252:255], v[44:47], v[108:111]
    ds_read_b128 v[36:39], v114 offset:38912
    s_waitcnt lgkmcnt(5)
    v_mfma_f32_16x16x32_bf16 v[80:83], v[192:195], v[16:19], v[80:83]
    s_add_u32 m0, s46, 19840
    v_mfma_f32_16x16x32_bf16 v[84:87], v[196:199], v[16:19], v[84:87]
    buffer_load_dwordx4 v3, s[20:23], s45 offen offset:640 sc1 lds
    v_mfma_f32_16x16x32_bf16 v[96:99], v[200:203], v[16:19], v[96:99]
    v_mfma_f32_16x16x32_bf16 v[100:103], v[204:207], v[16:19], v[100:103]
    ds_read_b128 v[40:43], v115 offset:36864
    s_waitcnt lgkmcnt(5)
    v_mfma_f32_16x16x32_bf16 v[88:91], v[192:195], v[20:23], v[88:91]
    s_add_u32 m0, s46, 23808
    v_mfma_f32_16x16x32_bf16 v[92:95], v[196:199], v[20:23], v[92:95]
    buffer_load_dwordx4 v3, s[20:23], s45 offen offset:768 sc1 lds
    v_mfma_f32_16x16x32_bf16 v[104:107], v[200:203], v[20:23], v[104:107]
    v_mfma_f32_16x16x32_bf16 v[108:111], v[204:207], v[20:23], v[108:111]
    ds_read_b128 v[44:47], v115 offset:38912
    s_waitcnt lgkmcnt(5)
    v_mfma_f32_16x16x32_bf16 v[80:83], v[208:211], v[24:27], v[80:83]
    s_add_u32 m0, s46, 27776
    v_mfma_f32_16x16x32_bf16 v[84:87], v[212:215], v[24:27], v[84:87]
    buffer_load_dwordx4 v3, s[20:23], s45 offen offset:896 sc1 lds
    v_mfma_f32_16x16x32_bf16 v[96:99], v[216:219], v[24:27], v[96:99]
    v_mfma_f32_16x16x32_bf16 v[100:103], v[220:223], v[24:27], v[100:103]
    ds_read_b128 v[16:19], v112 offset:0
    s_waitcnt lgkmcnt(5)
    v_mfma_f32_16x16x32_bf16 v[88:91], v[208:211], v[28:31], v[88:91]
    s_add_u32 m0, s46, 31744
    v_mfma_f32_16x16x32_bf16 v[92:95], v[212:215], v[28:31], v[92:95]
    buffer_load_dwordx4 v3, s[20:23], s45 offen offset:1024 sc1 lds
    v_mfma_f32_16x16x32_bf16 v[104:107], v[216:219], v[28:31], v[104:107]
    v_mfma_f32_16x16x32_bf16 v[108:111], v[220:223], v[28:31], v[108:111]
    ds_read_b128 v[20:23], v112 offset:2048
    s_waitcnt lgkmcnt(5)
    v_mfma_f32_16x16x32_bf16 v[80:83], v[224:227], v[32:35], v[80:83]
    s_add_u32 m0, s46, 35712
    v_mfma_f32_16x16x32_bf16 v[84:87], v[228:231], v[32:35], v[84:87]
    buffer_load_dwordx4 v3, s[20:23], s45 offen offset:1152 sc1 lds
    v_mfma_f32_16x16x32_bf16 v[96:99], v[232:235], v[32:35], v[96:99]
    v_mfma_f32_16x16x32_bf16 v[100:103], v[236:239], v[32:35], v[100:103]
    ds_read_b128 v[24:27], v113 offset:0
    s_waitcnt lgkmcnt(5)
    v_mfma_f32_16x16x32_bf16 v[88:91], v[224:227], v[36:39], v[88:91]
    buffer_load_dword v117, v116, s[20:23], s59 offen sc1
    v_mfma_f32_16x16x32_bf16 v[92:95], v[228:231], v[36:39], v[92:95]
    v_mfma_f32_16x16x32_bf16 v[104:107], v[232:235], v[36:39], v[104:107]
    v_mfma_f32_16x16x32_bf16 v[108:111], v[236:239], v[36:39], v[108:111]
    ds_read_b128 v[28:31], v113 offset:2048
    s_waitcnt lgkmcnt(5)
    v_mfma_f32_16x16x32_bf16 v[80:83], v[240:243], v[40:43], v[80:83]
    v_mfma_f32_16x16x32_bf16 v[84:87], v[244:247], v[40:43], v[84:87]
    v_mfma_f32_16x16x32_bf16 v[96:99], v[248:251], v[40:43], v[96:99]
    v_mfma_f32_16x16x32_bf16 v[100:103], v[252:255], v[40:43], v[100:103]
    ds_read_b128 v[32:35], v112 offset:4096
    s_waitcnt lgkmcnt(5)
    v_mfma_f32_16x16x32_bf16 v[88:91], v[240:243], v[44:47], v[88:91]
    v_mfma_f32_16x16x32_bf16 v[92:95], v[244:247], v[44:47], v[92:95]
    v_mfma_f32_16x16x32_bf16 v[104:107], v[248:251], v[44:47], v[104:107]
    s_cmp_lt_u32 s44, s33
    v_mfma_f32_16x16x32_bf16 v[108:111], v[252:255], v[44:47], v[108:111]
    ds_read_b128 v[36:39], v112 offset:6144
    s_cbranch_scc1 Lg_R0
Lg_Re1:
    v_cvt_pk_bf16_f32 v80, v80, v81
    v_cvt_pk_bf16_f32 v81, v82, v83
    v_cvt_pk_bf16_f32 v82, v84, v85
    v_cvt_pk_bf16_f32 v83, v86, v87
    s_add_u32 s48, s53, s36
    buffer_store_dwordx4 v[80:83], v4, s[24:27], s48 offen
    v_cvt_pk_bf16_f32 v88, v88, v89
    v_cvt_pk_bf16_f32 v89, v90, v91
    v_cvt_pk_bf16_f32 v90, v92, v93
    v_cvt_pk_bf16_f32 v91, v94, v95
    s_add_u32 s48, s53, s37
    buffer_store_dwordx4 v[88:91], v4, s[24:27], s48 offen
    v_cvt_pk_bf16_f32 v96, v96, v97
    v_cvt_pk_bf16_f32 v97, v98, v99
    v_cvt_pk_bf16_f32 v98, v100, v101
    v_cvt_pk_bf16_f32 v99, v102, v103
    s_add_u32 s48, s53, s38
    buffer_store_dwordx4 v[96:99], v4, s[24:27], s48 offen
    v_cvt_pk_bf16_f32 v104, v104, v105
    v_cvt_pk_bf16_f32 v105, v106, v107
    v_cvt_pk_bf16_f32 v106, v108, v109
    v_cvt_pk_bf16_f32 v107, v110, v111
    s_add_u32 s48, s53, s39
    buffer_store_dwordx4 v[104:107], v4, s[24:27], s48 offen
    s_branch Lg_end
Lg_Re0:
    v_cvt_pk_bf16_f32 v48, v48, v49
    v_cvt_pk_bf16_f32 v49, v50, v51
    v_cvt_pk_bf16_f32 v50, v52, v53
    v_cvt_pk_bf16_f32 v51, v54, v55
    s_add_u32 s48, s53, s36
    buffer_store_dwordx4 v[48:51], v4, s[24:27], s48 offen
    v_cvt_pk_bf16_f32 v56, v56, v57
    v_cvt_pk_bf16_f32 v57, v58, v59
    v_cvt_pk_bf16_f32 v58, v60, v61
    v_cvt_pk_bf16_f32 v59, v62, v63
    s_add_u32 s48, s53, s37
    buffer_store_dwordx4 v[56:59], v4, s[24:27], s48 offen
    v_cvt_pk_bf16_f32 v64, v64, v65
    v_cvt_pk_bf16_f32 v65, v66, v67
    v_cvt_pk_bf16_f32 v66, v68, v69
    v_cvt_pk_bf16_f32 v67, v70, v71
    s_add_u32 s48, s53, s38
    buffer_store_dwordx4 v[64:67], v4, s[24:27], s48 offen
    v_cvt_pk_bf16_f32 v72, v72, v73
    v_cvt_pk_bf16_f32 v73, v74, v75
    v_cvt_pk_bf16_f32 v74, v76, v77
    v_cvt_pk_bf16_f32 v75, v78, v79
    s_add_u32 s48, s53, s39
    buffer_store_dwordx4 v[72:75], v4, s[24:27], s48 offen
    s_branch Lg_end
Lg_end:
    s_waitcnt vmcnt(0) lgkmcnt(0)
    v_mov_b32 v10, s44
    buffer_store_dword v10, v5, s[4:7], s40 offen sc1
    s_cmp_eq_u32 s42, 1
    s_cbranch_scc1 Lb_p2
    s_cmp_eq_u32 s42, 0
    s_cbranch_scc1 Lb_p3
    s_and_b32 s45, s10, 31
    s_or_b32 s45, s45, s13
    s_cbranch_scc1 Lg_fin
    s_add_u32 s47, s14, 5570560
Lg_hw:
    buffer_load_dword v10, off, s[4:7], s47 sc1
    s_sub_u32 s12, s12, 4
    s_cbranch_scc1 L_abort
    s_waitcnt vmcnt(0)
    v_cmp_gt_u32 vcc, 62, v10
    s_cbranch_vccz Lg_hw_ok
    s_sleep 16
    s_branch Lg_hw
Lg_hw_ok:
    buffer_wbl2 sc1
Lg_fin:
    s_endpgm
Lb_p2:
    s_waitcnt vmcnt(0)
    s_barrier
    s_cmp_eq_u32 s13, 0
    s_cbranch_scc0 Lb_a1
    buffer_wbl2 sc1
    s_waitcnt vmcnt(0)
    v_mov_b32 v10, 76
    v_mov_b32 v11, 1
    s_mov_b64 exec, 1
    global_atomic_add v10, v11, s[8:9]
    s_mov_b64 exec, -1
Lb_a1:
    v_mov_b32 v10, 76
Lb_w1:
    global_load_dword v11, v10, s[8:9] sc1
    s_sub_u32 s12, s12, 1
    s_cbranch_scc1 L_abort
    s_waitcnt vmcnt(0)
    v_cmp_eq_u32 vcc, 16, v11
    s_cbranch_vccnz Lb_w1_ok
    s_sleep 8
    s_branch Lb_w1
Lb_w1_ok:
    v_lshrrev_b32 v252, 5, v0
    v_and_b32 v253, 31, v0
    v_mul_u32_u24 v253, 40, v253
    v_mul_u32_u24 v254, 3840, v252
    v_add_u32 v2, v254, v253
    v_mul_u32_u24 v254, 1280, v252
    v_add_u32 v3, v254, v253
    s_lshl_b32 s45, s43, 2
    s_add_u32 s45, s45, s13
    s_lshl_b32 s45, s45, 5
    s_sub_u32 s49, s45, 14
    s_sub_u32 s45, s49, 2
    v_add_u32 v4, s45, v252
    s_mov_b32 s50, 0x3fb8aa3b
    s_mov_b32 s51, 0x3e64f92e
    v_mov_b32 v5, 0xce6e6b28
    s_mul_i32 s45, s49, 3840
    s_add_u32 s45, s45, 104857600
    s_cmp_lt_u32 s49, 2048
    s_cselect_b32 s45, s45, 1073741824
    buffer_load_dwordx4 v[168:171], v2, s[4:7], s45 offen offset:0 sc1
    buffer_load_dwordx4 v[172:175], v2, s[4:7], s45 offen offset:16 sc1
    buffer_load_dwordx2 v[176:177], v2, s[4:7], s45 offen offset:32 sc1
    buffer_load_dwordx4 v[178:181], v2, s[4:7], s45 offen offset:1280 sc1
    buffer_load_dwordx4 v[182:185], v2, s[4:7], s45 offen offset:1296 sc1
    buffer_load_dwordx2 v[186:187], v2, s[4:7], s45 offen offset:1312 sc1
    buffer_load_dwordx4 v[188:191], v2, s[4:7], s45 offen offset:2560 sc1
    buffer_load_dwordx4 v[192:195], v2, s[4:7], s45 offen offset:2576 sc1
    buffer_load_dwordx2 v[196:197], v2, s[4:7], s45 offen offset:2592 sc1
    s_mov_b32 s44, 0
Lb_warm:
    s_waitcnt vmcnt(0)
Lb_loop:
    v_mov_b64 v[78:79], v[68:69]
    v_mov_b64 v[80:81], v[70:71]
    v_mov_b64 v[82:83], v[72:73]
    v_mov_b64 v[84:85], v[74:75]
    v_mov_b64 v[86:87], v[76:77]
    v_mov_b64 v[68:69], v[58:59]
    v_mov_b64 v[70:71], v[60:61]
    v_mov_b64 v[72:73], v[62:63]
    v_mov_b64 v[74:75], v[64:65]
    v_mov_b64 v[76:77], v[66:67]
    v_mov_b64 v[58:59], v[48:49]
    v_mov_b64 v[60:61], v[50:51]
    v_mov_b64 v[62:63], v[52:53]
    v_mov_b64 v[64:65], v[54:55]
    v_mov_b64 v[66:67], v[56:57]
    v_mov_b64 v[48:49], v[38:39]
    v_mov_b64 v[50:51], v[40:41]
    v_mov_b64 v[52:53], v[42:43]
    v_mov_b64 v[54:55], v[44:45]
    v_mov_b64 v[56:57], v[46:47]
    v_mov_b64 v[38:39], v[28:29]
    v_mov_b64 v[40:41], v[30:31]
    v_mov_b64 v[42:43], v[32:33]
    v_mov_b64 v[44:45], v[34:35]
    v_mov_b64 v[46:47], v[36:37]
    v_mov_b64 v[28:29], v[18:19]
    v_mov_b64 v[30:31], v[20:21]
    v_mov_b64 v[32:33], v[22:23]
    v_mov_b64 v[34:35], v[24:25]
    v_mov_b64 v[36:37], v[26:27]
    v_mov_b64 v[18:19], v[8:9]
    v_mov_b64 v[20:21], v[10:11]
    v_mov_b64 v[22:23], v[12:13]
    v_mov_b64 v[24:25], v[14:15]
    v_mov_b64 v[26:27], v[16:17]
    v_mov_b64 v[158:159], v[148:149]
    v_mov_b64 v[160:161], v[150:151]
    v_mov_b64 v[162:163], v[152:153]
    v_mov_b64 v[164:165], v[154:155]
    v_mov_b64 v[166:167], v[156:157]
    v_mov_b64 v[148:149], v[138:139]
    v_mov_b64 v[150:151], v[140:141]
    v_mov_b64 v[152:153], v[142:143]
    v_mov_b64 v[154:155], v[144:145]
    v_mov_b64 v[156:157], v[146:147]
    v_mov_b64 v[138:139], v[128:129]
    v_mov_b64 v[140:141], v[130:131]
    v_mov_b64 v[142:143], v[132:133]
    v_mov_b64 v[144:145], v[134:135]
    v_mov_b64 v[146:147], v[136:137]
    v_mov_b64 v[128:129], v[118:119]
    v_mov_b64 v[130:131], v[120:121]
    v_mov_b64 v[132:133], v[122:123]
    v_mov_b64 v[134:135], v[124:125]
    v_mov_b64 v[136:137], v[126:127]
    v_mov_b64 v[118:119], v[108:109]
    v_mov_b64 v[120:121], v[110:111]
    v_mov_b64 v[122:123], v[112:113]
    v_mov_b64 v[124:125], v[114:115]
    v_mov_b64 v[126:127], v[116:117]
    v_mov_b64 v[108:109], v[98:99]
    v_mov_b64 v[110:111], v[100:101]
    v_mov_b64 v[112:113], v[102:103]
    v_mov_b64 v[114:115], v[104:105]
    v_mov_b64 v[116:117], v[106:107]
    v_mov_b64 v[98:99], v[88:89]
    v_mov_b64 v[100:101], v[90:91]
    v_mov_b64 v[102:103], v[92:93]
    v_mov_b64 v[104:105], v[94:95]
    v_mov_b64 v[106:107], v[96:97]
    v_mov_b64 v[198:199], v[168:169]
    v_mov_b64 v[200:201], v[170:171]
    v_mov_b64 v[202:203], v[172:173]
    v_mov_b64 v[204:205], v[174:175]
    v_mov_b64 v[206:207], v[176:177]
    v_mov_b64 v[8:9], v[178:179]
    v_mov_b64 v[10:11], v[180:181]
    v_mov_b64 v[12:13], v[182:183]
    v_mov_b64 v[14:15], v[184:185]
    v_mov_b64 v[16:17], v[186:187]
    v_mov_b64 v[88:89], v[188:189]
    v_mov_b64 v[90:91], v[190:191]
    v_mov_b64 v[92:93], v[192:193]
    v_mov_b64 v[94:95], v[194:195]
    v_mov_b64 v[96:97], v[196:197]
    s_mul_i32 s47, s49, 1280
    s_add_u32 s47, s47, 113246208
    s_add_u32 s49, s49, 2
    v_add_u32 v4, 2, v4
    s_mul_i32 s45, s49, 3840
    s_add_u32 s45, s45, 104857600
    s_cmp_lt_u32 s49, 2048
    s_cselect_b32 s45, s45, 1073741824
    buffer_load_dwordx4 v[168:171], v2, s[4:7], s45 offen offset:0 sc1
    buffer_load_dwordx4 v[172:175], v2, s[4:7], s45 offen offset:16 sc1
    buffer_load_dwordx2 v[176:177], v2, s[4:7], s45 offen offset:32 sc1
    buffer_load_dwordx4 v[178:181], v2, s[4:7], s45 offen offset:1280 sc1
    buffer_load_dwordx4 v[182:185], v2, s[4:7], s45 offen offset:1296 sc1
    buffer_load_dwordx2 v[186:187], v2, s[4:7], s45 offen offset:1312 sc1
    buffer_load_dwordx4 v[188:191], v2, s[4:7], s45 offen offset:2560 sc1
    buffer_load_dwordx4 v[192:195], v2, s[4:7], s45 offen offset:2576 sc1
    buffer_load_dwordx2 v[196:197], v2, s[4:7], s45 offen offset:2592 sc1
    s_add_u32 s44, s44, 1
    s_cmp_lt_u32 s44, 8
    s_cbranch_scc1 Lb_warm
    v_dot2_f32_bf16 v208, v198, v8, 0
    v_dot2_f32_bf16 v209, v198, v18, 0
    v_dot2_f32_bf16 v210, v198, v28, 0
    v_dot2_f32_bf16 v211, v198, v38, 0
    v_dot2_f32_bf16 v212, v198, v48, 0
    v_dot2_f32_bf16 v213, v198, v58, 0
    v_dot2_f32_bf16 v214, v198, v68, 0
    v_dot2_f32_bf16 v215, v198, v78, 0
    v_dot2_f32_bf16 v208, v199, v9, v208
    v_dot2_f32_bf16 v209, v199, v19, v209
    v_dot2_f32_bf16 v210, v199, v29, v210
    v_dot2_f32_bf16 v211, v199, v39, v211
    v_dot2_f32_bf16 v212, v199, v49, v212
    v_dot2_f32_bf16 v213, v199, v59, v213
    v_dot2_f32_bf16 v214, v199, v69, v214
    v_dot2_f32_bf16 v215, v199, v79, v215
    v_dot2_f32_bf16 v208, v200, v10, v208
    v_dot2_f32_bf16 v209, v200, v20, v209
    v_dot2_f32_bf16 v210, v200, v30, v210
    v_dot2_f32_bf16 v211, v200, v40, v211
    v_dot2_f32_bf16 v212, v200, v50, v212
    v_dot2_f32_bf16 v213, v200, v60, v213
    v_dot2_f32_bf16 v214, v200, v70, v214
    v_dot2_f32_bf16 v215, v200, v80, v215
    v_dot2_f32_bf16 v208, v201, v11, v208
    v_dot2_f32_bf16 v209, v201, v21, v209
    v_dot2_f32_bf16 v210, v201, v31, v210
    v_dot2_f32_bf16 v211, v201, v41, v211
    v_dot2_f32_bf16 v212, v201, v51, v212
    v_dot2_f32_bf16 v213, v201, v61, v213
    v_dot2_f32_bf16 v214, v201, v71, v214
    v_dot2_f32_bf16 v215, v201, v81, v215
    v_dot2_f32_bf16 v208, v202, v12, v208
    v_dot2_f32_bf16 v209, v202, v22, v209
    v_dot2_f32_bf16 v210, v202, v32, v210
    v_dot2_f32_bf16 v211, v202, v42, v211
    v_dot2_f32_bf16 v212, v202, v52, v212
    v_dot2_f32_bf16 v213, v202, v62, v213
    v_dot2_f32_bf16 v214, v202, v72, v214
    v_dot2_f32_bf16 v215, v202, v82, v215
    v_dot2_f32_bf16 v208, v203, v13, v208
    v_dot2_f32_bf16 v209, v203, v23, v209
    v_dot2_f32_bf16 v210, v203, v33, v210
    v_dot2_f32_bf16 v211, v203, v43, v211
    v_dot2_f32_bf16 v212, v203, v53, v212
    v_dot2_f32_bf16 v213, v203, v63, v213
    v_dot2_f32_bf16 v214, v203, v73, v214
    v_dot2_f32_bf16 v215, v203, v83, v215
    v_dot2_f32_bf16 v208, v204, v14, v208
    v_dot2_f32_bf16 v209, v204, v24, v209
    v_dot2_f32_bf16 v210, v204, v34, v210
    v_dot2_f32_bf16 v211, v204, v44, v211
    v_dot2_f32_bf16 v212, v204, v54, v212
    v_dot2_f32_bf16 v213, v204, v64, v213
    v_dot2_f32_bf16 v214, v204, v74, v214
    v_dot2_f32_bf16 v215, v204, v84, v215
    v_dot2_f32_bf16 v208, v205, v15, v208
    v_dot2_f32_bf16 v209, v205, v25, v209
    v_dot2_f32_bf16 v210, v205, v35, v210
    v_dot2_f32_bf16 v211, v205, v45, v211
    v_dot2_f32_bf16 v212, v205, v55, v212
    v_dot2_f32_bf16 v213, v205, v65, v213
    v_dot2_f32_bf16 v214, v205, v75, v214
    v_dot2_f32_bf16 v215, v205, v85, v215
    v_dot2_f32_bf16 v208, v206, v16, v208
    v_dot2_f32_bf16 v209, v206, v26, v209
    v_dot2_f32_bf16 v210, v206, v36, v210
    v_dot2_f32_bf16 v211, v206, v46, v211
    v_dot2_f32_bf16 v212, v206, v56, v212
    v_dot2_f32_bf16 v213, v206, v66, v213
    v_dot2_f32_bf16 v214, v206, v76, v214
    v_dot2_f32_bf16 v215, v206, v86, v215
    v_dot2_f32_bf16 v208, v207, v17, v208
    v_dot2_f32_bf16 v209, v207, v27, v209
    v_dot2_f32_bf16 v210, v207, v37, v210
    v_dot2_f32_bf16 v211, v207, v47, v211
    v_dot2_f32_bf16 v212, v207, v57, v212
    v_dot2_f32_bf16 v213, v207, v67, v213
    v_dot2_f32_bf16 v214, v207, v77, v214
    v_dot2_f32_bf16 v215, v207, v87, v215
    v_cvt_pk_bf16_f32 v208, 0, v208
    v_cvt_pk_bf16_f32 v209, 0, v209
    v_cvt_pk_bf16_f32 v210, 0, v210
    v_cvt_pk_bf16_f32 v211, 0, v211
    v_cvt_pk_bf16_f32 v212, 0, v212
    v_cvt_pk_bf16_f32 v213, 0, v213
    v_cvt_pk_bf16_f32 v214, 0, v214
    v_cvt_pk_bf16_f32 v215, 0, v215
    v_mul_f32 v208, s51, v208
    v_mul_f32 v209, s51, v209
    v_mul_f32 v210, s51, v210
    v_mul_f32 v211, s51, v211
    v_mul_f32 v212, s51, v212
    v_mul_f32 v213, s51, v213
    v_mul_f32 v214, s51, v214
    v_mul_f32 v215, s51, v215
    v_cvt_pk_bf16_f32 v208, 0, v208
    v_cvt_pk_bf16_f32 v209, 0, v209
    v_cvt_pk_bf16_f32 v210, 0, v210
    v_cvt_pk_bf16_f32 v211, 0, v211
    v_cvt_pk_bf16_f32 v212, 0, v212
    v_cvt_pk_bf16_f32 v213, 0, v213
    v_cvt_pk_bf16_f32 v214, 0, v214
    v_cvt_pk_bf16_f32 v215, 0, v215
    v_cmp_le_i32 vcc, 2, v4
    s_nop 1
    v_cndmask_b32 v209, v5, v209, vcc
    v_cmp_le_i32 vcc, 4, v4
    s_nop 1
    v_cndmask_b32 v210, v5, v210, vcc
    v_cmp_le_i32 vcc, 6, v4
    s_nop 1
    v_cndmask_b32 v211, v5, v211, vcc
    v_cmp_le_i32 vcc, 8, v4
    s_nop 1
    v_cndmask_b32 v212, v5, v212, vcc
    v_cmp_le_i32 vcc, 10, v4
    s_nop 1
    v_cndmask_b32 v213, v5, v213, vcc
    v_cmp_le_i32 vcc, 12, v4
    s_nop 1
    v_cndmask_b32 v214, v5, v214, vcc
    v_cmp_le_i32 vcc, 14, v4
    s_nop 1
    v_cndmask_b32 v215, v5, v215, vcc
    v_max3_f32 v252, v208, v209, v210
    v_max3_f32 v252, v252, v211, v212
    v_max3_f32 v252, v252, v213, v214
    v_max_f32 v252, v252, v215
    v_sub_f32 v208, v208, v252
    v_sub_f32 v209, v209, v252
    v_sub_f32 v210, v210, v252
    v_sub_f32 v211, v211, v252
    v_sub_f32 v212, v212, v252
    v_sub_f32 v213, v213, v252
    v_sub_f32 v214, v214, v252
    v_sub_f32 v215, v215, v252
    v_mul_f32 v208, s50, v208
    v_mul_f32 v209, s50, v209
    v_mul_f32 v210, s50, v210
    v_mul_f32 v211, s50, v211
    v_mul_f32 v212, s50, v212
    v_mul_f32 v213, s50, v213
    v_mul_f32 v214, s50, v214
    v_mul_f32 v215, s50, v215
    v_exp_f32 v208, v208
    v_exp_f32 v209, v209
    v_exp_f32 v210, v210
    v_exp_f32 v211, v211
    v_exp_f32 v212, v212
    v_exp_f32 v213, v213
    v_exp_f32 v214, v214
    v_exp_f32 v215, v215
    v_add_f32 v253, v208, v209
    v_add_f32 v253, v253, v210
    v_add_f32 v253, v253, v211
    v_add_f32 v253, v253, v212
    v_add_f32 v253, v253, v213
    v_add_f32 v253, v253, v214
    v_add_f32 v253, v253, v215
    v_rcp_f32 v253, v253
    s_nop 0
    v_mul_f32 v208, v208, v253
    v_mul_f32 v209, v209, v253
    v_mul_f32 v210, v210, v253
    v_mul_f32 v211, v211, v253
    v_mul_f32 v212, v212, v253
    v_mul_f32 v213, v213, v253
    v_mul_f32 v214, v214, v253
    v_mul_f32 v215, v215, v253
    v_cvt_pk_bf16_f32 v216, v208, 0
    v_cvt_pk_bf16_f32 v224, 0, v208
    v_cvt_pk_bf16_f32 v217, v209, 0
    v_cvt_pk_bf16_f32 v225, 0, v209
    v_cvt_pk_bf16_f32 v218, v210, 0
    v_cvt_pk_bf16_f32 v226, 0, v210
    v_cvt_pk_bf16_f32 v219, v211, 0
    v_cvt_pk_bf16_f32 v227, 0, v211
    v_cvt_pk_bf16_f32 v220, v212, 0
    v_cvt_pk_bf16_f32 v228, 0, v212
    v_cvt_pk_bf16_f32 v221, v213, 0
    v_cvt_pk_bf16_f32 v229, 0, v213
    v_cvt_pk_bf16_f32 v222, v214, 0
    v_cvt_pk_bf16_f32 v230, 0, v214
    v_cvt_pk_bf16_f32 v223, v215, 0
    v_cvt_pk_bf16_f32 v231, 0, v215
    v_dot2_f32_bf16 v232, v88, v216, 0
    v_dot2_f32_bf16 v233, v88, v224, 0
    v_dot2_f32_bf16 v234, v89, v216, 0
    v_dot2_f32_bf16 v235, v89, v224, 0
    v_dot2_f32_bf16 v236, v90, v216, 0
    v_dot2_f32_bf16 v237, v90, v224, 0
    v_dot2_f32_bf16 v238, v91, v216, 0
    v_dot2_f32_bf16 v239, v91, v224, 0
    v_dot2_f32_bf16 v240, v92, v216, 0
    v_dot2_f32_bf16 v241, v92, v224, 0
    v_dot2_f32_bf16 v242, v93, v216, 0
    v_dot2_f32_bf16 v243, v93, v224, 0
    v_dot2_f32_bf16 v244, v94, v216, 0
    v_dot2_f32_bf16 v245, v94, v224, 0
    v_dot2_f32_bf16 v246, v95, v216, 0
    v_dot2_f32_bf16 v247, v95, v224, 0
    v_dot2_f32_bf16 v248, v96, v216, 0
    v_dot2_f32_bf16 v249, v96, v224, 0
    v_dot2_f32_bf16 v250, v97, v216, 0
    v_dot2_f32_bf16 v251, v97, v224, 0
    v_dot2_f32_bf16 v232, v98, v217, v232
    v_dot2_f32_bf16 v233, v98, v225, v233
    v_dot2_f32_bf16 v234, v99, v217, v234
    v_dot2_f32_bf16 v235, v99, v225, v235
    v_dot2_f32_bf16 v236, v100, v217, v236
    v_dot2_f32_bf16 v237, v100, v225, v237
    v_dot2_f32_bf16 v238, v101, v217, v238
    v_dot2_f32_bf16 v239, v101, v225, v239
    v_dot2_f32_bf16 v240, v102, v217, v240
    v_dot2_f32_bf16 v241, v102, v225, v241
    v_dot2_f32_bf16 v242, v103, v217, v242
    v_dot2_f32_bf16 v243, v103, v225, v243
    v_dot2_f32_bf16 v244, v104, v217, v244
    v_dot2_f32_bf16 v245, v104, v225, v245
    v_dot2_f32_bf16 v246, v105, v217, v246
    v_dot2_f32_bf16 v247, v105, v225, v247
    v_dot2_f32_bf16 v248, v106, v217, v248
    v_dot2_f32_bf16 v249, v106, v225, v249
    v_dot2_f32_bf16 v250, v107, v217, v250
    v_dot2_f32_bf16 v251, v107, v225, v251
    v_dot2_f32_bf16 v232, v108, v218, v232
    v_dot2_f32_bf16 v233, v108, v226, v233
    v_dot2_f32_bf16 v234, v109, v218, v234
    v_dot2_f32_bf16 v235, v109, v226, v235
    v_dot2_f32_bf16 v236, v110, v218, v236
    v_dot2_f32_bf16 v237, v110, v226, v237
    v_dot2_f32_bf16 v238, v111, v218, v238
    v_dot2_f32_bf16 v239, v111, v226, v239
    v_dot2_f32_bf16 v240, v112, v218, v240
    v_dot2_f32_bf16 v241, v112, v226, v241
    v_dot2_f32_bf16 v242, v113, v218, v242
    v_dot2_f32_bf16 v243, v113, v226, v243
    v_dot2_f32_bf16 v244, v114, v218, v244
    v_dot2_f32_bf16 v245, v114, v226, v245
    v_dot2_f32_bf16 v246, v115, v218, v246
    v_dot2_f32_bf16 v247, v115, v226, v247
    v_dot2_f32_bf16 v248, v116, v218, v248
    v_dot2_f32_bf16 v249, v116, v226, v249
    v_dot2_f32_bf16 v250, v117, v218, v250
    v_dot2_f32_bf16 v251, v117, v226, v251
    v_dot2_f32_bf16 v232, v118, v219, v232
    v_dot2_f32_bf16 v233, v118, v227, v233
    v_dot2_f32_bf16 v234, v119, v219, v234
    v_dot2_f32_bf16 v235, v119, v227, v235
    v_dot2_f32_bf16 v236, v120, v219, v236
    v_dot2_f32_bf16 v237, v120, v227, v237
    v_dot2_f32_bf16 v238, v121, v219, v238
    v_dot2_f32_bf16 v239, v121, v227, v239
    v_dot2_f32_bf16 v240, v122, v219, v240
    v_dot2_f32_bf16 v241, v122, v227, v241
    v_dot2_f32_bf16 v242, v123, v219, v242
    v_dot2_f32_bf16 v243, v123, v227, v243
    v_dot2_f32_bf16 v244, v124, v219, v244
    v_dot2_f32_bf16 v245, v124, v227, v245
    v_dot2_f32_bf16 v246, v125, v219, v246
    v_dot2_f32_bf16 v247, v125, v227, v247
    v_dot2_f32_bf16 v248, v126, v219, v248
    v_dot2_f32_bf16 v249, v126, v227, v249
    v_dot2_f32_bf16 v250, v127, v219, v250
    v_dot2_f32_bf16 v251, v127, v227, v251
    v_dot2_f32_bf16 v232, v128, v220, v232
    v_dot2_f32_bf16 v233, v128, v228, v233
    v_dot2_f32_bf16 v234, v129, v220, v234
    v_dot2_f32_bf16 v235, v129, v228, v235
    v_dot2_f32_bf16 v236, v130, v220, v236
    v_dot2_f32_bf16 v237, v130, v228, v237
    v_dot2_f32_bf16 v238, v131, v220, v238
    v_dot2_f32_bf16 v239, v131, v228, v239
    v_dot2_f32_bf16 v240, v132, v220, v240
    v_dot2_f32_bf16 v241, v132, v228, v241
    v_dot2_f32_bf16 v242, v133, v220, v242
    v_dot2_f32_bf16 v243, v133, v228, v243
    v_dot2_f32_bf16 v244, v134, v220, v244
    v_dot2_f32_bf16 v245, v134, v228, v245
    v_dot2_f32_bf16 v246, v135, v220, v246
    v_dot2_f32_bf16 v247, v135, v228, v247
    v_dot2_f32_bf16 v248, v136, v220, v248
    v_dot2_f32_bf16 v249, v136, v228, v249
    v_dot2_f32_bf16 v250, v137, v220, v250
    v_dot2_f32_bf16 v251, v137, v228, v251
    v_dot2_f32_bf16 v232, v138, v221, v232
    v_dot2_f32_bf16 v233, v138, v229, v233
    v_dot2_f32_bf16 v234, v139, v221, v234
    v_dot2_f32_bf16 v235, v139, v229, v235
    v_dot2_f32_bf16 v236, v140, v221, v236
    v_dot2_f32_bf16 v237, v140, v229, v237
    v_dot2_f32_bf16 v238, v141, v221, v238
    v_dot2_f32_bf16 v239, v141, v229, v239
    v_dot2_f32_bf16 v240, v142, v221, v240
    v_dot2_f32_bf16 v241, v142, v229, v241
    v_dot2_f32_bf16 v242, v143, v221, v242
    v_dot2_f32_bf16 v243, v143, v229, v243
    v_dot2_f32_bf16 v244, v144, v221, v244
    v_dot2_f32_bf16 v245, v144, v229, v245
    v_dot2_f32_bf16 v246, v145, v221, v246
    v_dot2_f32_bf16 v247, v145, v229, v247
    v_dot2_f32_bf16 v248, v146, v221, v248
    v_dot2_f32_bf16 v249, v146, v229, v249
    v_dot2_f32_bf16 v250, v147, v221, v250
    v_dot2_f32_bf16 v251, v147, v229, v251
    v_dot2_f32_bf16 v232, v148, v222, v232
    v_dot2_f32_bf16 v233, v148, v230, v233
    v_dot2_f32_bf16 v234, v149, v222, v234
    v_dot2_f32_bf16 v235, v149, v230, v235
    v_dot2_f32_bf16 v236, v150, v222, v236
    v_dot2_f32_bf16 v237, v150, v230, v237
    v_dot2_f32_bf16 v238, v151, v222, v238
    v_dot2_f32_bf16 v239, v151, v230, v239
    v_dot2_f32_bf16 v240, v152, v222, v240
    v_dot2_f32_bf16 v241, v152, v230, v241
    v_dot2_f32_bf16 v242, v153, v222, v242
    v_dot2_f32_bf16 v243, v153, v230, v243
    v_dot2_f32_bf16 v244, v154, v222, v244
    v_dot2_f32_bf16 v245, v154, v230, v245
    v_dot2_f32_bf16 v246, v155, v222, v246
    v_dot2_f32_bf16 v247, v155, v230, v247
    v_dot2_f32_bf16 v248, v156, v222, v248
    v_dot2_f32_bf16 v249, v156, v230, v249
    v_dot2_f32_bf16 v250, v157, v222, v250
    v_dot2_f32_bf16 v251, v157, v230, v251
    v_dot2_f32_bf16 v232, v158, v223, v232
    v_dot2_f32_bf16 v233, v158, v231, v233
    v_dot2_f32_bf16 v234, v159, v223, v234
    v_dot2_f32_bf16 v235, v159, v231, v235
    v_dot2_f32_bf16 v236, v160, v223, v236
    v_dot2_f32_bf16 v237, v160, v231, v237
    v_dot2_f32_bf16 v238, v161, v223, v238
    v_dot2_f32_bf16 v239, v161, v231, v239
    v_dot2_f32_bf16 v240, v162, v223, v240
    v_dot2_f32_bf16 v241, v162, v231, v241
    v_dot2_f32_bf16 v242, v163, v223, v242
    v_dot2_f32_bf16 v243, v163, v231, v243
    v_dot2_f32_bf16 v244, v164, v223, v244
    v_dot2_f32_bf16 v245, v164, v231, v245
    v_dot2_f32_bf16 v246, v165, v223, v246
    v_dot2_f32_bf16 v247, v165, v231, v247
    v_dot2_f32_bf16 v248, v166, v223, v248
    v_dot2_f32_bf16 v249, v166, v231, v249
    v_dot2_f32_bf16 v250, v167, v223, v250
    v_dot2_f32_bf16 v251, v167, v231, v251
    v_cvt_pk_bf16_f32 v208, v232, v233
    v_cvt_pk_bf16_f32 v209, v234, v235
    v_cvt_pk_bf16_f32 v210, v236, v237
    v_cvt_pk_bf16_f32 v211, v238, v239
    v_cvt_pk_bf16_f32 v212, v240, v241
    v_cvt_pk_bf16_f32 v213, v242, v243
    v_cvt_pk_bf16_f32 v214, v244, v245
    v_cvt_pk_bf16_f32 v215, v246, v247
    v_cvt_pk_bf16_f32 v216, v248, v249
    v_cvt_pk_bf16_f32 v217, v250, v251
    s_waitcnt vmcnt(0)
    buffer_store_dwordx4 v[208:211], v3, s[4:7], s47 offen offset:0
    buffer_store_dwordx4 v[212:215], v3, s[4:7], s47 offen offset:16
    buffer_store_dwordx2 v[216:217], v3, s[4:7], s47 offen offset:32
    s_cmp_lt_u32 s44, 23
    s_cbranch_scc1 Lb_loop
    s_waitcnt vmcnt(0)
    s_barrier
    s_cmp_eq_u32 s13, 0
    s_cbranch_scc0 Lb_a2
    buffer_wbl2 sc1
    s_waitcnt vmcnt(0)
    v_mov_b32 v10, 108
    v_mov_b32 v11, 1
    s_mov_b64 exec, 1
    global_atomic_add v10, v11, s[8:9]
    s_mov_b64 exec, -1
Lb_a2:
    s_branch Lg_fin
Lb_p3:
    s_lshr_b32 s45, s10, 5
    s_sub_u32 s45, s45, 4
    s_mul_i32 s45, s45, 18
    s_and_b32 s46, s10, 31
    s_add_u32 s43, s45, s46
    s_cmp_ge_u32 s43, 66
    s_cbranch_scc1 Lg_fin
    s_barrier
    s_load_dwordx2 s[16:17], s[0:1], 72
    s_mov_b32 s18, 819200
    s_mov_b32 s19, 0x20000
    s_load_dwordx2 s[24:25], s[0:1], 80
    s_mov_b32 s26, 5242880
    s_mov_b32 s27, 0x20000
    s_mov_b64 s[20:21], s[4:5]
    s_mov_b32 s22, 268435456
    s_mov_b32 s23, 0x20000
    s_mul_i32 s46, s43, 21846
    s_lshr_b32 s46, s46, 16
    s_mul_i32 s45, s46, 3
    s_sub_u32 s45, s43, s45
    s_mul_i32 s32, s46, 3
    s_add_u32 s33, s32, 3
    s_min_u32 s33, s33, 64
    s_mov_b32 s31, 113246208
    s_lshl_b32 s45, s45, 2
    s_add_u32 s45, s45, s13
    s_cmp_ge_u32 s45, 10
    s_cselect_b32 s47, 1073741824, 0
    s_lshl_b32 s45, s45, 7
    s_add_u32 s29, s45, s47
    s_mul_i32 s46, s32, 81920
    s_add_u32 s46, s46, s45
    s_add_u32 s34, s46, 1280
    s_mov_b32 s35, 81920
    s_mov_b32 s36, 0
    s_mov_b32 s37, 40960
    s_mov_b32 s38, 64
    s_mov_b32 s39, 41024
    s_mov_b32 s28, 1280
    s_mov_b32 s30, 1
    s_mov_b32 s41, 2
    s_mov_b32 s40, 1073741824
    s_mov_b32 s42, 3
    s_mov_b32 s57, 64
    s_and_b32 s48, s43, 0
    s_lshl_b32 s48, s48, 2
    s_add_u32 s58, s48, s13
    v_and_b32 v10, 15, v0
    v_lshrrev_b32 v11, 4, v0
    v_mul_u32_u24 v10, 2560, v10
    v_lshl_add_u32 v10, v11, 4, v10
    v_add_u32 v4, s47, v10
    s_waitcnt lgkmcnt(0)
    s_branch Lg_start
L5_start:
    s_lshr_b32 s33, s10, 5
    s_sub_u32 s33, s33, 4
    s_lshr_b32 s28, s33, 1
    s_and_b32 s34, s10, 31
    s_sub_u32 s34, s34, 18
    s_mul_i32 s35, s33, 10
    s_add_u32 s31, s35, s34
    s_and_b32 s30, s34, 1
    s_lshr_b32 s34, s34, 1
    s_and_b32 s33, s33, 1
    s_mul_i32 s33, s33, 5
    s_add_u32 s29, s33, s34
    s_lshl_b32 s33, s30, 2
    s_add_u32 s47, s33, s13
    s_load_dwordx2 s[16:17], s[0:1], 40
    s_mov_b32 s18, 7864320
    s_mov_b32 s19, 0x20000
    s_load_dwordx2 s[20:21], s[0:1], 80
    s_mov_b32 s22, 5242880
    s_mov_b32 s23, 0x20000
    s_add_u32 s35, s34, 0
    s_cmp_ge_u32 s35, 6
    s_cselect_b32 s36, 6, 0
    s_sub_u32 s35, s35, s36
    s_lshl_b32 s48, s35, 12
    s_add_u32 s35, s34, 1
    s_cmp_ge_u32 s35, 6
    s_cselect_b32 s36, 6, 0
    s_sub_u32 s35, s35, s36
    s_lshl_b32 s49, s35, 12
    s_add_u32 s35, s34, 2
    s_cmp_ge_u32 s35, 6
    s_cselect_b32 s36, 6, 0
    s_sub_u32 s35, s35, s36
    s_lshl_b32 s50, s35, 12
    s_add_u32 s35, s34, 3
    s_cmp_ge_u32 s35, 6
    s_cselect_b32 s36, 6, 0
    s_sub_u32 s35, s35, s36
    s_lshl_b32 s51, s35, 12
    s_add_u32 s35, s34, 4
    s_cmp_ge_u32 s35, 6
    s_cselect_b32 s36, 6, 0
    s_sub_u32 s35, s35, s36
    s_lshl_b32 s52, s35, 12
    s_add_u32 s35, s34, 5
    s_cmp_ge_u32 s35, 6
    s_cselect_b32 s36, 6, 0
    s_sub_u32 s35, s35, s36
    s_lshl_b32 s53, s35, 12
    v_lshlrev_b32 v1, 4, v0
    v_lshrrev_b32 v4, 3, v0
    v_and_b32 v5, 7, v0
    v_xor_b32 v5, v5, v4
    v_mul_u32_u24 v4, 1280, v4
    v_lshl_add_u32 v6, v5, 4, v4
    s_lshl_b32 s37, s13, 15
    v_lshrrev_b32 v4, 2, v0
    v_and_b32 v5, 7, v4
    v_lshl_add_u32 v4, v4, 7, s37
    v_and_b32 v7, 1, v0
    v_lshl_add_u32 v4, v7, 3, v4
    v_bfe_u32 v7, v0, 1, 1
    v_add_u32 v8, 0, v7
    v_xor_b32 v8, v8, v5
    v_lshl_add_u32 v92, v8, 4, v4
    v_add_u32 v8, 2, v7
    v_xor_b32 v8, v8, v5
    v_lshl_add_u32 v93, v8, 4, v4
    v_add_u32 v8, 4, v7
    v_xor_b32 v8, v8, v5
    v_lshl_add_u32 v94, v8, 4, v4
    v_add_u32 v8, 6, v7
    v_xor_b32 v8, v8, v5
    v_lshl_add_u32 v95, v8, 4, v4
    s_mul_i32 s36, s47, 983040
    s_lshl_b32 s33, s29, 7
    s_add_u32 s43, s36, s33
    s_waitcnt lgkmcnt(0)
    v_lshlrev_b32 v8, 2, v0
    s_branch L5_c0_z
L5_c0:
    global_load_dword v9, v8, s[8:9] sc1
    s_sub_u32 s12, s12, 32
    s_cbranch_scc1 L_abort
L5_c0_e:
    s_add_u32 s85, s15, 11
    s_cmp_lg_u32 s15, 0
    s_waitcnt vmcnt(0)
    s_cbranch_scc1 L5_c0_m
    v_cmp_eq_u32 vcc, -1, v9
    s_nop 0
    s_and_b32 s86, vcc_lo, vcc_hi
    v_cmp_eq_u32 vcc, 0x2000, v9
    s_nop 0
    s_and_b32 s87, vcc_lo, vcc_hi
    s_lshr_b32 s87, s87, 1
    s_and_b32 s86, s86, s87
    s_and_b32 s86, s86, 0x01010101
    s_cmp_eq_u32 s86, 0x01010101
    s_cbranch_scc1 L5_c0_m
    v_readlane_b32 s86, v9, 3
    s_mov_b32 s84, 0
    v_readlane_b32 s87, v9, 1
    s_nop 0
    s_lshr_b32 s87, s87, 8
    s_add_u32 s86, s86, s87
    s_max_u32 s84, s84, s87
    v_readlane_b32 s87, v9, 9
    s_nop 0
    s_lshr_b32 s87, s87, 8
    s_add_u32 s86, s86, s87
    s_max_u32 s84, s84, s87
    v_readlane_b32 s87, v9, 17
    s_nop 0
    s_lshr_b32 s87, s87, 8
    s_add_u32 s86, s86, s87
    s_max_u32 s84, s84, s87
    v_readlane_b32 s87, v9, 25
    s_nop 0
    s_lshr_b32 s87, s87, 8
    s_add_u32 s86, s86, s87
    s_max_u32 s84, s84, s87
    v_readlane_b32 s87, v9, 33
    s_nop 0
    s_lshr_b32 s87, s87, 8
    s_add_u32 s86, s86, s87
    s_max_u32 s84, s84, s87
    v_readlane_b32 s87, v9, 41
    s_nop 0
    s_lshr_b32 s87, s87, 8
    s_add_u32 s86, s86, s87
    s_max_u32 s84, s84, s87
    v_readlane_b32 s87, v9, 49
    s_nop 0
    s_lshr_b32 s87, s87, 8
    s_add_u32 s86, s86, s87
    s_max_u32 s84, s84, s87
    v_readlane_b32 s87, v9, 57
    s_nop 0
    s_lshr_b32 s87, s87, 8
    s_add_u32 s86, s86, s87
    s_max_u32 s84, s84, s87
    s_cmp_eq_u32 s86, 256
    s_cbranch_scc1 L_again
L5_c0_z:
    s_sleep 127
    s_branch L5_c0
L5_c0_m:
    v_readlane_b32 s84, v9, s85
    s_nop 0
    s_and_b32 s86, s84, 0xffff
    s_cmp_eq_u32 s86, 32
    s_cbranch_scc0 L5_c0_z
    s_add_u32 s35, s14, 5505024
L5_h:
    buffer_load_dword v8, off, s[4:7], s35 sc1
    s_sub_u32 s12, s12, 4
    s_cbranch_scc1 L_abort
    s_waitcnt vmcnt(0)
    v_cmp_gt_u32 vcc, 3, v8
    s_cbranch_vccz L5_h_ok
    s_sleep 16
    s_branch L5_h
L5_h_ok:
    s_mul_i32 s36, s48, 40
    s_add_u32 s36, s36, s43
    s_add_u32 m0, s37, 0
    s_nop 0
    buffer_load_dwordx4 v6, s[16:19], s36 offen  lds
    s_add_u32 s36, s36, 10240
    s_add_u32 m0, s37, 1024
    s_nop 0
    buffer_load_dwordx4 v6, s[16:19], s36 offen  lds
    s_add_u32 s36, s36, 10240
    s_add_u32 m0, s37, 2048
    s_nop 0
    buffer_load_dwordx4 v6, s[16:19], s36 offen  lds
    s_add_u32 s36, s36, 10240
    s_add_u32 m0, s37, 3072
    s_nop 0
    buffer_load_dwordx4 v6, s[16:19], s36 offen  lds
    s_add_u32 s36, s36, 10240
    s_add_u32 m0, s37, 4096
    s_nop 0
    buffer_load_dwordx4 v6, s[16:19], s36 offen  lds
    s_add_u32 s36, s36, 10240
    s_add_u32 m0, s37, 5120
    s_nop 0
    buffer_load_dwordx4 v6, s[16:19], s36 offen  lds
    s_add_u32 s36, s36, 10240
    s_add_u32 m0, s37, 6144
    s_nop 0
    buffer_load_dwordx4 v6, s[16:19], s36 offen  lds
    s_add_u32 s36, s36, 10240
    s_add_u32 m0, s37, 7168
    s_nop 0
    buffer_load_dwordx4 v6, s[16:19], s36 offen  lds
    s_add_u32 s36, s36, 10240
    s_mul_i32 s36, s48, 40
    s_add_u32 s36, s36, s43
    s_add_u32 s36, s36, 81920
    s_add_u32 m0, s37, 8192
    s_nop 0
    buffer_load_dwordx4 v6, s[16:19], s36 offen  lds
    s_add_u32 s36, s36, 10240
    s_add_u32 m0, s37, 9216
    s_nop 0
    buffer_load_dwordx4 v6, s[16:19], s36 offen  lds
    s_add_u32 s36, s36, 10240
    s_add_u32 m0, s37, 10240
    s_nop 0
    buffer_load_dwordx4 v6, s[16:19], s36 offen  lds
    s_add_u32 s36, s36, 10240
    s_add_u32 m0, s37, 11264
    s_nop 0
    buffer_load_dwordx4 v6, s[16:19], s36 offen  lds
    s_add_u32 s36, s36, 10240
    s_add_u32 m0, s37, 12288
    s_nop 0
    buffer_load_dwordx4 v6, s[16:19], s36 offen  lds
    s_add_u32 s36, s36, 10240
    s_add_u32 m0, s37, 13312
    s_nop 0
    buffer_load_dwordx4 v6, s[16:19], s36 offen  lds
    s_add_u32 s36, s36, 10240
    s_add_u32 m0, s37, 14336
    s_nop 0
    buffer_load_dwordx4 v6, s[16:19], s36 offen  lds
    s_add_u32 s36, s36, 10240
    s_add_u32 m0, s37, 15360
    s_nop 0
    buffer_load_dwordx4 v6, s[16:19], s36 offen  lds
    s_add_u32 s36, s36, 10240
    s_mul_i32 s36, s49, 40
    s_add_u32 s36, s36, s43
    s_add_u32 m0, s37, 16384
    s_nop 0
    buffer_load_dwordx4 v6, s[16:19], s36 offen  lds
    s_add_u32 s36, s36, 10240
    s_add_u32 m0, s37, 17408
    s_nop 0
    buffer_load_dwordx4 v6, s[16:19], s36 offen  lds
    s_add_u32 s36, s36, 10240
    s_add_u32 m0, s37, 18432
    s_nop 0
    buffer_load_dwordx4 v6, s[16:19], s36 offen  lds
    s_add_u32 s36, s36, 10240
    s_add_u32 m0, s37, 19456
    s_nop 0
    buffer_load_dwordx4 v6, s[16:19], s36 offen  lds
    s_add_u32 s36, s36, 10240
    s_add_u32 m0, s37, 20480
    s_nop 0
    buffer_load_dwordx4 v6, s[16:19], s36 offen  lds
    s_add_u32 s36, s36, 10240
    s_add_u32 m0, s37, 21504
    s_nop 0
    buffer_load_dwordx4 v6, s[16:19], s36 offen  lds
    s_add_u32 s36, s36, 10240
    s_add_u32 m0, s37, 22528
    s_nop 0
    buffer_load_dwordx4 v6, s[16:19], s36 offen  lds
    s_add_u32 s36, s36, 10240
    s_add_u32 m0, s37, 23552
    s_nop 0
    buffer_load_dwordx4 v6, s[16:19], s36 offen  lds
    s_add_u32 s36, s36, 10240
    s_mul_i32 s36, s49, 40
    s_add_u32 s36, s36, s43
    s_add_u32 s36, s36, 81920
    s_add_u32 m0, s37, 24576
    s_nop 0
    buffer_load_dwordx4 v6, s[16:19], s36 offen  lds
    s_add_u32 s36, s36, 10240
    s_add_u32 m0, s37, 25600
    s_nop 0
    buffer_load_dwordx4 v6, s[16:19], s36 offen  lds
    s_add_u32 s36, s36, 10240
    s_add_u32 m0, s37, 26624
    s_nop 0
    buffer_load_dwordx4 v6, s[16:19], s36 offen  lds
    s_add_u32 s36, s36, 10240
    s_add_u32 m0, s37, 27648
    s_nop 0
    buffer_load_dwordx4 v6, s[16:19], s36 offen  lds
    s_add_u32 s36, s36, 10240
    s_add_u32 m0, s37, 28672
    s_nop 0
    buffer_load_dwordx4 v6, s[16:19], s36 offen  lds
    s_add_u32 s36, s36, 10240
    s_add_u32 m0, s37, 29696
    s_nop 0
    buffer_load_dwordx4 v6, s[16:19], s36 offen  lds
    s_add_u32 s36, s36, 10240
    s_add_u32 m0, s37, 30720
    s_nop 0
    buffer_load_dwordx4 v6, s[16:19], s36 offen  lds
    s_add_u32 s36, s36, 10240
    s_add_u32 m0, s37, 31744
    s_nop 0
    buffer_load_dwordx4 v6, s[16:19], s36 offen  lds
    s_add_u32 s36, s36, 10240
    s_waitcnt vmcnt(24)
    ds_read_b64_tr_b16 a[0:1], v92 offset:0
    ds_read_b64_tr_b16 a[2:3], v92 offset:2048
    ds_read_b64_tr_b16 a[4:5], v93 offset:0
    ds_read_b64_tr_b16 a[6:7], v93 offset:2048
    ds_read_b64_tr_b16 a[8:9], v94 offset:0
    ds_read_b64_tr_b16 a[10:11], v94 offset:2048
    ds_read_b64_tr_b16 a[12:13], v95 offset:0
    ds_read_b64_tr_b16 a[14:15], v95 offset:2048
    ds_read_b64_tr_b16 a[16:17], v92 offset:4096
    ds_read_b64_tr_b16 a[18:19], v92 offset:6144
    ds_read_b64_tr_b16 a[20:21], v93 offset:4096
    ds_read_b64_tr_b16 a[22:23], v93 offset:6144
    ds_read_b64_tr_b16 a[24:25], v94 offset:4096
    ds_read_b64_tr_b16 a[26:27], v94 offset:6144
    ds_read_b64_tr_b16 a[28:29], v95 offset:4096
    s_waitcnt lgkmcnt(14)
    ds_read_b64_tr_b16 a[30:31], v95 offset:6144
    s_waitcnt lgkmcnt(0)
    s_mul_i32 s36, s50, 40
    s_add_u32 s36, s36, s43
    s_add_u32 m0, s37, 0
    s_nop 0
    buffer_load_dwordx4 v6, s[16:19], s36 offen  lds
    s_add_u32 s36, s36, 10240
    s_add_u32 m0, s37, 1024
    s_nop 0
    buffer_load_dwordx4 v6, s[16:19], s36 offen  lds
    s_add_u32 s36, s36, 10240
    s_add_u32 m0, s37, 2048
    s_nop 0
    buffer_load_dwordx4 v6, s[16:19], s36 offen  lds
    s_add_u32 s36, s36, 10240
    s_add_u32 m0, s37, 3072
    s_nop 0
    buffer_load_dwordx4 v6, s[16:19], s36 offen  lds
    s_add_u32 s36, s36, 10240
    s_add_u32 m0, s37, 4096
    s_nop 0
    buffer_load_dwordx4 v6, s[16:19], s36 offen  lds
    s_add_u32 s36, s36, 10240
    s_add_u32 m0, s37, 5120
    s_nop 0
    buffer_load_dwordx4 v6, s[16:19], s36 offen  lds
    s_add_u32 s36, s36, 10240
    s_add_u32 m0, s37, 6144
    s_nop 0
    buffer_load_dwordx4 v6, s[16:19], s36 offen  lds
    s_add_u32 s36, s36, 10240
    s_add_u32 m0, s37, 7168
    s_nop 0
    buffer_load_dwordx4 v6, s[16:19], s36 offen  lds
    s_add_u32 s36, s36, 10240
    s_waitcnt vmcnt(24)
    ds_read_b64_tr_b16 a[32:33], v92 offset:8192
    ds_read_b64_tr_b16 a[34:35], v92 offset:10240
    ds_read_b64_tr_b16 a[36:37], v93 offset:8192
    ds_read_b64_tr_b16 a[38:39], v93 offset:10240
    ds_read_b64_tr_b16 a[40:41], v94 offset:8192
    ds_read_b64_tr_b16 a[42:43], v94 offset:10240
    ds_read_b64_tr_b16 a[44:45], v95 offset:8192
    ds_read_b64_tr_b16 a[46:47], v95 offset:10240
    ds_read_b64_tr_b16 a[48:49], v92 offset:12288
    ds_read_b64_tr_b16 a[50:51], v92 offset:14336
    ds_read_b64_tr_b16 a[52:53], v93 offset:12288
    ds_read_b64_tr_b16 a[54:55], v93 offset:14336
    ds_read_b64_tr_b16 a[56:57], v94 offset:12288
    ds_read_b64_tr_b16 a[58:59], v94 offset:14336
    ds_read_b64_tr_b16 a[60:61], v95 offset:12288
    s_waitcnt lgkmcnt(14)
    ds_read_b64_tr_b16 a[62:63], v95 offset:14336
    s_waitcnt lgkmcnt(0)
    s_mul_i32 s36, s50, 40
    s_add_u32 s36, s36, s43
    s_add_u32 s36, s36, 81920
    s_add_u32 m0, s37, 8192
    s_nop 0
    buffer_load_dwordx4 v6, s[16:19], s36 offen  lds
    s_add_u32 s36, s36, 10240
    s_add_u32 m0, s37, 9216
    s_nop 0
    buffer_load_dwordx4 v6, s[16:19], s36 offen  lds
    s_add_u32 s36, s36, 10240
    s_add_u32 m0, s37, 10240
    s_nop 0
    buffer_load_dwordx4 v6, s[16:19], s36 offen  lds
    s_add_u32 s36, s36, 10240
    s_add_u32 m0, s37, 11264
    s_nop 0
    buffer_load_dwordx4 v6, s[16:19], s36 offen  lds
    s_add_u32 s36, s36, 10240
    s_add_u32 m0, s37, 12288
    s_nop 0
    buffer_load_dwordx4 v6, s[16:19], s36 offen  lds
    s_add_u32 s36, s36, 10240
    s_add_u32 m0, s37, 13312
    s_nop 0
    buffer_load_dwordx4 v6, s[16:19], s36 offen  lds
    s_add_u32 s36, s36, 10240
    s_add_u32 m0, s37, 14336
    s_nop 0
    buffer_load_dwordx4 v6, s[16:19], s36 offen  lds
    s_add_u32 s36, s36, 10240
    s_add_u32 m0, s37, 15360
    s_nop 0
    buffer_load_dwordx4 v6, s[16:19], s36 offen  lds
    s_add_u32 s36, s36, 10240
    s_waitcnt vmcnt(24)
    ds_read_b64_tr_b16 a[64:65], v92 offset:16384
    ds_read_b64_tr_b16 a[66:67], v92 offset:18432
    ds_read_b64_tr_b16 a[68:69], v93 offset:16384
    ds_read_b64_tr_b16 a[70:71], v93 offset:18432
    ds_read_b64_tr_b16 a[72:73], v94 offset:16384
    ds_read_b64_tr_b16 a[74:75], v94 offset:18432
    ds_read_b64_tr_b16 a[76:77], v95 offset:16384
    ds_read_b64_tr_b16 a[78:79], v95 offset:18432
    ds_read_b64_tr_b16 a[80:81], v92 offset:20480
    ds_read_b64_tr_b16 a[82:83], v92 offset:22528
    ds_read_b64_tr_b16 a[84:85], v93 offset:20480
    ds_read_b64_tr_b16 a[86:87], v93 offset:22528
    ds_read_b64_tr_b16 a[88:89], v94 offset:20480
    ds_read_b64_tr_b16 a[90:91], v94 offset:22528
    ds_read_b64_tr_b16 a[92:93], v95 offset:20480
    s_waitcnt lgkmcnt(14)
    ds_read_b64_tr_b16 a[94:95], v95 offset:22528
    s_waitcnt lgkmcnt(0)
    s_mul_i32 s36, s51, 40
    s_add_u32 s36, s36, s43
    s_add_u32 m0, s37, 16384
    s_nop 0
    buffer_load_dwordx4 v6, s[16:19], s36 offen  lds
    s_add_u32 s36, s36, 10240
    s_add_u32 m0, s37, 17408
    s_nop 0
    buffer_load_dwordx4 v6, s[16:19], s36 offen  lds
    s_add_u32 s36, s36, 10240
    s_add_u32 m0, s37, 18432
    s_nop 0
    buffer_load_dwordx4 v6, s[16:19], s36 offen  lds
    s_add_u32 s36, s36, 10240
    s_add_u32 m0, s37, 19456
    s_nop 0
    buffer_load_dwordx4 v6, s[16:19], s36 offen  lds
    s_add_u32 s36, s36, 10240
    s_add_u32 m0, s37, 20480
    s_nop 0
    buffer_load_dwordx4 v6, s[16:19], s36 offen  lds
    s_add_u32 s36, s36, 10240
    s_add_u32 m0, s37, 21504
    s_nop 0
    buffer_load_dwordx4 v6, s[16:19], s36 offen  lds
    s_add_u32 s36, s36, 10240
    s_add_u32 m0, s37, 22528
    s_nop 0
    buffer_load_dwordx4 v6, s[16:19], s36 offen  lds
    s_add_u32 s36, s36, 10240
    s_add_u32 m0, s37, 23552
    s_nop 0
    buffer_load_dwordx4 v6, s[16:19], s36 offen  lds
    s_add_u32 s36, s36, 10240
    s_waitcnt vmcnt(24)
    ds_read_b64_tr_b16 a[96:97], v92 offset:24576
    ds_read_b64_tr_b16 a[98:99], v92 offset:26624
    ds_read_b64_tr_b16 a[100:101], v93 offset:24576
    ds_read_b64_tr_b16 a[102:103], v93 offset:26624
    ds_read_b64_tr_b16 a[104:105], v94 offset:24576
    ds_read_b64_tr_b16 a[106:107], v94 offset:26624
    ds_read_b64_tr_b16 a[108:109], v95 offset:24576
    ds_read_b64_tr_b16 a[110:111], v95 offset:26624
    ds_read_b64_tr_b16 a[112:113], v92 offset:28672
    ds_read_b64_tr_b16 a[114:115], v92 offset:30720
    ds_read_b64_tr_b16 a[116:117], v93 offset:28672
    ds_read_b64_tr_b16 a[118:119], v93 offset:30720
    ds_read_b64_tr_b16 a[120:121], v94 offset:28672
    ds_read_b64_tr_b16 a[122:123], v94 offset:30720
    ds_read_b64_tr_b16 a[124:125], v95 offset:28672
    s_waitcnt lgkmcnt(14)
    ds_read_b64_tr_b16 a[126:127], v95 offset:30720
    s_waitcnt lgkmcnt(0)
    s_mul_i32 s36, s51, 40
    s_add_u32 s36, s36, s43
    s_add_u32 s36, s36, 81920
    s_add_u32 m0, s37, 24576
    s_nop 0
    buffer_load_dwordx4 v6, s[16:19], s36 offen  lds
    s_add_u32 s36, s36, 10240
    s_add_u32 m0, s37, 25600
    s_nop 0
    buffer_load_dwordx4 v6, s[16:19], s36 offen  lds
    s_add_u32 s36, s36, 10240
    s_add_u32 m0, s37, 26624
    s_nop 0
    buffer_load_dwordx4 v6, s[16:19], s36 offen  lds
    s_add_u32 s36, s36, 10240
    s_add_u32 m0, s37, 27648
    s_nop 0
    buffer_load_dwordx4 v6, s[16:19], s36 offen  lds
    s_add_u32 s36, s36, 10240
    s_add_u32 m0, s37, 28672
    s_nop 0
    buffer_load_dwordx4 v6, s[16:19], s36 offen  lds
    s_add_u32 s36, s36, 10240
    s_add_u32 m0, s37, 29696
    s_nop 0
    buffer_load_dwordx4 v6, s[16:19], s36 offen  lds
    s_add_u32 s36, s36, 10240
    s_add_u32 m0, s37, 30720
    s_nop 0
    buffer_load_dwordx4 v6, s[16:19], s36 offen  lds
    s_add_u32 s36, s36, 10240
    s_add_u32 m0, s37, 31744
    s_nop 0
    buffer_load_dwordx4 v6, s[16:19], s36 offen  lds
    s_add_u32 s36, s36, 10240
    s_waitcnt vmcnt(24)
    ds_read_b64_tr_b16 a[128:129], v92 offset:0
    ds_read_b64_tr_b16 a[130:131], v92 offset:2048
    ds_read_b64_tr_b16 a[132:133], v93 offset:0
    ds_read_b64_tr_b16 a[134:135], v93 offset:2048
    ds_read_b64_tr_b16 a[136:137], v94 offset:0
    ds_read_b64_tr_b16 a[138:139], v94 offset:2048
    ds_read_b64_tr_b16 a[140:141], v95 offset:0
    ds_read_b64_tr_b16 a[142:143], v95 offset:2048
    ds_read_b64_tr_b16 a[144:145], v92 offset:4096
    ds_read_b64_tr_b16 a[146:147], v92 offset:6144
    ds_read_b64_tr_b16 a[148:149], v93 offset:4096
    ds_read_b64_tr_b16 a[150:151], v93 offset:6144
    ds_read_b64_tr_b16 a[152:153], v94 offset:4096
    ds_read_b64_tr_b16 a[154:155], v94 offset:6144
    ds_read_b64_tr_b16 a[156:157], v95 offset:4096
    s_waitcnt lgkmcnt(14)
    ds_read_b64_tr_b16 a[158:159], v95 offset:6144
    s_waitcnt lgkmcnt(0)
    s_mul_i32 s36, s52, 40
    s_add_u32 s36, s36, s43
    s_add_u32 m0, s37, 0
    s_nop 0
    buffer_load_dwordx4 v6, s[16:19], s36 offen  lds
    s_add_u32 s36, s36, 10240
    s_add_u32 m0, s37, 1024
    s_nop 0
    buffer_load_dwordx4 v6, s[16:19], s36 offen  lds
    s_add_u32 s36, s36, 10240
    s_add_u32 m0, s37, 2048
    s_nop 0
    buffer_load_dwordx4 v6, s[16:19], s36 offen  lds
    s_add_u32 s36, s36, 10240
    s_add_u32 m0, s37, 3072
    s_nop 0
    buffer_load_dwordx4 v6, s[16:19], s36 offen  lds
    s_add_u32 s36, s36, 10240
    s_add_u32 m0, s37, 4096
    s_nop 0
    buffer_load_dwordx4 v6, s[16:19], s36 offen  lds
    s_add_u32 s36, s36, 10240
    s_add_u32 m0, s37, 5120
    s_nop 0
    buffer_load_dwordx4 v6, s[16:19], s36 offen  lds
    s_add_u32 s36, s36, 10240
    s_add_u32 m0, s37, 6144
    s_nop 0
    buffer_load_dwordx4 v6, s[16:19], s36 offen  lds
    s_add_u32 s36, s36, 10240
    s_add_u32 m0, s37, 7168
    s_nop 0
    buffer_load_dwordx4 v6, s[16:19], s36 offen  lds
    s_add_u32 s36, s36, 10240
    s_waitcnt vmcnt(24)
    ds_read_b64_tr_b16 a[160:161], v92 offset:8192
    ds_read_b64_tr_b16 a[162:163], v92 offset:10240
    ds_read_b64_tr_b16 a[164:165], v93 offset:8192
    ds_read_b64_tr_b16 a[166:167], v93 offset:10240
    ds_read_b64_tr_b16 a[168:169], v94 offset:8192
    ds_read_b64_tr_b16 a[170:171], v94 offset:10240
    ds_read_b64_tr_b16 a[172:173], v95 offset:8192
    ds_read_b64_tr_b16 a[174:175], v95 offset:10240
    ds_read_b64_tr_b16 a[176:177], v92 offset:12288
    ds_read_b64_tr_b16 a[178:179], v92 offset:14336
    ds_read_b64_tr_b16 a[180:181], v93 offset:12288
    ds_read_b64_tr_b16 a[182:183], v93 offset:14336
    ds_read_b64_tr_b16 a[184:185], v94 offset:12288
    ds_read_b64_tr_b16 a[186:187], v94 offset:14336
    ds_read_b64_tr_b16 a[188:189], v95 offset:12288
    s_waitcnt lgkmcnt(14)
    ds_read_b64_tr_b16 a[190:191], v95 offset:14336
    s_waitcnt lgkmcnt(0)
    s_mul_i32 s36, s52, 40
    s_add_u32 s36, s36, s43
    s_add_u32 s36, s36, 81920
    s_add_u32 m0, s37, 8192
    s_nop 0
    buffer_load_dwordx4 v6, s[16:19], s36 offen  lds
    s_add_u32 s36, s36, 10240
    s_add_u32 m0, s37, 9216
    s_nop 0
    buffer_load_dwordx4 v6, s[16:19], s36 offen  lds
    s_add_u32 s36, s36, 10240
    s_add_u32 m0, s37, 10240
    s_nop 0
    buffer_load_dwordx4 v6, s[16:19], s36 offen  lds
    s_add_u32 s36, s36, 10240
    s_add_u32 m0, s37, 11264
    s_nop 0
    buffer_load_dwordx4 v6, s[16:19], s36 offen  lds
    s_add_u32 s36, s36, 10240
    s_add_u32 m0, s37, 12288
    s_nop 0
    buffer_load_dwordx4 v6, s[16:19], s36 offen  lds
    s_add_u32 s36, s36, 10240
    s_add_u32 m0, s37, 13312
    s_nop 0
    buffer_load_dwordx4 v6, s[16:19], s36 offen  lds
    s_add_u32 s36, s36, 10240
    s_add_u32 m0, s37, 14336
    s_nop 0
    buffer_load_dwordx4 v6, s[16:19], s36 offen  lds
    s_add_u32 s36, s36, 10240
    s_add_u32 m0, s37, 15360
    s_nop 0
    buffer_load_dwordx4 v6, s[16:19], s36 offen  lds
    s_add_u32 s36, s36, 10240
    s_waitcnt vmcnt(24)
    ds_read_b64_tr_b16 a[192:193], v92 offset:16384
    ds_read_b64_tr_b16 a[194:195], v92 offset:18432
    ds_read_b64_tr_b16 a[196:197], v93 offset:16384
    ds_read_b64_tr_b16 a[198:199], v93 offset:18432
    ds_read_b64_tr_b16 a[200:201], v94 offset:16384
    ds_read_b64_tr_b16 a[202:203], v94 offset:18432
    ds_read_b64_tr_b16 a[204:205], v95 offset:16384
    ds_read_b64_tr_b16 a[206:207], v95 offset:18432
    ds_read_b64_tr_b16 a[208:209], v92 offset:20480
    ds_read_b64_tr_b16 a[210:211], v92 offset:22528
    ds_read_b64_tr_b16 a[212:213], v93 offset:20480
    ds_read_b64_tr_b16 a[214:215], v93 offset:22528
    ds_read_b64_tr_b16 a[216:217], v94 offset:20480
    ds_read_b64_tr_b16 a[218:219], v94 offset:22528
    ds_read_b64_tr_b16 a[220:221], v95 offset:20480
    s_waitcnt lgkmcnt(14)
    ds_read_b64_tr_b16 a[222:223], v95 offset:22528
    s_waitcnt lgkmcnt(0)
    s_mul_i32 s36, s53, 40
    s_add_u32 s36, s36, s43
    s_add_u32 m0, s37, 16384
    s_nop 0
    buffer_load_dwordx4 v6, s[16:19], s36 offen  lds
    s_add_u32 s36, s36, 10240
    s_add_u32 m0, s37, 17408
    s_nop 0
    buffer_load_dwordx4 v6, s[16:19], s36 offen  lds
    s_add_u32 s36, s36, 10240
    s_add_u32 m0, s37, 18432
    s_nop 0
    buffer_load_dwordx4 v6, s[16:19], s36 offen  lds
    s_add_u32 s36, s36, 10240
    s_add_u32 m0, s37, 19456
    s_nop 0
    buffer_load_dwordx4 v6, s[16:19], s36 offen  lds
    s_add_u32 s36, s36, 10240
    s_add_u32 m0, s37, 20480
    s_nop 0
    buffer_load_dwordx4 v6, s[16:19], s36 offen  lds
    s_add_u32 s36, s36, 10240
    s_add_u32 m0, s37, 21504
    s_nop 0
    buffer_load_dwordx4 v6, s[16:19], s36 offen  lds
    s_add_u32 s36, s36, 10240
    s_add_u32 m0, s37, 22528
    s_nop 0
    buffer_load_dwordx4 v6, s[16:19], s36 offen  lds
    s_add_u32 s36, s36, 10240
    s_add_u32 m0, s37, 23552
    s_nop 0
    buffer_load_dwordx4 v6, s[16:19], s36 offen  lds
    s_add_u32 s36, s36, 10240
    s_waitcnt vmcnt(24)
    ds_read_b64_tr_b16 a[224:225], v92 offset:24576
    ds_read_b64_tr_b16 a[226:227], v92 offset:26624
    ds_read_b64_tr_b16 a[228:229], v93 offset:24576
    ds_read_b64_tr_b16 a[230:231], v93 offset:26624
    ds_read_b64_tr_b16 a[232:233], v94 offset:24576
    ds_read_b64_tr_b16 a[234:235], v94 offset:26624
    ds_read_b64_tr_b16 a[236:237], v95 offset:24576
    ds_read_b64_tr_b16 a[238:239], v95 offset:26624
    ds_read_b64_tr_b16 a[240:241], v92 offset:28672
    ds_read_b64_tr_b16 a[242:243], v92 offset:30720
    ds_read_b64_tr_b16 a[244:245], v93 offset:28672
    ds_read_b64_tr_b16 a[246:247], v93 offset:30720
    ds_read_b64_tr_b16 a[248:249], v94 offset:28672
    ds_read_b64_tr_b16 a[250:251], v94 offset:30720
    ds_read_b64_tr_b16 a[252:253], v95 offset:28672
    s_waitcnt lgkmcnt(14)
    ds_read_b64_tr_b16 a[254:255], v95 offset:30720
    s_waitcnt lgkmcnt(0)
    s_mul_i32 s36, s53, 40
    s_add_u32 s36, s36, s43
    s_add_u32 s36, s36, 81920
    s_add_u32 m0, s37, 24576
    s_nop 0
    buffer_load_dwordx4 v6, s[16:19], s36 offen  lds
    s_add_u32 s36, s36, 10240
    s_add_u32 m0, s37, 25600
    s_nop 0
    buffer_load_dwordx4 v6, s[16:19], s36 offen  lds
    s_add_u32 s36, s36, 10240
    s_add_u32 m0, s37, 26624
    s_nop 0
    buffer_load_dwordx4 v6, s[16:19], s36 offen  lds
    s_add_u32 s36, s36, 10240
    s_add_u32 m0, s37, 27648
    s_nop 0
    buffer_load_dwordx4 v6, s[16:19], s36 offen  lds
    s_add_u32 s36, s36, 10240
    s_add_u32 m0, s37, 28672
    s_nop 0
    buffer_load_dwordx4 v6, s[16:19], s36 offen  lds
    s_add_u32 s36, s36, 10240
    s_add_u32 m0, s37, 29696
    s_nop 0
    buffer_load_dwordx4 v6, s[16:19], s36 offen  lds
    s_add_u32 s36, s36, 10240
    s_add_u32 m0, s37, 30720
    s_nop 0
    buffer_load_dwordx4 v6, s[16:19], s36 offen  lds
    s_add_u32 s36, s36, 10240
    s_add_u32 m0, s37, 31744
    s_nop 0
    buffer_load_dwordx4 v6, s[16:19], s36 offen  lds
    s_add_u32 s36, s36, 10240
    s_waitcnt vmcnt(24)
    ds_read_b64_tr_b16 v[128:129], v92 offset:0
    ds_read_b64_tr_b16 v[130:131], v92 offset:2048
    ds_read_b64_tr_b16 v[132:133], v93 offset:0
    ds_read_b64_tr_b16 v[134:135], v93 offset:2048
    ds_read_b64_tr_b16 v[136:137], v94 offset:0
    ds_read_b64_tr_b16 v[138:139], v94 offset:2048
    ds_read_b64_tr_b16 v[140:141], v95 offset:0
    ds_read_b64_tr_b16 v[142:143], v95 offset:2048
    ds_read_b64_tr_b16 v[144:145], v92 offset:4096
    ds_read_b64_tr_b16 v[146:147], v92 offset:6144
    ds_read_b64_tr_b16 v[148:149], v93 offset:4096
    ds_read_b64_tr_b16 v[150:151], v93 offset:6144
    ds_read_b64_tr_b16 v[152:153], v94 offset:4096
    ds_read_b64_tr_b16 v[154:155], v94 offset:6144
    ds_read_b64_tr_b16 v[156:157], v95 offset:4096
    s_waitcnt lgkmcnt(14)
    ds_read_b64_tr_b16 v[158:159], v95 offset:6144
    s_waitcnt lgkmcnt(0)
    s_waitcnt vmcnt(16)
    ds_read_b64_tr_b16 v[160:161], v92 offset:8192
    ds_read_b64_tr_b16 v[162:163], v92 offset:10240
    ds_read_b64_tr_b16 v[164:165], v93 offset:8192
    ds_read_b64_tr_b16 v[166:167], v93 offset:10240
    ds_read_b64_tr_b16 v[168:169], v94 offset:8192
    ds_read_b64_tr_b16 v[170:171], v94 offset:10240
    ds_read_b64_tr_b16 v[172:173], v95 offset:8192
    ds_read_b64_tr_b16 v[174:175], v95 offset:10240
    ds_read_b64_tr_b16 v[176:177], v92 offset:12288
    ds_read_b64_tr_b16 v[178:179], v92 offset:14336
    ds_read_b64_tr_b16 v[180:181], v93 offset:12288
    ds_read_b64_tr_b16 v[182:183], v93 offset:14336
    ds_read_b64_tr_b16 v[184:185], v94 offset:12288
    ds_read_b64_tr_b16 v[186:187], v94 offset:14336
    ds_read_b64_tr_b16 v[188:189], v95 offset:12288
    s_waitcnt lgkmcnt(14)
    ds_read_b64_tr_b16 v[190:191], v95 offset:14336
    s_waitcnt lgkmcnt(0)
    s_waitcnt vmcnt(8)
    ds_read_b64_tr_b16 v[192:193], v92 offset:16384
    ds_read_b64_tr_b16 v[194:195], v92 offset:18432
    ds_read_b64_tr_b16 v[196:197], v93 offset:16384
    ds_read_b64_tr_b16 v[198:199], v93 offset:18432
    ds_read_b64_tr_b16 v[200:201], v94 offset:16384
    ds_read_b64_tr_b16 v[202:203], v94 offset:18432
    ds_read_b64_tr_b16 v[204:205], v95 offset:16384
    ds_read_b64_tr_b16 v[206:207], v95 offset:18432
    ds_read_b64_tr_b16 v[208:209], v92 offset:20480
    ds_read_b64_tr_b16 v[210:211], v92 offset:22528
    ds_read_b64_tr_b16 v[212:213], v93 offset:20480
    ds_read_b64_tr_b16 v[214:215], v93 offset:22528
    ds_read_b64_tr_b16 v[216:217], v94 offset:20480
    ds_read_b64_tr_b16 v[218:219], v94 offset:22528
    ds_read_b64_tr_b16 v[220:221], v95 offset:20480
    s_waitcnt lgkmcnt(14)
    ds_read_b64_tr_b16 v[222:223], v95 offset:22528
    s_waitcnt lgkmcnt(0)
    s_waitcnt vmcnt(0)
    ds_read_b64_tr_b16 v[224:225], v92 offset:24576
    ds_read_b64_tr_b16 v[226:227], v92 offset:26624
    ds_read_b64_tr_b16 v[228:229], v93 offset:24576
    ds_read_b64_tr_b16 v[230:231], v93 offset:26624
    ds_read_b64_tr_b16 v[232:233], v94 offset:24576
    ds_read_b64_tr_b16 v[234:235], v94 offset:26624
    ds_read_b64_tr_b16 v[236:237], v95 offset:24576
    ds_read_b64_tr_b16 v[238:239], v95 offset:26624
    ds_read_b64_tr_b16 v[240:241], v92 offset:28672
    ds_read_b64_tr_b16 v[242:243], v92 offset:30720
    ds_read_b64_tr_b16 v[244:245], v93 offset:28672
    ds_read_b64_tr_b16 v[246:247], v93 offset:30720
    ds_read_b64_tr_b16 v[248:249], v94 offset:28672
    ds_read_b64_tr_b16 v[250:251], v94 offset:30720
    ds_read_b64_tr_b16 v[252:253], v95 offset:28672
    s_waitcnt lgkmcnt(14)
    ds_read_b64_tr_b16 v[254:255], v95 offset:30720
    s_waitcnt lgkmcnt(0)
    v_lshlrev_b32 v4, 2, v0
L5_cm:
    global_load_dword v5, v4, s[8:9] sc1
    s_sub_u32 s12, s12, 1
    s_cbranch_scc1 L_abort
L5_cm_e:
    s_add_u32 s85, s15, 11
    s_cmp_lg_u32 s15, 0
    s_waitcnt vmcnt(0)
    s_cbranch_scc1 L5_cm_m
    v_cmp_eq_u32 vcc, -1, v5
    s_nop 0
    s_and_b32 s86, vcc_lo, vcc_hi
    v_cmp_eq_u32 vcc, 0x2000, v5
    s_nop 0
    s_and_b32 s87, vcc_lo, vcc_hi
    s_lshr_b32 s87, s87, 1
    s_and_b32 s86, s86, s87
    s_and_b32 s86, s86, 0x01010101
    s_cmp_eq_u32 s86, 0x01010101
    s_cbranch_scc1 L5_cm_m
    v_readlane_b32 s86, v5, 3
    s_mov_b32 s84, 0
    v_readlane_b32 s87, v5, 1
    s_nop 0
    s_lshr_b32 s87, s87, 8
    s_add_u32 s86, s86, s87
    s_max_u32 s84, s84, s87
    v_readlane_b32 s87, v5, 9
    s_nop 0
    s_lshr_b32 s87, s87, 8
    s_add_u32 s86, s86, s87
    s_max_u32 s84, s84, s87
    v_readlane_b32 s87, v5, 17
    s_nop 0
    s_lshr_b32 s87, s87, 8
    s_add_u32 s86, s86, s87
    s_max_u32 s84, s84, s87
    v_readlane_b32 s87, v5, 25
    s_nop 0
    s_lshr_b32 s87, s87, 8
    s_add_u32 s86, s86, s87
    s_max_u32 s84, s84, s87
    v_readlane_b32 s87, v5, 33
    s_nop 0
    s_lshr_b32 s87, s87, 8
    s_add_u32 s86, s86, s87
    s_max_u32 s84, s84, s87
    v_readlane_b32 s87, v5, 41
    s_nop 0
    s_lshr_b32 s87, s87, 8
    s_add_u32 s86, s86, s87
    s_max_u32 s84, s84, s87
    v_readlane_b32 s87, v5, 49
    s_nop 0
    s_lshr_b32 s87, s87, 8
    s_add_u32 s86, s86, s87
    s_max_u32 s84, s84, s87
    v_readlane_b32 s87, v5, 57
    s_nop 0
    s_lshr_b32 s87, s87, 8
    s_add_u32 s86, s86, s87
    s_max_u32 s84, s84, s87
    s_cmp_eq_u32 s86, 256
    s_cbranch_scc1 L_again
L5_cm_z:
    s_sleep 4
    s_branch L5_cm
L5_cm_m:
    v_readlane_b32 s84, v5, s85
    s_nop 0
    s_and_b32 s86, s84, 0xffff
    s_cmp_eq_u32 s86, 32
    s_cbranch_scc0 L5_cm_z
    s_barrier
    v_and_b32 v4, 15, v0
    v_lshrrev_b32 v5, 4, v0
    v_mul_u32_u24 v6, 2560, v4
    v_lshl_add_u32 v2, v5, 3, v6
    v_lshrrev_b32 v4, 3, v0
    v_lshlrev_b32 v3, 7, v4
    s_mul_i32 s33, s28, 40960
    s_lshl_b32 s34, s29, 7
    s_add_u32 s33, s33, s34
    s_lshl_b32 s34, s13, 5
    s_add_u32 s41, s33, s34
    s_lshl_b32 s33, s28, 13
    s_lshl_b32 s34, s47, 10
    s_add_u32 s33, s33, s34
    s_add_u32 s33, s33, s14
    s_add_u32 s40, s33, 5570560
    s_mul_i32 s33, s28, 196608
    s_mul_i32 s34, s47, 24576
    s_add_u32 s33, s33, s34
    s_add_u32 s38, s33, 79691776
    s_and_b32 s34, s13, 1
    s_lshl_b32 s34, s34, 10
    s_add_u32 s34, s34, s14
    s_add_u32 s34, s34, 1310720
    s_lshl_b32 s33, s31, 13
    s_add_u32 s45, s33, s34
    s_xor_b32 s33, s33, 8192
    s_add_u32 s46, s33, s34
    s_mov_b32 s32, 0
    s_mov_b32 s42, 0
L5_wait:
    buffer_load_dword v4, v3, s[4:7], s40 offen sc1
    s_sub_u32 s12, s12, 1
    s_cbranch_scc1 L_abort
    s_waitcnt vmcnt(0)
    v_cmp_ge_u32 vcc, s32, v4
    s_cbranch_vccz L5_prime
    s_sleep 2
    s_branch L5_wait
L5_prime:
    s_add_u32 s36, s38, s48
    buffer_load_dwordx4 v[28:31], v1, s[4:7], s36 offen offset:0 sc1
    buffer_load_dwordx4 v[32:35], v1, s[4:7], s36 offen offset:1024 sc1
    buffer_load_dwordx4 v[36:39], v1, s[4:7], s36 offen offset:2048 sc1
    buffer_load_dwordx4 v[40:43], v1, s[4:7], s36 offen offset:3072 sc1
    s_add_u32 s36, s38, s49
    buffer_load_dwordx4 v[44:47], v1, s[4:7], s36 offen offset:0 sc1
    buffer_load_dwordx4 v[48:51], v1, s[4:7], s36 offen offset:1024 sc1
    buffer_load_dwordx4 v[52:55], v1, s[4:7], s36 offen offset:2048 sc1
    buffer_load_dwordx4 v[56:59], v1, s[4:7], s36 offen offset:3072 sc1
    s_add_u32 s36, s38, s50
    buffer_load_dwordx4 v[60:63], v1, s[4:7], s36 offen offset:0 sc1
    buffer_load_dwordx4 v[64:67], v1, s[4:7], s36 offen offset:1024 sc1
    buffer_load_dwordx4 v[68:71], v1, s[4:7], s36 offen offset:2048 sc1
    buffer_load_dwordx4 v[72:75], v1, s[4:7], s36 offen offset:3072 sc1
L5_unit:
    buffer_load_dword v4, v3, s[4:7], s40 offen sc1
    s_waitcnt vmcnt(12)
    v_mfma_f32_16x16x32_bf16 v[12:15], a[0:3], v[28:31], 0
    v_mfma_f32_16x16x32_bf16 v[16:19], a[4:7], v[28:31], 0
    v_mfma_f32_16x16x32_bf16 v[20:23], a[8:11], v[28:31], 0
    v_mfma_f32_16x16x32_bf16 v[24:27], a[12:15], v[28:31], 0
    s_add_u32 s36, s38, s51
    buffer_load_dwordx4 v[28:31], v1, s[4:7], s36 offen offset:0 sc1
    s_waitcnt vmcnt(12)
    v_mfma_f32_16x16x32_bf16 v[12:15], a[16:19], v[32:35], v[12:15]
    v_mfma_f32_16x16x32_bf16 v[16:19], a[20:23], v[32:35], v[16:19]
    v_mfma_f32_16x16x32_bf16 v[20:23], a[24:27], v[32:35], v[20:23]
    v_mfma_f32_16x16x32_bf16 v[24:27], a[28:31], v[32:35], v[24:27]
    buffer_load_dwordx4 v[32:35], v1, s[4:7], s36 offen offset:1024 sc1
    s_waitcnt vmcnt(12)
    v_mfma_f32_16x16x32_bf16 v[12:15], a[32:35], v[36:39], v[12:15]
    v_mfma_f32_16x16x32_bf16 v[16:19], a[36:39], v[36:39], v[16:19]
    v_mfma_f32_16x16x32_bf16 v[20:23], a[40:43], v[36:39], v[20:23]
    v_mfma_f32_16x16x32_bf16 v[24:27], a[44:47], v[36:39], v[24:27]
    buffer_load_dwordx4 v[36:39], v1, s[4:7], s36 offen offset:2048 sc1
    s_waitcnt vmcnt(12)
    v_mfma_f32_16x16x32_bf16 v[12:15], a[48:51], v[40:43], v[12:15]
    v_mfma_f32_16x16x32_bf16 v[16:19], a[52:55], v[40:43], v[16:19]
    v_mfma_f32_16x16x32_bf16 v[20:23], a[56:59], v[40:43], v[20:23]
    v_mfma_f32_16x16x32_bf16 v[24:27], a[60:63], v[40:43], v[24:27]
    buffer_load_dwordx4 v[40:43], v1, s[4:7], s36 offen offset:3072 sc1
    s_waitcnt vmcnt(12)
    v_mfma_f32_16x16x32_bf16 v[12:15], a[64:67], v[44:47], v[12:15]
    v_mfma_f32_16x16x32_bf16 v[16:19], a[68:71], v[44:47], v[16:19]
    v_mfma_f32_16x16x32_bf16 v[20:23], a[72:75], v[44:47], v[20:23]
    v_mfma_f32_16x16x32_bf16 v[24:27], a[76:79], v[44:47], v[24:27]
    s_add_u32 s36, s38, s52
    buffer_load_dwordx4 v[44:47], v1, s[4:7], s36 offen offset:0 sc1
    s_waitcnt vmcnt(12)
    v_mfma_f32_16x16x32_bf16 v[12:15], a[80:83], v[48:51], v[12:15]
    v_mfma_f32_16x16x32_bf16 v[16:19], a[84:87], v[48:51], v[16:19]
    v_mfma_f32_16x16x32_bf16 v[20:23], a[88:91], v[48:51], v[20:23]
    v_mfma_f32_16x16x32_bf16 v[24:27], a[92:95], v[48:51], v[24:27]
    buffer_load_dwordx4 v[48:51], v1, s[4:7], s36 offen offset:1024 sc1
    s_waitcnt vmcnt(12)
    v_mfma_f32_16x16x32_bf16 v[12:15], a[96:99], v[52:55], v[12:15]
    v_mfma_f32_16x16x32_bf16 v[16:19], a[100:103], v[52:55], v[16:19]
    v_mfma_f32_16x16x32_bf16 v[20:23], a[104:107], v[52:55], v[20:23]
    v_mfma_f32_16x16x32_bf16 v[24:27], a[108:111], v[52:55], v[24:27]
    buffer_load_dwordx4 v[52:55], v1, s[4:7], s36 offen offset:2048 sc1
    s_waitcnt vmcnt(12)
    v_mfma_f32_16x16x32_bf16 v[12:15], a[112:115], v[56:59], v[12:15]
    v_mfma_f32_16x16x32_bf16 v[16:19], a[116:119], v[56:59], v[16:19]
    v_mfma_f32_16x16x32_bf16 v[20:23], a[120:123], v[56:59], v[20:23]
    v_mfma_f32_16x16x32_bf16 v[24:27], a[124:127], v[56:59], v[24:27]
    buffer_load_dwordx4 v[56:59], v1, s[4:7], s36 offen offset:3072 sc1
    s_waitcnt vmcnt(12)
    v_mfma_f32_16x16x32_bf16 v[12:15], a[128:131], v[60:63], v[12:15]
    v_mfma_f32_16x16x32_bf16 v[16:19], a[132:135], v[60:63], v[16:19]
    v_mfma_f32_16x16x32_bf16 v[20:23], a[136:139], v[60:63], v[20:23]
    v_mfma_f32_16x16x32_bf16 v[24:27], a[140:143], v[60:63], v[24:27]
    s_add_u32 s36, s38, s53
    buffer_load_dwordx4 v[60:63], v1, s[4:7], s36 offen offset:0 sc1
    s_waitcnt vmcnt(12)
    v_mfma_f32_16x16x32_bf16 v[12:15], a[144:147], v[64:67], v[12:15]
    v_mfma_f32_16x16x32_bf16 v[16:19], a[148:151], v[64:67], v[16:19]
    v_mfma_f32_16x16x32_bf16 v[20:23], a[152:155], v[64:67], v[20:23]
    v_mfma_f32_16x16x32_bf16 v[24:27], a[156:159], v[64:67], v[24:27]
    buffer_load_dwordx4 v[64:67], v1, s[4:7], s36 offen offset:1024 sc1
    s_waitcnt vmcnt(12)
    v_mfma_f32_16x16x32_bf16 v[12:15], a[160:163], v[68:71], v[12:15]
    v_mfma_f32_16x16x32_bf16 v[16:19], a[164:167], v[68:71], v[16:19]
    v_mfma_f32_16x16x32_bf16 v[20:23], a[168:171], v[68:71], v[20:23]
    v_mfma_f32_16x16x32_bf16 v[24:27], a[172:175], v[68:71], v[24:27]
    buffer_load_dwordx4 v[68:71], v1, s[4:7], s36 offen offset:2048 sc1
    s_waitcnt vmcnt(12)
    v_mfma_f32_16x16x32_bf16 v[12:15], a[176:179], v[72:75], v[12:15]
    v_mfma_f32_16x16x32_bf16 v[16:19], a[180:183], v[72:75], v[16:19]
    v_mfma_f32_16x16x32_bf16 v[20:23], a[184:187], v[72:75], v[20:23]
    v_mfma_f32_16x16x32_bf16 v[24:27], a[188:191], v[72:75], v[24:27]
    buffer_load_dwordx4 v[72:75], v1, s[4:7], s36 offen offset:3072 sc1
    s_add_u32 s33, s32, 1
    s_add_u32 s39, s38, 393216
    s_waitcnt vmcnt(12)
    v_cmp_ge_u32 vcc, s33, v4
    s_cbranch_vccnz L5_dry
    s_waitcnt vmcnt(11)
    v_mfma_f32_16x16x32_bf16 v[12:15], a[192:195], v[28:31], v[12:15]
    v_mfma_f32_16x16x32_bf16 v[16:19], a[196:199], v[28:31], v[16:19]
    v_mfma_f32_16x16x32_bf16 v[20:23], a[200:203], v[28:31], v[20:23]
    v_mfma_f32_16x16x32_bf16 v[24:27], a[204:207], v[28:31], v[24:27]
    s_add_u32 s36, s39, s48
    buffer_load_dwordx4 v[28:31], v1, s[4:7], s36 offen offset:0 sc1
    s_waitcnt vmcnt(11)
    v_mfma_f32_16x16x32_bf16 v[12:15], a[208:211], v[32:35], v[12:15]
    v_mfma_f32_16x16x32_bf16 v[16:19], a[212:215], v[32:35], v[16:19]
    v_mfma_f32_16x16x32_bf16 v[20:23], a[216:219], v[32:35], v[20:23]
    v_mfma_f32_16x16x32_bf16 v[24:27], a[220:223], v[32:35], v[24:27]
    buffer_load_dwordx4 v[32:35], v1, s[4:7], s36 offen offset:1024 sc1
    s_waitcnt vmcnt(11)
    v_mfma_f32_16x16x32_bf16 v[12:15], a[224:227], v[36:39], v[12:15]
    v_mfma_f32_16x16x32_bf16 v[16:19], a[228:231], v[36:39], v[16:19]
    v_mfma_f32_16x16x32_bf16 v[20:23], a[232:235], v[36:39], v[20:23]
    v_mfma_f32_16x16x32_bf16 v[24:27], a[236:239], v[36:39], v[24:27]
    buffer_load_dwordx4 v[36:39], v1, s[4:7], s36 offen offset:2048 sc1
    s_waitcnt vmcnt(11)
    v_mfma_f32_16x16x32_bf16 v[12:15], a[240:243], v[40:43], v[12:15]
    v_mfma_f32_16x16x32_bf16 v[16:19], a[244:247], v[40:43], v[16:19]
    v_mfma_f32_16x16x32_bf16 v[20:23], a[248:251], v[40:43], v[20:23]
    v_mfma_f32_16x16x32_bf16 v[24:27], a[252:255], v[40:43], v[24:27]
    buffer_load_dwordx4 v[40:43], v1, s[4:7], s36 offen offset:3072 sc1
    s_waitcnt vmcnt(11)
    v_mfma_f32_16x16x32_bf16 v[12:15], v[128:131], v[44:47], v[12:15]
    v_mfma_f32_16x16x32_bf16 v[16:19], v[132:135], v[44:47], v[16:19]
    v_mfma_f32_16x16x32_bf16 v[20:23], v[136:139], v[44:47], v[20:23]
    v_mfma_f32_16x16x32_bf16 v[24:27], v[140:143], v[44:47], v[24:27]
    s_add_u32 s36, s39, s49
    buffer_load_dwordx4 v[44:47], v1, s[4:7], s36 offen offset:0 sc1
    s_waitcnt vmcnt(11)
    v_mfma_f32_16x16x32_bf16 v[12:15], v[144:147], v[48:51], v[12:15]
    v_mfma_f32_16x16x32_bf16 v[16:19], v[148:151], v[48:51], v[16:19]
    v_mfma_f32_16x16x32_bf16 v[20:23], v[152:155], v[48:51], v[20:23]
    v_mfma_f32_16x16x32_bf16 v[24:27], v[156:159], v[48:51], v[24:27]
    buffer_load_dwordx4 v[48:51], v1, s[4:7], s36 offen offset:1024 sc1
    s_waitcnt vmcnt(11)
    v_mfma_f32_16x16x32_bf16 v[12:15], v[160:163], v[52:55], v[12:15]
    v_mfma_f32_16x16x32_bf16 v[16:19], v[164:167], v[52:55], v[16:19]
    v_mfma_f32_16x16x32_bf16 v[20:23], v[168:171], v[52:55], v[20:23]
    v_mfma_f32_16x16x32_bf16 v[24:27], v[172:175], v[52:55], v[24:27]
    buffer_load_dwordx4 v[52:55], v1, s[4:7], s36 offen offset:2048 sc1
    s_waitcnt vmcnt(11)
    v_mfma_f32_16x16x32_bf16 v[12:15], v[176:179], v[56:59], v[12:15]
    v_mfma_f32_16x16x32_bf16 v[16:19], v[180:183], v[56:59], v[16:19]
    v_mfma_f32_16x16x32_bf16 v[20:23], v[184:187], v[56:59], v[20:23]
    v_mfma_f32_16x16x32_bf16 v[24:27], v[188:191], v[56:59], v[24:27]
    buffer_load_dwordx4 v[56:59], v1, s[4:7], s36 offen offset:3072 sc1
    s_waitcnt vmcnt(11)
    v_mfma_f32_16x16x32_bf16 v[12:15], v[192:195], v[60:63], v[12:15]
    v_mfma_f32_16x16x32_bf16 v[16:19], v[196:199], v[60:63], v[16:19]
    v_mfma_f32_16x16x32_bf16 v[20:23], v[200:203], v[60:63], v[20:23]
    v_mfma_f32_16x16x32_bf16 v[24:27], v[204:207], v[60:63], v[24:27]
    s_add_u32 s36, s39, s50
    buffer_load_dwordx4 v[60:63], v1, s[4:7], s36 offen offset:0 sc1
    s_waitcnt vmcnt(11)
    v_mfma_f32_16x16x32_bf16 v[12:15], v[208:211], v[64:67], v[12:15]
    v_mfma_f32_16x16x32_bf16 v[16:19], v[212:215], v[64:67], v[16:19]
    v_mfma_f32_16x16x32_bf16 v[20:23], v[216:219], v[64:67], v[20:23]
    v_mfma_f32_16x16x32_bf16 v[24:27], v[220:223], v[64:67], v[24:27]
    buffer_load_dwordx4 v[64:67], v1, s[4:7], s36 offen offset:1024 sc1
    s_waitcnt vmcnt(11)
    v_mfma_f32_16x16x32_bf16 v[12:15], v[224:227], v[68:71], v[12:15]
    v_mfma_f32_16x16x32_bf16 v[16:19], v[228:231], v[68:71], v[16:19]
    v_mfma_f32_16x16x32_bf16 v[20:23], v[232:235], v[68:71], v[20:23]
    v_mfma_f32_16x16x32_bf16 v[24:27], v[236:239], v[68:71], v[24:27]
    buffer_load_dwordx4 v[68:71], v1, s[4:7], s36 offen offset:2048 sc1
    s_waitcnt vmcnt(11)
    v_mfma_f32_16x16x32_bf16 v[12:15], v[240:243], v[72:75], v[12:15]
    v_mfma_f32_16x16x32_bf16 v[16:19], v[244:247], v[72:75], v[16:19]
    v_mfma_f32_16x16x32_bf16 v[20:23], v[248:251], v[72:75], v[20:23]
    v_mfma_f32_16x16x32_bf16 v[24:27], v[252:255], v[72:75], v[24:27]
    buffer_load_dwordx4 v[72:75], v1, s[4:7], s36 offen offset:3072 sc1
    s_mov_b32 s44, 1
    s_branch L5_red
L5_dry:
    s_waitcnt vmcnt(11)
    v_mfma_f32_16x16x32_bf16 v[12:15], a[192:195], v[28:31], v[12:15]
    v_mfma_f32_16x16x32_bf16 v[16:19], a[196:199], v[28:31], v[16:19]
    v_mfma_f32_16x16x32_bf16 v[20:23], a[200:203], v[28:31], v[20:23]
    v_mfma_f32_16x16x32_bf16 v[24:27], a[204:207], v[28:31], v[24:27]
    s_waitcnt vmcnt(10)
    v_mfma_f32_16x16x32_bf16 v[12:15], a[208:211], v[32:35], v[12:15]
    v_mfma_f32_16x16x32_bf16 v[16:19], a[212:215], v[32:35], v[16:19]
    v_mfma_f32_16x16x32_bf16 v[20:23], a[216:219], v[32:35], v[20:23]
    v_mfma_f32_16x16x32_bf16 v[24:27], a[220:223], v[32:35], v[24:27]
    s_waitcnt vmcnt(9)
    v_mfma_f32_16x16x32_bf16 v[12:15], a[224:227], v[36:39], v[12:15]
    v_mfma_f32_16x16x32_bf16 v[16:19], a[228:231], v[36:39], v[16:19]
    v_mfma_f32_16x16x32_bf16 v[20:23], a[232:235], v[36:39], v[20:23]
    v_mfma_f32_16x16x32_bf16 v[24:27], a[236:239], v[36:39], v[24:27]
    s_waitcnt vmcnt(8)
    v_mfma_f32_16x16x32_bf16 v[12:15], a[240:243], v[40:43], v[12:15]
    v_mfma_f32_16x16x32_bf16 v[16:19], a[244:247], v[40:43], v[16:19]
    v_mfma_f32_16x16x32_bf16 v[20:23], a[248:251], v[40:43], v[20:23]
    v_mfma_f32_16x16x32_bf16 v[24:27], a[252:255], v[40:43], v[24:27]
    s_waitcnt vmcnt(7)
    v_mfma_f32_16x16x32_bf16 v[12:15], v[128:131], v[44:47], v[12:15]
    v_mfma_f32_16x16x32_bf16 v[16:19], v[132:135], v[44:47], v[16:19]
    v_mfma_f32_16x16x32_bf16 v[20:23], v[136:139], v[44:47], v[20:23]
    v_mfma_f32_16x16x32_bf16 v[24:27], v[140:143], v[44:47], v[24:27]
    s_waitcnt vmcnt(6)
    v_mfma_f32_16x16x32_bf16 v[12:15], v[144:147], v[48:51], v[12:15]
    v_mfma_f32_16x16x32_bf16 v[16:19], v[148:151], v[48:51], v[16:19]
    v_mfma_f32_16x16x32_bf16 v[20:23], v[152:155], v[48:51], v[20:23]
    v_mfma_f32_16x16x32_bf16 v[24:27], v[156:159], v[48:51], v[24:27]
    buffer_load_dword v4, v3, s[4:7], s40 offen sc1
    s_waitcnt vmcnt(6)
    v_mfma_f32_16x16x32_bf16 v[12:15], v[160:163], v[52:55], v[12:15]
    v_mfma_f32_16x16x32_bf16 v[16:19], v[164:167], v[52:55], v[16:19]
    v_mfma_f32_16x16x32_bf16 v[20:23], v[168:171], v[52:55], v[20:23]
    v_mfma_f32_16x16x32_bf16 v[24:27], v[172:175], v[52:55], v[24:27]
    s_waitcnt vmcnt(5)
    v_mfma_f32_16x16x32_bf16 v[12:15], v[176:179], v[56:59], v[12:15]
    v_mfma_f32_16x16x32_bf16 v[16:19], v[180:183], v[56:59], v[16:19]
    v_mfma_f32_16x16x32_bf16 v[20:23], v[184:187], v[56:59], v[20:23]
    v_mfma_f32_16x16x32_bf16 v[24:27], v[188:191], v[56:59], v[24:27]
    s_waitcnt vmcnt(4)
    v_mfma_f32_16x16x32_bf16 v[12:15], v[192:195], v[60:63], v[12:15]
    v_mfma_f32_16x16x32_bf16 v[16:19], v[196:199], v[60:63], v[16:19]
    v_mfma_f32_16x16x32_bf16 v[20:23], v[200:203], v[60:63], v[20:23]
    v_mfma_f32_16x16x32_bf16 v[24:27], v[204:207], v[60:63], v[24:27]
    s_waitcnt vmcnt(3)
    v_mfma_f32_16x16x32_bf16 v[12:15], v[208:211], v[64:67], v[12:15]
    v_mfma_f32_16x16x32_bf16 v[16:19], v[212:215], v[64:67], v[16:19]
    v_mfma_f32_16x16x32_bf16 v[20:23], v[216:219], v[64:67], v[20:23]
    v_mfma_f32_16x16x32_bf16 v[24:27], v[220:223], v[64:67], v[24:27]
    s_waitcnt vmcnt(2)
    v_mfma_f32_16x16x32_bf16 v[12:15], v[224:227], v[68:71], v[12:15]
    v_mfma_f32_16x16x32_bf16 v[16:19], v[228:231], v[68:71], v[16:19]
    v_mfma_f32_16x16x32_bf16 v[20:23], v[232:235], v[68:71], v[20:23]
    v_mfma_f32_16x16x32_bf16 v[24:27], v[236:239], v[68:71], v[24:27]
    s_waitcnt vmcnt(1)
    v_mfma_f32_16x16x32_bf16 v[12:15], v[240:243], v[72:75], v[12:15]
    v_mfma_f32_16x16x32_bf16 v[16:19], v[244:247], v[72:75], v[16:19]
    v_mfma_f32_16x16x32_bf16 v[20:23], v[248:251], v[72:75], v[20:23]
    v_mfma_f32_16x16x32_bf16 v[24:27], v[252:255], v[72:75], v[24:27]
    s_mov_b32 s44, 0
    s_cmp_eq_u32 s32, 63
    s_cbranch_scc1 L5_red
    s_waitcnt vmcnt(0)
    v_cmp_ge_u32 vcc, s33, v4
    s_cbranch_vccnz L5_red
    s_add_u32 s36, s39, s48
    buffer_load_dwordx4 v[28:31], v1, s[4:7], s36 offen offset:0 sc1
    buffer_load_dwordx4 v[32:35], v1, s[4:7], s36 offen offset:1024 sc1
    buffer_load_dwordx4 v[36:39], v1, s[4:7], s36 offen offset:2048 sc1
    buffer_load_dwordx4 v[40:43], v1, s[4:7], s36 offen offset:3072 sc1
    s_add_u32 s36, s39, s49
    buffer_load_dwordx4 v[44:47], v1, s[4:7], s36 offen offset:0 sc1
    buffer_load_dwordx4 v[48:51], v1, s[4:7], s36 offen offset:1024 sc1
    buffer_load_dwordx4 v[52:55], v1, s[4:7], s36 offen offset:2048 sc1
    buffer_load_dwordx4 v[56:59], v1, s[4:7], s36 offen offset:3072 sc1
    s_add_u32 s36, s39, s50
    buffer_load_dwordx4 v[60:63], v1, s[4:7], s36 offen offset:0 sc1
    buffer_load_dwordx4 v[64:67], v1, s[4:7], s36 offen offset:1024 sc1
    buffer_load_dwordx4 v[68:71], v1, s[4:7], s36 offen offset:2048 sc1
    buffer_load_dwordx4 v[72:75], v1, s[4:7], s36 offen offset:3072 sc1
    s_mov_b32 s44, 1
L5_red:
    s_lshl_b32 s33, s13, 12
    s_add_u32 s33, s33, s42
    v_add_u32 v5, s33, v1
    s_lshl_b32 s33, s13, 10
    s_add_u32 s33, s33, s42
    v_add_u32 v6, s33, v1
    ds_write_b128 v5, v[12:15] offset:0
    ds_write_b128 v5, v[16:19] offset:1024
    ds_write_b128 v5, v[20:23] offset:2048
    ds_write_b128 v5, v[24:27] offset:3072
    s_and_b32 s33, s32, 3
    s_lshl_b32 s33, s33, 11
    s_bfe_u32 s34, s32, 0x10002
    s_waitcnt lgkmcnt(0)
    s_barrier
    ds_read_b128 v[76:79], v6 offset:0
    ds_read_b128 v[80:83], v6 offset:4096
    ds_read_b128 v[84:87], v6 offset:8192
    ds_read_b128 v[88:91], v6 offset:12288
    s_waitcnt lgkmcnt(2)
    v_pk_add_f32 v[76:77], v[76:77], v[80:81]
    v_pk_add_f32 v[78:79], v[78:79], v[82:83]
    s_waitcnt lgkmcnt(1)
    v_pk_add_f32 v[76:77], v[76:77], v[84:85]
    v_pk_add_f32 v[78:79], v[78:79], v[86:87]
    s_waitcnt lgkmcnt(0)
    v_pk_add_f32 v[76:77], v[76:77], v[88:89]
    v_pk_add_f32 v[78:79], v[78:79], v[90:91]
    s_lshr_b32 s35, s13, 1
    s_cmp_eq_u32 s35, s30
    s_cbranch_scc1 L5_fin
    s_add_u32 s33, s33, s45
    v_and_or_b32 v76, v76, -2, s34
    s_cmp_eq_u32 s11, 0
    s_cbranch_scc0 L5_sg
    buffer_store_dwordx4 v[76:79], v1, s[4:7], s33 offen
    s_branch L5_next
L5_sg:
    buffer_store_dwordx4 v[76:79], v1, s[4:7], s33 offen sc1
    s_branch L5_next
L5_fin:
    s_add_u32 s33, s33, s46
L5_px:
    buffer_load_dwordx4 v[80:83], v1, s[4:7], s33 offen sc1
    s_sub_u32 s12, s12, 1
    s_cbranch_scc1 L_abort
    s_waitcnt vmcnt(0)
    v_xor_b32 v5, s34, v80
    v_and_b32 v5, 1, v5
    v_cmp_ne_u32 vcc, 0, v5
    s_cbranch_vccnz L5_px
    v_pk_add_f32 v[76:77], v[76:77], v[80:81]
    v_pk_add_f32 v[78:79], v[78:79], v[82:83]
    v_cvt_pk_bf16_f32 v8, v76, v77
    v_cvt_pk_bf16_f32 v9, v78, v79
    buffer_store_dwordx2 v[8:9], v2, s[20:23], s41 offen
L5_next:
    s_xor_b32 s42, s42, 16384
    s_add_u32 s41, s41, 81920
    s_mov_b32 s38, s39
    s_add_u32 s32, s32, 1
    s_cmp_eq_u32 s44, 1
    s_cbranch_scc1 L5_unit
    s_cmp_lt_u32 s32, 64
    s_cbranch_scc1 L5_wait
    s_endpgm
L_last:
    .p2align 6
Lc10_loop:
    s_barrier
    s_and_b32 s41, s40, 1
    s_lshl_b32 s69, s41, 11
    s_lshl_b32 s41, s41, 13
    s_add_u32 s41, s41, 8192
    v_add_u32 v10, s41, v0
    ds_read_b128 v[72:75], v10 offset:0
    s_nop 13
    buffer_load_dwordx4 v[28:31], v0, s[4:7], s67 offen offset:0 sc1
    ds_read_b128 v[80:83], v10 offset:2048
    s_add_u32 s49, s69, s60
    s_and_b32 s41, s40, 3
    s_nop 4
    buffer_load_dwordx4 v[32:35], v0, s[4:7], s67 offen offset:1024 sc1
    s_mul_i32 s70, s41, 327680
    s_add_u32 s70, s70, s57
    s_mul_i32 s71, s41, 98304
    s_nop 4
    buffer_load_dwordx4 v[36:39], v0, s[4:7], s67 offen offset:2048 sc1
    s_add_u32 s71, s71, s64
    s_lshl_b32 s75, s41, 15
    s_bfe_u32 s50, s40, 0x10002
    s_nop 4
    buffer_load_dwordx4 v[40:43], v0, s[4:7], s67 offen offset:3072 sc1
    s_nop 7
    buffer_load_dwordx4 v[44:47], v0, s[4:7], s68 offen offset:0 sc1
    s_waitcnt vmcnt(4)
    v_cmp_u_f32 vcc, v28, v30
    s_cbranch_vccnz Lc10_Df0
Lc10_Dk0:
    v_smfmac_f32_16x16x64_bf16 v[48:51], v[28:31], a[0:7], v2
    s_waitcnt vmcnt(3)
    v_cmp_u_f32 vcc, v32, v34
    v_smfmac_f32_16x16x64_bf16 v[52:55], v[28:31], a[80:87], v2
    v_smfmac_f32_16x16x64_bf16 v[56:59], v[28:31], a[40:47], v2
    v_smfmac_f32_16x16x64_bf16 v[60:63], v[28:31], a[120:127], v2
    s_cbranch_vccnz Lc10_Df1
Lc10_Dk1:
    v_smfmac_f32_16x16x64_bf16 v[48:51], v[32:35], a[8:15], v2
    s_waitcnt vmcnt(2)
    v_cmp_u_f32 vcc, v36, v38
    v_smfmac_f32_16x16x64_bf16 v[52:55], v[32:35], a[88:95], v2
    v_smfmac_f32_16x16x64_bf16 v[56:59], v[32:35], a[48:55], v2
    v_smfmac_f32_16x16x64_bf16 v[60:63], v[32:35], a[128:135], v2
    s_cbranch_vccnz Lc10_Df2
Lc10_Dk2:
    v_smfmac_f32_16x16x64_bf16 v[48:51], v[36:39], a[16:23], v2
    s_waitcnt vmcnt(1)
    v_cmp_u_f32 vcc, v40, v42
    v_smfmac_f32_16x16x64_bf16 v[52:55], v[36:39], a[96:103], v2
    v_smfmac_f32_16x16x64_bf16 v[56:59], v[36:39], a[56:63], v2
    v_smfmac_f32_16x16x64_bf16 v[60:63], v[36:39], a[136:143], v2
    s_cbranch_vccnz Lc10_Df3
Lc10_Dk3:
    v_smfmac_f32_16x16x64_bf16 v[48:51], v[40:43], a[24:31], v2
    s_waitcnt vmcnt(0)
    v_cmp_u_f32 vcc, v44, v46
    v_smfmac_f32_16x16x64_bf16 v[52:55], v[40:43], a[104:111], v2
    v_smfmac_f32_16x16x64_bf16 v[56:59], v[40:43], a[64:71], v2
    v_smfmac_f32_16x16x64_bf16 v[60:63], v[40:43], a[144:151], v2
    s_cbranch_vccnz Lc10_Df4
Lc10_Dk4:
    v_smfmac_f32_16x16x64_bf16 v[48:51], v[44:47], a[32:39], v2
    v_smfmac_f32_16x16x64_bf16 v[52:55], v[44:47], a[112:119], v2
    v_smfmac_f32_16x16x64_bf16 v[56:59], v[44:47], a[72:79], v2
    v_smfmac_f32_16x16x64_bf16 v[60:63], v[44:47], a[152:159], v2
Lc10_Ddone:
    v_permlane32_swap_b32 v48, v52
    v_permlane32_swap_b32 v49, v53
    v_permlane32_swap_b32 v50, v54
    v_permlane32_swap_b32 v51, v55
    v_pk_add_f32 v[48:49], v[48:49], v[52:53]
    v_pk_add_f32 v[50:51], v[50:51], v[54:55]
    v_cvt_pk_bf16_f32 v48, v48, v49
    v_cvt_pk_bf16_f32 v49, v50, v51
    ds_write_b64 v3, v[48:49] offset:0
    v_permlane32_swap_b32 v56, v60
    v_permlane32_swap_b32 v57, v61
    v_permlane32_swap_b32 v58, v62
    v_permlane32_swap_b32 v59, v63
    v_pk_add_f32 v[56:57], v[56:57], v[60:61]
    v_pk_add_f32 v[58:59], v[58:59], v[62:63]
    v_cvt_pk_bf16_f32 v56, v56, v57
    v_cvt_pk_bf16_f32 v57, v58, v59
    ds_write_b64 v3, v[56:57] offset:128
    v_smfmac_f32_16x16x64_bf16 v[64:67], v[28:31], a[160:167], v2
    v_smfmac_f32_16x16x64_bf16 v[68:71], v[28:31], a[200:207], v2
    buffer_load_dword v143, off, s[4:7], s66 sc1
    v_smfmac_f32_16x16x64_bf16 v[64:67], v[32:35], a[168:175], v2
    s_waitcnt lgkmcnt(0)
    s_barrier
    v_smfmac_f32_16x16x64_bf16 v[68:71], v[32:35], a[208:215], v2
    ds_read_b64_tr_b16 v[48:49], v4 offset:0
    ds_read_b64_tr_b16 v[50:51], v4 offset:128
    ds_read_b64_tr_b16 v[56:57], v4 offset:256
    ds_read_b64_tr_b16 v[58:59], v4 offset:384
    s_waitcnt lgkmcnt(2)
    v_mfma_f32_16x16x32_bf16 v[104:107], v[72:75], v[48:51], 0
    s_waitcnt lgkmcnt(0)
    v_mfma_f32_16x16x32_bf16 v[104:107], v[80:83], v[56:59], v[104:107]
    v_smfmac_f32_16x16x64_bf16 v[64:67], v[36:39], a[176:183], v2
    s_nop 3
    v_add_f32_dpp v20, v104, v104 row_ror:8 row_mask:0xf bank_mask:0x3
    v_add_f32_dpp v21, v105, v105 row_ror:8 row_mask:0xf bank_mask:0x3
    v_add_f32_dpp v22, v106, v106 row_ror:8 row_mask:0xf bank_mask:0x3
    v_add_f32_dpp v23, v107, v107 row_ror:8 row_mask:0xf bank_mask:0x3
    buffer_store_dwordx4 v[20:23], v27, s[4:7], s49 offen sc1
    ds_read_b64_tr_b16 v[160:161], v4 offset:2304
    ds_read_b64_tr_b16 v[162:163], v4 offset:2432
    v_smfmac_f32_16x16x64_bf16 v[68:71], v[36:39], a[216:223], v2
    v_smfmac_f32_16x16x64_bf16 v[64:67], v[40:43], a[184:191], v2
    v_smfmac_f32_16x16x64_bf16 v[68:71], v[40:43], a[224:231], v2
    v_smfmac_f32_16x16x64_bf16 v[64:67], v[44:47], a[192:199], v2
    v_smfmac_f32_16x16x64_bf16 v[68:71], v[44:47], a[232:239], v2
    s_nop 7
    v_permlane32_swap_b32 v64, v68
    v_permlane32_swap_b32 v65, v69
    v_permlane32_swap_b32 v66, v70
    v_permlane32_swap_b32 v67, v71
    v_pk_add_f32 v[64:65], v[64:65], v[68:69]
    v_pk_add_f32 v[66:67], v[66:67], v[70:71]
    v_cvt_pk_bf16_f32 v64, v64, v65
    v_cvt_pk_bf16_f32 v65, v66, v67
    ds_write_b64 v5, v[64:65]
    s_cmp_eq_u32 s40, 63
    s_waitcnt lgkmcnt(0)
    s_barrier
    s_cbranch_scc1 Lc10_fin
    v_mov_b64 v[64:65], 0
    v_mov_b64 v[66:67], 0
    v_mov_b64 v[68:69], 0
    v_mov_b64 v[70:71], 0
    s_add_u32 s41, s40, 1
    s_and_b32 s41, s41, 3
    s_lshl_b32 s41, s41, 14
    s_add_u32 s67, s41, s58
    s_add_u32 s68, s67, 4096
    s_add_u32 s76, s41, s59
    s_add_u32 s41, s75, s56
    v_add_u32 v10, s41, v0
    v_and_or_b32 v160, v160, -2, s50
    s_cmp_ge_u32 s40, 61
    s_cbranch_scc1 Lc10_pe
Lc10_pe_c:
    s_and_b32 s41, s40, 3
    s_xor_b32 s41, s41, 2
    s_mul_i32 s72, s41, 327680
    s_add_u32 s72, s72, s57
    s_sub_u32 s72, s72, 0
    s_add_u32 s48, s40, 1
    s_and_b32 s42, s48, 1
    s_lshl_b32 s42, s42, 13
    s_add_u32 m0, s42, s65
    s_lshl_b32 s74, s48, 12
    s_add_u32 s74, s74, s63
    s_add_u32 s51, s40, 2
    s_waitcnt vmcnt(1)
    v_cmp_gt_u32 vcc, s51, v143
    s_cbranch_vccnz Lc10_F_s
Lc10_F_c:
    s_nop 15
    s_nop 15
    s_nop 15
    s_nop 15
    s_nop 5
    v_mov_b32 v20, s48
Lc10_al:
    s_cmp_eq_u32 s39, 20
    buffer_load_dword v138, v137, s[4:7], s73 offen sc1
    v_cmp_gt_u32 vcc, s48, v138
    s_nop 3
    s_cbranch_vccz Lc10_al_ok
    buffer_load_dword v138, v137, s[4:7], s73 offen sc1
    v_cmp_gt_u32 vcc, s48, v138
    s_nop 3
    s_cbranch_vccz Lc10_al_ok
    buffer_load_dword v138, v137, s[4:7], s73 offen sc1
    v_cmp_gt_u32 vcc, s48, v138
    s_nop 3
    s_cbranch_vccz Lc10_al_ok
    buffer_load_dword v138, v137, s[4:7], s73 offen sc1
    v_cmp_gt_u32 vcc, s48, v138
    s_nop 3
    s_cbranch_vccz Lc10_al_ok
    s_waitcnt vmcnt(16)
    s_sub_u32 s12, s12, 1
    s_cbranch_scc1 L_abort
    s_branch Lc10_al
Lc10_al_ok:
    s_cbranch_scc0 Lc10_al_n
    buffer_store_dword v20, v141, s[4:7], s78 offen sc1
Lc10_al_n:
    s_nop 5
    s_cmp_ge_u32 s39, 20
    s_barrier
    s_cbranch_scc1 Lc10_sh
    s_nop 10
    buffer_load_dwordx4 v[80:83], v10, s[4:7], s94 offen sc1
    s_nop 5
    buffer_load_dwordx4 v[84:87], v10, s[4:7], s95 offen sc1
    s_nop 5
    buffer_load_dwordx4 v[88:91], v10, s[4:7], s96 offen sc1
    s_nop 5
    buffer_load_dwordx4 v[92:95], v10, s[4:7], s97 offen sc1
    s_nop 5
    buffer_load_dwordx4 v[96:99], v10, s[4:7], s98 offen sc1
    s_nop 5
    buffer_load_dwordx4 v[100:103], v10, s[4:7], s99 offen sc1
    s_waitcnt vmcnt(4)
    v_cmp_u_f32 vcc, v80, v84
    s_cbranch_vccnz Lc10_Gf0
Lc10_Gk0:
    v_smfmac_f32_16x16x64_bf16 v[64:67], v[80:83], v[168:175], v2
    s_waitcnt vmcnt(2)
    v_cmp_u_f32 vcc, v88, v92
    v_smfmac_f32_16x16x64_bf16 v[68:71], v[80:83], v[176:183], v2
    v_smfmac_f32_16x16x64_bf16 v[64:67], v[84:87], v[184:191], v2
    v_smfmac_f32_16x16x64_bf16 v[68:71], v[84:87], v[192:199], v2
    s_cbranch_vccnz Lc10_Gf1
Lc10_Gk1:
    buffer_load_dword v140, v139, s[4:7], s78 offen sc1
    v_smfmac_f32_16x16x64_bf16 v[64:67], v[88:91], v[200:207], v2
    s_waitcnt vmcnt(2)
    v_cmp_u_f32 vcc, v96, v96
    v_smfmac_f32_16x16x64_bf16 v[68:71], v[88:91], v[208:215], v2
    v_smfmac_f32_16x16x64_bf16 v[64:67], v[92:95], v[216:223], v2
    v_smfmac_f32_16x16x64_bf16 v[68:71], v[92:95], v[224:231], v2
    s_cbranch_vccnz Lc10_Gf2
Lc10_Gk2:
    buffer_load_dword v140, v139, s[4:7], s78 offen sc1
    s_waitcnt vmcnt(2)
    v_cmp_u_f32 vcc, v100, v100
    v_smfmac_f32_16x16x64_bf16 v[64:67], v[96:99], v[232:239], v2
    v_smfmac_f32_16x16x64_bf16 v[68:71], v[96:99], v[240:247], v2
    s_cbranch_vccnz Lc10_Gf3
Lc10_Gk3:
    buffer_load_dword v140, v139, s[4:7], s78 offen sc1
    v_smfmac_f32_16x16x64_bf16 v[64:67], v[100:103], v[248:255], v2
    v_smfmac_f32_16x16x64_bf16 v[68:71], v[100:103], a[248:255], v2
Lc10_Gdone:
    buffer_load_dword v140, v139, s[4:7], s78 offen sc1
    buffer_load_dwordx4 v0, s[4:7], s74 offen offset:0 sc1 lds
    buffer_load_dwordx4 v0, s[4:7], s74 offen offset:1024 sc1 lds
    s_nop 0
    v_cvt_pk_bf16_f32 v64, v64, v65
    v_cvt_pk_bf16_f32 v65, v66, v67
    ds_write_b64 v11, v[64:65] offset:0
    s_nop 0
    v_cvt_pk_bf16_f32 v68, v68, v69
    v_cvt_pk_bf16_f32 v69, v70, v71
    ds_write_b64 v11, v[68:69] offset:256
    buffer_load_dwordx4 v0, s[4:7], s74 offen offset:2048 sc1 lds
    buffer_load_dwordx4 v0, s[4:7], s74 offen offset:3072 sc1 lds
    v_cmp_gt_u32 vcc, s48, v140
    s_cbranch_vccnz Lc10_xs
Lc10_xc:
    s_waitcnt lgkmcnt(0)
    s_barrier
    ds_read_b128 v[80:83], v26 offset:0
    ds_read_b128 v[84:87], v26 offset:512
    buffer_store_dwordx4 v[160:163], v0, s[4:7], s71 offen sc1
    s_waitcnt lgkmcnt(1)
    v_mfma_f32_16x16x32_bf16 v[116:119], v[80:83], v[12:15], 0
    s_waitcnt lgkmcnt(0)
    v_mfma_f32_16x16x32_bf16 v[116:119], v[84:87], v[12:15], v[116:119]
    s_nop 7
    v_cvt_pk_bf16_f32 v164, v116, v117
    v_cvt_pk_bf16_f32 v165, v118, v119
    buffer_store_dwordx2 v[164:165], v7, s[4:7], s70 offen sc1
    s_nop 15
    s_nop 15
    s_nop 1
    v_mov_b64 v[48:49], 0
    v_mov_b64 v[50:51], 0
    v_mov_b64 v[52:53], 0
    v_mov_b64 v[54:55], 0
    v_mov_b64 v[56:57], 0
    v_mov_b64 v[58:59], 0
    v_mov_b64 v[60:61], 0
    v_mov_b64 v[62:63], 0
    v_mov_b64 v[64:65], 0
    v_mov_b64 v[66:67], 0
    v_mov_b64 v[68:69], 0
    v_mov_b64 v[70:71], 0
    s_nop 15
    s_nop 15
    s_nop 3
    s_add_u32 s41, s70, 0
    buffer_load_dwordx4 v[28:31], v8, s[4:7], s41 offen sc1
    s_nop 15
    s_nop 9
    s_add_u32 s41, s70, 81920
    buffer_load_dwordx4 v[32:35], v8, s[4:7], s41 offen sc1
    buffer_store_dwordx4 v[16:19], v136, s[4:7], s72 offen sc1
    s_waitcnt vmcnt(2)
    v_mfma_f32_16x16x32_bf16 v[104:107], v[12:15], v[28:31], v[116:119]
    v_cmp_u_f32 vcc, v28, v30
    s_nop 4
    s_cbranch_vccnz Lc10_C_t
Lc10_C_c:
    s_nop 0
    v_cvt_pk_bf16_f32 v164, v104, v105
    v_cvt_pk_bf16_f32 v165, v106, v107
    buffer_store_dwordx2 v[164:165], v9, s[4:7], s76 offen sc1
    s_waitcnt vmcnt(3)
Lc10_join:
    s_add_u32 s40, s40, 1
    s_branch Lc10_loop
Lc10_fin:
    s_waitcnt lgkmcnt(0)
    v_and_or_b32 v160, v160, -2, s50
    buffer_store_dwordx4 v[160:163], v0, s[4:7], s71 offen sc1
    s_endpgm
Lc10_Dr0:
    s_waitcnt vmcnt(4)
    v_cmp_u_f32 vcc, v28, v30
    s_cbranch_vccz Lc10_Dk0
Lc10_Df0:
    buffer_load_dwordx4 v[28:31], v0, s[4:7], s67 offen offset:0 sc1
    buffer_load_dwordx4 v[32:35], v0, s[4:7], s67 offen offset:1024 sc1
    buffer_load_dwordx4 v[36:39], v0, s[4:7], s67 offen offset:2048 sc1
    buffer_load_dwordx4 v[40:43], v0, s[4:7], s67 offen offset:3072 sc1
    buffer_load_dwordx4 v[44:47], v0, s[4:7], s68 offen offset:0 sc1
    s_sub_u32 s12, s12, 1
    s_cbranch_scc1 L_abort
    s_and_b32 s52, s12, 15
    s_cbranch_scc1 Lc10_Dr0
    s_waitcnt vmcnt(0)
    v_cmp_eq_u32 s[32:33], s53, v28
    v_cmp_eq_u32 vcc, s53, v30
    s_nop 0
    s_or_b64 s[32:33], s[32:33], vcc
    s_cbranch_scc1 Lc10_Df0
    s_branch Lc10_Dk0
Lc10_Dr1:
    s_waitcnt vmcnt(3)
    v_cmp_u_f32 vcc, v32, v34
    s_cbranch_vccz Lc10_Dk1
Lc10_Df1:
    buffer_load_dwordx4 v[32:35], v0, s[4:7], s67 offen offset:1024 sc1
    buffer_load_dwordx4 v[36:39], v0, s[4:7], s67 offen offset:2048 sc1
    buffer_load_dwordx4 v[40:43], v0, s[4:7], s67 offen offset:3072 sc1
    buffer_load_dwordx4 v[44:47], v0, s[4:7], s68 offen offset:0 sc1
    s_sub_u32 s12, s12, 1
    s_cbranch_scc1 L_abort
    s_and_b32 s52, s12, 15
    s_cbranch_scc1 Lc10_Dr1
    s_waitcnt vmcnt(0)
    v_cmp_eq_u32 s[32:33], s53, v32
    v_cmp_eq_u32 vcc, s53, v34
    s_nop 0
    s_or_b64 s[32:33], s[32:33], vcc
    s_cbranch_scc1 Lc10_Df1
    s_branch Lc10_Dk1
Lc10_Dr2:
    s_waitcnt vmcnt(2)
    v_cmp_u_f32 vcc, v36, v38
    s_cbranch_vccz Lc10_Dk2
Lc10_Df2:
    buffer_load_dwordx4 v[36:39], v0, s[4:7], s67 offen offset:2048 sc1
    buffer_load_dwordx4 v[40:43], v0, s[4:7], s67 offen offset:3072 sc1
    buffer_load_dwordx4 v[44:47], v0, s[4:7], s68 offen offset:0 sc1
    s_sub_u32 s12, s12, 1
    s_cbranch_scc1 L_abort
    s_and_b32 s52, s12, 15
    s_cbranch_scc1 Lc10_Dr2
    s_waitcnt vmcnt(0)
    v_cmp_eq_u32 s[32:33], s53, v36
    v_cmp_eq_u32 vcc, s53, v38
    s_nop 0
    s_or_b64 s[32:33], s[32:33], vcc
    s_cbranch_scc1 Lc10_Df2
    s_branch Lc10_Dk2
Lc10_Dr3:
    s_waitcnt vmcnt(1)
    v_cmp_u_f32 vcc, v40, v42
    s_cbranch_vccz Lc10_Dk3
Lc10_Df3:
    buffer_load_dwordx4 v[40:43], v0, s[4:7], s67 offen offset:3072 sc1
    buffer_load_dwordx4 v[44:47], v0, s[4:7], s68 offen offset:0 sc1
    s_sub_u32 s12, s12, 1
    s_cbranch_scc1 L_abort
    s_and_b32 s52, s12, 15
    s_cbranch_scc1 Lc10_Dr3
    s_waitcnt vmcnt(0)
    v_cmp_eq_u32 s[32:33], s53, v40
    v_cmp_eq_u32 vcc, s53, v42
    s_nop 0
    s_or_b64 s[32:33], s[32:33], vcc
    s_cbranch_scc1 Lc10_Df3
    s_branch Lc10_Dk3
Lc10_Dr4:
    s_waitcnt vmcnt(0)
    v_cmp_u_f32 vcc, v44, v46
    s_cbranch_vccz Lc10_Dk4
Lc10_Df4:
    buffer_load_dwordx4 v[44:47], v0, s[4:7], s68 offen offset:0 sc1
    s_sub_u32 s12, s12, 1
    s_cbranch_scc1 L_abort
    s_and_b32 s52, s12, 15
    s_cbranch_scc1 Lc10_Dr4
    s_waitcnt vmcnt(0)
    v_cmp_eq_u32 s[32:33], s53, v44
    v_cmp_eq_u32 vcc, s53, v46
    s_nop 0
    s_or_b64 s[32:33], s[32:33], vcc
    s_cbranch_scc1 Lc10_Df4
    s_branch Lc10_Dk4
Lc10_pe:
    buffer_store_dwordx4 v[160:163], v0, s[4:7], s71 offen sc1
    s_mov_b32 s71, 1073741824
    s_branch Lc10_pe_c
Lc10_F_s:
    buffer_load_dword v143, off, s[4:7], s66 sc1
    s_sub_u32 s12, s12, 1
    s_cbranch_scc1 L_abort
    s_waitcnt vmcnt(0)
    v_cmp_gt_u32 vcc, s51, v143
    s_cbranch_vccnz Lc10_F_s
    s_branch Lc10_F_c
Lc10_sh:
    s_nop 15
    buffer_load_dword v140, v139, s[4:7], s78 offen sc1
    s_nop 15
    buffer_load_dword v140, v139, s[4:7], s78 offen sc1
    s_nop 15
    buffer_load_dword v140, v139, s[4:7], s78 offen sc1
    s_nop 15
    buffer_load_dword v140, v139, s[4:7], s78 offen sc1
    s_nop 15
    buffer_load_dword v140, v139, s[4:7], s78 offen sc1
    s_nop 15
    buffer_load_dword v140, v139, s[4:7], s78 offen sc1
    s_nop 15
    buffer_load_dword v140, v139, s[4:7], s78 offen sc1
    s_nop 15
    buffer_load_dword v140, v139, s[4:7], s78 offen sc1
    s_nop 15
    buffer_load_dword v140, v139, s[4:7], s78 offen sc1
    s_nop 15
    buffer_load_dword v140, v139, s[4:7], s78 offen sc1
    s_nop 15
    buffer_load_dword v140, v139, s[4:7], s78 offen sc1
    s_nop 15
    buffer_load_dword v140, v139, s[4:7], s78 offen sc1
    s_branch Lc10_Gdone
Lc10_Gr0:
    s_waitcnt vmcnt(0)
    v_cmp_u_f32 vcc, v80, v84
    s_cbranch_vccz Lc10_Gk0
Lc10_Gf0:
    buffer_load_dwordx4 v[80:83], v10, s[4:7], s94 offen sc1
    buffer_load_dwordx4 v[84:87], v10, s[4:7], s95 offen sc1
    buffer_load_dwordx4 v[88:91], v10, s[4:7], s96 offen sc1
    buffer_load_dwordx4 v[92:95], v10, s[4:7], s97 offen sc1
    buffer_load_dwordx4 v[96:99], v10, s[4:7], s98 offen sc1
    buffer_load_dwordx4 v[100:103], v10, s[4:7], s99 offen sc1
    s_sub_u32 s12, s12, 1
    s_cbranch_scc1 L_abort
    s_and_b32 s52, s12, 15
    s_cbranch_scc1 Lc10_Gr0
    s_waitcnt vmcnt(0)
    v_cmp_eq_u32 s[32:33], s53, v80
    v_cmp_eq_u32 vcc, s53, v84
    s_nop 0
    s_or_b64 s[32:33], s[32:33], vcc
    s_cbranch_scc1 Lc10_Gf0
    s_branch Lc10_Gk0
Lc10_Gr1:
    s_waitcnt vmcnt(0)
    v_cmp_u_f32 vcc, v88, v92
    s_cbranch_vccz Lc10_Gk1
Lc10_Gf1:
    buffer_load_dwordx4 v[88:91], v10, s[4:7], s96 offen sc1
    buffer_load_dwordx4 v[92:95], v10, s[4:7], s97 offen sc1
    buffer_load_dwordx4 v[96:99], v10, s[4:7], s98 offen sc1
    buffer_load_dwordx4 v[100:103], v10, s[4:7], s99 offen sc1
    s_sub_u32 s12, s12, 1
    s_cbranch_scc1 L_abort
    s_and_b32 s52, s12, 15
    s_cbranch_scc1 Lc10_Gr1
    s_waitcnt vmcnt(0)
    v_cmp_eq_u32 s[32:33], s53, v88
    v_cmp_eq_u32 vcc, s53, v92
    s_nop 0
    s_or_b64 s[32:33], s[32:33], vcc
    s_cbranch_scc1 Lc10_Gf1
    s_branch Lc10_Gk1
Lc10_Gr2:
    s_waitcnt vmcnt(0)
    v_cmp_u_f32 vcc, v96, v96
    s_cbranch_vccz Lc10_Gk2
Lc10_Gf2:
    buffer_load_dwordx4 v[96:99], v10, s[4:7], s98 offen sc1
    buffer_load_dwordx4 v[100:103], v10, s[4:7], s99 offen sc1
    s_sub_u32 s12, s12, 1
    s_cbranch_scc1 L_abort
    s_and_b32 s52, s12, 15
    s_cbranch_scc1 Lc10_Gr2
    s_waitcnt vmcnt(0)
    v_cmp_eq_u32 s[32:33], s53, v96
    v_cmp_eq_u32 vcc, s53, v96
    s_nop 0
    s_or_b64 s[32:33], s[32:33], vcc
    s_cbranch_scc1 Lc10_Gf2
    s_branch Lc10_Gk2
Lc10_Gr3:
    s_waitcnt vmcnt(0)
    v_cmp_u_f32 vcc, v100, v100
    s_cbranch_vccz Lc10_Gk3
Lc10_Gf3:
    buffer_load_dwordx4 v[100:103], v10, s[4:7], s99 offen sc1
    s_sub_u32 s12, s12, 1
    s_cbranch_scc1 L_abort
    s_and_b32 s52, s12, 15
    s_cbranch_scc1 Lc10_Gr3
    s_waitcnt vmcnt(0)
    v_cmp_eq_u32 s[32:33], s53, v100
    v_cmp_eq_u32 vcc, s53, v100
    s_nop 0
    s_or_b64 s[32:33], s[32:33], vcc
    s_cbranch_scc1 Lc10_Gf3
    s_branch Lc10_Gk3
Lc10_xs:
    buffer_load_dword v140, v139, s[4:7], s78 offen sc1
    s_nop 3
    v_cmp_gt_u32 vcc, s48, v140
    s_cbranch_vccz Lc10_xo
    buffer_load_dword v140, v139, s[4:7], s78 offen sc1
    s_nop 3
    v_cmp_gt_u32 vcc, s48, v140
    s_cbranch_vccz Lc10_xo
    buffer_load_dword v140, v139, s[4:7], s78 offen sc1
    s_nop 3
    v_cmp_gt_u32 vcc, s48, v140
    s_cbranch_vccz Lc10_xo
    buffer_load_dword v140, v139, s[4:7], s78 offen sc1
    s_nop 3
    v_cmp_gt_u32 vcc, s48, v140
    s_cbranch_vccz Lc10_xo
    s_waitcnt vmcnt(16)
    s_sub_u32 s12, s12, 1
    s_cbranch_scc1 L_abort
    s_branch Lc10_xs
Lc10_xo:
    s_branch Lc10_xc
Lc10_C_t:
    s_add_u32 s41, s70, 163840
    buffer_load_dwordx4 v[28:31], v8, s[4:7], s41 offen sc1
    s_waitcnt vmcnt(2)
    v_mfma_f32_16x16x32_bf16 v[104:107], v[12:15], v[32:35], v[116:119]
    v_cmp_u_f32 vcc, v32, v34
    s_nop 4
    s_cbranch_vccz Lc10_C_c
    s_add_u32 s41, s70, 245760
    buffer_load_dwordx4 v[32:35], v8, s[4:7], s41 offen sc1
    s_waitcnt vmcnt(1)
    v_mfma_f32_16x16x32_bf16 v[104:107], v[12:15], v[28:31], v[116:119]
    v_cmp_u_f32 vcc, v28, v30
    s_nop 4
    s_cbranch_vccz Lc10_C_c
    s_waitcnt vmcnt(0)
    v_mfma_f32_16x16x32_bf16 v[104:107], v[12:15], v[32:35], v[116:119]
    v_cmp_u_f32 vcc, v32, v34
    s_nop 4
    s_cbranch_vccz Lc10_C_c
Lc10_C_x:
    s_add_u32 s41, s70, 0
    buffer_load_dwordx4 v[28:31], v8, s[4:7], s41 offen sc1
    s_sub_u32 s12, s12, 1
    s_cbranch_scc1 L_abort
    s_and_b32 s52, s12, 15
    s_cbranch_scc1 Lc10_C_r
    s_waitcnt vmcnt(0)
    v_cmp_eq_u32 s[32:33], s53, v28
    v_cmp_eq_u32 vcc, s53, v30
    s_nop 0
    s_or_b64 s[32:33], s[32:33], vcc
    s_cbranch_scc1 Lc10_C_x
    v_mfma_f32_16x16x32_bf16 v[104:107], v[12:15], v[28:31], v[116:119]
    s_nop 5
    s_branch Lc10_C_c
Lc10_C_r:
    s_waitcnt vmcnt(0)
    v_mfma_f32_16x16x32_bf16 v[104:107], v[12:15], v[28:31], v[116:119]
    v_cmp_u_f32 vcc, v28, v30
    s_nop 4
    s_cbranch_vccz Lc10_C_c
    s_branch Lc10_C_x
    .p2align 6
Lc11_loop:
    s_barrier
    s_and_b32 s41, s40, 1
    s_lshl_b32 s69, s41, 11
    s_lshl_b32 s41, s41, 13
    s_add_u32 s41, s41, 8192
    v_add_u32 v10, s41, v0
    ds_read_b128 v[76:79], v10 offset:1024
    s_nop 13
    buffer_load_dwordx4 v[28:31], v0, s[4:7], s67 offen offset:0 sc1
    ds_read_b128 v[84:87], v10 offset:3072
    s_add_u32 s49, s69, s60
    s_and_b32 s41, s40, 3
    s_nop 4
    buffer_load_dwordx4 v[32:35], v0, s[4:7], s67 offen offset:1024 sc1
    s_mul_i32 s70, s41, 327680
    s_add_u32 s70, s70, s57
    s_mul_i32 s71, s41, 98304
    s_nop 4
    buffer_load_dwordx4 v[36:39], v0, s[4:7], s67 offen offset:2048 sc1
    s_add_u32 s71, s71, s64
    s_lshl_b32 s75, s41, 15
    s_bfe_u32 s50, s40, 0x10002
    s_nop 4
    buffer_load_dwordx4 v[40:43], v0, s[4:7], s67 offen offset:3072 sc1
    s_nop 7
    buffer_load_dwordx4 v[44:47], v0, s[4:7], s68 offen offset:0 sc1
    s_waitcnt vmcnt(4)
    v_cmp_u_f32 vcc, v28, v30
    s_cbranch_vccnz Lc11_Df0
Lc11_Dk0:
    v_smfmac_f32_16x16x64_bf16 v[48:51], v[28:31], a[0:7], v2
    s_waitcnt vmcnt(3)
    v_cmp_u_f32 vcc, v32, v34
    v_smfmac_f32_16x16x64_bf16 v[52:55], v[28:31], a[80:87], v2
    v_smfmac_f32_16x16x64_bf16 v[56:59], v[28:31], a[40:47], v2
    v_smfmac_f32_16x16x64_bf16 v[60:63], v[28:31], a[120:127], v2
    s_cbranch_vccnz Lc11_Df1
Lc11_Dk1:
    v_smfmac_f32_16x16x64_bf16 v[48:51], v[32:35], a[8:15], v2
    s_waitcnt vmcnt(2)
    v_cmp_u_f32 vcc, v36, v38
    v_smfmac_f32_16x16x64_bf16 v[52:55], v[32:35], a[88:95], v2
    v_smfmac_f32_16x16x64_bf16 v[56:59], v[32:35], a[48:55], v2
    v_smfmac_f32_16x16x64_bf16 v[60:63], v[32:35], a[128:135], v2
    s_cbranch_vccnz Lc11_Df2
Lc11_Dk2:
    v_smfmac_f32_16x16x64_bf16 v[48:51], v[36:39], a[16:23], v2
    s_waitcnt vmcnt(1)
    v_cmp_u_f32 vcc, v40, v42
    v_smfmac_f32_16x16x64_bf16 v[52:55], v[36:39], a[96:103], v2
    v_smfmac_f32_16x16x64_bf16 v[56:59], v[36:39], a[56:63], v2
    v_smfmac_f32_16x16x64_bf16 v[60:63], v[36:39], a[136:143], v2
    s_cbranch_vccnz Lc11_Df3
Lc11_Dk3:
    v_smfmac_f32_16x16x64_bf16 v[48:51], v[40:43], a[24:31], v2
    s_waitcnt vmcnt(0)
    v_cmp_u_f32 vcc, v44, v46
    v_smfmac_f32_16x16x64_bf16 v[52:55], v[40:43], a[104:111], v2
    v_smfmac_f32_16x16x64_bf16 v[56:59], v[40:43], a[64:71], v2
    v_smfmac_f32_16x16x64_bf16 v[60:63], v[40:43], a[144:151], v2
    s_cbranch_vccnz Lc11_Df4
Lc11_Dk4:
    v_smfmac_f32_16x16x64_bf16 v[48:51], v[44:47], a[32:39], v2
    v_smfmac_f32_16x16x64_bf16 v[52:55], v[44:47], a[112:119], v2
    v_smfmac_f32_16x16x64_bf16 v[56:59], v[44:47], a[72:79], v2
    v_smfmac_f32_16x16x64_bf16 v[60:63], v[44:47], a[152:159], v2
Lc11_Ddone:
    v_permlane32_swap_b32 v48, v52
    v_permlane32_swap_b32 v49, v53
    v_permlane32_swap_b32 v50, v54
    v_permlane32_swap_b32 v51, v55
    v_pk_add_f32 v[48:49], v[48:49], v[52:53]
    v_pk_add_f32 v[50:51], v[50:51], v[54:55]
    v_cvt_pk_bf16_f32 v48, v48, v49
    v_cvt_pk_bf16_f32 v49, v50, v51
    ds_write_b64 v3, v[48:49] offset:0
    v_permlane32_swap_b32 v56, v60
    v_permlane32_swap_b32 v57, v61
    v_permlane32_swap_b32 v58, v62
    v_permlane32_swap_b32 v59, v63
    v_pk_add_f32 v[56:57], v[56:57], v[60:61]
    v_pk_add_f32 v[58:59], v[58:59], v[62:63]
    v_cvt_pk_bf16_f32 v56, v56, v57
    v_cvt_pk_bf16_f32 v57, v58, v59
    ds_write_b64 v3, v[56:57] offset:128
    v_smfmac_f32_16x16x64_bf16 v[64:67], v[28:31], a[160:167], v2
    v_smfmac_f32_16x16x64_bf16 v[68:71], v[28:31], a[200:207], v2
    buffer_load_dword v143, off, s[4:7], s66 sc1
    v_smfmac_f32_16x16x64_bf16 v[64:67], v[32:35], a[168:175], v2
    s_waitcnt lgkmcnt(0)
    s_barrier
    v_smfmac_f32_16x16x64_bf16 v[68:71], v[32:35], a[208:215], v2
    ds_read_b64_tr_b16 v[48:49], v4 offset:0
    ds_read_b64_tr_b16 v[50:51], v4 offset:128
    ds_read_b64_tr_b16 v[56:57], v4 offset:256
    ds_read_b64_tr_b16 v[58:59], v4 offset:384
    s_waitcnt lgkmcnt(2)
    v_mfma_f32_16x16x32_bf16 v[108:111], v[76:79], v[48:51], 0
    s_waitcnt lgkmcnt(0)
    v_mfma_f32_16x16x32_bf16 v[108:111], v[84:87], v[56:59], v[108:111]
    v_smfmac_f32_16x16x64_bf16 v[64:67], v[36:39], a[176:183], v2
    s_nop 3
    v_add_f32_dpp v20, v108, v108 row_ror:8 row_mask:0xf bank_mask:0xc
    v_add_f32_dpp v21, v109, v109 row_ror:8 row_mask:0xf bank_mask:0xc
    v_add_f32_dpp v22, v110, v110 row_ror:8 row_mask:0xf bank_mask:0xc
    v_add_f32_dpp v23, v111, v111 row_ror:8 row_mask:0xf bank_mask:0xc
    buffer_store_dwordx4 v[20:23], v27, s[4:7], s49 offen sc1
    ds_read_b64_tr_b16 v[160:161], v4 offset:2560
    ds_read_b64_tr_b16 v[162:163], v4 offset:2688
    v_smfmac_f32_16x16x64_bf16 v[68:71], v[36:39], a[216:223], v2
    v_smfmac_f32_16x16x64_bf16 v[64:67], v[40:43], a[184:191], v2
    v_smfmac_f32_16x16x64_bf16 v[68:71], v[40:43], a[224:231], v2
    v_smfmac_f32_16x16x64_bf16 v[64:67], v[44:47], a[192:199], v2
    v_smfmac_f32_16x16x64_bf16 v[68:71], v[44:47], a[232:239], v2
    s_nop 7
    v_permlane32_swap_b32 v64, v68
    v_permlane32_swap_b32 v65, v69
    v_permlane32_swap_b32 v66, v70
    v_permlane32_swap_b32 v67, v71
    v_pk_add_f32 v[64:65], v[64:65], v[68:69]
    v_pk_add_f32 v[66:67], v[66:67], v[70:71]
    v_cvt_pk_bf16_f32 v64, v64, v65
    v_cvt_pk_bf16_f32 v65, v66, v67
    ds_write_b64 v5, v[64:65]
    s_cmp_eq_u32 s40, 63
    s_waitcnt lgkmcnt(0)
    s_barrier
    s_cbranch_scc1 Lc11_fin
    v_mov_b64 v[64:65], 0
    v_mov_b64 v[66:67], 0
    v_mov_b64 v[68:69], 0
    v_mov_b64 v[70:71], 0
    s_add_u32 s41, s40, 1
    s_and_b32 s41, s41, 3
    s_lshl_b32 s41, s41, 14
    s_add_u32 s67, s41, s58
    s_add_u32 s68, s67, 4096
    s_add_u32 s76, s41, s59
    s_add_u32 s41, s75, s56
    v_add_u32 v10, s41, v0
    v_and_or_b32 v160, v160, -2, s50
    s_cmp_ge_u32 s40, 61
    s_cbranch_scc1 Lc11_pe
Lc11_pe_c:
    s_and_b32 s41, s40, 3
    s_xor_b32 s41, s41, 2
    s_mul_i32 s72, s41, 327680
    s_add_u32 s72, s72, s57
    s_sub_u32 s72, s72, 512
    s_add_u32 s48, s40, 1
    s_and_b32 s42, s48, 1
    s_lshl_b32 s42, s42, 13
    s_add_u32 m0, s42, s65
    s_lshl_b32 s74, s48, 12
    s_add_u32 s74, s74, s63
    s_add_u32 s51, s40, 2
    s_waitcnt vmcnt(1)
    v_cmp_gt_u32 vcc, s51, v143
    s_cbranch_vccnz Lc11_F_s
Lc11_F_c:
    s_cmp_ge_u32 s39, 20
    s_barrier
    s_cbranch_scc1 Lc11_sh
    s_nop 10
    buffer_load_dwordx4 v[80:83], v10, s[4:7], s94 offen sc1
    s_nop 5
    buffer_load_dwordx4 v[84:87], v10, s[4:7], s95 offen sc1
    s_nop 5
    buffer_load_dwordx4 v[88:91], v10, s[4:7], s96 offen sc1
    s_nop 5
    buffer_load_dwordx4 v[92:95], v10, s[4:7], s97 offen sc1
    s_nop 5
    buffer_load_dwordx4 v[96:99], v10, s[4:7], s98 offen sc1
    s_nop 5
    buffer_load_dwordx4 v[100:103], v10, s[4:7], s99 offen sc1
    s_waitcnt vmcnt(4)
    v_cmp_u_f32 vcc, v80, v84
    s_cbranch_vccnz Lc11_Gf0
Lc11_Gk0:
    v_smfmac_f32_16x16x64_bf16 v[64:67], v[80:83], v[168:175], v2
    s_waitcnt vmcnt(2)
    v_cmp_u_f32 vcc, v88, v92
    v_smfmac_f32_16x16x64_bf16 v[68:71], v[80:83], v[176:183], v2
    v_smfmac_f32_16x16x64_bf16 v[64:67], v[84:87], v[184:191], v2
    v_smfmac_f32_16x16x64_bf16 v[68:71], v[84:87], v[192:199], v2
    s_cbranch_vccnz Lc11_Gf1
Lc11_Gk1:
    v_smfmac_f32_16x16x64_bf16 v[64:67], v[88:91], v[200:207], v2
    s_waitcnt vmcnt(1)
    v_cmp_u_f32 vcc, v96, v96
    v_smfmac_f32_16x16x64_bf16 v[68:71], v[88:91], v[208:215], v2
    v_smfmac_f32_16x16x64_bf16 v[64:67], v[92:95], v[216:223], v2
    v_smfmac_f32_16x16x64_bf16 v[68:71], v[92:95], v[224:231], v2
    s_cbranch_vccnz Lc11_Gf2
Lc11_Gk2:
    s_waitcnt vmcnt(0)
    v_cmp_u_f32 vcc, v100, v100
    v_smfmac_f32_16x16x64_bf16 v[64:67], v[96:99], v[232:239], v2
    v_smfmac_f32_16x16x64_bf16 v[68:71], v[96:99], v[240:247], v2
    s_cbranch_vccnz Lc11_Gf3
Lc11_Gk3:
    v_smfmac_f32_16x16x64_bf16 v[64:67], v[100:103], v[248:255], v2
    v_smfmac_f32_16x16x64_bf16 v[68:71], v[100:103], a[248:255], v2
Lc11_Gdone:
    buffer_load_dwordx4 v0, s[4:7], s74 offen offset:0 sc1 lds
    buffer_load_dwordx4 v0, s[4:7], s74 offen offset:1024 sc1 lds
    s_nop 1
    v_cvt_pk_bf16_f32 v64, v64, v65
    v_cvt_pk_bf16_f32 v65, v66, v67
    ds_write_b64 v11, v[64:65] offset:0
    s_nop 0
    v_cvt_pk_bf16_f32 v68, v68, v69
    v_cvt_pk_bf16_f32 v69, v70, v71
    ds_write_b64 v11, v[68:69] offset:256
    buffer_load_dwordx4 v0, s[4:7], s74 offen offset:2048 sc1 lds
    buffer_load_dwordx4 v0, s[4:7], s74 offen offset:3072 sc1 lds
    s_waitcnt lgkmcnt(0)
    s_barrier
    ds_read_b128 v[80:83], v26 offset:0
    ds_read_b128 v[84:87], v26 offset:512
    buffer_store_dwordx4 v[160:163], v0, s[4:7], s71 offen sc1
    s_waitcnt lgkmcnt(1)
    v_mfma_f32_16x16x32_bf16 v[116:119], v[80:83], v[12:15], 0
    s_waitcnt lgkmcnt(0)
    v_mfma_f32_16x16x32_bf16 v[116:119], v[84:87], v[12:15], v[116:119]
    s_nop 7
    v_cvt_pk_bf16_f32 v164, v116, v117
    v_cvt_pk_bf16_f32 v165, v118, v119
    buffer_store_dwordx2 v[164:165], v7, s[4:7], s70 offen sc1
    s_nop 15
    s_nop 15
    s_nop 13
    v_mov_b64 v[48:49], 0
    v_mov_b64 v[50:51], 0
    v_mov_b64 v[52:53], 0
    v_mov_b64 v[54:55], 0
    v_mov_b64 v[56:57], 0
    v_mov_b64 v[58:59], 0
    v_mov_b64 v[60:61], 0
    v_mov_b64 v[62:63], 0
    v_mov_b64 v[64:65], 0
    v_mov_b64 v[66:67], 0
    v_mov_b64 v[68:69], 0
    v_mov_b64 v[70:71], 0
    s_nop 15
    s_nop 7
    s_add_u32 s41, s70, 0
    buffer_load_dwordx4 v[28:31], v8, s[4:7], s41 offen sc1
    s_nop 15
    s_nop 9
    s_add_u32 s41, s70, 81920
    buffer_load_dwordx4 v[32:35], v8, s[4:7], s41 offen sc1
    buffer_store_dwordx4 v[16:19], v136, s[4:7], s72 offen sc1
    s_waitcnt vmcnt(2)
    v_mfma_f32_16x16x32_bf16 v[104:107], v[12:15], v[28:31], v[116:119]
    v_cmp_u_f32 vcc, v28, v30
    s_nop 4
    s_cbranch_vccnz Lc11_C_t
Lc11_C_c:
    s_nop 0
    v_cvt_pk_bf16_f32 v164, v104, v105
    v_cvt_pk_bf16_f32 v165, v106, v107
    buffer_store_dwordx2 v[164:165], v9, s[4:7], s76 offen sc1
    s_waitcnt vmcnt(3)
Lc11_join:
    s_add_u32 s40, s40, 1
    s_branch Lc11_loop
Lc11_fin:
    s_waitcnt lgkmcnt(0)
    v_and_or_b32 v160, v160, -2, s50
    buffer_store_dwordx4 v[160:163], v0, s[4:7], s71 offen sc1
    s_endpgm
Lc11_Dr0:
    s_waitcnt vmcnt(4)
    v_cmp_u_f32 vcc, v28, v30
    s_cbranch_vccz Lc11_Dk0
Lc11_Df0:
    buffer_load_dwordx4 v[28:31], v0, s[4:7], s67 offen offset:0 sc1
    buffer_load_dwordx4 v[32:35], v0, s[4:7], s67 offen offset:1024 sc1
    buffer_load_dwordx4 v[36:39], v0, s[4:7], s67 offen offset:2048 sc1
    buffer_load_dwordx4 v[40:43], v0, s[4:7], s67 offen offset:3072 sc1
    buffer_load_dwordx4 v[44:47], v0, s[4:7], s68 offen offset:0 sc1
    s_sub_u32 s12, s12, 1
    s_cbranch_scc1 L_abort
    s_and_b32 s52, s12, 15
    s_cbranch_scc1 Lc11_Dr0
    s_waitcnt vmcnt(0)
    v_cmp_eq_u32 s[32:33], s53, v28
    v_cmp_eq_u32 vcc, s53, v30
    s_nop 0
    s_or_b64 s[32:33], s[32:33], vcc
    s_cbranch_scc1 Lc11_Df0
    s_branch Lc11_Dk0
Lc11_Dr1:
    s_waitcnt vmcnt(3)
    v_cmp_u_f32 vcc, v32, v34
    s_cbranch_vccz Lc11_Dk1
Lc11_Df1:
    buffer_load_dwordx4 v[32:35], v0, s[4:7], s67 offen offset:1024 sc1
    buffer_load_dwordx4 v[36:39], v0, s[4:7], s67 offen offset:2048 sc1
    buffer_load_dwordx4 v[40:43], v0, s[4:7], s67 offen offset:3072 sc1
    buffer_load_dwordx4 v[44:47], v0, s[4:7], s68 offen offset:0 sc1
    s_sub_u32 s12, s12, 1
    s_cbranch_scc1 L_abort
    s_and_b32 s52, s12, 15
    s_cbranch_scc1 Lc11_Dr1
    s_waitcnt vmcnt(0)
    v_cmp_eq_u32 s[32:33], s53, v32
    v_cmp_eq_u32 vcc, s53, v34
    s_nop 0
    s_or_b64 s[32:33], s[32:33], vcc
    s_cbranch_scc1 Lc11_Df1
    s_branch Lc11_Dk1
Lc11_Dr2:
    s_waitcnt vmcnt(2)
    v_cmp_u_f32 vcc, v36, v38
    s_cbranch_vccz Lc11_Dk2
Lc11_Df2:
    buffer_load_dwordx4 v[36:39], v0, s[4:7], s67 offen offset:2048 sc1
    buffer_load_dwordx4 v[40:43], v0, s[4:7], s67 offen offset:3072 sc1
    buffer_load_dwordx4 v[44:47], v0, s[4:7], s68 offen offset:0 sc1
    s_sub_u32 s12, s12, 1
    s_cbranch_scc1 L_abort
    s_and_b32 s52, s12, 15
    s_cbranch_scc1 Lc11_Dr2
    s_waitcnt vmcnt(0)
    v_cmp_eq_u32 s[32:33], s53, v36
    v_cmp_eq_u32 vcc, s53, v38
    s_nop 0
    s_or_b64 s[32:33], s[32:33], vcc
    s_cbranch_scc1 Lc11_Df2
    s_branch Lc11_Dk2
Lc11_Dr3:
    s_waitcnt vmcnt(1)
    v_cmp_u_f32 vcc, v40, v42
    s_cbranch_vccz Lc11_Dk3
Lc11_Df3:
    buffer_load_dwordx4 v[40:43], v0, s[4:7], s67 offen offset:3072 sc1
    buffer_load_dwordx4 v[44:47], v0, s[4:7], s68 offen offset:0 sc1
    s_sub_u32 s12, s12, 1
    s_cbranch_scc1 L_abort
    s_and_b32 s52, s12, 15
    s_cbranch_scc1 Lc11_Dr3
    s_waitcnt vmcnt(0)
    v_cmp_eq_u32 s[32:33], s53, v40
    v_cmp_eq_u32 vcc, s53, v42
    s_nop 0
    s_or_b64 s[32:33], s[32:33], vcc
    s_cbranch_scc1 Lc11_Df3
    s_branch Lc11_Dk3
Lc11_Dr4:
    s_waitcnt vmcnt(0)
    v_cmp_u_f32 vcc, v44, v46
    s_cbranch_vccz Lc11_Dk4
Lc11_Df4:
    buffer_load_dwordx4 v[44:47], v0, s[4:7], s68 offen offset:0 sc1
    s_sub_u32 s12, s12, 1
    s_cbranch_scc1 L_abort
    s_and_b32 s52, s12, 15
    s_cbranch_scc1 Lc11_Dr4
    s_waitcnt vmcnt(0)
    v_cmp_eq_u32 s[32:33], s53, v44
    v_cmp_eq_u32 vcc, s53, v46
    s_nop 0
    s_or_b64 s[32:33], s[32:33], vcc
    s_cbranch_scc1 Lc11_Df4
    s_branch Lc11_Dk4
Lc11_pe:
    buffer_store_dwordx4 v[160:163], v0, s[4:7], s71 offen sc1
    s_mov_b32 s71, 1073741824
    s_branch Lc11_pe_c
Lc11_F_s:
    buffer_load_dword v143, off, s[4:7], s66 sc1
    s_sub_u32 s12, s12, 1
    s_cbranch_scc1 L_abort
    s_waitcnt vmcnt(0)
    v_cmp_gt_u32 vcc, s51, v143
    s_cbranch_vccnz Lc11_F_s
    s_branch Lc11_F_c
Lc11_sh:
    global_load_dword v140, v[138:139], off sc1
    s_nop 15
    s_nop 15
    s_nop 15
    s_nop 15
    s_nop 15
    s_nop 15
    s_nop 15
    s_nop 15
    s_nop 15
    s_nop 15
    s_nop 15
    s_nop 15
    s_nop 11
    s_branch Lc11_Gdone
Lc11_Gr0:
    s_waitcnt vmcnt(4)
    v_cmp_u_f32 vcc, v80, v84
    s_cbranch_vccz Lc11_Gk0
Lc11_Gf0:
    buffer_load_dwordx4 v[80:83], v10, s[4:7], s94 offen sc1
    buffer_load_dwordx4 v[84:87], v10, s[4:7], s95 offen sc1
    buffer_load_dwordx4 v[88:91], v10, s[4:7], s96 offen sc1
    buffer_load_dwordx4 v[92:95], v10, s[4:7], s97 offen sc1
    buffer_load_dwordx4 v[96:99], v10, s[4:7], s98 offen sc1
    buffer_load_dwordx4 v[100:103], v10, s[4:7], s99 offen sc1
    s_sub_u32 s12, s12, 1
    s_cbranch_scc1 L_abort
    s_and_b32 s52, s12, 15
    s_cbranch_scc1 Lc11_Gr0
    s_waitcnt vmcnt(0)
    v_cmp_eq_u32 s[32:33], s53, v80
    v_cmp_eq_u32 vcc, s53, v84
    s_nop 0
    s_or_b64 s[32:33], s[32:33], vcc
    s_cbranch_scc1 Lc11_Gf0
    s_branch Lc11_Gk0
Lc11_Gr1:
    s_waitcnt vmcnt(2)
    v_cmp_u_f32 vcc, v88, v92
    s_cbranch_vccz Lc11_Gk1
Lc11_Gf1:
    buffer_load_dwordx4 v[88:91], v10, s[4:7], s96 offen sc1
    buffer_load_dwordx4 v[92:95], v10, s[4:7], s97 offen sc1
    buffer_load_dwordx4 v[96:99], v10, s[4:7], s98 offen sc1
    buffer_load_dwordx4 v[100:103], v10, s[4:7], s99 offen sc1
    s_sub_u32 s12, s12, 1
    s_cbranch_scc1 L_abort
    s_and_b32 s52, s12, 15
    s_cbranch_scc1 Lc11_Gr1
    s_waitcnt vmcnt(0)
    v_cmp_eq_u32 s[32:33], s53, v88
    v_cmp_eq_u32 vcc, s53, v92
    s_nop 0
    s_or_b64 s[32:33], s[32:33], vcc
    s_cbranch_scc1 Lc11_Gf1
    s_branch Lc11_Gk1
Lc11_Gr2:
    s_waitcnt vmcnt(1)
    v_cmp_u_f32 vcc, v96, v96
    s_cbranch_vccz Lc11_Gk2
Lc11_Gf2:
    buffer_load_dwordx4 v[96:99], v10, s[4:7], s98 offen sc1
    buffer_load_dwordx4 v[100:103], v10, s[4:7], s99 offen sc1
    s_sub_u32 s12, s12, 1
    s_cbranch_scc1 L_abort
    s_and_b32 s52, s12, 15
    s_cbranch_scc1 Lc11_Gr2
    s_waitcnt vmcnt(0)
    v_cmp_eq_u32 s[32:33], s53, v96
    v_cmp_eq_u32 vcc, s53, v96
    s_nop 0
    s_or_b64 s[32:33], s[32:33], vcc
    s_cbranch_scc1 Lc11_Gf2
    s_branch Lc11_Gk2
Lc11_Gr3:
    s_waitcnt vmcnt(0)
    v_cmp_u_f32 vcc, v100, v100
    s_cbranch_vccz Lc11_Gk3
Lc11_Gf3:
    buffer_load_dwordx4 v[100:103], v10, s[4:7], s99 offen sc1
    s_sub_u32 s12, s12, 1
    s_cbranch_scc1 L_abort
    s_and_b32 s52, s12, 15
    s_cbranch_scc1 Lc11_Gr3
    s_waitcnt vmcnt(0)
    v_cmp_eq_u32 s[32:33], s53, v100
    v_cmp_eq_u32 vcc, s53, v100
    s_nop 0
    s_or_b64 s[32:33], s[32:33], vcc
    s_cbranch_scc1 Lc11_Gf3
    s_branch Lc11_Gk3
Lc11_C_t:
    s_add_u32 s41, s70, 163840
    buffer_load_dwordx4 v[28:31], v8, s[4:7], s41 offen sc1
    s_waitcnt vmcnt(2)
    v_mfma_f32_16x16x32_bf16 v[104:107], v[12:15], v[32:35], v[116:119]
    v_cmp_u_f32 vcc, v32, v34
    s_nop 4
    s_cbranch_vccz Lc11_C_c
    s_add_u32 s41, s70, 245760
    buffer_load_dwordx4 v[32:35], v8, s[4:7], s41 offen sc1
    s_waitcnt vmcnt(1)
    v_mfma_f32_16x16x32_bf16 v[104:107], v[12:15], v[28:31], v[116:119]
    v_cmp_u_f32 vcc, v28, v30
    s_nop 4
    s_cbranch_vccz Lc11_C_c
    s_waitcnt vmcnt(0)
    v_mfma_f32_16x16x32_bf16 v[104:107], v[12:15], v[32:35], v[116:119]
    v_cmp_u_f32 vcc, v32, v34
    s_nop 4
    s_cbranch_vccz Lc11_C_c
Lc11_C_x:
    s_add_u32 s41, s70, 0
    buffer_load_dwordx4 v[28:31], v8, s[4:7], s41 offen sc1
    s_sub_u32 s12, s12, 1
    s_cbranch_scc1 L_abort
    s_and_b32 s52, s12, 15
    s_cbranch_scc1 Lc11_C_r
    s_waitcnt vmcnt(0)
    v_cmp_eq_u32 s[32:33], s53, v28
    v_cmp_eq_u32 vcc, s53, v30
    s_nop 0
    s_or_b64 s[32:33], s[32:33], vcc
    s_cbranch_scc1 Lc11_C_x
    v_mfma_f32_16x16x32_bf16 v[104:107], v[12:15], v[28:31], v[116:119]
    s_nop 5
    s_branch Lc11_C_c
Lc11_C_r:
    s_waitcnt vmcnt(0)
    v_mfma_f32_16x16x32_bf16 v[104:107], v[12:15], v[28:31], v[116:119]
    v_cmp_u_f32 vcc, v28, v30
    s_nop 4
    s_cbranch_vccz Lc11_C_c
    s_branch Lc11_C_x
    .p2align 6
Lc12_loop:
    s_barrier
    s_and_b32 s41, s40, 1
    s_lshl_b32 s69, s41, 11
    s_lshl_b32 s41, s41, 13
    s_add_u32 s41, s41, 8192
    v_add_u32 v10, s41, v0
    s_add_u32 s49, s69, s60
    s_nop 13
    buffer_load_dwordx4 v[28:31], v0, s[4:7], s67 offen offset:0 sc1
    s_and_b32 s41, s40, 3
    s_mul_i32 s70, s41, 327680
    s_nop 5
    buffer_load_dwordx4 v[32:35], v0, s[4:7], s67 offen offset:1024 sc1
    s_add_u32 s70, s70, s57
    s_mul_i32 s71, s41, 98304
    s_nop 5
    buffer_load_dwordx4 v[36:39], v0, s[4:7], s67 offen offset:2048 sc1
    s_add_u32 s71, s71, s64
    s_lshl_b32 s75, s41, 15
    s_nop 5
    buffer_load_dwordx4 v[40:43], v0, s[4:7], s67 offen offset:3072 sc1
    s_bfe_u32 s50, s40, 0x10002
    s_nop 6
    buffer_load_dwordx4 v[44:47], v0, s[4:7], s68 offen offset:0 sc1
    s_waitcnt vmcnt(4)
    v_cmp_u_f32 vcc, v28, v30
    s_cbranch_vccnz Lc12_Df0
Lc12_Dk0:
    v_smfmac_f32_16x16x64_bf16 v[48:51], v[28:31], a[0:7], v2
    s_waitcnt vmcnt(3)
    v_cmp_u_f32 vcc, v32, v34
    v_smfmac_f32_16x16x64_bf16 v[52:55], v[28:31], a[80:87], v2
    v_smfmac_f32_16x16x64_bf16 v[56:59], v[28:31], a[40:47], v2
    v_smfmac_f32_16x16x64_bf16 v[60:63], v[28:31], a[120:127], v2
    s_cbranch_vccnz Lc12_Df1
Lc12_Dk1:
    v_smfmac_f32_16x16x64_bf16 v[48:51], v[32:35], a[8:15], v2
    s_waitcnt vmcnt(2)
    v_cmp_u_f32 vcc, v36, v38
    v_smfmac_f32_16x16x64_bf16 v[52:55], v[32:35], a[88:95], v2
    v_smfmac_f32_16x16x64_bf16 v[56:59], v[32:35], a[48:55], v2
    v_smfmac_f32_16x16x64_bf16 v[60:63], v[32:35], a[128:135], v2
    s_cbranch_vccnz Lc12_Df2
Lc12_Dk2:
    v_smfmac_f32_16x16x64_bf16 v[48:51], v[36:39], a[16:23], v2
    s_waitcnt vmcnt(1)
    v_cmp_u_f32 vcc, v40, v42
    v_smfmac_f32_16x16x64_bf16 v[52:55], v[36:39], a[96:103], v2
    v_smfmac_f32_16x16x64_bf16 v[56:59], v[36:39], a[56:63], v2
    v_smfmac_f32_16x16x64_bf16 v[60:63], v[36:39], a[136:143], v2
    s_cbranch_vccnz Lc12_Df3
Lc12_Dk3:
    v_smfmac_f32_16x16x64_bf16 v[48:51], v[40:43], a[24:31], v2
    s_waitcnt vmcnt(0)
    v_cmp_u_f32 vcc, v44, v46
    v_smfmac_f32_16x16x64_bf16 v[52:55], v[40:43], a[104:111], v2
    v_smfmac_f32_16x16x64_bf16 v[56:59], v[40:43], a[64:71], v2
    v_smfmac_f32_16x16x64_bf16 v[60:63], v[40:43], a[144:151], v2
    s_cbranch_vccnz Lc12_Df4
Lc12_Dk4:
    v_smfmac_f32_16x16x64_bf16 v[48:51], v[44:47], a[32:39], v2
    v_smfmac_f32_16x16x64_bf16 v[52:55], v[44:47], a[112:119], v2
    v_smfmac_f32_16x16x64_bf16 v[56:59], v[44:47], a[72:79], v2
    v_smfmac_f32_16x16x64_bf16 v[60:63], v[44:47], a[152:159], v2
Lc12_Ddone:
    v_permlane32_swap_b32 v48, v52
    v_permlane32_swap_b32 v49, v53
    v_permlane32_swap_b32 v50, v54
    v_permlane32_swap_b32 v51, v55
    v_pk_add_f32 v[48:49], v[48:49], v[52:53]
    v_pk_add_f32 v[50:51], v[50:51], v[54:55]
    v_cvt_pk_bf16_f32 v48, v48, v49
    v_cvt_pk_bf16_f32 v49, v50, v51
    ds_write_b64 v3, v[48:49] offset:0
    v_permlane32_swap_b32 v56, v60
    v_permlane32_swap_b32 v57, v61
    v_permlane32_swap_b32 v58, v62
    v_permlane32_swap_b32 v59, v63
    v_pk_add_f32 v[56:57], v[56:57], v[60:61]
    v_pk_add_f32 v[58:59], v[58:59], v[62:63]
    v_cvt_pk_bf16_f32 v56, v56, v57
    v_cvt_pk_bf16_f32 v57, v58, v59
    ds_write_b64 v3, v[56:57] offset:128
    v_smfmac_f32_16x16x64_bf16 v[64:67], v[28:31], a[160:167], v2
    v_smfmac_f32_16x16x64_bf16 v[68:71], v[28:31], a[200:207], v2
    v_smfmac_f32_16x16x64_bf16 v[64:67], v[32:35], a[168:175], v2
    s_waitcnt lgkmcnt(0)
    s_barrier
    ds_read_b64_tr_b16 v[48:49], v4 offset:0
    ds_read_b64_tr_b16 v[50:51], v4 offset:128
    ds_read_b64_tr_b16 v[52:53], v4 offset:2304
    ds_read_b64_tr_b16 v[54:55], v4 offset:2432
    ds_read_b64_tr_b16 v[56:57], v4 offset:256
    ds_read_b64_tr_b16 v[58:59], v4 offset:384
    ds_read_b64_tr_b16 v[60:61], v4 offset:2560
    ds_read_b64_tr_b16 v[62:63], v4 offset:2688
    s_waitcnt lgkmcnt(4)
    v_mfma_f32_16x16x32_bf16 v[112:115], v[52:55], v[48:51], 0
    s_waitcnt lgkmcnt(0)
    v_mfma_f32_16x16x32_bf16 v[112:115], v[60:63], v[56:59], v[112:115]
    v_smfmac_f32_16x16x64_bf16 v[68:71], v[32:35], a[208:215], v2
    s_nop 3
    v_add_f32_dpp v24, v112, v112 row_ror:8 row_mask:0xf bank_mask:0x3
    v_add_f32_dpp v25, v113, v113 row_ror:8 row_mask:0xf bank_mask:0x3
    s_nop 0
    v_add_f32_dpp v24, v114, v114 row_ror:8 row_mask:0xf bank_mask:0xc
    v_add_f32_dpp v25, v115, v115 row_ror:8 row_mask:0xf bank_mask:0xc
    s_nop 1
    v_permlane32_swap_b32 v24, v25
    v_add_f32 v24, v24, v25
    buffer_store_dword v24, v1, s[4:7], s49 offen offset:1024 sc1
    v_smfmac_f32_16x16x64_bf16 v[64:67], v[36:39], a[176:183], v2
    v_smfmac_f32_16x16x64_bf16 v[68:71], v[36:39], a[216:223], v2
    v_smfmac_f32_16x16x64_bf16 v[64:67], v[40:43], a[184:191], v2
    v_smfmac_f32_16x16x64_bf16 v[68:71], v[40:43], a[224:231], v2
    v_smfmac_f32_16x16x64_bf16 v[64:67], v[44:47], a[192:199], v2
    v_smfmac_f32_16x16x64_bf16 v[68:71], v[44:47], a[232:239], v2
    s_nop 7
    v_permlane32_swap_b32 v64, v68
    v_permlane32_swap_b32 v65, v69
    v_permlane32_swap_b32 v66, v70
    v_permlane32_swap_b32 v67, v71
    v_pk_add_f32 v[64:65], v[64:65], v[68:69]
    v_pk_add_f32 v[66:67], v[66:67], v[70:71]
    v_cvt_pk_bf16_f32 v64, v64, v65
    v_cvt_pk_bf16_f32 v65, v66, v67
    ds_write_b64 v5, v[64:65]
    s_cmp_eq_u32 s40, 63
    s_waitcnt lgkmcnt(0)
    s_barrier
    ds_read_b128 v[160:163], v0 offset:4608
    s_cbranch_scc1 Lc12_fin
    v_mov_b64 v[64:65], 0
    v_mov_b64 v[66:67], 0
    v_mov_b64 v[68:69], 0
    v_mov_b64 v[70:71], 0
    s_add_u32 s41, s40, 1
    s_and_b32 s41, s41, 3
    s_lshl_b32 s41, s41, 14
    s_add_u32 s67, s41, s58
    s_add_u32 s68, s67, 4096
    s_add_u32 s76, s41, s59
    s_add_u32 s41, s75, s56
    v_add_u32 v10, s41, v0
    s_waitcnt lgkmcnt(0)
    v_and_or_b32 v160, v160, -2, s50
    s_cmp_ge_u32 s40, 61
    s_cbranch_scc1 Lc12_pe
Lc12_pe_c:
    s_and_b32 s41, s40, 3
    s_xor_b32 s41, s41, 2
    s_lshl_b32 s41, s41, 14
    s_add_u32 s72, s41, s59
    s_sub_u32 s72, s72, 256
    s_xor_b32 s51, s75, 65536
    s_add_u32 s51, s51, s55
    s_cmp_ge_u32 s39, 20
    s_barrier
    s_cbranch_scc1 Lc12_sh
    s_nop 10
    buffer_load_dwordx4 v[80:83], v10, s[4:7], s94 offen sc1
    s_nop 5
    buffer_load_dwordx4 v[84:87], v10, s[4:7], s95 offen sc1
    s_nop 5
    buffer_load_dwordx4 v[88:91], v10, s[4:7], s96 offen sc1
    s_nop 5
    buffer_load_dwordx4 v[92:95], v10, s[4:7], s97 offen sc1
    s_nop 5
    buffer_load_dwordx4 v[96:99], v10, s[4:7], s98 offen sc1
    s_nop 5
    buffer_load_dwordx4 v[100:103], v10, s[4:7], s99 offen sc1
    s_waitcnt vmcnt(4)
    v_cmp_u_f32 vcc, v80, v84
    s_cbranch_vccnz Lc12_Gf0
Lc12_Gk0:
    v_smfmac_f32_16x16x64_bf16 v[64:67], v[80:83], v[168:175], v2
    s_waitcnt vmcnt(2)
    v_cmp_u_f32 vcc, v88, v92
    v_smfmac_f32_16x16x64_bf16 v[68:71], v[80:83], v[176:183], v2
    v_smfmac_f32_16x16x64_bf16 v[64:67], v[84:87], v[184:191], v2
    v_smfmac_f32_16x16x64_bf16 v[68:71], v[84:87], v[192:199], v2
    s_cbranch_vccnz Lc12_Gf1
Lc12_Gk1:
    v_smfmac_f32_16x16x64_bf16 v[64:67], v[88:91], v[200:207], v2
    s_waitcnt vmcnt(1)
    v_cmp_u_f32 vcc, v96, v96
    v_smfmac_f32_16x16x64_bf16 v[68:71], v[88:91], v[208:215], v2
    v_smfmac_f32_16x16x64_bf16 v[64:67], v[92:95], v[216:223], v2
    v_smfmac_f32_16x16x64_bf16 v[68:71], v[92:95], v[224:231], v2
    s_cbranch_vccnz Lc12_Gf2
Lc12_Gk2:
    s_waitcnt vmcnt(0)
    v_cmp_u_f32 vcc, v100, v100
    v_smfmac_f32_16x16x64_bf16 v[64:67], v[96:99], v[232:239], v2
    v_smfmac_f32_16x16x64_bf16 v[68:71], v[96:99], v[240:247], v2
    s_cbranch_vccnz Lc12_Gf3
Lc12_Gk3:
    v_smfmac_f32_16x16x64_bf16 v[64:67], v[100:103], v[248:255], v2
    v_smfmac_f32_16x16x64_bf16 v[68:71], v[100:103], a[248:255], v2
Lc12_Gdone:
    buffer_store_dwordx4 v[16:19], v136, s[4:7], s72 offen sc1
    buffer_store_dwordx4 v[16:19], v0, s[4:7], s51 offen sc1
    s_nop 1
    v_cvt_pk_bf16_f32 v64, v64, v65
    v_cvt_pk_bf16_f32 v65, v66, v67
    ds_write_b64 v11, v[64:65] offset:0
    s_nop 0
    v_cvt_pk_bf16_f32 v68, v68, v69
    v_cvt_pk_bf16_f32 v69, v70, v71
    ds_write_b64 v11, v[68:69] offset:256
    buffer_store_dwordx4 v[160:163], v0, s[4:7], s71 offen sc1
    s_waitcnt lgkmcnt(0)
    s_barrier
    ds_read_b128 v[80:83], v26 offset:0
    ds_read_b128 v[84:87], v26 offset:512
    s_waitcnt lgkmcnt(1)
    v_mfma_f32_16x16x32_bf16 v[116:119], v[80:83], v[12:15], 0
    s_waitcnt lgkmcnt(0)
    v_mfma_f32_16x16x32_bf16 v[116:119], v[84:87], v[12:15], v[116:119]
    s_nop 7
    v_cvt_pk_bf16_f32 v164, v116, v117
    v_cvt_pk_bf16_f32 v165, v118, v119
    buffer_store_dwordx2 v[164:165], v7, s[4:7], s70 offen sc1
    s_nop 15
    s_nop 15
    s_nop 15
    s_nop 9
    v_mov_b64 v[48:49], 0
    v_mov_b64 v[50:51], 0
    v_mov_b64 v[52:53], 0
    v_mov_b64 v[54:55], 0
    v_mov_b64 v[56:57], 0
    v_mov_b64 v[58:59], 0
    v_mov_b64 v[60:61], 0
    v_mov_b64 v[62:63], 0
    v_mov_b64 v[64:65], 0
    v_mov_b64 v[66:67], 0
    v_mov_b64 v[68:69], 0
    v_mov_b64 v[70:71], 0
    s_nop 11
    s_add_u32 s41, s70, 0
    buffer_load_dwordx4 v[28:31], v8, s[4:7], s41 offen sc1
    s_nop 15
    s_nop 9
    s_add_u32 s41, s70, 81920
    buffer_load_dwordx4 v[32:35], v8, s[4:7], s41 offen sc1
    s_waitcnt vmcnt(1)
    v_mfma_f32_16x16x32_bf16 v[104:107], v[12:15], v[28:31], v[116:119]
    v_cmp_u_f32 vcc, v28, v30
    s_nop 4
    s_cbranch_vccnz Lc12_C_t
Lc12_C_c:
    s_nop 0
    v_cvt_pk_bf16_f32 v164, v104, v105
    v_cvt_pk_bf16_f32 v165, v106, v107
    buffer_store_dwordx2 v[164:165], v9, s[4:7], s76 offen sc1
    s_waitcnt vmcnt(2)
Lc12_join:
    s_add_u32 s40, s40, 1
    s_branch Lc12_loop
Lc12_fin:
    s_waitcnt lgkmcnt(0)
    v_and_or_b32 v160, v160, -2, s50
    buffer_store_dwordx4 v[160:163], v0, s[4:7], s71 offen sc1
    s_endpgm
Lc12_Dr0:
    s_waitcnt vmcnt(4)
    v_cmp_u_f32 vcc, v28, v30
    s_cbranch_vccz Lc12_Dk0
Lc12_Df0:
    buffer_load_dwordx4 v[28:31], v0, s[4:7], s67 offen offset:0 sc1
    buffer_load_dwordx4 v[32:35], v0, s[4:7], s67 offen offset:1024 sc1
    buffer_load_dwordx4 v[36:39], v0, s[4:7], s67 offen offset:2048 sc1
    buffer_load_dwordx4 v[40:43], v0, s[4:7], s67 offen offset:3072 sc1
    buffer_load_dwordx4 v[44:47], v0, s[4:7], s68 offen offset:0 sc1
    s_sub_u32 s12, s12, 1
    s_cbranch_scc1 L_abort
    s_and_b32 s52, s12, 15
    s_cbranch_scc1 Lc12_Dr0
    s_waitcnt vmcnt(0)
    v_cmp_eq_u32 s[32:33], s53, v28
    v_cmp_eq_u32 vcc, s53, v30
    s_nop 0
    s_or_b64 s[32:33], s[32:33], vcc
    s_cbranch_scc1 Lc12_Df0
    s_branch Lc12_Dk0
Lc12_Dr1:
    s_waitcnt vmcnt(3)
    v_cmp_u_f32 vcc, v32, v34
    s_cbranch_vccz Lc12_Dk1
Lc12_Df1:
    buffer_load_dwordx4 v[32:35], v0, s[4:7], s67 offen offset:1024 sc1
    buffer_load_dwordx4 v[36:39], v0, s[4:7], s67 offen offset:2048 sc1
    buffer_load_dwordx4 v[40:43], v0, s[4:7], s67 offen offset:3072 sc1
    buffer_load_dwordx4 v[44:47], v0, s[4:7], s68 offen offset:0 sc1
    s_sub_u32 s12, s12, 1
    s_cbranch_scc1 L_abort
    s_and_b32 s52, s12, 15
    s_cbranch_scc1 Lc12_Dr1
    s_waitcnt vmcnt(0)
    v_cmp_eq_u32 s[32:33], s53, v32
    v_cmp_eq_u32 vcc, s53, v34
    s_nop 0
    s_or_b64 s[32:33], s[32:33], vcc
    s_cbranch_scc1 Lc12_Df1
    s_branch Lc12_Dk1
Lc12_Dr2:
    s_waitcnt vmcnt(2)
    v_cmp_u_f32 vcc, v36, v38
    s_cbranch_vccz Lc12_Dk2
Lc12_Df2:
    buffer_load_dwordx4 v[36:39], v0, s[4:7], s67 offen offset:2048 sc1
    buffer_load_dwordx4 v[40:43], v0, s[4:7], s67 offen offset:3072 sc1
    buffer_load_dwordx4 v[44:47], v0, s[4:7], s68 offen offset:0 sc1
    s_sub_u32 s12, s12, 1
    s_cbranch_scc1 L_abort
    s_and_b32 s52, s12, 15
    s_cbranch_scc1 Lc12_Dr2
    s_waitcnt vmcnt(0)
    v_cmp_eq_u32 s[32:33], s53, v36
    v_cmp_eq_u32 vcc, s53, v38
    s_nop 0
    s_or_b64 s[32:33], s[32:33], vcc
    s_cbranch_scc1 Lc12_Df2
    s_branch Lc12_Dk2
Lc12_Dr3:
    s_waitcnt vmcnt(1)
    v_cmp_u_f32 vcc, v40, v42
    s_cbranch_vccz Lc12_Dk3
Lc12_Df3:
    buffer_load_dwordx4 v[40:43], v0, s[4:7], s67 offen offset:3072 sc1
    buffer_load_dwordx4 v[44:47], v0, s[4:7], s68 offen offset:0 sc1
    s_sub_u32 s12, s12, 1
    s_cbranch_scc1 L_abort
    s_and_b32 s52, s12, 15
    s_cbranch_scc1 Lc12_Dr3
    s_waitcnt vmcnt(0)
    v_cmp_eq_u32 s[32:33], s53, v40
    v_cmp_eq_u32 vcc, s53, v42
    s_nop 0
    s_or_b64 s[32:33], s[32:33], vcc
    s_cbranch_scc1 Lc12_Df3
    s_branch Lc12_Dk3
Lc12_Dr4:
    s_waitcnt vmcnt(0)
    v_cmp_u_f32 vcc, v44, v46
    s_cbranch_vccz Lc12_Dk4
Lc12_Df4:
    buffer_load_dwordx4 v[44:47], v0, s[4:7], s68 offen offset:0 sc1
    s_sub_u32 s12, s12, 1
    s_cbranch_scc1 L_abort
    s_and_b32 s52, s12, 15
    s_cbranch_scc1 Lc12_Dr4
    s_waitcnt vmcnt(0)
    v_cmp_eq_u32 s[32:33], s53, v44
    v_cmp_eq_u32 vcc, s53, v46
    s_nop 0
    s_or_b64 s[32:33], s[32:33], vcc
    s_cbranch_scc1 Lc12_Df4
    s_branch Lc12_Dk4
Lc12_pe:
    buffer_store_dwordx4 v[160:163], v0, s[4:7], s71 offen sc1
    ds_read_b128 v[128:131], v0 offset:5632
    s_waitcnt lgkmcnt(0)
    v_and_or_b32 v128, v128, -2, s50
    buffer_store_dwordx4 v[128:131], v0, s[4:7], s71 offen offset:1024 sc1
    s_mov_b32 s71, 1073741824
    s_branch Lc12_pe_c
Lc12_sh:
    s_nop 15
    s_nop 15
    s_nop 15
    s_nop 15
    s_nop 15
    s_nop 15
    s_nop 15
    s_nop 15
    s_nop 15
    s_nop 15
    s_nop 15
    s_nop 15
    s_nop 11
    s_branch Lc12_Gdone
Lc12_Gr0:
    s_waitcnt vmcnt(4)
    v_cmp_u_f32 vcc, v80, v84
    s_cbranch_vccz Lc12_Gk0
Lc12_Gf0:
    buffer_load_dwordx4 v[80:83], v10, s[4:7], s94 offen sc1
    buffer_load_dwordx4 v[84:87], v10, s[4:7], s95 offen sc1
    buffer_load_dwordx4 v[88:91], v10, s[4:7], s96 offen sc1
    buffer_load_dwordx4 v[92:95], v10, s[4:7], s97 offen sc1
    buffer_load_dwordx4 v[96:99], v10, s[4:7], s98 offen sc1
    buffer_load_dwordx4 v[100:103], v10, s[4:7], s99 offen sc1
    s_sub_u32 s12, s12, 1
    s_cbranch_scc1 L_abort
    s_and_b32 s52, s12, 15
    s_cbranch_scc1 Lc12_Gr0
    s_waitcnt vmcnt(0)
    v_cmp_eq_u32 s[32:33], s53, v80
    v_cmp_eq_u32 vcc, s53, v84
    s_nop 0
    s_or_b64 s[32:33], s[32:33], vcc
    s_cbranch_scc1 Lc12_Gf0
    s_branch Lc12_Gk0
Lc12_Gr1:
    s_waitcnt vmcnt(2)
    v_cmp_u_f32 vcc, v88, v92
    s_cbranch_vccz Lc12_Gk1
Lc12_Gf1:
    buffer_load_dwordx4 v[88:91], v10, s[4:7], s96 offen sc1
    buffer_load_dwordx4 v[92:95], v10, s[4:7], s97 offen sc1
    buffer_load_dwordx4 v[96:99], v10, s[4:7], s98 offen sc1
    buffer_load_dwordx4 v[100:103], v10, s[4:7], s99 offen sc1
    s_sub_u32 s12, s12, 1
    s_cbranch_scc1 L_abort
    s_and_b32 s52, s12, 15
    s_cbranch_scc1 Lc12_Gr1
    s_waitcnt vmcnt(0)
    v_cmp_eq_u32 s[32:33], s53, v88
    v_cmp_eq_u32 vcc, s53, v92
    s_nop 0
    s_or_b64 s[32:33], s[32:33], vcc
    s_cbranch_scc1 Lc12_Gf1
    s_branch Lc12_Gk1
Lc12_Gr2:
    s_waitcnt vmcnt(1)
    v_cmp_u_f32 vcc, v96, v96
    s_cbranch_vccz Lc12_Gk2
Lc12_Gf2:
    buffer_load_dwordx4 v[96:99], v10, s[4:7], s98 offen sc1
    buffer_load_dwordx4 v[100:103], v10, s[4:7], s99 offen sc1
    s_sub_u32 s12, s12, 1
    s_cbranch_scc1 L_abort
    s_and_b32 s52, s12, 15
    s_cbranch_scc1 Lc12_Gr2
    s_waitcnt vmcnt(0)
    v_cmp_eq_u32 s[32:33], s53, v96
    v_cmp_eq_u32 vcc, s53, v96
    s_nop 0
    s_or_b64 s[32:33], s[32:33], vcc
    s_cbranch_scc1 Lc12_Gf2
    s_branch Lc12_Gk2
Lc12_Gr3:
    s_waitcnt vmcnt(0)
    v_cmp_u_f32 vcc, v100, v100
    s_cbranch_vccz Lc12_Gk3
Lc12_Gf3:
    buffer_load_dwordx4 v[100:103], v10, s[4:7], s99 offen sc1
    s_sub_u32 s12, s12, 1
    s_cbranch_scc1 L_abort
    s_and_b32 s52, s12, 15
    s_cbranch_scc1 Lc12_Gr3
    s_waitcnt vmcnt(0)
    v_cmp_eq_u32 s[32:33], s53, v100
    v_cmp_eq_u32 vcc, s53, v100
    s_nop 0
    s_or_b64 s[32:33], s[32:33], vcc
    s_cbranch_scc1 Lc12_Gf3
    s_branch Lc12_Gk3
Lc12_C_t:
    s_add_u32 s41, s70, 163840
    buffer_load_dwordx4 v[28:31], v8, s[4:7], s41 offen sc1
    s_waitcnt vmcnt(1)
    v_mfma_f32_16x16x32_bf16 v[104:107], v[12:15], v[32:35], v[116:119]
    v_cmp_u_f32 vcc, v32, v34
    s_nop 4
    s_cbranch_vccz Lc12_C_c
    s_add_u32 s41, s70, 245760
    buffer_load_dwordx4 v[32:35], v8, s[4:7], s41 offen sc1
    s_waitcnt vmcnt(1)
    v_mfma_f32_16x16x32_bf16 v[104:107], v[12:15], v[28:31], v[116:119]
    v_cmp_u_f32 vcc, v28, v30
    s_nop 4
    s_cbranch_vccz Lc12_C_c
    s_waitcnt vmcnt(0)
    v_mfma_f32_16x16x32_bf16 v[104:107], v[12:15], v[32:35], v[116:119]
    v_cmp_u_f32 vcc, v32, v34
    s_nop 4
    s_cbranch_vccz Lc12_C_c
Lc12_C_x:
    s_add_u32 s41, s70, 0
    buffer_load_dwordx4 v[28:31], v8, s[4:7], s41 offen sc1
    s_sub_u32 s12, s12, 1
    s_cbranch_scc1 L_abort
    s_and_b32 s52, s12, 15
    s_cbranch_scc1 Lc12_C_r
    s_waitcnt vmcnt(0)
    v_cmp_eq_u32 s[32:33], s53, v28
    v_cmp_eq_u32 vcc, s53, v30
    s_nop 0
    s_or_b64 s[32:33], s[32:33], vcc
    s_cbranch_scc1 Lc12_C_x
    v_mfma_f32_16x16x32_bf16 v[104:107], v[12:15], v[28:31], v[116:119]
    s_nop 5
    s_branch Lc12_C_c
Lc12_C_r:
    s_waitcnt vmcnt(0)
    v_mfma_f32_16x16x32_bf16 v[104:107], v[12:15], v[28:31], v[116:119]
    v_cmp_u_f32 vcc, v28, v30
    s_nop 4
    s_cbranch_vccz Lc12_C_c
    s_branch Lc12_C_x
    .p2align 6
Lc13_loop:
    s_barrier
    s_and_b32 s41, s40, 1
    s_lshl_b32 s69, s41, 11
    s_lshl_b32 s41, s41, 13
    s_add_u32 s41, s41, 8192
    v_add_u32 v10, s41, v0
    ds_read_b128 v[72:75], v10 offset:0
    s_nop 13
    buffer_load_dwordx4 v[28:31], v0, s[4:7], s67 offen offset:0 sc1
    ds_read_b128 v[76:79], v10 offset:1024
    ds_read_b128 v[80:83], v10 offset:2048
    ds_read_b128 v[84:87], v10 offset:3072
    ds_read_b128 v[88:91], v10 offset:4096
    s_nop 3
    buffer_load_dwordx4 v[32:35], v0, s[4:7], s67 offen offset:1024 sc1
    ds_read_b128 v[92:95], v10 offset:5120
    ds_read_b128 v[96:99], v10 offset:6144
    ds_read_b128 v[100:103], v10 offset:7168
    s_add_u32 s49, s69, s60
    s_nop 3
    buffer_load_dwordx4 v[36:39], v0, s[4:7], s67 offen offset:2048 sc1
    s_and_b32 s41, s40, 3
    s_mul_i32 s70, s41, 327680
    s_add_u32 s70, s70, s57
    s_mul_i32 s71, s41, 98304
    s_nop 3
    buffer_load_dwordx4 v[40:43], v0, s[4:7], s67 offen offset:3072 sc1
    s_add_u32 s71, s71, s64
    s_lshl_b32 s75, s41, 15
    s_bfe_u32 s50, s40, 0x10002
    s_nop 4
    buffer_load_dwordx4 v[44:47], v0, s[4:7], s68 offen offset:0 sc1
    s_waitcnt vmcnt(4)
    v_cmp_u_f32 vcc, v28, v30
    s_cbranch_vccnz Lc13_Df0
Lc13_Dk0:
    v_smfmac_f32_16x16x64_bf16 v[48:51], v[28:31], a[0:7], v2
    s_waitcnt vmcnt(3)
    v_cmp_u_f32 vcc, v32, v34
    v_smfmac_f32_16x16x64_bf16 v[52:55], v[28:31], a[80:87], v2
    v_smfmac_f32_16x16x64_bf16 v[56:59], v[28:31], a[40:47], v2
    v_smfmac_f32_16x16x64_bf16 v[60:63], v[28:31], a[120:127], v2
    s_cbranch_vccnz Lc13_Df1
Lc13_Dk1:
    v_smfmac_f32_16x16x64_bf16 v[48:51], v[32:35], a[8:15], v2
    s_waitcnt vmcnt(2)
    v_cmp_u_f32 vcc, v36, v38
    v_smfmac_f32_16x16x64_bf16 v[52:55], v[32:35], a[88:95], v2
    v_smfmac_f32_16x16x64_bf16 v[56:59], v[32:35], a[48:55], v2
    v_smfmac_f32_16x16x64_bf16 v[60:63], v[32:35], a[128:135], v2
    s_cbranch_vccnz Lc13_Df2
Lc13_Dk2:
    v_smfmac_f32_16x16x64_bf16 v[48:51], v[36:39], a[16:23], v2
    s_waitcnt vmcnt(1)
    v_cmp_u_f32 vcc, v40, v42
    v_smfmac_f32_16x16x64_bf16 v[52:55], v[36:39], a[96:103], v2
    v_smfmac_f32_16x16x64_bf16 v[56:59], v[36:39], a[56:63], v2
    v_smfmac_f32_16x16x64_bf16 v[60:63], v[36:39], a[136:143], v2
    s_cbranch_vccnz Lc13_Df3
Lc13_Dk3:
    v_smfmac_f32_16x16x64_bf16 v[48:51], v[40:43], a[24:31], v2
    s_waitcnt vmcnt(0)
    v_cmp_u_f32 vcc, v44, v46
    v_smfmac_f32_16x16x64_bf16 v[52:55], v[40:43], a[104:111], v2
    v_smfmac_f32_16x16x64_bf16 v[56:59], v[40:43], a[64:71], v2
    v_smfmac_f32_16x16x64_bf16 v[60:63], v[40:43], a[144:151], v2
    s_cbranch_vccnz Lc13_Df4
Lc13_Dk4:
    v_smfmac_f32_16x16x64_bf16 v[48:51], v[44:47], a[32:39], v2
    v_smfmac_f32_16x16x64_bf16 v[52:55], v[44:47], a[112:119], v2
    v_smfmac_f32_16x16x64_bf16 v[56:59], v[44:47], a[72:79], v2
    v_smfmac_f32_16x16x64_bf16 v[60:63], v[44:47], a[152:159], v2
Lc13_Ddone:
    v_permlane32_swap_b32 v48, v52
    v_permlane32_swap_b32 v49, v53
    v_permlane32_swap_b32 v50, v54
    v_permlane32_swap_b32 v51, v55
    v_pk_add_f32 v[48:49], v[48:49], v[52:53]
    v_pk_add_f32 v[50:51], v[50:51], v[54:55]
    v_cvt_pk_bf16_f32 v48, v48, v49
    v_cvt_pk_bf16_f32 v49, v50, v51
    ds_write_b64 v3, v[48:49] offset:0
    v_permlane32_swap_b32 v56, v60
    v_permlane32_swap_b32 v57, v61
    v_permlane32_swap_b32 v58, v62
    v_permlane32_swap_b32 v59, v63
    v_pk_add_f32 v[56:57], v[56:57], v[60:61]
    v_pk_add_f32 v[58:59], v[58:59], v[62:63]
    v_cvt_pk_bf16_f32 v56, v56, v57
    v_cvt_pk_bf16_f32 v57, v58, v59
    ds_write_b64 v3, v[56:57] offset:128
    v_smfmac_f32_16x16x64_bf16 v[64:67], v[28:31], a[160:167], v2
    v_smfmac_f32_16x16x64_bf16 v[68:71], v[28:31], a[200:207], v2
    v_smfmac_f32_16x16x64_bf16 v[64:67], v[32:35], a[168:175], v2
    s_waitcnt lgkmcnt(0)
    s_barrier
    v_smfmac_f32_16x16x64_bf16 v[68:71], v[32:35], a[208:215], v2
    v_smfmac_f32_16x16x64_bf16 v[64:67], v[36:39], a[176:183], v2
    v_smfmac_f32_16x16x64_bf16 v[68:71], v[36:39], a[216:223], v2
    ds_read_b64_tr_b16 v[48:49], v4 offset:0
    ds_read_b64_tr_b16 v[50:51], v4 offset:128
    ds_read_b64_tr_b16 v[52:53], v4 offset:2304
    v_smfmac_f32_16x16x64_bf16 v[64:67], v[40:43], a[184:191], v2
    ds_read_b64_tr_b16 v[54:55], v4 offset:2432
    ds_read_b64_tr_b16 v[56:57], v4 offset:256
    ds_read_b64_tr_b16 v[58:59], v4 offset:384
    v_smfmac_f32_16x16x64_bf16 v[68:71], v[40:43], a[224:231], v2
    ds_read_b64_tr_b16 v[60:61], v4 offset:2560
    ds_read_b64_tr_b16 v[62:63], v4 offset:2688
    v_smfmac_f32_16x16x64_bf16 v[64:67], v[44:47], a[192:199], v2
    v_smfmac_f32_16x16x64_bf16 v[68:71], v[44:47], a[232:239], v2
    s_add_u32 s43, s61, s69
    s_add_u32 s44, s62, s69
    v_add_u32 v143, s40, 1
    s_waitcnt lgkmcnt(4)
    v_mfma_f32_16x16x32_bf16 v[112:115], v[52:55], v[48:51], 0
    s_waitcnt lgkmcnt(0)
    v_mfma_f32_16x16x32_bf16 v[112:115], v[60:63], v[56:59], v[112:115]
    v_mfma_f32_16x16x32_bf16 v[104:107], v[72:75], v[48:51], 0
    v_mfma_f32_16x16x32_bf16 v[104:107], v[80:83], v[56:59], v[104:107]
    v_mfma_f32_16x16x32_bf16 v[108:111], v[76:79], v[48:51], 0
    v_add_f32_dpp v24, v112, v112 row_ror:8 row_mask:0xf bank_mask:0x3
    v_add_f32_dpp v25, v113, v113 row_ror:8 row_mask:0xf bank_mask:0x3
    v_mfma_f32_16x16x32_bf16 v[108:111], v[84:87], v[56:59], v[108:111]
    v_add_f32_dpp v24, v114, v114 row_ror:8 row_mask:0xf bank_mask:0xc
    v_add_f32_dpp v25, v115, v115 row_ror:8 row_mask:0xf bank_mask:0xc
    v_add_f32_dpp v20, v104, v104 row_ror:8 row_mask:0xf bank_mask:0x3
    v_add_f32_dpp v21, v105, v105 row_ror:8 row_mask:0xf bank_mask:0x3
    v_add_f32_dpp v22, v106, v106 row_ror:8 row_mask:0xf bank_mask:0x3
    v_add_f32_dpp v23, v107, v107 row_ror:8 row_mask:0xf bank_mask:0x3
    v_permlane32_swap_b32 v24, v25
    v_add_f32 v24, v24, v25
    v_add_f32_dpp v20, v108, v108 row_ror:8 row_mask:0xf bank_mask:0xc
    v_add_f32_dpp v21, v109, v109 row_ror:8 row_mask:0xf bank_mask:0xc
    v_add_f32_dpp v22, v110, v110 row_ror:8 row_mask:0xf bank_mask:0xc
    v_add_f32_dpp v23, v111, v111 row_ror:8 row_mask:0xf bank_mask:0xc
    v_permlane32_swap_b32 v64, v68
    v_permlane32_swap_b32 v65, v69
    v_permlane32_swap_b32 v66, v70
    v_permlane32_swap_b32 v67, v71
    v_pk_add_f32 v[64:65], v[64:65], v[68:69]
    v_pk_add_f32 v[66:67], v[66:67], v[70:71]
    v_cvt_pk_bf16_f32 v64, v64, v65
    v_cvt_pk_bf16_f32 v65, v66, v67
    ds_write_b64 v5, v[64:65]
    s_nop 3
    buffer_load_dwordx4 v[116:119], v0, s[4:7], s43 offen sc1
    buffer_load_dwordx4 v[122:125], v0, s[4:7], s44 offen sc1
    buffer_load_dword v120, v1, s[4:7], s43 offen offset:1024 sc1
    buffer_load_dword v126, v1, s[4:7], s44 offen offset:1024 sc1
    v_pk_mul_f32 v[20:21], v[20:21], s[34:35]
    v_pk_mul_f32 v[22:23], v[22:23], s[34:35]
    v_mul_f32 v24, s34, v24
    s_cmp_eq_u32 s40, 63
    s_waitcnt lgkmcnt(0)
    s_barrier
    ds_read_b128 v[128:131], v0 offset:4608
    ds_read_b128 v[132:135], v0 offset:5632
    ds_read_b128 v[160:163], v0 offset:5632
    s_cbranch_scc1 Lc13_fin
    s_add_u32 s41, s75, s56
    v_add_u32 v10, s41, v0
    v_mov_b64 v[64:65], 0
    v_mov_b64 v[66:67], 0
    v_mov_b64 v[68:69], 0
    v_mov_b64 v[70:71], 0
    s_nop 5
    buffer_load_dwordx4 v[144:147], v0, s[4:7], s43 offen sc1
    buffer_load_dwordx4 v[150:153], v0, s[4:7], s44 offen sc1
    buffer_load_dword v148, v1, s[4:7], s43 offen offset:1024 sc1
    buffer_load_dword v154, v1, s[4:7], s44 offen offset:1024 sc1
Lc13_A_chk:
    s_waitcnt vmcnt(7)
    v_pk_fma_f32 v[104:105], v[116:117], s[34:35], v[20:21]
    v_pk_fma_f32 v[106:107], v[118:119], s[34:35], v[22:23]
    s_waitcnt vmcnt(4)
    v_pk_fma_f32 v[104:105], v[122:123], s[34:35], v[104:105]
    v_pk_fma_f32 v[106:107], v[124:125], s[34:35], v[106:107]
    v_fma_f32 v108, v120, s34, v24
    v_maximum3_f32 v164, v104, v105, v106
    v_fmac_f32 v108, s34, v126
    v_maximum3_f32 v164, v164, v107, v108
    v_cmp_u_f32 vcc, v164, v164
    s_add_u32 s42, s75, s55
    v_max_f32_dpp v165, v164, v164 row_ror:8 row_mask:0xf bank_mask:0xf
    v_max_f32_dpp v164, v164, v164 row_ror:8 row_mask:0xf bank_mask:0xf
    s_nop 1
    v_permlane16_swap_b32 v164, v165
    v_max_f32 v166, v164, v165
    v_max_f32 v164, v164, v165
    s_cbranch_vccnz Lc13_A_s
Lc13_A_c:
    buffer_store_dword v143, off, s[4:7], s73 sc1
    v_permlane32_swap_b32 v164, v166
    v_max_f32 v164, v164, v166
    v_pk_add_f32 v[104:105], v[104:105], v[164:165] op_sel_hi:[1,0] neg_lo:[0,1] neg_hi:[0,1]
    v_pk_add_f32 v[106:107], v[106:107], v[164:165] op_sel_hi:[1,0] neg_lo:[0,1] neg_hi:[0,1]
    v_exp_f32 v104, v104
    v_exp_f32 v105, v105
    v_exp_f32 v106, v106
    v_cvt_pk_bf16_f32 v136, v104, v105
    v_exp_f32 v107, v107
    v_sub_f32 v108, v108, v164
    v_cvt_pk_bf16_f32 v137, v106, v107
    v_mov_b32_dpp v138, v136 row_shl:8 row_mask:0xf bank_mask:0xf bound_ctrl:0
    v_exp_f32 v140, v108
    v_mov_b32_dpp v139, v137 row_shl:8 row_mask:0xf bank_mask:0xf bound_ctrl:0
    v_cndmask_b32 v30, v136, 0, s[36:37]
    v_cndmask_b32 v31, v137, 0, s[36:37]
    v_cndmask_b32 v136, 0, v136, s[36:37]
    v_cndmask_b32 v137, 0, v137, s[36:37]
    v_mov_b32 v142, v140
    s_nop 0
    v_mfma_f32_16x16x32_bf16 v[112:115], a[240:243], v[136:139], 0
    v_mov_b32_dpp v28, v136 row_shr:8 row_mask:0xf bank_mask:0xf bound_ctrl:0
    v_mov_b32_dpp v29, v137 row_shr:8 row_mask:0xf bank_mask:0xf bound_ctrl:0
    v_mfma_f32_16x16x32_bf16 v[48:51], v[88:91], v[136:139], 0
    v_permlane32_swap_b32 v140, v142
    v_mfma_f32_16x16x32_bf16 v[52:55], v[92:95], v[136:139], 0
    v_cvt_pk_bf16_f32 v140, v140, v142
    s_waitcnt lgkmcnt(0)
    v_mfma_f32_16x16x32_bf16 v[48:51], v[96:99], v[28:31], v[48:51]
    v_cndmask_b32 v34, 0, v140, s[36:37]
    v_mov_b32_dpp v35, v140 row_shl:8 row_mask:0xf bank_mask:0xf bound_ctrl:0
    v_mfma_f32_16x16x32_bf16 v[52:55], v[100:103], v[28:31], v[52:55]
    v_mov_b32_dpp v32, v140 row_shr:8 row_mask:0xf bank_mask:0xf bound_ctrl:0
    v_cndmask_b32 v33, v140, 0, s[36:37]
    v_mfma_f32_16x16x16_bf16 v[112:115], a[244:245], v[34:35], v[112:115]
    v_mfma_f32_16x16x16_bf16 v[48:51], v[128:129], v[34:35], v[48:51]
    v_mfma_f32_16x16x16_bf16 v[48:51], v[132:133], v[32:33], v[48:51]
    v_add_f32_dpp v166, v112, v112 row_ror:8 row_mask:0xf bank_mask:0xf
    v_mfma_f32_16x16x16_bf16 v[52:55], v[130:131], v[34:35], v[52:55]
    v_rcp_f32 v166, v166
    v_mfma_f32_16x16x16_bf16 v[52:55], v[134:135], v[32:33], v[52:55]
    v_mul_f32 v48, v48, v166
    v_mul_f32 v49, v49, v166
    v_mul_f32 v50, v50, v166
    v_mul_f32 v51, v51, v166
    v_cvt_pk_bf16_f32 v72, v48, v49
    v_cvt_pk_bf16_f32 v73, v50, v51
    s_nop 1
    v_pk_mul_f32 v[52:53], v[52:53], v[166:167] op_sel_hi:[1,0]
    v_pk_mul_f32 v[54:55], v[54:55], v[166:167] op_sel_hi:[1,0]
    v_cvt_pk_bf16_f32 v74, v52, v53
    v_cvt_pk_bf16_f32 v75, v54, v55
    buffer_store_dwordx4 v[72:75], v0, s[4:7], s42 offen sc1
    s_cmp_ge_u32 s39, 20
    s_barrier
    s_cbranch_scc1 Lc13_sh
    s_nop 10
    buffer_load_dwordx4 v[80:83], v10, s[4:7], s94 offen sc1
    s_add_u32 s41, s40, 1
    s_and_b32 s41, s41, 3
    s_nop 3
    buffer_load_dwordx4 v[84:87], v10, s[4:7], s95 offen sc1
    s_lshl_b32 s41, s41, 14
    s_add_u32 s67, s41, s58
    s_nop 3
    buffer_load_dwordx4 v[88:91], v10, s[4:7], s96 offen sc1
    s_add_u32 s68, s67, 4096
    s_add_u32 s76, s41, s59
    s_nop 3
    buffer_load_dwordx4 v[92:95], v10, s[4:7], s97 offen sc1
    v_and_or_b32 v160, v160, -2, s50
    s_nop 4
    buffer_load_dwordx4 v[96:99], v10, s[4:7], s98 offen sc1
    s_nop 5
    buffer_load_dwordx4 v[100:103], v10, s[4:7], s99 offen sc1
    s_waitcnt vmcnt(4)
    v_cmp_u_f32 vcc, v80, v84
    s_cbranch_vccnz Lc13_Gf0
Lc13_Gk0:
    v_smfmac_f32_16x16x64_bf16 v[64:67], v[80:83], v[168:175], v2
    s_waitcnt vmcnt(2)
    v_cmp_u_f32 vcc, v88, v92
    v_smfmac_f32_16x16x64_bf16 v[68:71], v[80:83], v[176:183], v2
    v_smfmac_f32_16x16x64_bf16 v[64:67], v[84:87], v[184:191], v2
    v_smfmac_f32_16x16x64_bf16 v[68:71], v[84:87], v[192:199], v2
    s_cbranch_vccnz Lc13_Gf1
Lc13_Gk1:
    v_smfmac_f32_16x16x64_bf16 v[64:67], v[88:91], v[200:207], v2
    s_waitcnt vmcnt(1)
    v_cmp_u_f32 vcc, v96, v96
    v_smfmac_f32_16x16x64_bf16 v[68:71], v[88:91], v[208:215], v2
    v_smfmac_f32_16x16x64_bf16 v[64:67], v[92:95], v[216:223], v2
    v_smfmac_f32_16x16x64_bf16 v[68:71], v[92:95], v[224:231], v2
    s_cbranch_vccnz Lc13_Gf2
Lc13_Gk2:
    s_waitcnt vmcnt(0)
    v_cmp_u_f32 vcc, v100, v100
    v_smfmac_f32_16x16x64_bf16 v[64:67], v[96:99], v[232:239], v2
    v_smfmac_f32_16x16x64_bf16 v[68:71], v[96:99], v[240:247], v2
    s_cbranch_vccnz Lc13_Gf3
Lc13_Gk3:
    v_smfmac_f32_16x16x64_bf16 v[64:67], v[100:103], v[248:255], v2
    v_smfmac_f32_16x16x64_bf16 v[68:71], v[100:103], a[248:255], v2
Lc13_Gdone:
    buffer_store_dwordx4 v[160:163], v0, s[4:7], s71 offen sc1
    s_nop 2
    v_cvt_pk_bf16_f32 v64, v64, v65
    v_cvt_pk_bf16_f32 v65, v66, v67
    ds_write_b64 v11, v[64:65] offset:0
    s_nop 0
    v_cvt_pk_bf16_f32 v68, v68, v69
    v_cvt_pk_bf16_f32 v69, v70, v71
    ds_write_b64 v11, v[68:69] offset:256
    s_waitcnt lgkmcnt(0)
    s_barrier
    ds_read_b128 v[80:83], v26 offset:0
    ds_read_b128 v[84:87], v26 offset:512
    buffer_store_dwordx4 v[16:19], v0, s[4:7], s49 offen sc1
    s_waitcnt lgkmcnt(1)
    v_mfma_f32_16x16x32_bf16 v[116:119], v[80:83], v[12:15], 0
    s_waitcnt lgkmcnt(0)
    v_mfma_f32_16x16x32_bf16 v[116:119], v[84:87], v[12:15], v[116:119]
    s_nop 7
    v_cvt_pk_bf16_f32 v164, v116, v117
    v_cvt_pk_bf16_f32 v165, v118, v119
    buffer_store_dwordx2 v[164:165], v7, s[4:7], s70 offen sc1
    buffer_store_dword v16, v1, s[4:7], s49 offen offset:1024 sc1
    s_nop 15
    s_nop 15
    s_nop 15
    s_nop 15
    s_nop 4
    v_mov_b64 v[48:49], 0
    v_mov_b64 v[50:51], 0
    v_mov_b64 v[52:53], 0
    v_mov_b64 v[54:55], 0
    v_mov_b64 v[56:57], 0
    v_mov_b64 v[58:59], 0
    v_mov_b64 v[60:61], 0
    v_mov_b64 v[62:63], 0
    v_mov_b64 v[64:65], 0
    v_mov_b64 v[66:67], 0
    v_mov_b64 v[68:69], 0
    v_mov_b64 v[70:71], 0
    s_add_u32 s41, s70, 0
    buffer_load_dwordx4 v[28:31], v8, s[4:7], s41 offen sc1
    s_nop 15
    s_nop 9
    s_add_u32 s41, s70, 81920
    buffer_load_dwordx4 v[32:35], v8, s[4:7], s41 offen sc1
    s_waitcnt vmcnt(1)
    v_mfma_f32_16x16x32_bf16 v[104:107], v[12:15], v[28:31], v[116:119]
    v_cmp_u_f32 vcc, v28, v30
    s_nop 4
    s_cbranch_vccnz Lc13_C_t
Lc13_C_c:
    s_nop 0
    v_cvt_pk_bf16_f32 v164, v104, v105
    v_cvt_pk_bf16_f32 v165, v106, v107
    buffer_store_dwordx2 v[164:165], v9, s[4:7], s76 offen sc1
    s_waitcnt vmcnt(2)
Lc13_join:
    s_add_u32 s40, s40, 1
    s_branch Lc13_loop
Lc13_fin:
    s_waitcnt lgkmcnt(0)
    v_and_or_b32 v160, v160, -2, s50
    buffer_store_dwordx4 v[160:163], v0, s[4:7], s71 offen sc1
    s_endpgm
Lc13_Dr0:
    s_waitcnt vmcnt(4)
    v_cmp_u_f32 vcc, v28, v30
    s_cbranch_vccz Lc13_Dk0
Lc13_Df0:
    buffer_load_dwordx4 v[28:31], v0, s[4:7], s67 offen offset:0 sc1
    buffer_load_dwordx4 v[32:35], v0, s[4:7], s67 offen offset:1024 sc1
    buffer_load_dwordx4 v[36:39], v0, s[4:7], s67 offen offset:2048 sc1
    buffer_load_dwordx4 v[40:43], v0, s[4:7], s67 offen offset:3072 sc1
    buffer_load_dwordx4 v[44:47], v0, s[4:7], s68 offen offset:0 sc1
    s_sub_u32 s12, s12, 1
    s_cbranch_scc1 L_abort
    s_and_b32 s52, s12, 15
    s_cbranch_scc1 Lc13_Dr0
    s_waitcnt vmcnt(0)
    v_cmp_eq_u32 s[32:33], s53, v28
    v_cmp_eq_u32 vcc, s53, v30
    s_nop 0
    s_or_b64 s[32:33], s[32:33], vcc
    s_cbranch_scc1 Lc13_Df0
    s_branch Lc13_Dk0
Lc13_Dr1:
    s_waitcnt vmcnt(3)
    v_cmp_u_f32 vcc, v32, v34
    s_cbranch_vccz Lc13_Dk1
Lc13_Df1:
    buffer_load_dwordx4 v[32:35], v0, s[4:7], s67 offen offset:1024 sc1
    buffer_load_dwordx4 v[36:39], v0, s[4:7], s67 offen offset:2048 sc1
    buffer_load_dwordx4 v[40:43], v0, s[4:7], s67 offen offset:3072 sc1
    buffer_load_dwordx4 v[44:47], v0, s[4:7], s68 offen offset:0 sc1
    s_sub_u32 s12, s12, 1
    s_cbranch_scc1 L_abort
    s_and_b32 s52, s12, 15
    s_cbranch_scc1 Lc13_Dr1
    s_waitcnt vmcnt(0)
    v_cmp_eq_u32 s[32:33], s53, v32
    v_cmp_eq_u32 vcc, s53, v34
    s_nop 0
    s_or_b64 s[32:33], s[32:33], vcc
    s_cbranch_scc1 Lc13_Df1
    s_branch Lc13_Dk1
Lc13_Dr2:
    s_waitcnt vmcnt(2)
    v_cmp_u_f32 vcc, v36, v38
    s_cbranch_vccz Lc13_Dk2
Lc13_Df2:
    buffer_load_dwordx4 v[36:39], v0, s[4:7], s67 offen offset:2048 sc1
    buffer_load_dwordx4 v[40:43], v0, s[4:7], s67 offen offset:3072 sc1
    buffer_load_dwordx4 v[44:47], v0, s[4:7], s68 offen offset:0 sc1
    s_sub_u32 s12, s12, 1
    s_cbranch_scc1 L_abort
    s_and_b32 s52, s12, 15
    s_cbranch_scc1 Lc13_Dr2
    s_waitcnt vmcnt(0)
    v_cmp_eq_u32 s[32:33], s53, v36
    v_cmp_eq_u32 vcc, s53, v38
    s_nop 0
    s_or_b64 s[32:33], s[32:33], vcc
    s_cbranch_scc1 Lc13_Df2
    s_branch Lc13_Dk2
Lc13_Dr3:
    s_waitcnt vmcnt(1)
    v_cmp_u_f32 vcc, v40, v42
    s_cbranch_vccz Lc13_Dk3
Lc13_Df3:
    buffer_load_dwordx4 v[40:43], v0, s[4:7], s67 offen offset:3072 sc1
    buffer_load_dwordx4 v[44:47], v0, s[4:7], s68 offen offset:0 sc1
    s_sub_u32 s12, s12, 1
    s_cbranch_scc1 L_abort
    s_and_b32 s52, s12, 15
    s_cbranch_scc1 Lc13_Dr3
    s_waitcnt vmcnt(0)
    v_cmp_eq_u32 s[32:33], s53, v40
    v_cmp_eq_u32 vcc, s53, v42
    s_nop 0
    s_or_b64 s[32:33], s[32:33], vcc
    s_cbranch_scc1 Lc13_Df3
    s_branch Lc13_Dk3
Lc13_Dr4:
    s_waitcnt vmcnt(0)
    v_cmp_u_f32 vcc, v44, v46
    s_cbranch_vccz Lc13_Dk4
Lc13_Df4:
    buffer_load_dwordx4 v[44:47], v0, s[4:7], s68 offen offset:0 sc1
    s_sub_u32 s12, s12, 1
    s_cbranch_scc1 L_abort
    s_and_b32 s52, s12, 15
    s_cbranch_scc1 Lc13_Dr4
    s_waitcnt vmcnt(0)
    v_cmp_eq_u32 s[32:33], s53, v44
    v_cmp_eq_u32 vcc, s53, v46
    s_nop 0
    s_or_b64 s[32:33], s[32:33], vcc
    s_cbranch_scc1 Lc13_Df4
    s_branch Lc13_Dk4
Lc13_A_s:
    buffer_load_dwordx4 v[116:119], v0, s[4:7], s43 offen sc1
    buffer_load_dwordx4 v[122:125], v0, s[4:7], s44 offen sc1
    buffer_load_dword v120, v1, s[4:7], s43 offen offset:1024 sc1
    buffer_load_dword v126, v1, s[4:7], s44 offen offset:1024 sc1
    s_waitcnt vmcnt(7)
    v_pk_fma_f32 v[104:105], v[144:145], s[34:35], v[20:21]
    v_pk_fma_f32 v[106:107], v[146:147], s[34:35], v[22:23]
    s_waitcnt vmcnt(4)
    v_pk_fma_f32 v[104:105], v[150:151], s[34:35], v[104:105]
    v_pk_fma_f32 v[106:107], v[152:153], s[34:35], v[106:107]
    v_fma_f32 v108, v148, s34, v24
    v_maximum3_f32 v164, v104, v105, v106
    v_fmac_f32 v108, s34, v154
    v_maximum3_f32 v164, v164, v107, v108
    v_cmp_u_f32 vcc, v164, v164
    s_nop 0
    v_max_f32_dpp v165, v164, v164 row_ror:8 row_mask:0xf bank_mask:0xf
    v_max_f32_dpp v164, v164, v164 row_ror:8 row_mask:0xf bank_mask:0xf
    s_nop 1
    v_permlane16_swap_b32 v164, v165
    v_max_f32 v166, v164, v165
    v_max_f32 v164, v164, v165
    s_cbranch_vccz Lc13_A_c
    buffer_load_dwordx4 v[144:147], v0, s[4:7], s43 offen sc1
    buffer_load_dwordx4 v[150:153], v0, s[4:7], s44 offen sc1
    buffer_load_dword v148, v1, s[4:7], s43 offen offset:1024 sc1
    buffer_load_dword v154, v1, s[4:7], s44 offen offset:1024 sc1
    s_sub_u32 s12, s12, 1
    s_cbranch_scc1 L_abort
    s_and_b32 s52, s12, 15
    s_cbranch_scc1 Lc13_A_chk
    s_waitcnt vmcnt(0)
    v_cmp_eq_u32 s[32:33], s53, v116
    v_cmp_eq_u32 vcc, s53, v120
    s_nop 0
    s_or_b64 s[32:33], s[32:33], vcc
    v_cmp_eq_u32 vcc, s53, v122
    s_nop 0
    s_or_b64 s[32:33], s[32:33], vcc
    v_cmp_eq_u32 vcc, s53, v126
    s_nop 0
    s_or_b64 s[32:33], s[32:33], vcc
    s_cbranch_scc1 Lc13_A_s
    s_waitcnt vmcnt(3)
    v_pk_fma_f32 v[104:105], v[116:117], s[34:35], v[20:21]
    v_pk_fma_f32 v[106:107], v[118:119], s[34:35], v[22:23]
    s_waitcnt vmcnt(0)
    v_pk_fma_f32 v[104:105], v[122:123], s[34:35], v[104:105]
    v_pk_fma_f32 v[106:107], v[124:125], s[34:35], v[106:107]
    v_fma_f32 v108, v120, s34, v24
    v_maximum3_f32 v164, v104, v105, v106
    v_fmac_f32 v108, s34, v126
    v_maximum3_f32 v164, v164, v107, v108
    v_cmp_u_f32 vcc, v164, v164
    s_add_u32 s42, s75, s55
    v_max_f32_dpp v165, v164, v164 row_ror:8 row_mask:0xf bank_mask:0xf
    v_max_f32_dpp v164, v164, v164 row_ror:8 row_mask:0xf bank_mask:0xf
    s_nop 1
    v_permlane16_swap_b32 v164, v165
    v_max_f32 v166, v164, v165
    v_max_f32 v164, v164, v165
    s_branch Lc13_A_c
Lc13_sh:
    s_add_u32 s41, s40, 1
    s_and_b32 s41, s41, 3
    s_lshl_b32 s41, s41, 14
    s_add_u32 s67, s41, s58
    s_add_u32 s68, s67, 4096
    s_add_u32 s76, s41, s59
    v_and_or_b32 v160, v160, -2, s50
    s_nop 15
    s_nop 15
    s_nop 15
    s_nop 15
    s_nop 15
    s_nop 15
    s_nop 15
    s_nop 15
    s_nop 15
    s_nop 15
    s_nop 15
    s_nop 15
    s_nop 11
    s_branch Lc13_Gdone
Lc13_Gr0:
    s_waitcnt vmcnt(4)
    v_cmp_u_f32 vcc, v80, v84
    s_cbranch_vccz Lc13_Gk0
Lc13_Gf0:
    buffer_load_dwordx4 v[80:83], v10, s[4:7], s94 offen sc1
    buffer_load_dwordx4 v[84:87], v10, s[4:7], s95 offen sc1
    buffer_load_dwordx4 v[88:91], v10, s[4:7], s96 offen sc1
    buffer_load_dwordx4 v[92:95], v10, s[4:7], s97 offen sc1
    buffer_load_dwordx4 v[96:99], v10, s[4:7], s98 offen sc1
    buffer_load_dwordx4 v[100:103], v10, s[4:7], s99 offen sc1
    s_sub_u32 s12, s12, 1
    s_cbranch_scc1 L_abort
    s_and_b32 s52, s12, 15
    s_cbranch_scc1 Lc13_Gr0
    s_waitcnt vmcnt(0)
    v_cmp_eq_u32 s[32:33], s53, v80
    v_cmp_eq_u32 vcc, s53, v84
    s_nop 0
    s_or_b64 s[32:33], s[32:33], vcc
    s_cbranch_scc1 Lc13_Gf0
    s_branch Lc13_Gk0
Lc13_Gr1:
    s_waitcnt vmcnt(2)
    v_cmp_u_f32 vcc, v88, v92
    s_cbranch_vccz Lc13_Gk1
Lc13_Gf1:
    buffer_load_dwordx4 v[88:91], v10, s[4:7], s96 offen sc1
    buffer_load_dwordx4 v[92:95], v10, s[4:7], s97 offen sc1
    buffer_load_dwordx4 v[96:99], v10, s[4:7], s98 offen sc1
    buffer_load_dwordx4 v[100:103], v10, s[4:7], s99 offen sc1
    s_sub_u32 s12, s12, 1
    s_cbranch_scc1 L_abort
    s_and_b32 s52, s12, 15
    s_cbranch_scc1 Lc13_Gr1
    s_waitcnt vmcnt(0)
    v_cmp_eq_u32 s[32:33], s53, v88
    v_cmp_eq_u32 vcc, s53, v92
    s_nop 0
    s_or_b64 s[32:33], s[32:33], vcc
    s_cbranch_scc1 Lc13_Gf1
    s_branch Lc13_Gk1
Lc13_Gr2:
    s_waitcnt vmcnt(1)
    v_cmp_u_f32 vcc, v96, v96
    s_cbranch_vccz Lc13_Gk2
Lc13_Gf2:
    buffer_load_dwordx4 v[96:99], v10, s[4:7], s98 offen sc1
    buffer_load_dwordx4 v[100:103], v10, s[4:7], s99 offen sc1
    s_sub_u32 s12, s12, 1
    s_cbranch_scc1 L_abort
    s_and_b32 s52, s12, 15
    s_cbranch_scc1 Lc13_Gr2
    s_waitcnt vmcnt(0)
    v_cmp_eq_u32 s[32:33], s53, v96
    v_cmp_eq_u32 vcc, s53, v96
    s_nop 0
    s_or_b64 s[32:33], s[32:33], vcc
    s_cbranch_scc1 Lc13_Gf2
    s_branch Lc13_Gk2
Lc13_Gr3:
    s_waitcnt vmcnt(0)
    v_cmp_u_f32 vcc, v100, v100
    s_cbranch_vccz Lc13_Gk3
Lc13_Gf3:
    buffer_load_dwordx4 v[100:103], v10, s[4:7], s99 offen sc1
    s_sub_u32 s12, s12, 1
    s_cbranch_scc1 L_abort
    s_and_b32 s52, s12, 15
    s_cbranch_scc1 Lc13_Gr3
    s_waitcnt vmcnt(0)
    v_cmp_eq_u32 s[32:33], s53, v100
    v_cmp_eq_u32 vcc, s53, v100
    s_nop 0
    s_or_b64 s[32:33], s[32:33], vcc
    s_cbranch_scc1 Lc13_Gf3
    s_branch Lc13_Gk3
Lc13_C_t:
    s_add_u32 s41, s70, 163840
    buffer_load_dwordx4 v[28:31], v8, s[4:7], s41 offen sc1
    s_waitcnt vmcnt(1)
    v_mfma_f32_16x16x32_bf16 v[104:107], v[12:15], v[32:35], v[116:119]
    v_cmp_u_f32 vcc, v32, v34
    s_nop 4
    s_cbranch_vccz Lc13_C_c
    s_add_u32 s41, s70, 245760
    buffer_load_dwordx4 v[32:35], v8, s[4:7], s41 offen sc1
    s_waitcnt vmcnt(1)
    v_mfma_f32_16x16x32_bf16 v[104:107], v[12:15], v[28:31], v[116:119]
    v_cmp_u_f32 vcc, v28, v30
    s_nop 4
    s_cbranch_vccz Lc13_C_c
    s_waitcnt vmcnt(0)
    v_mfma_f32_16x16x32_bf16 v[104:107], v[12:15], v[32:35], v[116:119]
    v_cmp_u_f32 vcc, v32, v34
    s_nop 4
    s_cbranch_vccz Lc13_C_c
Lc13_C_x:
    s_add_u32 s41, s70, 0
    buffer_load_dwordx4 v[28:31], v8, s[4:7], s41 offen sc1
    s_sub_u32 s12, s12, 1
    s_cbranch_scc1 L_abort
    s_and_b32 s52, s12, 15
    s_cbranch_scc1 Lc13_C_r
    s_waitcnt vmcnt(0)
    v_cmp_eq_u32 s[32:33], s53, v28
    v_cmp_eq_u32 vcc, s53, v30
    s_nop 0
    s_or_b64 s[32:33], s[32:33], vcc
    s_cbranch_scc1 Lc13_C_x
    v_mfma_f32_16x16x32_bf16 v[104:107], v[12:15], v[28:31], v[116:119]
    s_nop 5
    s_branch Lc13_C_c
Lc13_C_r:
    s_waitcnt vmcnt(0)
    v_mfma_f32_16x16x32_bf16 v[104:107], v[12:15], v[28:31], v[116:119]
    v_cmp_u_f32 vcc, v28, v30
    s_nop 4
    s_cbranch_vccz Lc13_C_c
    s_branch Lc13_C_x
.section .rodata,"a"
.p2align 6
.amdhsa_kernel concat_heads__memory_aug_recurrent_mem_tr__sliding_local_dilated__prompt_kernel
  .amdhsa_next_free_vgpr 512
  .amdhsa_next_free_sgpr 102
  .amdhsa_accum_offset 256
  .amdhsa_group_segment_fixed_size 0
  .amdhsa_kernarg_size 104
  .amdhsa_user_sgpr_count 2
  .amdhsa_user_sgpr_kernarg_segment_ptr 1
  .amdhsa_system_sgpr_workgroup_id_x 1
.end_amdhsa_kernel
```
